```python
import torch

def _softmax(x, axis=-1):
    return torch.softmax(x, dim=axis)

def _gelu(x):
    return torch.nn.functional.gelu(x, approximate='tanh')

def _silu(x):
    return torch.nn.functional.silu(x)

def _sigmoid(x):
    return torch.sigmoid(x)

def _layernorm(x, axis=-1, eps=1e-05):
    m = x.mean(dim=axis, keepdim=True)
    v = x.var(dim=axis, keepdim=True, unbiased=False)
    return (x - m) / torch.sqrt(v + eps)

def _scatter_add(tgt, idx, src, axis=0):
    return tgt.clone().index_add_(axis, idx, src)

def _segment_sum(src, seg, n):
    out = torch.zeros((n,) + src.shape[1:], dtype=src.dtype)
    return out.index_add_(0, seg, src)

def _pad(x, pw):
    flat = tuple((v for pair in reversed(pw) for v in pair))
    return torch.nn.functional.pad(x, flat)
kernel_name = 'adaLN_cond__sliding_local_dilated__glu_gated_glu__prompt'

def setup_inputs():

    _w = lambda a: (lambda t: t.to(torch.bfloat16) if t.is_floating_point() else t)(torch.as_tensor(a))

    def _A_setup():
        B, S, D = (1, 2048, 576)
        return {'x': _w((lambda *s: torch.randn(*s, dtype=torch.bfloat16) * 0.05)(B, S, D)), 'wqkv': _w((lambda *s: torch.randn(*s, dtype=torch.bfloat16) * 0.05)(D, 3 * D)), 'wo': _w((lambda *s: torch.randn(*s, dtype=torch.bfloat16) * 0.05)(D, D))}
    _A_in = _A_setup()

    def _B_setup():
        B, S, D, F = (1, 2048, 576, 4608)
        return {'x': _w((lambda *s: torch.randn(*s, dtype=torch.bfloat16) * 0.05)(B, S, D)), 'w_gate': _w((lambda *s: torch.randn(*s, dtype=torch.bfloat16) * 0.05)(D, F)), 'w_up': _w((lambda *s: torch.randn(*s, dtype=torch.bfloat16) * 0.05)(D, F)), 'w_down': _w((lambda *s: torch.randn(*s, dtype=torch.bfloat16) * 0.05)(F, D))}
    _B_in = _B_setup()
    return {'A_x': _A_in['x'], 'A_wqkv': _A_in['wqkv'], 'A_wo': _A_in['wo'], 'B_x': _B_in['x'], 'B_w_gate': _B_in['w_gate'], 'B_w_up': _B_in['w_up'], 'B_w_down': _B_in['w_down'], 'c': _w((lambda *s: torch.randn(*s, dtype=torch.bfloat16) * 0.1)(1, 576) * 8.0), 'w_mod': _w((lambda *s: torch.randn(*s, dtype=torch.bfloat16) * 0.1)(576, 6 * 576) * 576 ** (-0.5) * 8.0)}

def reference(A_x, A_wqkv, A_wo, B_x, B_w_gate, B_w_up, B_w_down, c, w_mod):

    def _A_ref(x, wqkv, wo):
        B, S, D = x.shape
        H = 32
        Dh = D // H
        W, dil = (8, 2)
        qkv = (lambda x, *d: x.permute(*d))((x @ wqkv).reshape(B, S, 3, H, Dh), 2, 0, 3, 1, 4)
        q, k, v = (qkv[0], qkv[1], qkv[2])
        scale = Dh ** (-0.5)
        pos = torch.arange(S)
        off = torch.arange(W) * dil
        idx = pos[:, None] - off[None, :]
        mask = idx >= 0
        idx_c = torch.where(mask, idx, 0).reshape(-1)
        kg = k[:, :, idx_c, :].reshape(B, H, S, W, Dh)
        vg = v[:, :, idx_c, :].reshape(B, H, S, W, Dh)
        logits = torch.einsum('bhsd,bhswd->bhsw', q, kg) * scale
        logits = torch.where(mask[None, None, :, :], logits, -1000000000.0)
        attn = _softmax(logits, axis=-1)
        o = torch.einsum('bhsw,bhswd->bhsd', attn, vg)
        return (lambda x, *d: x.permute(*d))(o, 0, 2, 1, 3).reshape(B, S, D) @ wo

    def _B_ref(x, w_gate, w_up, w_down):
        g = torch.einsum('bsd,df->bsf', x, w_gate)
        u = torch.einsum('bsd,df->bsf', x, w_up)
        h = _sigmoid(g) * u
        return torch.einsum('bsf,fd->bsd', h, w_down)
    x = A_x
    mod = (_silu(c) @ w_mod).reshape(c.shape[0], 6, 1, -1)
    sa, ca, ga, sb, cb, gb = (mod[:, 0].clone(), mod[:, 1].clone(), mod[:, 2].clone(), mod[:, 3].clone(), mod[:, 4].clone(), mod[:, 5].clone())
    h = _layernorm(x, axis=-1) * (1 + ca) + sa
    x = x + ga * _A_ref(h, A_wqkv, A_wo)
    h = _layernorm(x, axis=-1) * (1 + cb) + sb
    x = x + gb * _B_ref(h, B_w_gate, B_w_up, B_w_down)
    return x
```

```asm
; @launch grid=(256,1,1) block=(256,1,1) lds=163840
.amdgcn_target "amdgcn-amd-amdhsa--gfx950"
.text
.globl adaLN_cond__sliding_local_dilated__glu_gated_glu__prompt_kernel
.p2align 8
.type adaLN_cond__sliding_local_dilated__glu_gated_glu__prompt_kernel,@function
adaLN_cond__sliding_local_dilated__glu_gated_glu__prompt_kernel:
    s_cmp_ge_u32 s2, 256
    s_cbranch_scc1 L_end
    s_load_dwordx16 s[4:19], s[0:1], 0
    s_load_dwordx8 s[20:27], s[0:1], 64
    v_lshrrev_b32 v4, 6, v0
    v_and_b32 v1, 63, v0
    v_readfirstlane_b32 s68, v4
    v_and_b32 v2, 15, v1
    v_lshrrev_b32 v3, 4, v1
    s_branch L_main
    .p2align 12
L_main:
    s_cmp_eq_u32 s68, 3
    s_cbranch_scc0 L_nopf
    s_getpc_b64 s[96:97]
L_pc:
    s_sub_u32 s96, s96, L_pc-L_main
    s_subb_u32 s97, s97, 0
    s_lshr_b32 s100, s2, 3
    s_lshl_b32 s100, s100, 12
    v_lshlrev_b32 v4, 7, v1
    v_add_u32 v4, s100, v4
    s_mov_b32 s100, L_end-L_main
    v_min_u32 v4, s100, v4
    s_mov_b32 exec_hi, 0
    global_load_dword v253, v4, s[96:97]
    s_mov_b32 exec_hi, -1
L_nopf:
    s_waitcnt lgkmcnt(0)
    s_mov_b32 s28, s4
    s_mov_b32 s29, s5
    s_mov_b32 s30, 2359296
    s_mov_b32 s31, 0x20000
    s_mov_b32 s32, s6
    s_mov_b32 s33, s7
    s_mov_b32 s34, 1990656
    s_mov_b32 s35, 0x20000
    s_mov_b32 s36, s8
    s_mov_b32 s37, s9
    s_mov_b32 s38, 663552
    s_mov_b32 s39, 0x20000
    s_mov_b32 s40, s12
    s_mov_b32 s41, s13
    s_mov_b32 s42, 5308416
    s_mov_b32 s43, 0x20000
    s_mov_b32 s44, s14
    s_mov_b32 s45, s15
    s_mov_b32 s46, 5308416
    s_mov_b32 s47, 0x20000
    s_mov_b32 s48, s16
    s_mov_b32 s49, s17
    s_mov_b32 s50, 5308416
    s_mov_b32 s51, 0x20000
    s_mov_b32 s52, s18
    s_mov_b32 s53, s19
    s_mov_b32 s54, 1152
    s_mov_b32 s55, 0x20000
    s_mov_b32 s56, s20
    s_mov_b32 s57, s21
    s_mov_b32 s58, 3981312
    s_mov_b32 s59, 0x20000
    s_mov_b32 s60, s22
    s_mov_b32 s61, s23
    s_mov_b32 s62, 2359296
    s_mov_b32 s63, 0x20000
    s_mov_b32 s64, s26
    s_mov_b32 s65, s27
    s_mov_b32 s66, 268435456
    s_mov_b32 s67, 0x20000
    s_mov_b32 s8, 46170112
    buffer_load_dword v252, off, s[64:67], s8 sc1
    s_and_b32 s4, s2, 7
    s_lshr_b32 s5, s2, 3
    s_lshr_b32 s69, s4, 1
    s_lshl_b32 s69, s69, 3
    s_lshr_b32 s6, s5, 2
    s_add_u32 s69, s69, s6
    s_and_b32 s70, s4, 1
    s_lshl_b32 s70, s70, 2
    s_and_b32 s6, s5, 3
    s_add_u32 s70, s70, s6
    v_lshlrev_b32 v21, 4, v1
    s_mul_i32 s94, s2, 57
    s_lshr_b32 s94, s94, 10
    s_min_u32 s94, s94, 7
    s_cmp_lt_u32 s2, 144
    s_cbranch_scc0 L_mduty
    s_mul_i32 s6, s94, 18
    s_sub_u32 s6, s2, s6
    s_mul_i32 s6, s6, 110592
    v_lshrrev_b32 v4, 4, v1
    s_and_b32 s4, s68, 1
    s_lshl_b32 s4, s4, 2
    v_or_b32 v5, s4, v4
    v_lshlrev_b32 v5, 1, v5
    v_and_b32 v6, 15, v1
    v_xor_b32 v5, v5, v6
    v_mul_u32_u24 v9, 3456, v4
    v_lshl_add_u32 v9, v5, 4, v9
    s_mul_i32 s4, s94, 144
    s_and_b32 s4, s4, 0xffffff80
    s_mul_i32 s5, s68, 27648
    s_add_u32 s4, s4, s5
    v_add_u32 v9, s4, v9
    s_lshl_b32 s84, s68, 11
    s_add_u32 m0, s84, 98304
    s_add_u32 s4, s6, 0
    buffer_load_dwordx4 v9, s[32:35], s4 offen lds
    s_add_u32 m0, s84, 99328
    s_add_u32 s4, s6, 13824
    buffer_load_dwordx4 v9, s[32:35], s4 offen lds
    s_add_u32 m0, s84, 106496
    s_add_u32 s4, s6, 1152
    buffer_load_dwordx4 v9, s[32:35], s4 offen lds
    s_add_u32 m0, s84, 107520
    s_add_u32 s4, s6, 14976
    buffer_load_dwordx4 v9, s[32:35], s4 offen lds
    s_add_u32 m0, s84, 114688
    s_add_u32 s4, s6, 2304
    buffer_load_dwordx4 v9, s[32:35], s4 offen lds
    s_add_u32 m0, s84, 115712
    s_add_u32 s4, s6, 16128
    buffer_load_dwordx4 v9, s[32:35], s4 offen lds
    s_branch L_dutyE
L_mduty:
    s_sub_u32 s4, s2, 144
    s_cmp_ge_u32 s4, 54
    s_cselect_b32 s5, 54, 0
    s_cselect_b32 s6, 4, 0
    s_sub_u32 s5, s4, s5
    s_add_u32 s6, s6, s68
    s_lshl_b32 s93, s5, 9
    s_lshr_b32 s7, s6, 2
    s_mul_i32 s7, s7, 27648
    s_add_u32 s93, s93, s7
    s_add_u32 s93, s93, 18939904
    s_cmp_lt_u32 s2, 252
    s_cselect_b32 s93, s93, 0x7ff00000
    s_cselect_b32 s4, 0, 0x7ff00000
    s_mul_i32 s6, s6, 72
    v_lshrrev_b32 v4, 3, v1
    v_mul_u32_u24 v5, 9, v4
    v_add_u32 v5, s6, v5
    v_lshlrev_b32 v17, 1, v5
    v_and_b32 v17, -4, v17
    v_mul_u32_u24 v16, 6912, v5
    v_and_b32_e64 v5, 7, v1
    v_lshl_add_u32 v16, v5, 4, v16
    s_lshl_b32 s5, s5, 7
    s_add_u32 s5, s5, s4
    v_add_u32 v16, s5, v16
    v_add_u32 v17, s4, v17
    buffer_load_dwordx4 v[232:235], v17, s[52:55], 0 offen
    buffer_load_dword v236, v17, s[52:55], 0 offen offset:16
    s_mov_b32 s4, 0
    s_nop 0
    buffer_load_dwordx4 v[48:51], v16, s[56:59], s4 offen
    s_mov_b32 s4, 6912
    buffer_load_dwordx4 v[52:55], v16, s[56:59], s4 offen
    s_mov_b32 s4, 13824
    buffer_load_dwordx4 v[56:59], v16, s[56:59], s4 offen
    s_mov_b32 s4, 20736
    buffer_load_dwordx4 v[60:63], v16, s[56:59], s4 offen
    s_mov_b32 s4, 27648
    buffer_load_dwordx4 v[64:67], v16, s[56:59], s4 offen
    s_mov_b32 s4, 34560
    buffer_load_dwordx4 v[68:71], v16, s[56:59], s4 offen
    s_mov_b32 s4, 41472
    buffer_load_dwordx4 v[72:75], v16, s[56:59], s4 offen
    s_mov_b32 s4, 48384
    buffer_load_dwordx4 v[76:79], v16, s[56:59], s4 offen
    s_mov_b32 s4, 55296
    buffer_load_dwordx4 v[80:83], v16, s[56:59], s4 offen
L_dutyE:
    v_lshrrev_b32_e64 v4, 3, v1
    v_mul_u32_u24 v8, 1152, v4
    v_lshrrev_b32 v4, 4, v1
    s_and_b32 s4, s68, 1
    s_lshl_b32 s4, s4, 2
    v_or_b32 v4, s4, v4
    v_and_b32 v5, 7, v1
    v_xor_b32 v4, v4, v5
    v_lshl_add_u32 v8, v4, 4, v8
    s_and_b32 s27, s69, 7
    s_mul_i32 s95, s27, 221184
    s_mul_i32 s5, s69, 73728
    s_mul_i32 s6, s68, 9216
    s_add_u32 s5, s5, s6
    s_sub_u32 s7, s5, 18432
    s_cmp_lt_u32 s68, 2
    s_cselect_b32 s8, s69, 1
    s_cselect_b32 s26, 3, 2
    s_cmp_eq_u32 s8, 0
    s_cselect_b32 s7, s6, s7
    s_sub_u32 s5, s5, 18432
    s_and_b32 s8, s70, 3
    s_cmp_ge_u32 s8, s26
    s_cselect_b32 s9, s26, 0
    s_sub_u32 s8, s8, s9
    s_cmp_ge_u32 s8, s26
    s_cselect_b32 s9, s26, 0
    s_sub_u32 s8, s8, s9
    s_add_u32 s9, s27, 0
    s_cmp_ge_u32 s9, 9
    s_cselect_b32 s4, 9, 0
    s_sub_u32 s9, s9, s4
    s_lshl_b32 s10, s9, 7
    s_add_u32 s9, s27, 1
    s_cmp_ge_u32 s9, 9
    s_cselect_b32 s4, 9, 0
    s_sub_u32 s9, s9, s4
    s_lshl_b32 s11, s9, 7
    s_add_u32 s9, s27, 2
    s_cmp_ge_u32 s9, 9
    s_cselect_b32 s4, 9, 0
    s_sub_u32 s9, s9, s4
    s_lshl_b32 s12, s9, 7
    s_add_u32 s9, s27, 3
    s_cmp_ge_u32 s9, 9
    s_cselect_b32 s4, 9, 0
    s_sub_u32 s9, s9, s4
    s_lshl_b32 s13, s9, 7
    s_add_u32 s9, s27, 4
    s_cmp_ge_u32 s9, 9
    s_cselect_b32 s4, 9, 0
    s_sub_u32 s9, s9, s4
    s_lshl_b32 s14, s9, 7
    s_add_u32 s9, s27, 5
    s_cmp_ge_u32 s9, 9
    s_cselect_b32 s4, 9, 0
    s_sub_u32 s9, s9, s4
    s_lshl_b32 s15, s9, 7
    s_add_u32 s9, s27, 6
    s_cmp_ge_u32 s9, 9
    s_cselect_b32 s4, 9, 0
    s_sub_u32 s9, s9, s4
    s_lshl_b32 s16, s9, 7
    s_add_u32 s9, s27, 7
    s_cmp_ge_u32 s9, 9
    s_cselect_b32 s4, 9, 0
    s_sub_u32 s9, s9, s4
    s_lshl_b32 s17, s9, 7
    s_add_u32 s9, s27, 8
    s_cmp_ge_u32 s9, 9
    s_cselect_b32 s4, 9, 0
    s_sub_u32 s9, s9, s4
    s_lshl_b32 s18, s9, 7
    s_add_u32 s9, s8, 0
    s_cmp_ge_u32 s9, s26
    s_cselect_b32 s4, s26, 0
    s_sub_u32 s9, s9, s4
    s_mul_i32 s4, s9, 36864
    s_add_u32 s91, s6, s4
    s_add_u32 s92, s5, s4
    s_cmp_eq_u32 s9, 0
    s_cselect_b32 s92, s7, s92
    s_mov_b32 s22, 33559056
    s_mov_b32 s23, 50402065
    s_cmp_eq_u32 s68, 1
    s_cselect_b32 s22, 100931092, s22
    s_cselect_b32 s23, 117774101, s23
    s_cmp_eq_u32 s68, 2
    s_cselect_b32 s22, 270737688, s22
    s_cselect_b32 s23, 287580704, s23
    s_cmp_eq_u32 s68, 3
    s_cselect_b32 s22, 268969765, s22
    s_cselect_b32 s23, 285747238, s23
    v_mov_b32 v4, s22
    s_add_u32 m0, s91, 0
    s_add_u32 s4, s92, s10
    s_nop 0
    buffer_load_dwordx4 v8, s[28:31], s4 offen lds
    v_mov_b32 v5, s23
    v_and_b32 v6, 2, v2
    v_cmp_eq_u32 vcc, 0, v6
    s_nop 1
    v_cndmask_b32 v18, v5, v4, vcc
    s_add_u32 m0, s91, 1024
    s_add_u32 s4, s92, s11
    buffer_load_dwordx4 v8, s[28:31], s4 offen lds
    v_lshrrev_b32 v6, 2, v2
    v_and_b32 v7, 1, v3
    v_lshl_or_b32 v7, v7, 2, v6
    v_lshlrev_b32_e64 v19, 1, v7
    v_lshl_add_u32 v6, v3, 3, v6
    s_add_u32 m0, s91, 2048
    s_add_u32 s4, s92, s12
    s_nop 0
    buffer_load_dwordx4 v8, s[28:31], s4 offen lds
    v_lshlrev_b32 v6, 8, v6
    v_and_b32 v7, 1, v2
    v_lshl_or_b32 v20, v7, 3, v6
    v_bfe_u32 v4, v18, 0, 4
    v_bfe_u32 v5, v18, 4, 2
    s_add_u32 m0, s91, 3072
    s_add_u32 s4, s92, s13
    s_nop 0
    buffer_load_dwordx4 v8, s[28:31], s4 offen lds
    v_add_u32 v4, s94, v4
    v_xor_b32 v4, v4, v19
    v_lshl_add_u32 v4, v4, 4, v20
    v_lshl_add_u32 v44, v5, 13, v4
    v_add_u32 v44, 65536, v44
    s_add_u32 m0, s91, 4096
    s_add_u32 s4, s92, s14
    s_nop 0
    buffer_load_dwordx4 v8, s[28:31], s4 offen lds
    v_bfe_u32 v4, v18, 8, 4
    v_bfe_u32 v5, v18, 12, 2
    v_add_u32 v4, s94, v4
    v_xor_b32 v4, v4, v19
    v_lshl_add_u32 v4, v4, 4, v20
    s_add_u32 m0, s91, 5120
    s_add_u32 s4, s92, s15
    s_nop 0
    buffer_load_dwordx4 v8, s[28:31], s4 offen lds
    v_lshl_add_u32 v45, v5, 13, v4
    v_add_u32 v45, 65536, v45
    v_bfe_u32 v4, v18, 16, 4
    v_bfe_u32 v5, v18, 20, 2
    v_add_u32 v4, s94, v4
    s_add_u32 m0, s91, 6144
    s_add_u32 s4, s92, s16
    buffer_load_dwordx4 v8, s[28:31], s4 offen lds
    v_xor_b32_e64 v4, v4, v19
    v_lshl_add_u32 v4, v4, 4, v20
    v_lshl_add_u32 v46, v5, 13, v4
    v_add_u32 v46, 65536, v46
    v_bfe_u32 v4, v18, 24, 4
    s_add_u32 m0, s91, 7168
    s_add_u32 s4, s92, s17
    s_nop 0
    buffer_load_dwordx4 v8, s[28:31], s4 offen lds
    v_bfe_u32 v5, v18, 28, 2
    v_add_u32 v4, s94, v4
    v_xor_b32 v4, v4, v19
    v_lshl_add_u32 v4, v4, 4, v20
    v_lshl_add_u32 v47, v5, 13, v4
    s_add_u32 m0, s91, 8192
    s_add_u32 s4, s92, s18
    s_nop 0
    buffer_load_dwordx4 v8, s[28:31], s4 offen lds
    v_add_u32 v47, 65536, v47
    s_sub_u32 s88, 3, s68
    s_and_b32 s22, s88, 1
    s_lshl_b32 s22, s22, 2
    v_or_b32 v4, s22, v3
    v_bfe_u32 v5, v2, 1, 3
    v_xor_b32 v4, v4, v5
    v_lshlrev_b32 v4, 4, v4
    s_add_u32 s9, s8, 1
    s_cmp_ge_u32 s9, s26
    s_cselect_b32 s4, s26, 0
    s_sub_u32 s9, s9, s4
    s_mul_i32 s4, s9, 36864
    s_add_u32 s91, s6, s4
    s_add_u32 s92, s5, s4
    s_cmp_eq_u32 s9, 0
    s_cselect_b32 s92, s7, s92
    s_add_u32 m0, s91, 0
    s_add_u32 s4, s92, s10
    buffer_load_dwordx4 v8, s[28:31], s4 offen lds
    v_and_b32_e64 v5, 7, v2
    v_lshl_or_b32 v4, v5, 7, v4
    v_lshrrev_b32_e64 v5, 3, v2
    v_mul_u32_u24 v5, 9216, v5
    s_add_u32 m0, s91, 1024
    s_add_u32 s4, s92, s11
    s_nop 0
    buffer_load_dwordx4 v8, s[28:31], s4 offen lds
    s_lshr_b32 s22, s88, 1
    s_lshl_b32 s22, s22, 10
    v_add3_u32 v18, v4, v5, s22
    v_add_u32 v19, 55296, v18
    v_add_u32 v22, 55296, v21
    s_lshl_b32 s22, s88, 7
    s_add_u32 s22, s22, 157696
    v_lshlrev_b32 v23, 5, v3
    v_add_u32 v23, s22, v23
    s_add_u32 m0, s91, 2048
    s_add_u32 s4, s92, s12
    buffer_load_dwordx4 v8, s[28:31], s4 offen lds
    v_and_b32_e64 v4, 3, v2
    v_cmp_eq_u32 s[76:77], 1, v4
    v_cmp_eq_u32 s[78:79], 2, v4
    v_cmp_eq_u32 s[80:81], 3, v4
    v_lshrrev_b32 v4, 2, v2
    s_add_u32 m0, s91, 3072
    s_add_u32 s4, s92, s13
    buffer_load_dwordx4 v8, s[28:31], s4 offen lds
    v_cmp_eq_u32 s[82:83], v4, v3
    s_mov_b32 s90, 0xffff0000
    s_mov_b32 s22, 168362240
    s_cmp_eq_u32 s68, 1
    s_cselect_b32 s22, 202048258, s22
    s_cmp_eq_u32 s68, 2
    s_cselect_b32 s22, 4278584580, s22
    s_cmp_eq_u32 s68, 3
    s_cselect_b32 s22, 4279044103, s22
    s_bfe_u32 s23, s22, 524288
    s_lshl_b32 s23, s23, 10
    s_cmp_gt_u32 s23, 0x10000
    s_cselect_b32 s23, 0x7ff00000, s23
    v_add_u32 v10, s23, v21
    s_bfe_u32 s23, s22, 524296
    s_lshl_b32 s23, s23, 10
    s_cmp_gt_u32 s23, 0x10000
    s_cselect_b32 s23, 0x7ff00000, s23
    v_add_u32 v11, s23, v21
    s_bfe_u32 s23, s22, 524304
    s_lshl_b32 s23, s23, 10
    s_cmp_gt_u32 s23, 0x10000
    s_cselect_b32 s23, 0x7ff00000, s23
    v_add_u32 v12, s23, v21
    s_bfe_u32 s23, s22, 524312
    s_lshl_b32 s23, s23, 10
    s_cmp_gt_u32 s23, 0x10000
    s_cselect_b32 s23, 0x7ff00000, s23
    v_add_u32 v13, s23, v21
    s_add_u32 m0, s91, 4096
    s_add_u32 s4, s92, s14
    buffer_load_dwordx4 v8, s[28:31], s4 offen lds
    v_mov_b32 v120, 0x3f803f80
    v_mov_b32 v121, 0x3f803f80
    v_mov_b32 v122, 0x3f803f80
    v_mov_b32 v123, 0x3f803f80
    v_mov_b32 v140, 0
    s_add_u32 m0, s91, 5120
    s_add_u32 s4, s92, s15
    buffer_load_dwordx4 v8, s[28:31], s4 offen lds
    v_mov_b32 v141, 0
    v_mov_b32 v142, 0
    v_mov_b32 v143, 0
    v_mov_b32 v160, 0
    v_mov_b32 v161, 0
    s_add_u32 m0, s91, 6144
    s_add_u32 s4, s92, s16
    buffer_load_dwordx4 v8, s[28:31], s4 offen lds
    v_mov_b32 v162, 0
    v_mov_b32 v163, 0
    v_mov_b32 v180, 0
    v_mov_b32 v181, 0
    v_mov_b32 v182, 0
    s_add_u32 m0, s91, 7168
    s_add_u32 s4, s92, s17
    buffer_load_dwordx4 v8, s[28:31], s4 offen lds
    v_mov_b32 v183, 0
    v_mov_b32 v200, 0
    v_mov_b32 v201, 0
    v_mov_b32 v202, 0
    v_mov_b32 v203, 0
    s_add_u32 m0, s91, 8192
    s_add_u32 s4, s92, s18
    buffer_load_dwordx4 v8, s[28:31], s4 offen lds
    v_mov_b32 v220, 0
    v_mov_b32 v221, 0
    v_mov_b32 v222, 0
    v_mov_b32 v223, 0
    s_cmp_lt_u32 s68, 2
    s_cbranch_scc0 L_x2
    s_add_u32 s9, s8, 2
    s_cmp_ge_u32 s9, s26
    s_cselect_b32 s4, s26, 0
    s_sub_u32 s9, s9, s4
    s_mul_i32 s4, s9, 36864
    s_add_u32 s91, s6, s4
    s_add_u32 s92, s5, s4
    s_cmp_eq_u32 s9, 0
    s_cselect_b32 s92, s7, s92
    s_add_u32 m0, s91, 0
    s_add_u32 s4, s92, s10
    buffer_load_dwordx4 v8, s[28:31], s4 offen lds
    s_add_u32 m0, s91, 1024
    s_add_u32 s4, s92, s11
    s_nop 0
    buffer_load_dwordx4 v8, s[28:31], s4 offen lds
    s_add_u32 m0, s91, 2048
    s_add_u32 s4, s92, s12
    s_nop 0
    buffer_load_dwordx4 v8, s[28:31], s4 offen lds
    s_add_u32 m0, s91, 3072
    s_add_u32 s4, s92, s13
    s_nop 0
    buffer_load_dwordx4 v8, s[28:31], s4 offen lds
    s_add_u32 m0, s91, 4096
    s_add_u32 s4, s92, s14
    s_nop 0
    buffer_load_dwordx4 v8, s[28:31], s4 offen lds
    s_add_u32 m0, s91, 5120
    s_add_u32 s4, s92, s15
    s_nop 0
    buffer_load_dwordx4 v8, s[28:31], s4 offen lds
    s_add_u32 m0, s91, 6144
    s_add_u32 s4, s92, s16
    s_nop 0
    buffer_load_dwordx4 v8, s[28:31], s4 offen lds
    s_add_u32 m0, s91, 7168
    s_add_u32 s4, s92, s17
    s_nop 0
    buffer_load_dwordx4 v8, s[28:31], s4 offen lds
    s_add_u32 m0, s91, 8192
    s_add_u32 s4, s92, s18
    s_nop 0
    buffer_load_dwordx4 v8, s[28:31], s4 offen lds
L_x2:
    s_and_b32 s4, s69, 7
    s_mul_i32 s95, s4, 28672
    s_mul_i32 s84, s70, 258048
    s_add_u32 s84, s84, 54525952
    s_lshl_b32 s6, s2, 7
    s_add_u32 s6, s6, 47185920
    s_cmp_lt_u32 s2, 144
    s_cselect_b32 s6, s6, 0x7ff00000
    s_cmp_lt_u32 s2, 144
    s_cbranch_scc0 L_mfin
    s_waitcnt vmcnt(18)
    v_readfirstlane_b32 s3, v252
    s_nop 2
    s_mul_i32 s3, s3, 0x9E3779B1
    s_add_u32 s3, s3, 0x7F4A7C15
    s_barrier
    s_nop 0
    ds_read_b64_tr_b16 v[24:25], v44 offset:32768
    ds_read_b64_tr_b16 v[26:27], v44 offset:33792
    ds_read_b64_tr_b16 v[28:29], v45 offset:32768
    ds_read_b64_tr_b16 v[30:31], v45 offset:33792
    ds_read_b64_tr_b16 v[32:33], v46 offset:32768
    ds_read_b64_tr_b16 v[34:35], v46 offset:33792
    ds_read_b64_tr_b16 v[36:37], v47 offset:32768
    ds_read_b64_tr_b16 v[38:39], v47 offset:33792
    s_mul_i32 s22, s2, 14336
    s_add_u32 s22, s22, 54525952
    s_waitcnt lgkmcnt(6)
    s_nop 0
    buffer_store_dwordx4 v[24:27], v10, s[64:67], s22 offen sc1
    s_waitcnt lgkmcnt(4)
    s_nop 0
    buffer_store_dwordx4 v[28:31], v11, s[64:67], s22 offen sc1
    s_waitcnt lgkmcnt(2)
    s_nop 0
    buffer_store_dwordx4 v[32:35], v12, s[64:67], s22 offen sc1
    s_waitcnt lgkmcnt(0)
    s_nop 0
    buffer_store_dwordx4 v[36:39], v13, s[64:67], s22 offen sc1
    s_waitcnt vmcnt(4)
    s_branch L_finE
L_mfin:
    s_waitcnt vmcnt(18)
    v_readfirstlane_b32 s3, v252
    s_nop 2
    s_mul_i32 s3, s3, 0x9E3779B1
    s_add_u32 s3, s3, 0x7F4A7C15
    v_lshrrev_b32 v4, 3, v1
    v_and_b32 v4, 1, v4
    v_lshlrev_b32 v4, 4, v4
    v_alignbit_b32 v232, v233, v232, v4
    v_alignbit_b32 v233, v234, v233, v4
    v_alignbit_b32 v234, v235, v234, v4
    v_alignbit_b32 v235, v236, v235, v4
    v_alignbit_b32 v236, v236, v236, v4
    v_lshlrev_b32 v24, 16, v232
    v_and_b32 v25, s90, v232
    v_lshlrev_b32 v26, 16, v233
    v_and_b32 v27, s90, v233
    v_lshlrev_b32 v28, 16, v234
    v_and_b32 v29, s90, v234
    v_lshlrev_b32 v30, 16, v235
    v_and_b32 v31, s90, v235
    v_lshlrev_b32_e64 v32, 16, v236
    v_mov_b32 v42, 0xbfb8aa3b
    v_mul_f32 v224, v42, v24
    v_mul_f32 v225, v42, v25
    v_mul_f32 v226, v42, v26
    v_mul_f32 v227, v42, v27
    v_mul_f32 v228, v42, v28
    v_mul_f32 v229, v42, v29
    v_mul_f32 v230, v42, v30
    v_mul_f32 v231, v42, v31
    v_mul_f32 v232, v42, v32
    v_exp_f32 v224, v224
    v_exp_f32 v225, v225
    v_exp_f32 v226, v226
    v_exp_f32 v227, v227
    v_exp_f32 v228, v228
    v_exp_f32 v229, v229
    v_exp_f32 v230, v230
    v_exp_f32 v231, v231
    v_exp_f32 v232, v232
    v_add_f32 v224, 1.0, v224
    v_add_f32 v225, 1.0, v225
    v_add_f32 v226, 1.0, v226
    v_add_f32 v227, 1.0, v227
    v_add_f32 v228, 1.0, v228
    v_add_f32 v229, 1.0, v229
    v_add_f32 v230, 1.0, v230
    v_add_f32 v231, 1.0, v231
    v_add_f32 v232, 1.0, v232
    v_rcp_f32 v224, v224
    v_rcp_f32 v225, v225
    v_rcp_f32 v226, v226
    v_rcp_f32 v227, v227
    v_rcp_f32 v228, v228
    v_rcp_f32 v229, v229
    v_rcp_f32 v230, v230
    v_rcp_f32 v231, v231
    v_rcp_f32 v232, v232
    v_mul_f32 v224, v224, v24
    v_mul_f32 v225, v225, v25
    v_mul_f32 v226, v226, v26
    v_mul_f32 v227, v227, v27
    v_mul_f32 v228, v228, v28
    v_mul_f32 v229, v229, v29
    v_mul_f32 v230, v230, v30
    v_mul_f32 v231, v231, v31
    v_mul_f32_e64 v232, v232, v32
    v_cvt_pk_bf16_f32 v224, v224, v224
    v_cvt_pk_bf16_f32 v225, v225, v225
    v_cvt_pk_bf16_f32 v226, v226, v226
    v_cvt_pk_bf16_f32 v227, v227, v227
    v_cvt_pk_bf16_f32 v228, v228, v228
    v_cvt_pk_bf16_f32 v229, v229, v229
    v_cvt_pk_bf16_f32 v230, v230, v230
    v_cvt_pk_bf16_f32 v231, v231, v231
    v_cvt_pk_bf16_f32 v232, v232, v232
    v_and_b32 v24, s90, v224
    v_and_b32 v25, s90, v225
    v_and_b32 v26, s90, v226
    v_and_b32 v27, s90, v227
    v_and_b32 v28, s90, v228
    v_and_b32 v29, s90, v229
    v_and_b32 v30, s90, v230
    v_and_b32 v31, s90, v231
    v_and_b32 v32, s90, v232
    v_lshlrev_b32 v96, 16, v48
    v_and_b32 v97, s90, v48
    v_lshlrev_b32 v98, 16, v49
    v_and_b32 v99, s90, v49
    v_lshlrev_b32 v100, 16, v50
    v_and_b32 v101, s90, v50
    v_lshlrev_b32 v102, 16, v51
    v_and_b32_e64 v103, s90, v51
    v_pk_mul_f32 v[88:89], v[96:97], v[24:25] op_sel:[0,0] op_sel_hi:[1,0]
    v_pk_mul_f32 v[90:91], v[98:99], v[24:25] op_sel:[0,0] op_sel_hi:[1,0]
    v_pk_mul_f32 v[92:93], v[100:101], v[24:25] op_sel:[0,0] op_sel_hi:[1,0]
    v_pk_mul_f32 v[94:95], v[102:103], v[24:25] op_sel:[0,0] op_sel_hi:[1,0]
    v_lshlrev_b32 v96, 16, v52
    v_and_b32 v97, s90, v52
    v_lshlrev_b32 v98, 16, v53
    v_and_b32 v99, s90, v53
    v_lshlrev_b32 v100, 16, v54
    v_and_b32 v101, s90, v54
    v_lshlrev_b32 v102, 16, v55
    v_and_b32 v103, s90, v55
    v_pk_fma_f32 v[88:89], v[96:97], v[24:25], v[88:89] op_sel:[0,1,0] op_sel_hi:[1,1,1]
    v_pk_fma_f32 v[90:91], v[98:99], v[24:25], v[90:91] op_sel:[0,1,0] op_sel_hi:[1,1,1]
    v_pk_fma_f32 v[92:93], v[100:101], v[24:25], v[92:93] op_sel:[0,1,0] op_sel_hi:[1,1,1]
    v_pk_fma_f32 v[94:95], v[102:103], v[24:25], v[94:95] op_sel:[0,1,0] op_sel_hi:[1,1,1]
    v_lshlrev_b32 v96, 16, v56
    v_and_b32 v97, s90, v56
    v_lshlrev_b32 v98, 16, v57
    v_and_b32 v99, s90, v57
    v_lshlrev_b32 v100, 16, v58
    v_and_b32 v101, s90, v58
    v_lshlrev_b32 v102, 16, v59
    v_and_b32 v103, s90, v59
    v_pk_fma_f32 v[88:89], v[96:97], v[26:27], v[88:89] op_sel:[0,0,0] op_sel_hi:[1,0,1]
    v_pk_fma_f32 v[90:91], v[98:99], v[26:27], v[90:91] op_sel:[0,0,0] op_sel_hi:[1,0,1]
    v_pk_fma_f32 v[92:93], v[100:101], v[26:27], v[92:93] op_sel:[0,0,0] op_sel_hi:[1,0,1]
    v_pk_fma_f32 v[94:95], v[102:103], v[26:27], v[94:95] op_sel:[0,0,0] op_sel_hi:[1,0,1]
    v_lshlrev_b32 v96, 16, v60
    v_and_b32 v97, s90, v60
    v_lshlrev_b32 v98, 16, v61
    v_and_b32 v99, s90, v61
    v_lshlrev_b32 v100, 16, v62
    v_and_b32 v101, s90, v62
    v_lshlrev_b32 v102, 16, v63
    v_and_b32 v103, s90, v63
    v_pk_fma_f32 v[88:89], v[96:97], v[26:27], v[88:89] op_sel:[0,1,0] op_sel_hi:[1,1,1]
    v_pk_fma_f32 v[90:91], v[98:99], v[26:27], v[90:91] op_sel:[0,1,0] op_sel_hi:[1,1,1]
    v_pk_fma_f32 v[92:93], v[100:101], v[26:27], v[92:93] op_sel:[0,1,0] op_sel_hi:[1,1,1]
    v_pk_fma_f32 v[94:95], v[102:103], v[26:27], v[94:95] op_sel:[0,1,0] op_sel_hi:[1,1,1]
    v_lshlrev_b32 v96, 16, v64
    v_and_b32 v97, s90, v64
    v_lshlrev_b32 v98, 16, v65
    v_and_b32 v99, s90, v65
    v_lshlrev_b32 v100, 16, v66
    v_and_b32 v101, s90, v66
    v_lshlrev_b32 v102, 16, v67
    v_and_b32 v103, s90, v67
    v_pk_fma_f32 v[88:89], v[96:97], v[28:29], v[88:89] op_sel:[0,0,0] op_sel_hi:[1,0,1]
    v_pk_fma_f32 v[90:91], v[98:99], v[28:29], v[90:91] op_sel:[0,0,0] op_sel_hi:[1,0,1]
    v_pk_fma_f32 v[92:93], v[100:101], v[28:29], v[92:93] op_sel:[0,0,0] op_sel_hi:[1,0,1]
    v_pk_fma_f32 v[94:95], v[102:103], v[28:29], v[94:95] op_sel:[0,0,0] op_sel_hi:[1,0,1]
    v_lshlrev_b32 v96, 16, v68
    v_and_b32 v97, s90, v68
    v_lshlrev_b32 v98, 16, v69
    v_and_b32 v99, s90, v69
    v_lshlrev_b32 v100, 16, v70
    v_and_b32 v101, s90, v70
    v_lshlrev_b32 v102, 16, v71
    v_and_b32 v103, s90, v71
    v_pk_fma_f32 v[88:89], v[96:97], v[28:29], v[88:89] op_sel:[0,1,0] op_sel_hi:[1,1,1]
    v_pk_fma_f32 v[90:91], v[98:99], v[28:29], v[90:91] op_sel:[0,1,0] op_sel_hi:[1,1,1]
    v_pk_fma_f32 v[92:93], v[100:101], v[28:29], v[92:93] op_sel:[0,1,0] op_sel_hi:[1,1,1]
    v_pk_fma_f32 v[94:95], v[102:103], v[28:29], v[94:95] op_sel:[0,1,0] op_sel_hi:[1,1,1]
    v_lshlrev_b32 v96, 16, v72
    v_and_b32 v97, s90, v72
    v_lshlrev_b32 v98, 16, v73
    v_and_b32 v99, s90, v73
    v_lshlrev_b32 v100, 16, v74
    v_and_b32 v101, s90, v74
    v_lshlrev_b32 v102, 16, v75
    v_and_b32 v103, s90, v75
    v_pk_fma_f32 v[88:89], v[96:97], v[30:31], v[88:89] op_sel:[0,0,0] op_sel_hi:[1,0,1]
    v_pk_fma_f32 v[90:91], v[98:99], v[30:31], v[90:91] op_sel:[0,0,0] op_sel_hi:[1,0,1]
    v_pk_fma_f32 v[92:93], v[100:101], v[30:31], v[92:93] op_sel:[0,0,0] op_sel_hi:[1,0,1]
    v_pk_fma_f32 v[94:95], v[102:103], v[30:31], v[94:95] op_sel:[0,0,0] op_sel_hi:[1,0,1]
    v_lshlrev_b32 v96, 16, v76
    v_and_b32 v97, s90, v76
    v_lshlrev_b32 v98, 16, v77
    v_and_b32 v99, s90, v77
    v_lshlrev_b32 v100, 16, v78
    v_and_b32 v101, s90, v78
    v_lshlrev_b32 v102, 16, v79
    v_and_b32 v103, s90, v79
    v_pk_fma_f32 v[88:89], v[96:97], v[30:31], v[88:89] op_sel:[0,1,0] op_sel_hi:[1,1,1]
    v_pk_fma_f32 v[90:91], v[98:99], v[30:31], v[90:91] op_sel:[0,1,0] op_sel_hi:[1,1,1]
    v_pk_fma_f32 v[92:93], v[100:101], v[30:31], v[92:93] op_sel:[0,1,0] op_sel_hi:[1,1,1]
    v_pk_fma_f32 v[94:95], v[102:103], v[30:31], v[94:95] op_sel:[0,1,0] op_sel_hi:[1,1,1]
    v_lshlrev_b32 v96, 16, v80
    v_and_b32 v97, s90, v80
    v_lshlrev_b32 v98, 16, v81
    v_and_b32 v99, s90, v81
    v_lshlrev_b32 v100, 16, v82
    v_and_b32 v101, s90, v82
    v_lshlrev_b32 v102, 16, v83
    v_and_b32 v103, s90, v83
    v_pk_fma_f32 v[88:89], v[96:97], v[32:33], v[88:89] op_sel:[0,0,0] op_sel_hi:[1,0,1]
    v_pk_fma_f32 v[90:91], v[98:99], v[32:33], v[90:91] op_sel:[0,0,0] op_sel_hi:[1,0,1]
    v_pk_fma_f32 v[92:93], v[100:101], v[32:33], v[92:93] op_sel:[0,0,0] op_sel_hi:[1,0,1]
    v_pk_fma_f32 v[94:95], v[102:103], v[32:33], v[94:95] op_sel:[0,0,0] op_sel_hi:[1,0,1]
    s_nop 0
    v_permlane32_swap_b32 v88, v92
    v_permlane32_swap_b32 v89, v93
    v_permlane32_swap_b32 v90, v94
    v_permlane32_swap_b32 v91, v95
    v_add_f32 v88, v88, v92
    v_add_f32 v89, v89, v93
    v_add_f32 v90, v90, v94
    v_add_f32 v91, v91, v95
    s_nop 0
    v_permlane16_swap_b32 v88, v90
    v_permlane16_swap_b32 v89, v91
    v_add_f32 v88, v88, v90
    v_add_f32 v89, v89, v91
L_stub_0:
    s_nop 0
    v_and_b32 v4, 8, v1
    v_cmp_eq_u32 vcc, 0, v4
    s_nop 1
    v_cndmask_b32 v90, v89, v88, vcc
    v_cndmask_b32 v91, v88, v89, vcc
    s_nop 1
    s_nop 0
    v_add_f32_dpp v90, v91, v90 row_ror:8 row_mask:0xf bank_mask:0xf
    v_and_b32 v4, 7, v1
    v_lshrrev_b32 v5, 3, v1
    v_lshl_add_u32 v4, v4, 3, v5
    v_lshlrev_b32 v4, 2, v4
    s_lshl_b32 s22, s68, 8
    s_add_u32 s22, s22, 150528
    v_add_u32_e64 v4, s22, v4
    ds_write_b32 v4, v90
    v_lshlrev_b32_e64 v4, 2, v1
    v_add_u32 v5, 150528, v4
    s_waitcnt vmcnt(0) lgkmcnt(0)
    s_barrier
    s_cmp_eq_u32 s68, 0
    s_cbranch_scc0 L_finE
    ds_read_b32 v88, v5
    ds_read_b32 v89, v5 offset:256
    ds_read_b32 v90, v5 offset:512
    ds_read_b32 v92, v5 offset:768
    v_mov_b32 v91, s3
    v_lshlrev_b32 v4, 3, v1
    s_waitcnt lgkmcnt(0)
    v_add_f32 v88, v88, v89
    v_add_f32 v90, v90, v92
    v_add_f32 v90, v90, v88
    buffer_store_dwordx2 v[90:91], v4, s[64:67], s93 offen sc1
L_finE:
    s_barrier
    s_cmp_ge_u32 s68, 2
    s_cbranch_scc0 L_xz
    s_nop 0
    ds_read_b128 v[140:143], v18 offset:8192
    ds_read_b128 v[160:163], v18 offset:26624
    ds_read_b128 v[180:183], v18 offset:45056
    ds_read_b128 v[200:203], v19 offset:8192
    ds_read_b128 v[220:223], v19 offset:26624
L_xz:
    ds_read_b128 v[124:127], v18 offset:0
    ds_read_b128 v[144:147], v18 offset:18432
    ds_read_b128 v[164:167], v18 offset:36864
    ds_read_b128 v[184:187], v19 offset:0
    ds_read_b128 v[204:207], v19 offset:18432
    ds_read_b128 v[128:131], v18 offset:2048
    ds_read_b128 v[148:151], v18 offset:20480
    ds_read_b128 v[168:171], v18 offset:38912
    ds_read_b128 v[188:191], v19 offset:2048
    ds_read_b128 v[208:211], v19 offset:20480
    s_mov_b64 exec, 0
    s_cmp_eq_u32 s68, 0
    s_cbranch_scc1 L_stub_1
    s_cmp_eq_u32 s68, 1
    s_cbranch_scc1 L_stub_2
    s_cmp_eq_u32 s68, 2
    s_cbranch_scc1 L_stub_3
    s_branch L_stub_4
L_tchret_m0_m1:
    s_mov_b64 exec, -1
    s_waitcnt vmcnt(0)
    s_barrier
    s_cmp_eq_u32 s68, 0
    s_cbranch_scc0 L_fl_1
    v_mov_b32 v4, s3
    s_mov_b64 exec, 1
    s_nop 0
    buffer_store_dword v4, off, s[64:67], s6 sc1
    s_mov_b64 exec, -1
L_fl_1:
    s_waitcnt lgkmcnt(5)
    v_mfma_f32_16x16x32_bf16 v[24:27], v[120:123], v[124:127], 0
    ds_read_b128 v[132:135], v18 offset:4096
    v_mfma_f32_16x16x32_bf16 v[28:31], v[124:127], v[124:127], 0
    v_mfma_f32_16x16x32_bf16 v[32:35], v[120:123], v[144:147], 0
    ds_read_b128 v[152:155], v18 offset:22528
    v_mfma_f32_16x16x32_bf16 v[36:39], v[144:147], v[144:147], 0
    v_mfma_f32_16x16x32_bf16 v[40:43], v[120:123], v[164:167], 0
    ds_read_b128 v[172:175], v18 offset:40960
    v_mfma_f32_16x16x32_bf16 v[44:47], v[164:167], v[164:167], 0
    v_mfma_f32_16x16x32_bf16 v[48:51], v[120:123], v[184:187], 0
    ds_read_b128 v[192:195], v19 offset:4096
    v_mfma_f32_16x16x32_bf16 v[52:55], v[184:187], v[184:187], 0
    v_mfma_f32_16x16x32_bf16 v[56:59], v[120:123], v[204:207], 0
    ds_read_b128 v[212:215], v19 offset:22528
    v_mfma_f32_16x16x32_bf16 v[60:63], v[204:207], v[204:207], 0
    s_waitcnt lgkmcnt(5)
    s_nop 0
    v_mfma_f32_16x16x32_bf16 v[24:27], v[120:123], v[128:131], v[24:27]
    ds_read_b128 v[136:139], v18 offset:6144
    v_mfma_f32_16x16x32_bf16 v[28:31], v[128:131], v[128:131], v[28:31]
    v_mfma_f32_16x16x32_bf16 v[32:35], v[120:123], v[148:151], v[32:35]
    ds_read_b128 v[156:159], v18 offset:24576
    v_mfma_f32_16x16x32_bf16 v[36:39], v[148:151], v[148:151], v[36:39]
    v_mfma_f32_16x16x32_bf16 v[40:43], v[120:123], v[168:171], v[40:43]
    ds_read_b128 v[176:179], v18 offset:43008
    v_mfma_f32_16x16x32_bf16 v[44:47], v[168:171], v[168:171], v[44:47]
    v_mfma_f32_16x16x32_bf16 v[48:51], v[120:123], v[188:191], v[48:51]
    ds_read_b128 v[196:199], v19 offset:6144
    v_mfma_f32_16x16x32_bf16 v[52:55], v[188:191], v[188:191], v[52:55]
    v_mfma_f32_16x16x32_bf16 v[56:59], v[120:123], v[208:211], v[56:59]
    ds_read_b128 v[216:219], v19 offset:24576
    v_mfma_f32_16x16x32_bf16 v[60:63], v[208:211], v[208:211], v[60:63]
    s_waitcnt lgkmcnt(5)
    s_nop 0
    v_mfma_f32_16x16x32_bf16 v[24:27], v[120:123], v[132:135], v[24:27]
    v_mfma_f32_16x16x32_bf16 v[28:31], v[132:135], v[132:135], v[28:31]
    v_mfma_f32_16x16x32_bf16 v[32:35], v[120:123], v[152:155], v[32:35]
    v_mfma_f32_16x16x32_bf16 v[36:39], v[152:155], v[152:155], v[36:39]
    v_mfma_f32_16x16x32_bf16 v[40:43], v[120:123], v[172:175], v[40:43]
    v_mfma_f32_16x16x32_bf16 v[44:47], v[172:175], v[172:175], v[44:47]
    v_mfma_f32_16x16x32_bf16 v[48:51], v[120:123], v[192:195], v[48:51]
    v_mfma_f32_16x16x32_bf16 v[52:55], v[192:195], v[192:195], v[52:55]
    v_mfma_f32_16x16x32_bf16 v[56:59], v[120:123], v[212:215], v[56:59]
    v_mfma_f32_16x16x32_bf16 v[60:63], v[212:215], v[212:215], v[60:63]
    s_waitcnt lgkmcnt(0)
    s_nop 0
    v_mfma_f32_16x16x32_bf16 v[24:27], v[120:123], v[136:139], v[24:27]
    v_mfma_f32_16x16x32_bf16 v[28:31], v[136:139], v[136:139], v[28:31]
    v_mfma_f32_16x16x32_bf16 v[32:35], v[120:123], v[156:159], v[32:35]
    v_mfma_f32_16x16x32_bf16 v[36:39], v[156:159], v[156:159], v[36:39]
    v_mfma_f32_16x16x32_bf16 v[40:43], v[120:123], v[176:179], v[40:43]
    v_mfma_f32_16x16x32_bf16 v[44:47], v[176:179], v[176:179], v[44:47]
    v_mfma_f32_16x16x32_bf16 v[48:51], v[120:123], v[196:199], v[48:51]
    v_mfma_f32_16x16x32_bf16 v[52:55], v[196:199], v[196:199], v[52:55]
    v_mfma_f32_16x16x32_bf16 v[56:59], v[120:123], v[216:219], v[56:59]
    v_mfma_f32_16x16x32_bf16 v[60:63], v[216:219], v[216:219], v[60:63]
    v_mfma_f32_16x16x32_bf16 v[24:27], v[120:123], v[140:143], v[24:27]
    v_mfma_f32_16x16x32_bf16 v[28:31], v[140:143], v[140:143], v[28:31]
    v_mfma_f32_16x16x32_bf16 v[32:35], v[120:123], v[160:163], v[32:35]
    v_mfma_f32_16x16x32_bf16 v[36:39], v[160:163], v[160:163], v[36:39]
    v_mfma_f32_16x16x32_bf16 v[40:43], v[120:123], v[180:183], v[40:43]
    v_mfma_f32_16x16x32_bf16 v[44:47], v[180:183], v[180:183], v[44:47]
    v_mfma_f32_16x16x32_bf16 v[48:51], v[120:123], v[200:203], v[48:51]
    v_mfma_f32_16x16x32_bf16 v[52:55], v[200:203], v[200:203], v[52:55]
    v_mfma_f32_16x16x32_bf16 v[56:59], v[120:123], v[220:223], v[56:59]
    v_mfma_f32_16x16x32_bf16 v[60:63], v[220:223], v[220:223], v[60:63]
    s_mul_i32 s4, s70, 2304
    s_add_u32 s4, s4, 47185920
    v_min_u32 v8, 17, v1
    v_lshlrev_b32 v8, 7, v8
    v_add_u32 v8, s4, v8
    s_mul_i32 s89, s68, 640
    s_add_u32 s89, s89, 147456
    v_lshlrev_b32 v5, 3, v2
    v_add_u32 v6, 147456, v5
    v_add_u32_e64 v5, s89, v5
    v_cndmask_b32 v25, v28, v29, s[76:77]
    v_cndmask_b32 v25, v25, v30, s[78:79]
    v_cndmask_b32 v25, v25, v31, s[80:81]
    v_cndmask_b32 v33, v36, v37, s[76:77]
    v_cndmask_b32 v33, v33, v38, s[78:79]
    v_cndmask_b32 v33, v33, v39, s[80:81]
    v_cndmask_b32 v41, v44, v45, s[76:77]
    v_cndmask_b32 v41, v41, v46, s[78:79]
    v_cndmask_b32 v41, v41, v47, s[80:81]
    v_cndmask_b32 v49, v52, v53, s[76:77]
    v_cndmask_b32 v49, v49, v54, s[78:79]
    v_cndmask_b32 v49, v49, v55, s[80:81]
    v_cndmask_b32 v57, v60, v61, s[76:77]
    v_cndmask_b32 v57, v57, v62, s[78:79]
    v_cndmask_b32 v57, v57, v63, s[80:81]
    s_mov_b64 exec, s[82:83]
    s_nop 0
    ds_write_b64 v5, v[24:25] offset:0
    ds_write_b64 v5, v[32:33] offset:128
    ds_write_b64 v5, v[40:41] offset:256
    ds_write_b64 v5, v[48:49] offset:384
    ds_write_b64 v5, v[56:57] offset:512
    s_mov_b64 exec, -1
    s_waitcnt lgkmcnt(0)
    s_barrier
    s_nop 0
    v_lshl_add_u32 v5, v3, 7, v6
    ds_read_b64 v[64:65], v5 offset:0
    ds_read_b64 v[66:67], v5 offset:640
    ds_read_b64 v[68:69], v5 offset:1280
    ds_read_b64 v[70:71], v5 offset:1920
    ds_read_b64 v[72:73], v6 offset:512
    ds_read_b64 v[74:75], v6 offset:1152
    ds_read_b64 v[76:77], v6 offset:1792
    ds_read_b64 v[78:79], v6 offset:2432
    buffer_load_dword v9, v8, s[64:67], 0 offen sc1
    s_cmp_eq_u32 s68, 1
    s_cselect_b32 s4, s2, 0
    s_sub_u32 s4, s4, 18
    s_cmp_lt_u32 s4, 36
    s_cselect_b32 s4, 0, 0x7ff00000
    s_lshl_b32 s22, s2, 9
    s_add_u32 s22, s22, 18939904
    s_add_u32 s23, s22, 27648
    v_lshlrev_b32 v7, 3, v1
    v_add_u32_e64 v7, s4, v7
    buffer_load_dwordx2 v[224:225], v7, s[64:67], s22 offen sc1
    buffer_load_dwordx2 v[226:227], v7, s[64:67], s23 offen sc1
    s_waitcnt lgkmcnt(0)
    s_nop 0
    v_pk_add_f32 v[64:65], v[64:65], v[66:67]
    v_pk_add_f32 v[68:69], v[68:69], v[70:71]
    v_pk_add_f32 v[64:65], v[64:65], v[68:69]
    v_pk_add_f32 v[72:73], v[72:73], v[74:75]
    v_pk_add_f32 v[76:77], v[76:77], v[78:79]
    v_pk_add_f32 v[72:73], v[72:73], v[76:77]
    v_mul_f32 v64, 0x3ae38e39, v64
    v_mul_f32 v72, 0x3ae38e39, v72
    v_mul_f32 v65, 0x3ae38e39, v65
    v_mul_f32 v73, 0x3ae38e39, v73
    v_fma_f32 v65, -v64, v64, v65
    v_fma_f32 v73, -v72, v72, v73
    v_max_f32 v65, 0, v65
    v_max_f32 v73, 0, v73
    v_cvt_pk_bf16_f32 v64, v64, v64
    v_cvt_pk_bf16_f32 v72, v72, v72
    v_and_b32 v64, s90, v64
    v_and_b32 v72, s90, v72
    v_cvt_pk_bf16_f32 v65, v65, v65
    v_cvt_pk_bf16_f32 v73, v73, v73
    v_and_b32 v65, s90, v65
    v_and_b32 v73, s90, v73
    v_add_f32 v65, 0x3727c5ac, v65
    v_add_f32 v73, 0x3727c5ac, v73
    v_cvt_pk_bf16_f32 v65, v65, v65
    v_cvt_pk_bf16_f32 v73, v73, v73
    v_and_b32 v65, s90, v65
    v_and_b32 v73, s90, v73
    v_sqrt_f32 v65, v65
    v_sqrt_f32 v73, v73
    v_cvt_pk_bf16_f32 v65, v65, v65
    v_cvt_pk_bf16_f32 v73, v73, v73
    v_and_b32 v65, s90, v65
    v_and_b32 v73, s90, v73
    v_rcp_f32 v104, v65
    v_rcp_f32 v112, v73
    v_mul_f32 v105, -v64, v104
    v_mul_f32 v113, -v72, v112
    v_mov_b32 v106, v104
    v_mov_b32 v107, v105
    s_nop 0
    v_permlane16_swap_b32 v104, v106
    v_permlane16_swap_b32 v105, v107
    v_mov_b32 v108, v104
    v_mov_b32 v109, v105
    v_mov_b32 v110, v106
    v_mov_b32 v111, v107
    v_permlane32_swap_b32 v104, v108
    v_permlane32_swap_b32 v105, v109
    v_permlane32_swap_b32 v106, v110
    v_permlane32_swap_b32 v107, v111
    s_waitcnt vmcnt(0)
    s_cmp_eq_u32 s68, 1
    s_cselect_b32 s4, s2, 0
    s_sub_u32 s4, s4, 18
    s_cmp_lt_u32 s4, 36
    s_cbranch_scc0 L_nomod2
    s_mov_b32 s89, 0
    s_branch L_m2_chk
L_m2:
    s_nop 0
    buffer_load_dwordx2 v[224:225], v7, s[64:67], s22 offen sc1
    buffer_load_dwordx2 v[226:227], v7, s[64:67], s23 offen sc1
    s_add_u32 s89, s89, 1
    s_cmp_gt_u32 s89, 262144
    s_cbranch_scc1 L_m2_to
    s_waitcnt vmcnt(0)
L_m2_chk:
    v_xor_b32 v225, s3, v225
    v_xor_b32 v227, s3, v227
    v_or_b32 v225, v225, v227
    v_cmp_ne_u32 vcc, 0, v225
    s_nop 2
    s_cbranch_vccnz L_m2
    s_branch L_m2_ok
L_m2_to:
    s_waitcnt vmcnt(0)
L_m2_ok:
    v_add_f32 v224, v224, v226
    v_cvt_pk_bf16_f32 v224, v224, v224
    v_and_b32 v224, s90, v224
    v_add_f32 v225, 1.0, v224
    v_cvt_pk_bf16_f32 v225, v225, v225
    v_and_b32 v225, s90, v225
    s_sub_u32 s4, s2, 36
    s_cmp_lt_u32 s4, 9
    s_cselect_b64 vcc, -1, 0
    v_cndmask_b32 v224, v224, v225, vcc
    v_lshlrev_b32 v4, 2, v1
    s_lshl_b32 s4, s2, 8
    s_add_u32 s4, s4, 18874368
    s_nop 0
    buffer_store_dword v224, v4, s[64:67], s4 offen sc1
L_nomod2:
    s_mov_b32 s91, 157696
    s_lshl_b32 s52, s68, 10
    s_add_u32 s53, s52, 18939904
    s_add_u32 s54, s53, 4096
    s_cmp_eq_u32 s68, 0
    s_cselect_b32 s56, 8192, s52
    s_add_u32 s55, s56, 18939904
    s_add_u32 s57, s53, 27648
    s_add_u32 s58, s54, 27648
    s_add_u32 s59, s55, 27648
    buffer_load_dwordx4 v[80:83], v21, s[64:67], s53 offen sc1
    buffer_load_dwordx4 v[84:87], v21, s[64:67], s57 offen sc1
    buffer_load_dwordx4 v[88:91], v21, s[64:67], s54 offen sc1
    buffer_load_dwordx4 v[92:95], v21, s[64:67], s58 offen sc1
    buffer_load_dwordx4 v[96:99], v21, s[64:67], s55 offen sc1
    buffer_load_dwordx4 v[100:103], v21, s[64:67], s59 offen sc1
    s_lshr_b32 s56, s56, 1
    s_lshr_b32 s52, s52, 1
    v_lshlrev_b32 v5, 3, v1
    v_add_u32 v6, s56, v5
    v_add_u32_e64 v5, s52, v5
    v_add_u32 v7, 2048, v5
    s_and_b32 s52, s69, 7
    s_lshl_b32 s52, s52, 8
    v_mov_b32 v38, 2304
    v_cmp_le_u32 s[22:23], v38, v5
    s_nop 1
    s_nop 0
    v_cndmask_b32 v37, 0, v38, s[22:23]
    v_add_u32 v37, s52, v37
    v_cmp_lt_u32 vcc, v5, v37
    v_subrev_u32 v5, s52, v5
    s_nop 0
    v_cndmask_b32_e64 v36, 0, v38, vcc
    v_add3_u32 v5, v5, v36, s91
    v_cmp_le_u32 s[24:25], v38, v7
    s_nop 1
    s_nop 0
    v_cndmask_b32 v37, 0, v38, s[24:25]
    v_add_u32 v37, s52, v37
    v_cmp_lt_u32 vcc, v7, v37
    v_subrev_u32 v7, s52, v7
    s_nop 0
    v_cndmask_b32_e64 v36, 0, v38, vcc
    v_add3_u32 v7, v7, v36, s91
    v_cmp_le_u32 s[26:27], v38, v6
    s_nop 1
    s_nop 0
    v_cndmask_b32 v37, 0, v38, s[26:27]
    v_add_u32 v37, s52, v37
    v_cmp_lt_u32 vcc, v6, v37
    v_subrev_u32 v6, s52, v6
    s_nop 0
    v_cndmask_b32_e64 v36, 0, v38, vcc
    v_add3_u32 v6, v6, v36, s91
    s_mov_b32 s88, 0
L_pq:
    v_cmp_ne_u32 vcc, s3, v9
    s_nop 2
    s_cbranch_vccz L_pq_ok
    s_add_u32 s88, s88, 1
    s_cmp_gt_u32 s88, 262144
    s_cbranch_scc1 L_pq_ok
    buffer_load_dword v9, v8, s[64:67], 0 offen sc1
    s_waitcnt vmcnt(0)
    s_branch L_pq
L_pq_ok:
    s_add_u32 s4, s84, s95
    s_nop 0
    buffer_load_dwordx4 a[0:3], v10, s[64:67], s4 offen sc1
    buffer_load_dwordx4 a[72:75], v11, s[64:67], s4 offen sc1
    buffer_load_dwordx4 a[144:147], v12, s[64:67], s4 offen sc1
    buffer_load_dwordx4 a[216:219], v13, s[64:67], s4 offen sc1
    s_sub_u32 s5, 3, s68
    s_lshl_b32 s5, s5, 10
    v_add_u32_e64 v18, s5, v21
    v_add_u32 v19, 55296, v18
    s_mov_b64 exec, 0
    s_cmp_eq_u32 s68, 0
    s_cbranch_scc1 L_stub_9
    s_cmp_eq_u32 s68, 1
    s_cbranch_scc1 L_tchret_m1_m2
    s_cmp_eq_u32 s68, 2
    s_cbranch_scc1 L_tchret_m1_m2
    s_branch L_tchret_m1_m2
L_tchret_m1_m2:
    s_mov_b64 exec, -1
    s_waitcnt vmcnt(4)
    s_mov_b32 s89, 0
    s_branch L_pm_chk
L_pm:
    buffer_load_dwordx4 v[80:83], v21, s[64:67], s53 offen sc1
    buffer_load_dwordx4 v[84:87], v21, s[64:67], s57 offen sc1
    buffer_load_dwordx4 v[88:91], v21, s[64:67], s54 offen sc1
    buffer_load_dwordx4 v[92:95], v21, s[64:67], s58 offen sc1
    buffer_load_dwordx4 v[96:99], v21, s[64:67], s55 offen sc1
    buffer_load_dwordx4 v[100:103], v21, s[64:67], s59 offen sc1
    s_add_u32 s89, s89, 1
    s_cmp_gt_u32 s89, 262144
    s_cbranch_scc1 L_pm_done
    s_waitcnt vmcnt(0)
L_pm_chk:
    v_xor_b32 v81, s3, v81
    v_xor_b32 v83, s3, v83
    v_xor_b32 v85, s3, v85
    v_xor_b32 v87, s3, v87
    v_xor_b32 v89, s3, v89
    v_xor_b32 v91, s3, v91
    v_xor_b32 v93, s3, v93
    v_xor_b32 v95, s3, v95
    v_xor_b32 v97, s3, v97
    v_xor_b32 v99, s3, v99
    v_xor_b32 v101, s3, v101
    v_xor_b32_e64 v103, s3, v103
    v_or3_b32 v81, v81, v83, v85
    v_or3_b32 v89, v89, v91, v93
    v_or3_b32 v97, v97, v99, v101
    v_or3_b32 v81, v81, v87, v89
    v_or3_b32 v97, v97, v103, v95
    v_or_b32 v81, v81, v97
    v_cmp_ne_u32 vcc, 0, v81
    s_nop 2
    s_cbranch_vccnz L_pm
    s_branch L_pm_ok
L_pm_done:
    s_waitcnt vmcnt(0)
L_pm_ok:
    v_add_f32 v80, v80, v84
    v_add_f32 v82, v82, v86
    v_add_f32 v88, v88, v92
    v_add_f32 v90, v90, v94
    v_add_f32 v96, v96, v100
    v_add_f32 v98, v98, v102
    v_cvt_pk_bf16_f32 v81, v80, v82
    v_cvt_pk_bf16_f32 v89, v88, v90
    v_cvt_pk_bf16_f32 v97, v96, v98
    v_lshlrev_b32 v80, 16, v81
    v_and_b32 v82, s90, v81
    v_lshlrev_b32 v88, 16, v89
    v_and_b32 v90, s90, v89
    v_lshlrev_b32 v96, 16, v97
    v_and_b32 v98, s90, v97
    v_add_f32 v84, 1.0, v80
    v_add_f32 v86, 1.0, v82
    v_add_f32 v92, 1.0, v88
    v_add_f32 v94, 1.0, v90
    v_add_f32 v100, 1.0, v96
    v_add_f32 v102, 1.0, v98
    v_cvt_pk_bf16_f32 v81, v84, v86
    v_cvt_pk_bf16_f32 v89, v92, v94
    v_cvt_pk_bf16_f32 v97, v100, v102
    v_lshlrev_b32 v84, 16, v81
    v_and_b32 v86, s90, v81
    v_lshlrev_b32 v92, 16, v89
    v_and_b32 v94, s90, v89
    v_lshlrev_b32 v100, 16, v97
    v_and_b32 v102, s90, v97
    v_cndmask_b32 v80, v80, v84, s[22:23]
    v_cndmask_b32 v82, v82, v86, s[22:23]
    v_cndmask_b32 v88, v88, v92, s[24:25]
    v_cndmask_b32 v90, v90, v94, s[24:25]
    v_cndmask_b32 v96, v96, v100, s[26:27]
    v_cndmask_b32 v98, v98, v102, s[26:27]
    ds_write2_b32 v5, v80, v82 offset1:1
    ds_write2_b32 v7, v88, v90 offset1:1
    ds_write2_b32 v6, v96, v98 offset1:1
    s_add_u32 s95, s95, 14336
    s_cmp_eq_u32 s95, 258048
    s_cselect_b32 s95, 0, s95
    s_add_u32 s4, s84, s95
    buffer_load_dwordx4 a[4:7], v10, s[64:67], s4 offen sc1
    buffer_load_dwordx4 a[76:79], v11, s[64:67], s4 offen sc1
    buffer_load_dwordx4 a[148:151], v12, s[64:67], s4 offen sc1
    buffer_load_dwordx4 a[220:223], v13, s[64:67], s4 offen sc1
    s_waitcnt lgkmcnt(0)
    s_barrier
    ds_read_b128 v[24:27], v23 offset:2304
    ds_read_b128 v[28:31], v23 offset:2320
    ds_read_b128 v[32:35], v23 offset:0
    ds_read_b128 v[36:39], v23 offset:16
    ds_read_b128 v[40:43], v23 offset:2816
    ds_read_b128 v[44:47], v23 offset:2832
    ds_read_b128 v[48:51], v23 offset:512
    ds_read_b128 v[52:55], v23 offset:528
    v_lshlrev_b32 v56, 16, v124
    v_and_b32 v57, s90, v124
    v_lshlrev_b32 v58, 16, v125
    v_and_b32 v59, s90, v125
    v_lshlrev_b32 v60, 16, v126
    v_and_b32 v61, s90, v126
    v_lshlrev_b32 v62, 16, v127
    v_and_b32 v63, s90, v127
    s_add_u32 s95, s95, 14336
    s_cmp_eq_u32 s95, 258048
    s_cselect_b32 s95, 0, s95
    s_add_u32 s4, s84, s95
    buffer_load_dwordx4 a[8:11], v10, s[64:67], s4 offen sc1
    buffer_load_dwordx4 a[80:83], v11, s[64:67], s4 offen sc1
    v_pk_fma_f32 v[56:57], v[56:57], v[104:105], v[104:105] op_sel:[0,0,1] op_sel_hi:[1,0,1]
    v_pk_fma_f32 v[58:59], v[58:59], v[104:105], v[104:105] op_sel:[0,0,1] op_sel_hi:[1,0,1]
    v_pk_fma_f32 v[60:61], v[60:61], v[104:105], v[104:105] op_sel:[0,0,1] op_sel_hi:[1,0,1]
    v_pk_fma_f32 v[62:63], v[62:63], v[104:105], v[104:105] op_sel:[0,0,1] op_sel_hi:[1,0,1]
    s_waitcnt lgkmcnt(4)
    s_nop 0
    v_pk_fma_f32 v[56:57], v[56:57], v[24:25], v[32:33]
    v_pk_fma_f32 v[58:59], v[58:59], v[26:27], v[34:35]
    v_pk_fma_f32 v[60:61], v[60:61], v[28:29], v[36:37]
    v_pk_fma_f32 v[62:63], v[62:63], v[30:31], v[38:39]
    v_cvt_pk_bf16_f32 v72, v56, v57
    v_cvt_pk_bf16_f32 v73, v58, v59
    v_cvt_pk_bf16_f32 v74, v60, v61
    v_cvt_pk_bf16_f32 v75, v62, v63
    ds_write_b128 v18, v[72:75] offset:0
    v_lshlrev_b32 v64, 16, v144
    v_and_b32 v65, s90, v144
    v_lshlrev_b32 v66, 16, v145
    v_and_b32 v67, s90, v145
    v_lshlrev_b32 v68, 16, v146
    v_and_b32 v69, s90, v146
    v_lshlrev_b32 v70, 16, v147
    v_and_b32 v71, s90, v147
    buffer_load_dwordx4 a[152:155], v12, s[64:67], s4 offen sc1
    buffer_load_dwordx4 a[224:227], v13, s[64:67], s4 offen sc1
    v_pk_fma_f32 v[64:65], v[64:65], v[106:107], v[106:107] op_sel:[0,0,1] op_sel_hi:[1,0,1]
    v_pk_fma_f32 v[66:67], v[66:67], v[106:107], v[106:107] op_sel:[0,0,1] op_sel_hi:[1,0,1]
    v_pk_fma_f32 v[68:69], v[68:69], v[106:107], v[106:107] op_sel:[0,0,1] op_sel_hi:[1,0,1]
    v_pk_fma_f32 v[70:71], v[70:71], v[106:107], v[106:107] op_sel:[0,0,1] op_sel_hi:[1,0,1]
    v_pk_fma_f32 v[64:65], v[64:65], v[24:25], v[32:33]
    v_pk_fma_f32 v[66:67], v[66:67], v[26:27], v[34:35]
    v_pk_fma_f32 v[68:69], v[68:69], v[28:29], v[36:37]
    v_pk_fma_f32 v[70:71], v[70:71], v[30:31], v[38:39]
    v_cvt_pk_bf16_f32 v76, v64, v65
    v_cvt_pk_bf16_f32 v77, v66, v67
    v_cvt_pk_bf16_f32 v78, v68, v69
    v_cvt_pk_bf16_f32 v79, v70, v71
    ds_write_b128 v18, v[76:79] offset:18432
    v_lshlrev_b32 v56, 16, v164
    v_and_b32 v57, s90, v164
    v_lshlrev_b32 v58, 16, v165
    v_and_b32 v59, s90, v165
    v_lshlrev_b32 v60, 16, v166
    v_and_b32 v61, s90, v166
    v_lshlrev_b32 v62, 16, v167
    v_and_b32 v63, s90, v167
    s_add_u32 s95, s95, 14336
    s_cmp_eq_u32 s95, 258048
    s_cselect_b32 s95, 0, s95
    s_add_u32 s4, s84, s95
    buffer_load_dwordx4 a[12:15], v10, s[64:67], s4 offen sc1
    buffer_load_dwordx4 a[84:87], v11, s[64:67], s4 offen sc1
    v_pk_fma_f32 v[56:57], v[56:57], v[108:109], v[108:109] op_sel:[0,0,1] op_sel_hi:[1,0,1]
    v_pk_fma_f32 v[58:59], v[58:59], v[108:109], v[108:109] op_sel:[0,0,1] op_sel_hi:[1,0,1]
    v_pk_fma_f32 v[60:61], v[60:61], v[108:109], v[108:109] op_sel:[0,0,1] op_sel_hi:[1,0,1]
    v_pk_fma_f32 v[62:63], v[62:63], v[108:109], v[108:109] op_sel:[0,0,1] op_sel_hi:[1,0,1]
    v_pk_fma_f32 v[56:57], v[56:57], v[24:25], v[32:33]
    v_pk_fma_f32 v[58:59], v[58:59], v[26:27], v[34:35]
    v_pk_fma_f32 v[60:61], v[60:61], v[28:29], v[36:37]
    v_pk_fma_f32 v[62:63], v[62:63], v[30:31], v[38:39]
    v_cvt_pk_bf16_f32 v72, v56, v57
    v_cvt_pk_bf16_f32 v73, v58, v59
    v_cvt_pk_bf16_f32 v74, v60, v61
    v_cvt_pk_bf16_f32 v75, v62, v63
    ds_write_b128 v18, v[72:75] offset:36864
    v_lshlrev_b32 v64, 16, v184
    v_and_b32 v65, s90, v184
    v_lshlrev_b32 v66, 16, v185
    v_and_b32 v67, s90, v185
    v_lshlrev_b32 v68, 16, v186
    v_and_b32 v69, s90, v186
    v_lshlrev_b32 v70, 16, v187
    v_and_b32 v71, s90, v187
    buffer_load_dwordx4 a[156:159], v12, s[64:67], s4 offen sc1
    buffer_load_dwordx4 a[228:231], v13, s[64:67], s4 offen sc1
    v_pk_fma_f32 v[64:65], v[64:65], v[110:111], v[110:111] op_sel:[0,0,1] op_sel_hi:[1,0,1]
    v_pk_fma_f32 v[66:67], v[66:67], v[110:111], v[110:111] op_sel:[0,0,1] op_sel_hi:[1,0,1]
    v_pk_fma_f32 v[68:69], v[68:69], v[110:111], v[110:111] op_sel:[0,0,1] op_sel_hi:[1,0,1]
    v_pk_fma_f32 v[70:71], v[70:71], v[110:111], v[110:111] op_sel:[0,0,1] op_sel_hi:[1,0,1]
    v_pk_fma_f32 v[64:65], v[64:65], v[24:25], v[32:33]
    v_pk_fma_f32 v[66:67], v[66:67], v[26:27], v[34:35]
    v_pk_fma_f32 v[68:69], v[68:69], v[28:29], v[36:37]
    v_pk_fma_f32 v[70:71], v[70:71], v[30:31], v[38:39]
    v_cvt_pk_bf16_f32 v76, v64, v65
    v_cvt_pk_bf16_f32 v77, v66, v67
    v_cvt_pk_bf16_f32 v78, v68, v69
    v_cvt_pk_bf16_f32 v79, v70, v71
    ds_write_b128 v19, v[76:79] offset:0
    v_lshlrev_b32 v56, 16, v204
    v_and_b32 v57, s90, v204
    v_lshlrev_b32 v58, 16, v205
    v_and_b32 v59, s90, v205
    v_lshlrev_b32 v60, 16, v206
    v_and_b32 v61, s90, v206
    v_lshlrev_b32 v62, 16, v207
    v_and_b32 v63, s90, v207
    s_add_u32 s95, s95, 14336
    s_cmp_eq_u32 s95, 258048
    s_cselect_b32 s95, 0, s95
    s_add_u32 s4, s84, s95
    buffer_load_dwordx4 a[16:19], v10, s[64:67], s4 offen sc1
    buffer_load_dwordx4 a[88:91], v11, s[64:67], s4 offen sc1
    v_pk_fma_f32 v[56:57], v[56:57], v[112:113], v[112:113] op_sel:[0,0,1] op_sel_hi:[1,0,1]
    v_pk_fma_f32 v[58:59], v[58:59], v[112:113], v[112:113] op_sel:[0,0,1] op_sel_hi:[1,0,1]
    v_pk_fma_f32 v[60:61], v[60:61], v[112:113], v[112:113] op_sel:[0,0,1] op_sel_hi:[1,0,1]
    v_pk_fma_f32 v[62:63], v[62:63], v[112:113], v[112:113] op_sel:[0,0,1] op_sel_hi:[1,0,1]
    v_pk_fma_f32 v[56:57], v[56:57], v[24:25], v[32:33]
    v_pk_fma_f32 v[58:59], v[58:59], v[26:27], v[34:35]
    v_pk_fma_f32 v[60:61], v[60:61], v[28:29], v[36:37]
    v_pk_fma_f32 v[62:63], v[62:63], v[30:31], v[38:39]
    v_cvt_pk_bf16_f32 v72, v56, v57
    v_cvt_pk_bf16_f32 v73, v58, v59
    v_cvt_pk_bf16_f32 v74, v60, v61
    v_cvt_pk_bf16_f32 v75, v62, v63
    ds_write_b128 v19, v[72:75] offset:18432
    ds_read_b128 v[24:27], v23 offset:3328
    ds_read_b128 v[28:31], v23 offset:3344
    ds_read_b128 v[32:35], v23 offset:1024
    ds_read_b128 v[36:39], v23 offset:1040
    v_lshlrev_b32 v64, 16, v128
    v_and_b32 v65, s90, v128
    v_lshlrev_b32 v66, 16, v129
    v_and_b32 v67, s90, v129
    v_lshlrev_b32 v68, 16, v130
    v_and_b32 v69, s90, v130
    v_lshlrev_b32 v70, 16, v131
    v_and_b32 v71, s90, v131
    buffer_load_dwordx4 a[160:163], v12, s[64:67], s4 offen sc1
    buffer_load_dwordx4 a[232:235], v13, s[64:67], s4 offen sc1
    v_pk_fma_f32 v[64:65], v[64:65], v[104:105], v[104:105] op_sel:[0,0,1] op_sel_hi:[1,0,1]
    v_pk_fma_f32 v[66:67], v[66:67], v[104:105], v[104:105] op_sel:[0,0,1] op_sel_hi:[1,0,1]
    v_pk_fma_f32 v[68:69], v[68:69], v[104:105], v[104:105] op_sel:[0,0,1] op_sel_hi:[1,0,1]
    v_pk_fma_f32 v[70:71], v[70:71], v[104:105], v[104:105] op_sel:[0,0,1] op_sel_hi:[1,0,1]
    s_waitcnt lgkmcnt(9)
    s_nop 0
    v_pk_fma_f32 v[64:65], v[64:65], v[40:41], v[48:49]
    v_pk_fma_f32 v[66:67], v[66:67], v[42:43], v[50:51]
    v_pk_fma_f32 v[68:69], v[68:69], v[44:45], v[52:53]
    v_pk_fma_f32 v[70:71], v[70:71], v[46:47], v[54:55]
    v_cvt_pk_bf16_f32 v76, v64, v65
    v_cvt_pk_bf16_f32 v77, v66, v67
    v_cvt_pk_bf16_f32 v78, v68, v69
    v_cvt_pk_bf16_f32 v79, v70, v71
    ds_write_b128 v18, v[76:79] offset:4096
    v_lshlrev_b32 v56, 16, v148
    v_and_b32 v57, s90, v148
    v_lshlrev_b32 v58, 16, v149
    v_and_b32 v59, s90, v149
    v_lshlrev_b32 v60, 16, v150
    v_and_b32 v61, s90, v150
    v_lshlrev_b32 v62, 16, v151
    v_and_b32 v63, s90, v151
    s_add_u32 s95, s95, 14336
    s_cmp_eq_u32 s95, 258048
    s_cselect_b32 s95, 0, s95
    s_add_u32 s4, s84, s95
    buffer_load_dwordx4 a[20:23], v10, s[64:67], s4 offen sc1
    buffer_load_dwordx4 a[92:95], v11, s[64:67], s4 offen sc1
    v_pk_fma_f32 v[56:57], v[56:57], v[106:107], v[106:107] op_sel:[0,0,1] op_sel_hi:[1,0,1]
    v_pk_fma_f32 v[58:59], v[58:59], v[106:107], v[106:107] op_sel:[0,0,1] op_sel_hi:[1,0,1]
    v_pk_fma_f32 v[60:61], v[60:61], v[106:107], v[106:107] op_sel:[0,0,1] op_sel_hi:[1,0,1]
    v_pk_fma_f32 v[62:63], v[62:63], v[106:107], v[106:107] op_sel:[0,0,1] op_sel_hi:[1,0,1]
    v_pk_fma_f32 v[56:57], v[56:57], v[40:41], v[48:49]
    v_pk_fma_f32 v[58:59], v[58:59], v[42:43], v[50:51]
    v_pk_fma_f32 v[60:61], v[60:61], v[44:45], v[52:53]
    v_pk_fma_f32 v[62:63], v[62:63], v[46:47], v[54:55]
    v_cvt_pk_bf16_f32 v72, v56, v57
    v_cvt_pk_bf16_f32 v73, v58, v59
    v_cvt_pk_bf16_f32 v74, v60, v61
    v_cvt_pk_bf16_f32 v75, v62, v63
    ds_write_b128 v18, v[72:75] offset:22528
    v_lshlrev_b32 v64, 16, v168
    v_and_b32 v65, s90, v168
    v_lshlrev_b32 v66, 16, v169
    v_and_b32 v67, s90, v169
    v_lshlrev_b32 v68, 16, v170
    v_and_b32 v69, s90, v170
    v_lshlrev_b32 v70, 16, v171
    v_and_b32 v71, s90, v171
    buffer_load_dwordx4 a[164:167], v12, s[64:67], s4 offen sc1
    buffer_load_dwordx4 a[236:239], v13, s[64:67], s4 offen sc1
    v_pk_fma_f32 v[64:65], v[64:65], v[108:109], v[108:109] op_sel:[0,0,1] op_sel_hi:[1,0,1]
    v_pk_fma_f32 v[66:67], v[66:67], v[108:109], v[108:109] op_sel:[0,0,1] op_sel_hi:[1,0,1]
    v_pk_fma_f32 v[68:69], v[68:69], v[108:109], v[108:109] op_sel:[0,0,1] op_sel_hi:[1,0,1]
L_stub_1:
    s_cbranch_execz L_stub_5
    s_nop 0
    v_pk_fma_f32 v[70:71], v[70:71], v[108:109], v[108:109] op_sel:[0,0,1] op_sel_hi:[1,0,1]
    v_pk_fma_f32 v[64:65], v[64:65], v[40:41], v[48:49]
    v_pk_fma_f32 v[66:67], v[66:67], v[42:43], v[50:51]
    v_pk_fma_f32 v[68:69], v[68:69], v[44:45], v[52:53]
    v_pk_fma_f32 v[70:71], v[70:71], v[46:47], v[54:55]
    v_cvt_pk_bf16_f32 v76, v64, v65
    v_cvt_pk_bf16_f32 v77, v66, v67
    v_cvt_pk_bf16_f32 v78, v68, v69
    v_cvt_pk_bf16_f32 v79, v70, v71
    ds_write_b128 v18, v[76:79] offset:40960
    v_lshlrev_b32 v56, 16, v188
    v_and_b32 v57, s90, v188
    v_lshlrev_b32 v58, 16, v189
    v_and_b32 v59, s90, v189
    v_lshlrev_b32 v60, 16, v190
    v_and_b32 v61, s90, v190
    v_lshlrev_b32 v62, 16, v191
    v_and_b32 v63, s90, v191
    s_add_u32 s95, s95, 14336
    s_cmp_eq_u32 s95, 258048
    s_cselect_b32 s95, 0, s95
    s_add_u32 s4, s84, s95
    buffer_load_dwordx4 a[24:27], v10, s[64:67], s4 offen sc1
    v_pk_fma_f32 v[56:57], v[56:57], v[110:111], v[110:111] op_sel:[0,0,1] op_sel_hi:[1,0,1]
    v_pk_fma_f32 v[58:59], v[58:59], v[110:111], v[110:111] op_sel:[0,0,1] op_sel_hi:[1,0,1]
    v_pk_fma_f32 v[60:61], v[60:61], v[110:111], v[110:111] op_sel:[0,0,1] op_sel_hi:[1,0,1]
    v_pk_fma_f32 v[62:63], v[62:63], v[110:111], v[110:111] op_sel:[0,0,1] op_sel_hi:[1,0,1]
    v_pk_fma_f32 v[56:57], v[56:57], v[40:41], v[48:49]
    v_pk_fma_f32 v[58:59], v[58:59], v[42:43], v[50:51]
    v_pk_fma_f32 v[60:61], v[60:61], v[44:45], v[52:53]
    v_pk_fma_f32 v[62:63], v[62:63], v[46:47], v[54:55]
    v_cvt_pk_bf16_f32 v72, v56, v57
    v_cvt_pk_bf16_f32 v73, v58, v59
    v_cvt_pk_bf16_f32 v74, v60, v61
    v_cvt_pk_bf16_f32 v75, v62, v63
    ds_write_b128 v19, v[72:75] offset:4096
    v_lshlrev_b32 v64, 16, v208
    v_and_b32 v65, s90, v208
    v_lshlrev_b32 v66, 16, v209
    v_and_b32 v67, s90, v209
    v_lshlrev_b32 v68, 16, v210
    v_and_b32 v69, s90, v210
    v_lshlrev_b32 v70, 16, v211
    v_and_b32 v71, s90, v211
    buffer_load_dwordx4 a[96:99], v11, s[64:67], s4 offen sc1
    v_pk_fma_f32 v[64:65], v[64:65], v[112:113], v[112:113] op_sel:[0,0,1] op_sel_hi:[1,0,1]
    v_pk_fma_f32 v[66:67], v[66:67], v[112:113], v[112:113] op_sel:[0,0,1] op_sel_hi:[1,0,1]
    v_pk_fma_f32 v[68:69], v[68:69], v[112:113], v[112:113] op_sel:[0,0,1] op_sel_hi:[1,0,1]
    v_pk_fma_f32 v[70:71], v[70:71], v[112:113], v[112:113] op_sel:[0,0,1] op_sel_hi:[1,0,1]
    v_pk_fma_f32 v[64:65], v[64:65], v[40:41], v[48:49]
    v_pk_fma_f32 v[66:67], v[66:67], v[42:43], v[50:51]
    v_pk_fma_f32 v[68:69], v[68:69], v[44:45], v[52:53]
    v_pk_fma_f32 v[70:71], v[70:71], v[46:47], v[54:55]
    v_cvt_pk_bf16_f32 v76, v64, v65
    v_cvt_pk_bf16_f32 v77, v66, v67
    v_cvt_pk_bf16_f32 v78, v68, v69
    v_cvt_pk_bf16_f32 v79, v70, v71
    ds_write_b128 v19, v[76:79] offset:22528
    ds_read_b128 v[40:43], v23 offset:3840
    ds_read_b128 v[44:47], v23 offset:3856
    ds_read_b128 v[48:51], v23 offset:1536
    ds_read_b128 v[52:55], v23 offset:1552
    v_lshlrev_b32 v56, 16, v132
    v_and_b32 v57, s90, v132
    v_lshlrev_b32 v58, 16, v133
    v_and_b32 v59, s90, v133
    v_lshlrev_b32 v60, 16, v134
    v_and_b32 v61, s90, v134
    v_lshlrev_b32 v62, 16, v135
    v_and_b32 v63, s90, v135
    buffer_load_dwordx4 a[168:171], v12, s[64:67], s4 offen sc1
    v_pk_fma_f32 v[56:57], v[56:57], v[104:105], v[104:105] op_sel:[0,0,1] op_sel_hi:[1,0,1]
    v_pk_fma_f32 v[58:59], v[58:59], v[104:105], v[104:105] op_sel:[0,0,1] op_sel_hi:[1,0,1]
    v_pk_fma_f32 v[60:61], v[60:61], v[104:105], v[104:105] op_sel:[0,0,1] op_sel_hi:[1,0,1]
    v_pk_fma_f32 v[62:63], v[62:63], v[104:105], v[104:105] op_sel:[0,0,1] op_sel_hi:[1,0,1]
    s_waitcnt lgkmcnt(9)
    s_nop 0
    v_pk_fma_f32 v[56:57], v[56:57], v[24:25], v[32:33]
    v_pk_fma_f32 v[58:59], v[58:59], v[26:27], v[34:35]
    v_pk_fma_f32 v[60:61], v[60:61], v[28:29], v[36:37]
    v_pk_fma_f32 v[62:63], v[62:63], v[30:31], v[38:39]
    v_cvt_pk_bf16_f32 v72, v56, v57
    v_cvt_pk_bf16_f32 v73, v58, v59
    v_cvt_pk_bf16_f32 v74, v60, v61
    v_cvt_pk_bf16_f32 v75, v62, v63
    ds_write_b128 v18, v[72:75] offset:8192
    v_lshlrev_b32 v64, 16, v152
    v_and_b32 v65, s90, v152
    v_lshlrev_b32 v66, 16, v153
    v_and_b32 v67, s90, v153
    v_lshlrev_b32 v68, 16, v154
    v_and_b32 v69, s90, v154
    v_lshlrev_b32 v70, 16, v155
    v_and_b32 v71, s90, v155
    buffer_load_dwordx4 a[240:243], v13, s[64:67], s4 offen sc1
    v_pk_fma_f32 v[64:65], v[64:65], v[106:107], v[106:107] op_sel:[0,0,1] op_sel_hi:[1,0,1]
    v_pk_fma_f32 v[66:67], v[66:67], v[106:107], v[106:107] op_sel:[0,0,1] op_sel_hi:[1,0,1]
    v_pk_fma_f32 v[68:69], v[68:69], v[106:107], v[106:107] op_sel:[0,0,1] op_sel_hi:[1,0,1]
    v_pk_fma_f32 v[70:71], v[70:71], v[106:107], v[106:107] op_sel:[0,0,1] op_sel_hi:[1,0,1]
    v_pk_fma_f32 v[64:65], v[64:65], v[24:25], v[32:33]
    v_pk_fma_f32 v[66:67], v[66:67], v[26:27], v[34:35]
    v_pk_fma_f32 v[68:69], v[68:69], v[28:29], v[36:37]
    v_pk_fma_f32 v[70:71], v[70:71], v[30:31], v[38:39]
    v_cvt_pk_bf16_f32 v76, v64, v65
    v_cvt_pk_bf16_f32 v77, v66, v67
    v_cvt_pk_bf16_f32 v78, v68, v69
    v_cvt_pk_bf16_f32 v79, v70, v71
    ds_write_b128 v18, v[76:79] offset:26624
    v_lshlrev_b32 v56, 16, v172
    v_and_b32 v57, s90, v172
    v_lshlrev_b32 v58, 16, v173
    v_and_b32 v59, s90, v173
    v_lshlrev_b32 v60, 16, v174
    v_and_b32 v61, s90, v174
    v_lshlrev_b32 v62, 16, v175
    v_and_b32 v63, s90, v175
    s_add_u32 s95, s95, 14336
    s_cmp_eq_u32 s95, 258048
    s_cselect_b32 s95, 0, s95
    s_add_u32 s4, s84, s95
    buffer_load_dwordx4 a[28:31], v10, s[64:67], s4 offen sc1
    v_pk_fma_f32 v[56:57], v[56:57], v[108:109], v[108:109] op_sel:[0,0,1] op_sel_hi:[1,0,1]
    v_pk_fma_f32 v[58:59], v[58:59], v[108:109], v[108:109] op_sel:[0,0,1] op_sel_hi:[1,0,1]
    v_pk_fma_f32 v[60:61], v[60:61], v[108:109], v[108:109] op_sel:[0,0,1] op_sel_hi:[1,0,1]
    v_pk_fma_f32 v[62:63], v[62:63], v[108:109], v[108:109] op_sel:[0,0,1] op_sel_hi:[1,0,1]
    v_pk_fma_f32 v[56:57], v[56:57], v[24:25], v[32:33]
    v_pk_fma_f32 v[58:59], v[58:59], v[26:27], v[34:35]
    v_pk_fma_f32 v[60:61], v[60:61], v[28:29], v[36:37]
    v_pk_fma_f32 v[62:63], v[62:63], v[30:31], v[38:39]
    v_cvt_pk_bf16_f32 v72, v56, v57
    v_cvt_pk_bf16_f32 v73, v58, v59
    v_cvt_pk_bf16_f32 v74, v60, v61
    v_cvt_pk_bf16_f32 v75, v62, v63
    ds_write_b128 v18, v[72:75] offset:45056
    v_lshlrev_b32 v64, 16, v192
    v_and_b32 v65, s90, v192
    v_lshlrev_b32 v66, 16, v193
    v_and_b32 v67, s90, v193
    v_lshlrev_b32 v68, 16, v194
    v_and_b32 v69, s90, v194
    v_lshlrev_b32 v70, 16, v195
    v_and_b32 v71, s90, v195
    buffer_load_dwordx4 a[100:103], v11, s[64:67], s4 offen sc1
    v_pk_fma_f32 v[64:65], v[64:65], v[110:111], v[110:111] op_sel:[0,0,1] op_sel_hi:[1,0,1]
    v_pk_fma_f32 v[66:67], v[66:67], v[110:111], v[110:111] op_sel:[0,0,1] op_sel_hi:[1,0,1]
    v_pk_fma_f32 v[68:69], v[68:69], v[110:111], v[110:111] op_sel:[0,0,1] op_sel_hi:[1,0,1]
    v_pk_fma_f32 v[70:71], v[70:71], v[110:111], v[110:111] op_sel:[0,0,1] op_sel_hi:[1,0,1]
    v_pk_fma_f32 v[64:65], v[64:65], v[24:25], v[32:33]
    v_pk_fma_f32 v[66:67], v[66:67], v[26:27], v[34:35]
    v_pk_fma_f32 v[68:69], v[68:69], v[28:29], v[36:37]
    v_pk_fma_f32 v[70:71], v[70:71], v[30:31], v[38:39]
    v_cvt_pk_bf16_f32 v76, v64, v65
    v_cvt_pk_bf16_f32 v77, v66, v67
    v_cvt_pk_bf16_f32 v78, v68, v69
    v_cvt_pk_bf16_f32 v79, v70, v71
    ds_write_b128 v19, v[76:79] offset:8192
    v_lshlrev_b32 v56, 16, v212
    v_and_b32 v57, s90, v212
    v_lshlrev_b32 v58, 16, v213
    v_and_b32 v59, s90, v213
    v_lshlrev_b32 v60, 16, v214
    v_and_b32 v61, s90, v214
    v_lshlrev_b32 v62, 16, v215
    v_and_b32 v63, s90, v215
    buffer_load_dwordx4 a[172:175], v12, s[64:67], s4 offen sc1
    v_pk_fma_f32 v[56:57], v[56:57], v[112:113], v[112:113] op_sel:[0,0,1] op_sel_hi:[1,0,1]
    v_pk_fma_f32 v[58:59], v[58:59], v[112:113], v[112:113] op_sel:[0,0,1] op_sel_hi:[1,0,1]
    v_pk_fma_f32 v[60:61], v[60:61], v[112:113], v[112:113] op_sel:[0,0,1] op_sel_hi:[1,0,1]
    v_pk_fma_f32 v[62:63], v[62:63], v[112:113], v[112:113] op_sel:[0,0,1] op_sel_hi:[1,0,1]
    v_pk_fma_f32 v[56:57], v[56:57], v[24:25], v[32:33]
    v_pk_fma_f32 v[58:59], v[58:59], v[26:27], v[34:35]
    v_pk_fma_f32 v[60:61], v[60:61], v[28:29], v[36:37]
    v_pk_fma_f32 v[62:63], v[62:63], v[30:31], v[38:39]
    v_cvt_pk_bf16_f32 v72, v56, v57
    v_cvt_pk_bf16_f32 v73, v58, v59
    v_cvt_pk_bf16_f32 v74, v60, v61
    v_cvt_pk_bf16_f32 v75, v62, v63
    ds_write_b128 v19, v[72:75] offset:26624
    ds_read_b128 v[24:27], v23 offset:4352
    ds_read_b128 v[28:31], v23 offset:4368
    ds_read_b128 v[32:35], v23 offset:2048
    ds_read_b128 v[36:39], v23 offset:2064
    v_lshlrev_b32 v64, 16, v136
    v_and_b32 v65, s90, v136
    v_lshlrev_b32 v66, 16, v137
    v_and_b32 v67, s90, v137
    v_lshlrev_b32 v68, 16, v138
    v_and_b32 v69, s90, v138
    v_lshlrev_b32 v70, 16, v139
    v_and_b32 v71, s90, v139
    buffer_load_dwordx4 a[244:247], v13, s[64:67], s4 offen sc1
    v_pk_fma_f32 v[64:65], v[64:65], v[104:105], v[104:105] op_sel:[0,0,1] op_sel_hi:[1,0,1]
    v_pk_fma_f32 v[66:67], v[66:67], v[104:105], v[104:105] op_sel:[0,0,1] op_sel_hi:[1,0,1]
    v_pk_fma_f32 v[68:69], v[68:69], v[104:105], v[104:105] op_sel:[0,0,1] op_sel_hi:[1,0,1]
    v_pk_fma_f32 v[70:71], v[70:71], v[104:105], v[104:105] op_sel:[0,0,1] op_sel_hi:[1,0,1]
    s_waitcnt lgkmcnt(9)
    s_nop 0
    v_pk_fma_f32 v[64:65], v[64:65], v[40:41], v[48:49]
    v_pk_fma_f32 v[66:67], v[66:67], v[42:43], v[50:51]
    v_pk_fma_f32 v[68:69], v[68:69], v[44:45], v[52:53]
    v_pk_fma_f32 v[70:71], v[70:71], v[46:47], v[54:55]
    v_cvt_pk_bf16_f32 v76, v64, v65
    v_cvt_pk_bf16_f32 v77, v66, v67
    v_cvt_pk_bf16_f32 v78, v68, v69
    v_cvt_pk_bf16_f32 v79, v70, v71
    ds_write_b128 v18, v[76:79] offset:12288
    v_lshlrev_b32 v56, 16, v156
    v_and_b32 v57, s90, v156
    v_lshlrev_b32 v58, 16, v157
    v_and_b32 v59, s90, v157
    v_lshlrev_b32 v60, 16, v158
    v_and_b32 v61, s90, v158
    v_lshlrev_b32 v62, 16, v159
    v_and_b32 v63, s90, v159
    s_add_u32 s95, s95, 14336
    s_cmp_eq_u32 s95, 258048
    s_cselect_b32 s95, 0, s95
    s_add_u32 s4, s84, s95
    buffer_load_dwordx4 a[32:35], v10, s[64:67], s4 offen sc1
    v_pk_fma_f32 v[56:57], v[56:57], v[106:107], v[106:107] op_sel:[0,0,1] op_sel_hi:[1,0,1]
    v_pk_fma_f32 v[58:59], v[58:59], v[106:107], v[106:107] op_sel:[0,0,1] op_sel_hi:[1,0,1]
    v_pk_fma_f32 v[60:61], v[60:61], v[106:107], v[106:107] op_sel:[0,0,1] op_sel_hi:[1,0,1]
    v_pk_fma_f32 v[62:63], v[62:63], v[106:107], v[106:107] op_sel:[0,0,1] op_sel_hi:[1,0,1]
    v_pk_fma_f32 v[56:57], v[56:57], v[40:41], v[48:49]
    v_pk_fma_f32 v[58:59], v[58:59], v[42:43], v[50:51]
    v_pk_fma_f32 v[60:61], v[60:61], v[44:45], v[52:53]
    v_pk_fma_f32 v[62:63], v[62:63], v[46:47], v[54:55]
    v_cvt_pk_bf16_f32 v72, v56, v57
    v_cvt_pk_bf16_f32 v73, v58, v59
    v_cvt_pk_bf16_f32 v74, v60, v61
    v_cvt_pk_bf16_f32 v75, v62, v63
    ds_write_b128 v18, v[72:75] offset:30720
    v_lshlrev_b32 v64, 16, v176
    v_and_b32 v65, s90, v176
    v_lshlrev_b32 v66, 16, v177
    v_and_b32 v67, s90, v177
    v_lshlrev_b32 v68, 16, v178
    v_and_b32 v69, s90, v178
    v_lshlrev_b32 v70, 16, v179
    v_and_b32 v71, s90, v179
    buffer_load_dwordx4 a[104:107], v11, s[64:67], s4 offen sc1
    v_pk_fma_f32 v[64:65], v[64:65], v[108:109], v[108:109] op_sel:[0,0,1] op_sel_hi:[1,0,1]
    v_pk_fma_f32 v[66:67], v[66:67], v[108:109], v[108:109] op_sel:[0,0,1] op_sel_hi:[1,0,1]
    v_pk_fma_f32 v[68:69], v[68:69], v[108:109], v[108:109] op_sel:[0,0,1] op_sel_hi:[1,0,1]
    v_pk_fma_f32 v[70:71], v[70:71], v[108:109], v[108:109] op_sel:[0,0,1] op_sel_hi:[1,0,1]
    v_pk_fma_f32 v[64:65], v[64:65], v[40:41], v[48:49]
    v_pk_fma_f32 v[66:67], v[66:67], v[42:43], v[50:51]
    v_pk_fma_f32 v[68:69], v[68:69], v[44:45], v[52:53]
    v_pk_fma_f32 v[70:71], v[70:71], v[46:47], v[54:55]
    v_cvt_pk_bf16_f32 v76, v64, v65
    v_cvt_pk_bf16_f32 v77, v66, v67
    v_cvt_pk_bf16_f32 v78, v68, v69
    v_cvt_pk_bf16_f32 v79, v70, v71
    ds_write_b128 v18, v[76:79] offset:49152
    v_lshlrev_b32 v56, 16, v196
    v_and_b32 v57, s90, v196
    v_lshlrev_b32 v58, 16, v197
    v_and_b32 v59, s90, v197
    v_lshlrev_b32 v60, 16, v198
    v_and_b32 v61, s90, v198
    v_lshlrev_b32 v62, 16, v199
    v_and_b32 v63, s90, v199
    buffer_load_dwordx4 a[176:179], v12, s[64:67], s4 offen sc1
    v_pk_fma_f32 v[56:57], v[56:57], v[110:111], v[110:111] op_sel:[0,0,1] op_sel_hi:[1,0,1]
    v_pk_fma_f32 v[58:59], v[58:59], v[110:111], v[110:111] op_sel:[0,0,1] op_sel_hi:[1,0,1]
    v_pk_fma_f32 v[60:61], v[60:61], v[110:111], v[110:111] op_sel:[0,0,1] op_sel_hi:[1,0,1]
    v_pk_fma_f32 v[62:63], v[62:63], v[110:111], v[110:111] op_sel:[0,0,1] op_sel_hi:[1,0,1]
    v_pk_fma_f32 v[56:57], v[56:57], v[40:41], v[48:49]
    v_pk_fma_f32 v[58:59], v[58:59], v[42:43], v[50:51]
    v_pk_fma_f32 v[60:61], v[60:61], v[44:45], v[52:53]
    v_pk_fma_f32 v[62:63], v[62:63], v[46:47], v[54:55]
    v_cvt_pk_bf16_f32 v72, v56, v57
    v_cvt_pk_bf16_f32 v73, v58, v59
    v_cvt_pk_bf16_f32 v74, v60, v61
    v_cvt_pk_bf16_f32 v75, v62, v63
    ds_write_b128 v19, v[72:75] offset:12288
    v_lshlrev_b32 v64, 16, v216
    v_and_b32 v65, s90, v216
    v_lshlrev_b32 v66, 16, v217
    v_and_b32 v67, s90, v217
    v_lshlrev_b32 v68, 16, v218
    v_and_b32 v69, s90, v218
    v_lshlrev_b32 v70, 16, v219
    v_and_b32 v71, s90, v219
    buffer_load_dwordx4 a[248:251], v13, s[64:67], s4 offen sc1
    v_pk_fma_f32 v[64:65], v[64:65], v[112:113], v[112:113] op_sel:[0,0,1] op_sel_hi:[1,0,1]
    v_pk_fma_f32 v[66:67], v[66:67], v[112:113], v[112:113] op_sel:[0,0,1] op_sel_hi:[1,0,1]
    v_pk_fma_f32 v[68:69], v[68:69], v[112:113], v[112:113] op_sel:[0,0,1] op_sel_hi:[1,0,1]
    v_pk_fma_f32 v[70:71], v[70:71], v[112:113], v[112:113] op_sel:[0,0,1] op_sel_hi:[1,0,1]
    v_pk_fma_f32 v[64:65], v[64:65], v[40:41], v[48:49]
    v_pk_fma_f32 v[66:67], v[66:67], v[42:43], v[50:51]
    v_pk_fma_f32 v[68:69], v[68:69], v[44:45], v[52:53]
    v_pk_fma_f32 v[70:71], v[70:71], v[46:47], v[54:55]
    v_cvt_pk_bf16_f32 v76, v64, v65
    v_cvt_pk_bf16_f32 v77, v66, v67
    v_cvt_pk_bf16_f32 v78, v68, v69
    v_cvt_pk_bf16_f32 v79, v70, v71
    ds_write_b128 v19, v[76:79] offset:30720
    s_cmp_ge_u32 s68, 2
    s_cbranch_scc0 L_m1_e
    v_lshlrev_b32 v56, 16, v140
    v_and_b32 v57, s90, v140
    v_lshlrev_b32 v58, 16, v141
    v_and_b32 v59, s90, v141
    v_lshlrev_b32 v60, 16, v142
    v_and_b32 v61, s90, v142
    v_lshlrev_b32 v62, 16, v143
    v_and_b32 v63, s90, v143
    v_pk_fma_f32 v[56:57], v[56:57], v[104:105], v[104:105] op_sel:[0,0,1] op_sel_hi:[1,0,1]
    v_pk_fma_f32 v[58:59], v[58:59], v[104:105], v[104:105] op_sel:[0,0,1] op_sel_hi:[1,0,1]
    v_pk_fma_f32 v[60:61], v[60:61], v[104:105], v[104:105] op_sel:[0,0,1] op_sel_hi:[1,0,1]
    v_pk_fma_f32 v[62:63], v[62:63], v[104:105], v[104:105] op_sel:[0,0,1] op_sel_hi:[1,0,1]
    s_waitcnt lgkmcnt(5)
    s_nop 0
    v_pk_fma_f32 v[56:57], v[56:57], v[24:25], v[32:33]
    v_pk_fma_f32 v[58:59], v[58:59], v[26:27], v[34:35]
    v_pk_fma_f32 v[60:61], v[60:61], v[28:29], v[36:37]
    v_pk_fma_f32 v[62:63], v[62:63], v[30:31], v[38:39]
    v_cvt_pk_bf16_f32 v72, v56, v57
    v_cvt_pk_bf16_f32 v73, v58, v59
    v_cvt_pk_bf16_f32 v74, v60, v61
    v_cvt_pk_bf16_f32 v75, v62, v63
    ds_write_b128 v18, v[72:75] offset:16384
    v_lshlrev_b32 v64, 16, v160
    v_and_b32 v65, s90, v160
    v_lshlrev_b32 v66, 16, v161
    v_and_b32 v67, s90, v161
    v_lshlrev_b32 v68, 16, v162
    v_and_b32 v69, s90, v162
    v_lshlrev_b32 v70, 16, v163
    v_and_b32 v71, s90, v163
    v_pk_fma_f32 v[64:65], v[64:65], v[106:107], v[106:107] op_sel:[0,0,1] op_sel_hi:[1,0,1]
    v_pk_fma_f32 v[66:67], v[66:67], v[106:107], v[106:107] op_sel:[0,0,1] op_sel_hi:[1,0,1]
    v_pk_fma_f32 v[68:69], v[68:69], v[106:107], v[106:107] op_sel:[0,0,1] op_sel_hi:[1,0,1]
    v_pk_fma_f32 v[70:71], v[70:71], v[106:107], v[106:107] op_sel:[0,0,1] op_sel_hi:[1,0,1]
    v_pk_fma_f32 v[64:65], v[64:65], v[24:25], v[32:33]
    v_pk_fma_f32 v[66:67], v[66:67], v[26:27], v[34:35]
    v_pk_fma_f32 v[68:69], v[68:69], v[28:29], v[36:37]
    v_pk_fma_f32 v[70:71], v[70:71], v[30:31], v[38:39]
    v_cvt_pk_bf16_f32 v76, v64, v65
    v_cvt_pk_bf16_f32 v77, v66, v67
    v_cvt_pk_bf16_f32 v78, v68, v69
    v_cvt_pk_bf16_f32 v79, v70, v71
    ds_write_b128 v18, v[76:79] offset:34816
    v_lshlrev_b32 v56, 16, v180
    v_and_b32 v57, s90, v180
    v_lshlrev_b32 v58, 16, v181
    v_and_b32 v59, s90, v181
    v_lshlrev_b32 v60, 16, v182
    v_and_b32 v61, s90, v182
    v_lshlrev_b32 v62, 16, v183
    v_and_b32 v63, s90, v183
    v_pk_fma_f32 v[56:57], v[56:57], v[108:109], v[108:109] op_sel:[0,0,1] op_sel_hi:[1,0,1]
    v_pk_fma_f32 v[58:59], v[58:59], v[108:109], v[108:109] op_sel:[0,0,1] op_sel_hi:[1,0,1]
    v_pk_fma_f32 v[60:61], v[60:61], v[108:109], v[108:109] op_sel:[0,0,1] op_sel_hi:[1,0,1]
    v_pk_fma_f32 v[62:63], v[62:63], v[108:109], v[108:109] op_sel:[0,0,1] op_sel_hi:[1,0,1]
    v_pk_fma_f32 v[56:57], v[56:57], v[24:25], v[32:33]
    v_pk_fma_f32 v[58:59], v[58:59], v[26:27], v[34:35]
    v_pk_fma_f32 v[60:61], v[60:61], v[28:29], v[36:37]
    v_pk_fma_f32 v[62:63], v[62:63], v[30:31], v[38:39]
    v_cvt_pk_bf16_f32 v72, v56, v57
    v_cvt_pk_bf16_f32 v73, v58, v59
    v_cvt_pk_bf16_f32 v74, v60, v61
    v_cvt_pk_bf16_f32 v75, v62, v63
    ds_write_b128 v18, v[72:75] offset:53248
    v_lshlrev_b32 v64, 16, v200
    v_and_b32 v65, s90, v200
    v_lshlrev_b32 v66, 16, v201
    v_and_b32 v67, s90, v201
    v_lshlrev_b32 v68, 16, v202
    v_and_b32 v69, s90, v202
    v_lshlrev_b32 v70, 16, v203
    v_and_b32 v71, s90, v203
    v_pk_fma_f32 v[64:65], v[64:65], v[110:111], v[110:111] op_sel:[0,0,1] op_sel_hi:[1,0,1]
    v_pk_fma_f32 v[66:67], v[66:67], v[110:111], v[110:111] op_sel:[0,0,1] op_sel_hi:[1,0,1]
    v_pk_fma_f32 v[68:69], v[68:69], v[110:111], v[110:111] op_sel:[0,0,1] op_sel_hi:[1,0,1]
    v_pk_fma_f32 v[70:71], v[70:71], v[110:111], v[110:111] op_sel:[0,0,1] op_sel_hi:[1,0,1]
    v_pk_fma_f32 v[64:65], v[64:65], v[24:25], v[32:33]
    v_pk_fma_f32 v[66:67], v[66:67], v[26:27], v[34:35]
    v_pk_fma_f32 v[68:69], v[68:69], v[28:29], v[36:37]
    v_pk_fma_f32 v[70:71], v[70:71], v[30:31], v[38:39]
    v_cvt_pk_bf16_f32 v76, v64, v65
    v_cvt_pk_bf16_f32 v77, v66, v67
    v_cvt_pk_bf16_f32 v78, v68, v69
    v_cvt_pk_bf16_f32 v79, v70, v71
    ds_write_b128 v19, v[76:79] offset:16384
    v_lshlrev_b32 v56, 16, v220
    v_and_b32 v57, s90, v220
    v_lshlrev_b32 v58, 16, v221
    v_and_b32 v59, s90, v221
    v_lshlrev_b32 v60, 16, v222
    v_and_b32 v61, s90, v222
    v_lshlrev_b32 v62, 16, v223
    v_and_b32 v63, s90, v223
    v_pk_fma_f32 v[56:57], v[56:57], v[112:113], v[112:113] op_sel:[0,0,1] op_sel_hi:[1,0,1]
    v_pk_fma_f32 v[58:59], v[58:59], v[112:113], v[112:113] op_sel:[0,0,1] op_sel_hi:[1,0,1]
    v_pk_fma_f32 v[60:61], v[60:61], v[112:113], v[112:113] op_sel:[0,0,1] op_sel_hi:[1,0,1]
    v_pk_fma_f32 v[62:63], v[62:63], v[112:113], v[112:113] op_sel:[0,0,1] op_sel_hi:[1,0,1]
    v_pk_fma_f32 v[56:57], v[56:57], v[24:25], v[32:33]
    v_pk_fma_f32 v[58:59], v[58:59], v[26:27], v[34:35]
    v_pk_fma_f32 v[60:61], v[60:61], v[28:29], v[36:37]
    v_pk_fma_f32 v[62:63], v[62:63], v[30:31], v[38:39]
    v_cvt_pk_bf16_f32 v72, v56, v57
    v_cvt_pk_bf16_f32 v73, v58, v59
    v_cvt_pk_bf16_f32 v74, v60, v61
    v_cvt_pk_bf16_f32 v75, v62, v63
    ds_write_b128 v19, v[72:75] offset:34816
    s_waitcnt lgkmcnt(0)
L_m1_e:
    s_waitcnt lgkmcnt(0)
    s_barrier
    s_cmp_eq_u32 s68, 0
    s_cbranch_scc0 L_g1
    s_nop 0
    ds_read_b128 v[104:107], v21 offset:0
    ds_read_b128 v[108:111], v21 offset:18432
    ds_read_b128 v[112:115], v21 offset:36864
    ds_read_b128 v[116:119], v22 offset:0
    ds_read_b128 v[120:123], v22 offset:18432
    s_waitcnt lgkmcnt(0)
    s_waitcnt vmcnt(32)
    v_mfma_f32_16x16x32_bf16 v[24:27], a[0:3], v[104:107], 0
    ds_read_b128 v[124:127], v21 offset:1024
    v_mfma_f32_16x16x32_bf16 v[44:47], a[72:75], v[104:107], 0
    s_add_u32 s95, s95, 14336
    s_cmp_eq_u32 s95, 258048
    s_cselect_b32 s95, 0, s95
    s_add_u32 s4, s84, s95
    buffer_load_dwordx4 a[36:39], v10, s[64:67], s4 offen sc1
    v_mfma_f32_16x16x32_bf16 v[28:31], a[0:3], v[108:111], 0
    s_lshr_b32 s22, s2, 3
    s_lshl_b32 s22, s22, 2
    s_add_u32 s22, s22, s68
    s_nop 0
    v_mfma_f32_16x16x32_bf16 v[48:51], a[72:75], v[108:111], 0
    ds_read_b128 v[128:131], v21 offset:19456
    v_mfma_f32_16x16x32_bf16 v[68:71], a[144:147], v[108:111], 0
    buffer_load_dwordx4 a[108:111], v11, s[64:67], s4 offen sc1
    v_mfma_f32_16x16x32_bf16 v[88:91], a[216:219], v[108:111], 0
    s_and_b32 s23, s2, 7
    s_mul_i32 s24, s22, 57
    s_lshr_b32 s24, s24, 11
    s_nop 0
    v_mfma_f32_16x16x32_bf16 v[32:35], a[0:3], v[112:115], 0
    ds_read_b128 v[132:135], v21 offset:37888
    v_mfma_f32_16x16x32_bf16 v[52:55], a[72:75], v[112:115], 0
    buffer_load_dwordx4 a[180:183], v12, s[64:67], s4 offen sc1
    v_mfma_f32_16x16x32_bf16 v[72:75], a[144:147], v[112:115], 0
    s_mul_i32 s25, s24, 36
    s_sub_u32 s25, s22, s25
    v_mfma_f32_16x16x32_bf16 v[92:95], a[216:219], v[112:115], 0
    ds_read_b128 v[136:139], v22 offset:1024
    v_mfma_f32_16x16x32_bf16 v[36:39], a[0:3], v[116:119], 0
    s_cmp_ge_u32 s25, 18
    s_cselect_b32 s26, 18, 0
    s_cselect_b32 s27, 1, 0
    s_nop 0
    v_mfma_f32_16x16x32_bf16 v[56:59], a[72:75], v[116:119], 0
    s_sub_u32 s25, s25, s26
    s_mul_i32 s9, s25, 294912
    s_mul_i32 s26, s23, 1152
    s_nop 0
    v_mfma_f32_16x16x32_bf16 v[76:79], a[144:147], v[116:119], 0
    ds_read_b128 v[140:143], v22 offset:19456
    v_mfma_f32_16x16x32_bf16 v[96:99], a[216:219], v[116:119], 0
    buffer_load_dwordx4 a[252:255], v13, s[64:67], s4 offen sc1
    v_mfma_f32_16x16x32_bf16 v[40:43], a[0:3], v[120:123], 0
    s_add_u32 s9, s9, s26
    s_lshl_b32 s26, s24, 7
    s_add_u32 s9, s9, s26
    s_nop 0
    v_mfma_f32_16x16x32_bf16 v[60:63], a[72:75], v[120:123], 0
    s_mul_i32 s92, s23, 36
    s_lshl_b32 s26, s24, 2
    s_add_u32 s92, s92, s26
    s_nop 0
    v_mfma_f32_16x16x32_bf16 v[80:83], a[144:147], v[120:123], 0
    s_mul_i32 s92, s92, 18
    s_add_u32 s92, s92, s25
    s_lshl_b32 s92, s92, 1
    s_nop 0
    v_mfma_f32_16x16x32_bf16 v[100:103], a[216:219], v[120:123], 0
    s_add_u32 s92, s92, s27
    s_lshl_b32 s92, s92, 10
    s_add_u32 s92, s92, 1048576
    s_waitcnt lgkmcnt(0)
    s_waitcnt vmcnt(32)
    s_cmp_eq_u32 s68, 1
    s_cselect_b32 s93, s2, 0
    s_cmp_ge_u32 s93, 18
    s_cselect_b32 s93, s93, 99
    s_cmp_lt_u32 s93, 54
    s_cbranch_scc0 L_nofm0
    s_lshl_b32 s93, s93, 2
    s_add_u32 s93, s93, 46157752
    v_mov_b32 v147, s3
    s_mov_b64 exec, 1
    buffer_store_dword v147, off, s[64:67], s93 sc1
    s_mov_b64 exec, -1
L_nofm0:
    s_nop 0
    v_mfma_f32_16x16x32_bf16 v[24:27], a[4:7], v[124:127], v[24:27]
    ds_read_b128 v[104:107], v21 offset:2048
    v_mfma_f32_16x16x32_bf16 v[44:47], a[76:79], v[124:127], v[44:47]
    s_add_u32 s95, s95, 14336
    s_cmp_eq_u32 s95, 258048
    s_cselect_b32 s95, 0, s95
    s_add_u32 s4, s84, s95
    buffer_load_dwordx4 a[40:43], v10, s[64:67], s4 offen sc1
    v_mfma_f32_16x16x32_bf16 v[28:31], a[4:7], v[128:131], v[28:31]
    s_add_u32 s10, s9, 0
    s_add_u32 s11, s92, 0
    v_mfma_f32_16x16x32_bf16 v[48:51], a[76:79], v[128:131], v[48:51]
    ds_read_b128 v[108:111], v21 offset:20480
    v_mfma_f32_16x16x32_bf16 v[68:71], a[148:151], v[128:131], v[68:71]
    buffer_load_dwordx4 a[112:115], v11, s[64:67], s4 offen sc1
    v_mfma_f32_16x16x32_bf16 v[88:91], a[220:223], v[128:131], v[88:91]
    s_cmp_ge_u32 s22, 108
    s_cselect_b32 s12, 3, s27
    s_cselect_b32 s11, 0x7ff00000, s11
    s_nop 0
    v_mfma_f32_16x16x32_bf16 v[32:35], a[4:7], v[132:135], v[32:35]
    ds_read_b128 v[112:115], v21 offset:38912
    v_mfma_f32_16x16x32_bf16 v[52:55], a[76:79], v[132:135], v[52:55]
    buffer_load_dwordx4 a[184:187], v12, s[64:67], s4 offen sc1
    v_mfma_f32_16x16x32_bf16 v[72:75], a[148:151], v[132:135], v[72:75]
    s_add_i32 s24, s22, -108
    s_mul_i32 s25, s24, 57
    s_lshr_b32 s25, s25, 9
    v_mfma_f32_16x16x32_bf16 v[92:95], a[220:223], v[132:135], v[92:95]
    ds_read_b128 v[116:119], v22 offset:2048
    v_mfma_f32_16x16x32_bf16 v[36:39], a[4:7], v[136:139], v[36:39]
    s_mul_i32 s26, s25, 9
    s_sub_u32 s24, s24, s26
    s_mul_i32 s6, s23, 663552
    v_mfma_f32_16x16x32_bf16 v[56:59], a[76:79], v[136:139], v[56:59]
    s_mul_i32 s26, s25, 36864
    s_add_u32 s6, s6, s26
    s_lshl_b32 s26, s24, 7
    v_mfma_f32_16x16x32_bf16 v[76:79], a[148:151], v[136:139], v[76:79]
    ds_read_b128 v[120:123], v22 offset:20480
    v_mfma_f32_16x16x32_bf16 v[96:99], a[220:223], v[136:139], v[96:99]
    buffer_load_dwordx4 v[224:227], v13, s[64:67], s4 offen sc1
    v_mfma_f32_16x16x32_bf16 v[40:43], a[4:7], v[140:143], v[40:43]
    s_add_u32 s6, s6, s26
    s_mul_i32 s7, s23, 36
    s_lshl_b32 s26, s24, 2
    s_nop 0
    v_mfma_f32_16x16x32_bf16 v[60:63], a[76:79], v[140:143], v[60:63]
    s_add_u32 s7, s7, s26
    s_mul_i32 s7, s7, 18
    s_add_u32 s7, s7, s25
    s_nop 0
    v_mfma_f32_16x16x32_bf16 v[80:83], a[148:151], v[140:143], v[80:83]
    s_lshl_b32 s7, s7, 10
    s_add_u32 s7, s7, 12582912
    s_add_u32 s13, s9, 384
    s_nop 0
    v_mfma_f32_16x16x32_bf16 v[100:103], a[220:223], v[140:143], v[100:103]
    s_add_u32 s14, s92, 442368
    s_waitcnt lgkmcnt(0)
    s_waitcnt vmcnt(32)
    v_mfma_f32_16x16x32_bf16 v[24:27], a[8:11], v[104:107], v[24:27]
    ds_read_b128 v[124:127], v21 offset:3072
    v_mfma_f32_16x16x32_bf16 v[44:47], a[80:83], v[104:107], v[44:47]
    s_add_u32 s95, s95, 14336
    s_cmp_eq_u32 s95, 258048
    s_cselect_b32 s95, 0, s95
    s_add_u32 s4, s84, s95
    buffer_load_dwordx4 a[44:47], v10, s[64:67], s4 offen sc1
    v_mfma_f32_16x16x32_bf16 v[28:31], a[8:11], v[108:111], v[28:31]
    s_cmp_ge_u32 s22, 108
    s_cselect_b32 s15, 2, s27
    s_cselect_b32 s13, s6, s13
    s_cselect_b32 s14, s7, s14
    s_nop 0
    v_mfma_f32_16x16x32_bf16 v[48:51], a[80:83], v[108:111], v[48:51]
    ds_read_b128 v[128:131], v21 offset:21504
    v_mfma_f32_16x16x32_bf16 v[68:71], a[152:155], v[108:111], v[68:71]
    buffer_load_dwordx4 a[116:119], v11, s[64:67], s4 offen sc1
    v_mfma_f32_16x16x32_bf16 v[88:91], a[224:227], v[108:111], v[88:91]
    s_add_i32 s24, s22, -88
    s_mul_i32 s25, s24, 57
    s_lshr_b32 s25, s25, 9
    v_mfma_f32_16x16x32_bf16 v[32:35], a[8:11], v[112:115], v[32:35]
    ds_read_b128 v[132:135], v21 offset:39936
    v_mfma_f32_16x16x32_bf16 v[52:55], a[80:83], v[112:115], v[52:55]
    buffer_load_dwordx4 a[188:191], v12, s[64:67], s4 offen sc1
    v_mfma_f32_16x16x32_bf16 v[72:75], a[152:155], v[112:115], v[72:75]
    s_mul_i32 s26, s25, 9
    s_sub_u32 s24, s24, s26
    s_mul_i32 s6, s23, 663552
    v_mfma_f32_16x16x32_bf16 v[92:95], a[224:227], v[112:115], v[92:95]
    ds_read_b128 v[136:139], v22 offset:3072
    v_mfma_f32_16x16x32_bf16 v[36:39], a[8:11], v[116:119], v[36:39]
    s_mul_i32 s26, s25, 36864
    s_add_u32 s6, s6, s26
    s_lshl_b32 s26, s24, 7
    v_mfma_f32_16x16x32_bf16 v[56:59], a[80:83], v[116:119], v[56:59]
    s_add_u32 s6, s6, s26
    s_mul_i32 s7, s23, 36
    s_lshl_b32 s26, s24, 2
    s_nop 0
    v_mfma_f32_16x16x32_bf16 v[76:79], a[152:155], v[116:119], v[76:79]
    ds_read_b128 v[140:143], v22 offset:21504
    v_mfma_f32_16x16x32_bf16 v[96:99], a[224:227], v[116:119], v[96:99]
    buffer_load_dwordx4 v[228:231], v13, s[64:67], s4 offen sc1
    v_mfma_f32_16x16x32_bf16 v[40:43], a[8:11], v[120:123], v[40:43]
    s_add_u32 s7, s7, s26
    s_mul_i32 s7, s7, 18
    s_add_u32 s7, s7, s25
    s_nop 0
    v_mfma_f32_16x16x32_bf16 v[60:63], a[80:83], v[120:123], v[60:63]
    s_lshl_b32 s7, s7, 10
    s_add_u32 s7, s7, 12582912
    s_add_u32 s16, s9, 768
    s_nop 0
    v_mfma_f32_16x16x32_bf16 v[80:83], a[152:155], v[120:123], v[80:83]
    s_add_u32 s17, s92, 884736
    v_mfma_f32_16x16x32_bf16 v[100:103], a[224:227], v[120:123], v[100:103]
    s_cmp_ge_u32 s22, 108
    s_cselect_b32 s18, 2, s27
    s_cselect_b32 s16, s6, s16
    s_cselect_b32 s17, s7, s17
    s_waitcnt lgkmcnt(0)
    s_waitcnt vmcnt(32)
    s_nop 0
    v_mfma_f32_16x16x32_bf16 v[24:27], a[12:15], v[124:127], v[24:27]
    ds_read_b128 v[104:107], v21 offset:4096
    v_mfma_f32_16x16x32_bf16 v[44:47], a[84:87], v[124:127], v[44:47]
    s_add_u32 s95, s95, 14336
    s_cmp_eq_u32 s95, 258048
    s_cselect_b32 s95, 0, s95
    s_add_u32 s4, s84, s95
    buffer_load_dwordx4 a[48:51], v10, s[64:67], s4 offen sc1
    v_mfma_f32_16x16x32_bf16 v[28:31], a[12:15], v[128:131], v[28:31]
    s_add_i32 s24, s22, 40
    s_mul_i32 s25, s24, 57
    s_lshr_b32 s25, s25, 9
    s_nop 0
    v_mfma_f32_16x16x32_bf16 v[48:51], a[84:87], v[128:131], v[48:51]
    ds_read_b128 v[108:111], v21 offset:22528
    v_mfma_f32_16x16x32_bf16 v[68:71], a[156:159], v[128:131], v[68:71]
L_stub_2:
    s_cbranch_execz L_stub_6
    s_nop 0
    buffer_load_dwordx4 a[120:123], v11, s[64:67], s4 offen sc1
    v_mfma_f32_16x16x32_bf16 v[88:91], a[228:231], v[128:131], v[88:91]
    s_mul_i32 s26, s25, 9
    s_sub_u32 s24, s24, s26
    s_mul_i32 s6, s23, 663552
    v_mfma_f32_16x16x32_bf16 v[32:35], a[12:15], v[132:135], v[32:35]
    ds_read_b128 v[112:115], v21 offset:40960
    v_mfma_f32_16x16x32_bf16 v[52:55], a[84:87], v[132:135], v[52:55]
    buffer_load_dwordx4 a[192:195], v12, s[64:67], s4 offen sc1
    v_mfma_f32_16x16x32_bf16 v[72:75], a[156:159], v[132:135], v[72:75]
    s_mul_i32 s26, s25, 36864
    s_add_u32 s6, s6, s26
    s_lshl_b32 s26, s24, 7
    v_mfma_f32_16x16x32_bf16 v[92:95], a[228:231], v[132:135], v[92:95]
    ds_read_b128 v[116:119], v22 offset:4096
    v_mfma_f32_16x16x32_bf16 v[36:39], a[12:15], v[136:139], v[36:39]
    s_add_u32 s6, s6, s26
    s_mul_i32 s7, s23, 36
    s_lshl_b32 s26, s24, 2
    s_nop 0
    v_mfma_f32_16x16x32_bf16 v[56:59], a[84:87], v[136:139], v[56:59]
    s_add_u32 s7, s7, s26
    s_mul_i32 s7, s7, 18
    s_add_u32 s7, s7, s25
    s_nop 0
    v_mfma_f32_16x16x32_bf16 v[76:79], a[156:159], v[136:139], v[76:79]
    ds_read_b128 v[120:123], v22 offset:22528
    v_mfma_f32_16x16x32_bf16 v[96:99], a[228:231], v[136:139], v[96:99]
    buffer_load_dwordx4 v[232:235], v13, s[64:67], s4 offen sc1
    v_mfma_f32_16x16x32_bf16 v[40:43], a[12:15], v[140:143], v[40:43]
    s_lshl_b32 s7, s7, 10
    s_add_u32 s7, s7, 12582912
    s_mov_b32 s19, s6
    v_mfma_f32_16x16x32_bf16 v[60:63], a[84:87], v[140:143], v[60:63]
    s_cmp_ge_u32 s22, 122
    s_cselect_b32 s21, 3, 2
    s_cselect_b32 s20, 0x7ff00000, s7
    s_nop 0
    v_mfma_f32_16x16x32_bf16 v[80:83], a[156:159], v[140:143], v[80:83]
    s_and_b32 s5, s2, 63
    s_lshr_b32 s5, s5, 3
    v_mfma_f32_16x16x32_bf16 v[100:103], a[228:231], v[140:143], v[100:103]
    s_mul_i32 s5, s5, 2304
    s_add_u32 s5, s5, 47316992
    s_waitcnt lgkmcnt(0)
    s_waitcnt vmcnt(32)
    v_mfma_f32_16x16x32_bf16 v[24:27], a[16:19], v[104:107], v[24:27]
    ds_read_b128 v[124:127], v21 offset:5120
    v_mfma_f32_16x16x32_bf16 v[44:47], a[88:91], v[104:107], v[44:47]
    s_add_u32 s95, s95, 14336
    s_cmp_eq_u32 s95, 258048
    s_cselect_b32 s95, 0, s95
    s_add_u32 s4, s84, s95
    buffer_load_dwordx4 a[52:55], v10, s[64:67], s4 offen sc1
    v_mfma_f32_16x16x32_bf16 v[28:31], a[16:19], v[108:111], v[28:31]
    v_min_u32_e64 v160, 35, v1
    v_mfma_f32_16x16x32_bf16 v[48:51], a[88:91], v[108:111], v[48:51]
    ds_read_b128 v[128:131], v21 offset:23552
    v_mfma_f32_16x16x32_bf16 v[68:71], a[160:163], v[108:111], v[68:71]
    buffer_load_dwordx4 a[124:127], v11, s[64:67], s4 offen sc1
    v_mfma_f32_16x16x32_bf16 v[88:91], a[232:235], v[108:111], v[88:91]
    v_lshlrev_b32_e64 v160, 2, v160
    v_mfma_f32_16x16x32_bf16 v[32:35], a[16:19], v[112:115], v[32:35]
    ds_read_b128 v[132:135], v21 offset:41984
    v_mfma_f32_16x16x32_bf16 v[52:55], a[88:91], v[112:115], v[52:55]
    buffer_load_dwordx4 a[196:199], v12, s[64:67], s4 offen sc1
    v_mfma_f32_16x16x32_bf16 v[72:75], a[160:163], v[112:115], v[72:75]
    v_add_u32 v160, 46157824, v160
    v_mfma_f32_16x16x32_bf16 v[92:95], a[232:235], v[112:115], v[92:95]
    ds_read_b128 v[136:139], v22 offset:5120
    v_mfma_f32_16x16x32_bf16 v[36:39], a[16:19], v[116:119], v[36:39]
    v_min_u32_e64 v161, 17, v1
    v_mfma_f32_16x16x32_bf16 v[56:59], a[88:91], v[116:119], v[56:59]
    v_lshlrev_b32_e64 v161, 7, v161
    v_mfma_f32_16x16x32_bf16 v[76:79], a[160:163], v[116:119], v[76:79]
    ds_read_b128 v[140:143], v22 offset:23552
    v_mfma_f32_16x16x32_bf16 v[96:99], a[232:235], v[116:119], v[96:99]
    buffer_load_dwordx4 v[236:239], v13, s[64:67], s4 offen sc1
    v_mfma_f32_16x16x32_bf16 v[40:43], a[16:19], v[120:123], v[40:43]
    v_add_u32_e64 v161, s5, v161
    v_mfma_f32_16x16x32_bf16 v[60:63], a[88:91], v[120:123], v[60:63]
    v_lshrrev_b32_e64 v4, 3, v1
    v_mfma_f32_16x16x32_bf16 v[80:83], a[160:163], v[120:123], v[80:83]
    v_lshrrev_b32_e64 v5, 1, v4
    v_mfma_f32_16x16x32_bf16 v[100:103], a[232:235], v[120:123], v[100:103]
    v_xor_b32 v150, v5, v4
    s_waitcnt lgkmcnt(0)
    s_waitcnt vmcnt(32)
    s_nop 0
    v_mfma_f32_16x16x32_bf16 v[24:27], a[20:23], v[124:127], v[24:27]
    ds_read_b128 v[104:107], v21 offset:6144
    v_mfma_f32_16x16x32_bf16 v[44:47], a[92:95], v[124:127], v[44:47]
    s_add_u32 s95, s95, 14336
    s_cmp_eq_u32 s95, 258048
    s_cselect_b32 s95, 0, s95
    s_add_u32 s4, s84, s95
    buffer_load_dwordx4 a[56:59], v10, s[64:67], s4 offen sc1
    v_mfma_f32_16x16x32_bf16 v[28:31], a[20:23], v[128:131], v[28:31]
    v_lshrrev_b32_e64 v150, 2, v150
    v_mfma_f32_16x16x32_bf16 v[48:51], a[92:95], v[128:131], v[48:51]
    ds_read_b128 v[108:111], v21 offset:24576
    v_mfma_f32_16x16x32_bf16 v[68:71], a[164:167], v[128:131], v[68:71]
    buffer_load_dwordx4 a[128:131], v11, s[64:67], s4 offen sc1
    v_mfma_f32_16x16x32_bf16 v[88:91], a[236:239], v[128:131], v[88:91]
    v_and_b32_e64 v150, 1, v150
    v_mfma_f32_16x16x32_bf16 v[32:35], a[20:23], v[132:135], v[32:35]
    ds_read_b128 v[112:115], v21 offset:43008
    v_mfma_f32_16x16x32_bf16 v[52:55], a[92:95], v[132:135], v[52:55]
    buffer_load_dwordx4 a[200:203], v12, s[64:67], s4 offen sc1
    v_mfma_f32_16x16x32_bf16 v[72:75], a[164:167], v[132:135], v[72:75]
    v_and_b32_e64 v5, 1, v5
    v_mfma_f32_16x16x32_bf16 v[92:95], a[236:239], v[132:135], v[92:95]
    ds_read_b128 v[116:119], v22 offset:6144
    v_mfma_f32_16x16x32_bf16 v[36:39], a[20:23], v[136:139], v[36:39]
    v_lshl_or_b32 v150, v150, 1, v5
    v_mfma_f32_16x16x32_bf16 v[56:59], a[92:95], v[136:139], v[56:59]
    v_lshlrev_b32_e64 v150, 1, v150
    v_mfma_f32_16x16x32_bf16 v[76:79], a[164:167], v[136:139], v[76:79]
    ds_read_b128 v[120:123], v22 offset:24576
    v_mfma_f32_16x16x32_bf16 v[96:99], a[236:239], v[136:139], v[96:99]
    buffer_load_dwordx4 v[240:243], v13, s[64:67], s4 offen sc1
    v_mfma_f32_16x16x32_bf16 v[40:43], a[20:23], v[140:143], v[40:43]
    v_and_b32_e64 v5, 7, v1
    v_mfma_f32_16x16x32_bf16 v[60:63], a[92:95], v[140:143], v[60:63]
    v_xor_b32_e64 v150, v150, v5
    v_mfma_f32_16x16x32_bf16 v[80:83], a[164:167], v[140:143], v[80:83]
    v_lshrrev_b32_e64 v4, 3, v1
    v_mfma_f32_16x16x32_bf16 v[100:103], a[236:239], v[140:143], v[100:103]
    v_or_b32 v4, 8, v4
    s_waitcnt lgkmcnt(0)
    s_waitcnt vmcnt(32)
    s_nop 0
    v_mfma_f32_16x16x32_bf16 v[24:27], a[24:27], v[104:107], v[24:27]
    ds_read_b128 v[124:127], v21 offset:7168
    v_mfma_f32_16x16x32_bf16 v[44:47], a[96:99], v[104:107], v[44:47]
    s_add_u32 s95, s95, 14336
    s_cmp_eq_u32 s95, 258048
    s_cselect_b32 s95, 0, s95
    s_add_u32 s4, s84, s95
    buffer_load_dwordx4 a[60:63], v10, s[64:67], s4 offen sc1
    v_mfma_f32_16x16x32_bf16 v[28:31], a[24:27], v[108:111], v[28:31]
    v_lshrrev_b32_e64 v5, 1, v4
    v_mfma_f32_16x16x32_bf16 v[48:51], a[96:99], v[108:111], v[48:51]
    ds_read_b128 v[128:131], v21 offset:25600
    v_mfma_f32_16x16x32_bf16 v[68:71], a[168:171], v[108:111], v[68:71]
    buffer_load_dwordx4 a[132:135], v11, s[64:67], s4 offen sc1
    v_mfma_f32_16x16x32_bf16 v[88:91], a[240:243], v[108:111], v[88:91]
    v_xor_b32_e64 v151, v5, v4
    v_mfma_f32_16x16x32_bf16 v[32:35], a[24:27], v[112:115], v[32:35]
    ds_read_b128 v[132:135], v21 offset:44032
    v_mfma_f32_16x16x32_bf16 v[52:55], a[96:99], v[112:115], v[52:55]
    buffer_load_dwordx4 a[204:207], v12, s[64:67], s4 offen sc1
    v_mfma_f32_16x16x32_bf16 v[72:75], a[168:171], v[112:115], v[72:75]
    v_lshrrev_b32_e64 v151, 2, v151
    v_mfma_f32_16x16x32_bf16 v[92:95], a[240:243], v[112:115], v[92:95]
    ds_read_b128 v[136:139], v22 offset:7168
    v_mfma_f32_16x16x32_bf16 v[36:39], a[24:27], v[116:119], v[36:39]
    v_and_b32_e64 v151, 1, v151
    v_mfma_f32_16x16x32_bf16 v[56:59], a[96:99], v[116:119], v[56:59]
    v_and_b32_e64 v5, 1, v5
    v_mfma_f32_16x16x32_bf16 v[76:79], a[168:171], v[116:119], v[76:79]
    ds_read_b128 v[140:143], v22 offset:25600
    v_mfma_f32_16x16x32_bf16 v[96:99], a[240:243], v[116:119], v[96:99]
    buffer_load_dwordx4 v[244:247], v13, s[64:67], s4 offen sc1
    v_mfma_f32_16x16x32_bf16 v[40:43], a[24:27], v[120:123], v[40:43]
    v_lshl_or_b32 v151, v151, 1, v5
    v_mfma_f32_16x16x32_bf16 v[60:63], a[96:99], v[120:123], v[60:63]
    v_lshlrev_b32_e64 v151, 1, v151
    v_mfma_f32_16x16x32_bf16 v[80:83], a[168:171], v[120:123], v[80:83]
    v_and_b32_e64 v5, 7, v1
    v_mfma_f32_16x16x32_bf16 v[100:103], a[240:243], v[120:123], v[100:103]
    v_xor_b32 v151, v151, v5
    s_waitcnt lgkmcnt(0)
    s_waitcnt vmcnt(32)
    s_nop 0
    v_mfma_f32_16x16x32_bf16 v[24:27], a[28:31], v[124:127], v[24:27]
    ds_read_b128 v[104:107], v21 offset:8192
    v_mfma_f32_16x16x32_bf16 v[44:47], a[100:103], v[124:127], v[44:47]
    s_add_u32 s95, s95, 14336
    s_cmp_eq_u32 s95, 258048
    s_cselect_b32 s95, 0, s95
    s_add_u32 s4, s84, s95
    buffer_load_dwordx4 a[64:67], v10, s[64:67], s4 offen sc1
    v_mfma_f32_16x16x32_bf16 v[28:31], a[28:31], v[128:131], v[28:31]
    v_lshlrev_b32_e64 v150, 4, v150
    v_mfma_f32_16x16x32_bf16 v[48:51], a[100:103], v[128:131], v[48:51]
    ds_read_b128 v[108:111], v21 offset:26624
    v_mfma_f32_16x16x32_bf16 v[68:71], a[172:175], v[128:131], v[68:71]
    buffer_load_dwordx4 a[136:139], v11, s[64:67], s4 offen sc1
    v_mfma_f32_16x16x32_bf16 v[88:91], a[244:247], v[128:131], v[88:91]
    v_lshlrev_b32_e64 v151, 4, v151
    v_mfma_f32_16x16x32_bf16 v[32:35], a[28:31], v[132:135], v[32:35]
    ds_read_b128 v[112:115], v21 offset:45056
    v_mfma_f32_16x16x32_bf16 v[52:55], a[100:103], v[132:135], v[52:55]
    buffer_load_dwordx4 a[208:211], v12, s[64:67], s4 offen sc1
    v_mfma_f32_16x16x32_bf16 v[72:75], a[172:175], v[132:135], v[72:75]
    v_lshrrev_b32_e64 v146, 3, v1
    v_mfma_f32_16x16x32_bf16 v[92:95], a[244:247], v[132:135], v[92:95]
    ds_read_b128 v[116:119], v22 offset:8192
    v_mfma_f32_16x16x32_bf16 v[36:39], a[28:31], v[136:139], v[36:39]
    s_lshl_b32 s27, s68, 14
    s_nop 0
    v_mfma_f32_16x16x32_bf16 v[56:59], a[100:103], v[136:139], v[56:59]
    s_add_u32 s27, s27, 98304
    v_mfma_f32_16x16x32_bf16 v[76:79], a[172:175], v[136:139], v[76:79]
    ds_read_b128 v[120:123], v22 offset:26624
    v_mfma_f32_16x16x32_bf16 v[96:99], a[244:247], v[136:139], v[96:99]
    buffer_load_dwordx4 v[248:251], v13, s[64:67], s4 offen sc1
    v_mfma_f32_16x16x32_bf16 v[40:43], a[28:31], v[140:143], v[40:43]
    v_lshlrev_b32_e64 v4, 2, v3
    v_mfma_f32_16x16x32_bf16 v[60:63], a[100:103], v[140:143], v[60:63]
    v_add_u32_e64 v4, 0, v4
    v_mfma_f32_16x16x32_bf16 v[80:83], a[172:175], v[140:143], v[80:83]
    v_mul_u32_u24_e64 v5, 57, v4
    v_mfma_f32_16x16x32_bf16 v[100:103], a[244:247], v[140:143], v[100:103]
    v_lshrrev_b32 v5, 10, v5
    s_waitcnt lgkmcnt(0)
    s_waitcnt vmcnt(32)
    s_nop 0
    v_mfma_f32_16x16x32_bf16 v[24:27], a[32:35], v[104:107], v[24:27]
    ds_read_b128 v[124:127], v21 offset:9216
    v_mfma_f32_16x16x32_bf16 v[44:47], a[104:107], v[104:107], v[44:47]
    s_add_u32 s95, s95, 14336
    s_cmp_eq_u32 s95, 258048
    s_cselect_b32 s95, 0, s95
    s_add_u32 s4, s84, s95
    buffer_load_dwordx4 a[68:71], v10, s[64:67], s4 offen sc1
    v_mfma_f32_16x16x32_bf16 v[28:31], a[32:35], v[108:111], v[28:31]
    v_mul_u32_u24 v5, 3804, v5
    v_mfma_f32_16x16x32_bf16 v[48:51], a[104:107], v[108:111], v[48:51]
    ds_read_b128 v[128:131], v21 offset:27648
    v_mfma_f32_16x16x32_bf16 v[68:71], a[176:179], v[108:111], v[68:71]
    buffer_load_dwordx4 a[140:143], v11, s[64:67], s4 offen sc1
    v_mfma_f32_16x16x32_bf16 v[88:91], a[248:251], v[108:111], v[88:91]
    v_mul_u32_u24_e64 v4, 2, v4
    v_mfma_f32_16x16x32_bf16 v[32:35], a[32:35], v[112:115], v[32:35]
    ds_read_b128 v[132:135], v21 offset:46080
    v_mfma_f32_16x16x32_bf16 v[52:55], a[104:107], v[112:115], v[52:55]
    buffer_load_dwordx4 a[212:215], v12, s[64:67], s4 offen sc1
    v_mfma_f32_16x16x32_bf16 v[72:75], a[176:179], v[112:115], v[72:75]
    v_mul_u32_u24_e64 v6, 48, v2
    v_mfma_f32_16x16x32_bf16 v[92:95], a[248:251], v[112:115], v[92:95]
    ds_read_b128 v[136:139], v22 offset:9216
    v_mfma_f32_16x16x32_bf16 v[36:39], a[32:35], v[116:119], v[36:39]
    v_add3_u32 v152, v4, v5, v6
    v_mfma_f32_16x16x32_bf16 v[56:59], a[104:107], v[116:119], v[56:59]
    v_add_u32_e64 v152, 0, v152
    v_mfma_f32_16x16x32_bf16 v[76:79], a[176:179], v[116:119], v[76:79]
    ds_read_b128 v[140:143], v22 offset:27648
    v_mfma_f32_16x16x32_bf16 v[96:99], a[248:251], v[116:119], v[96:99]
    buffer_load_dwordx4 v[252:255], v13, s[64:67], s4 offen sc1
    v_mfma_f32_16x16x32_bf16 v[40:43], a[32:35], v[120:123], v[40:43]
    v_lshlrev_b32_e64 v4, 2, v3
    v_mfma_f32_16x16x32_bf16 v[60:63], a[104:107], v[120:123], v[60:63]
    v_add_u32_e64 v4, 2, v4
    v_mfma_f32_16x16x32_bf16 v[80:83], a[176:179], v[120:123], v[80:83]
    v_mul_u32_u24_e64 v5, 57, v4
    v_mfma_f32_16x16x32_bf16 v[100:103], a[248:251], v[120:123], v[100:103]
    v_lshrrev_b32 v5, 10, v5
    s_waitcnt lgkmcnt(0)
    s_waitcnt vmcnt(32)
    s_nop 0
    v_mfma_f32_16x16x32_bf16 v[24:27], a[36:39], v[124:127], v[24:27]
    ds_read_b128 v[104:107], v21 offset:10240
    v_mfma_f32_16x16x32_bf16 v[44:47], a[108:111], v[124:127], v[44:47]
    buffer_load_dword v7, v160, s[64:67], 0 offen sc1
    v_mfma_f32_16x16x32_bf16 v[28:31], a[36:39], v[128:131], v[28:31]
    s_cmp_eq_u32 s12, 1
    s_cselect_b32 s72, s44, s40
    s_cselect_b32 s73, s45, s41
    s_nop 0
    v_mfma_f32_16x16x32_bf16 v[48:51], a[108:111], v[128:131], v[48:51]
    ds_read_b128 v[108:111], v21 offset:28672
    v_mfma_f32_16x16x32_bf16 v[68:71], a[180:183], v[128:131], v[68:71]
    s_cmp_eq_u32 s12, 2
    s_cselect_b32 s72, s48, s72
    s_cselect_b32 s73, s49, s73
    s_movk_i32 s8, 9216
    s_cselect_b32 s8, 1152, s8
    v_mfma_f32_16x16x32_bf16 v[88:91], a[252:255], v[128:131], v[88:91]
    s_mov_b32 s74, 5308416
    s_cmp_eq_u32 s12, 3
    s_cselect_b32 s74, 0, s74
    s_mov_b32 s75, 0x20000
    v_mfma_f32_16x16x32_bf16 v[32:35], a[36:39], v[132:135], v[32:35]
    ds_read_b128 v[112:115], v21 offset:47104
    v_mfma_f32_16x16x32_bf16 v[52:55], a[108:111], v[132:135], v[52:55]
    v_mul_u32_u24_e64 v147, s8, v146
    v_mfma_f32_16x16x32_bf16 v[72:75], a[180:183], v[132:135], v[72:75]
    v_add_u32_e64 v144, v147, v150
    v_mfma_f32_16x16x32_bf16 v[92:95], a[252:255], v[132:135], v[92:95]
    ds_read_b128 v[116:119], v22 offset:10240
    v_mfma_f32_16x16x32_bf16 v[36:39], a[36:39], v[136:139], v[36:39]
    v_add_u32_e64 v145, v147, v151
    v_mfma_f32_16x16x32_bf16 v[56:59], a[108:111], v[136:139], v[56:59]
    s_lshl_b32 s26, s8, 3
    s_nop 0
    v_mfma_f32_16x16x32_bf16 v[76:79], a[180:183], v[136:139], v[76:79]
    ds_read_b128 v[120:123], v22 offset:28672
    v_mfma_f32_16x16x32_bf16 v[96:99], a[252:255], v[136:139], v[96:99]
    v_mul_u32_u24 v5, 3804, v5
    v_mfma_f32_16x16x32_bf16 v[40:43], a[36:39], v[140:143], v[40:43]
    s_add_u32 m0, s27, 0
    s_nop 0
    buffer_load_dwordx4 v144, s[72:75], s10 offen lds
    v_mfma_f32_16x16x32_bf16 v[60:63], a[108:111], v[140:143], v[60:63]
    v_mul_u32_u24_e64 v4, 2, v4
    v_mfma_f32_16x16x32_bf16 v[80:83], a[180:183], v[140:143], v[80:83]
    s_add_u32 m0, s27, 1024
    s_add_u32 s10, s10, s26
    s_nop 0
    buffer_load_dwordx4 v145, s[72:75], s10 offen lds
    v_mfma_f32_16x16x32_bf16 v[100:103], a[252:255], v[140:143], v[100:103]
    v_mul_u32_u24 v6, 48, v2
    s_waitcnt lgkmcnt(0)
    s_waitcnt vmcnt(31)
    s_nop 0
    v_mfma_f32_16x16x32_bf16 v[24:27], a[40:43], v[104:107], v[24:27]
    ds_read_b128 v[124:127], v21 offset:11264
    v_mfma_f32_16x16x32_bf16 v[44:47], a[112:115], v[104:107], v[44:47]
    s_add_u32 m0, s27, 2048
    s_add_u32 s10, s10, s26
    s_nop 0
    buffer_load_dwordx4 v144, s[72:75], s10 offen lds
    v_mfma_f32_16x16x32_bf16 v[28:31], a[40:43], v[108:111], v[28:31]
    s_add_u32 m0, s27, 3072
    s_add_u32 s10, s10, s26
    s_nop 0
    buffer_load_dwordx4 v145, s[72:75], s10 offen lds
    v_mfma_f32_16x16x32_bf16 v[48:51], a[112:115], v[108:111], v[48:51]
    ds_read_b128 v[128:131], v21 offset:29696
    v_mfma_f32_16x16x32_bf16 v[68:71], a[184:187], v[108:111], v[68:71]
    s_cmp_eq_u32 s15, 1
    s_cselect_b32 s72, s44, s40
    s_cselect_b32 s73, s45, s41
    s_nop 0
    v_mfma_f32_16x16x32_bf16 v[88:91], v[224:227], v[108:111], v[88:91]
    s_cmp_eq_u32 s15, 2
    s_cselect_b32 s72, s48, s72
    s_cselect_b32 s73, s49, s73
    s_movk_i32 s8, 9216
    s_cselect_b32 s8, 1152, s8
    v_mfma_f32_16x16x32_bf16 v[32:35], a[40:43], v[112:115], v[32:35]
    ds_read_b128 v[132:135], v21 offset:48128
    v_mfma_f32_16x16x32_bf16 v[52:55], a[112:115], v[112:115], v[52:55]
    s_mov_b32 s74, 5308416
    s_cmp_eq_u32 s15, 3
    s_cselect_b32 s74, 0, s74
    s_mov_b32 s75, 0x20000
    v_mfma_f32_16x16x32_bf16 v[72:75], a[184:187], v[112:115], v[72:75]
    v_mul_u32_u24_e64 v147, s8, v146
    v_mfma_f32_16x16x32_bf16 v[92:95], v[224:227], v[112:115], v[92:95]
    ds_read_b128 v[136:139], v22 offset:11264
    v_mfma_f32_16x16x32_bf16 v[36:39], a[40:43], v[116:119], v[36:39]
    v_add_u32_e64 v144, v147, v150
    v_mfma_f32_16x16x32_bf16 v[56:59], a[112:115], v[116:119], v[56:59]
    v_add_u32_e64 v145, v147, v151
    v_mfma_f32_16x16x32_bf16 v[76:79], a[184:187], v[116:119], v[76:79]
    ds_read_b128 v[140:143], v22 offset:29696
    v_mfma_f32_16x16x32_bf16 v[96:99], v[224:227], v[116:119], v[96:99]
    s_lshl_b32 s26, s8, 3
    s_nop 0
    v_mfma_f32_16x16x32_bf16 v[40:43], a[40:43], v[120:123], v[40:43]
    v_add3_u32 v153, v4, v5, v6
    v_mfma_f32_16x16x32_bf16 v[60:63], a[112:115], v[120:123], v[60:63]
    v_add_u32_e64 v153, 0, v153
    v_mfma_f32_16x16x32_bf16 v[80:83], a[184:187], v[120:123], v[80:83]
    v_lshlrev_b32_e64 v4, 2, v3
    v_mfma_f32_16x16x32_bf16 v[100:103], v[224:227], v[120:123], v[100:103]
    v_add_u32 v4, 16, v4
    s_waitcnt lgkmcnt(0)
    s_waitcnt vmcnt(29)
    s_nop 0
    v_mfma_f32_16x16x32_bf16 v[24:27], a[44:47], v[124:127], v[24:27]
    ds_read_b128 v[104:107], v21 offset:12288
    v_mfma_f32_16x16x32_bf16 v[44:47], a[116:119], v[124:127], v[44:47]
    s_add_u32 m0, s27, 4096
    s_nop 0
    s_nop 0
    buffer_load_dwordx4 v144, s[72:75], s13 offen lds
    v_mfma_f32_16x16x32_bf16 v[28:31], a[44:47], v[128:131], v[28:31]
    s_add_u32 m0, s27, 5120
    s_add_u32 s13, s13, s26
    s_nop 0
    buffer_load_dwordx4 v145, s[72:75], s13 offen lds
    v_mfma_f32_16x16x32_bf16 v[48:51], a[116:119], v[128:131], v[48:51]
    ds_read_b128 v[108:111], v21 offset:30720
    v_mfma_f32_16x16x32_bf16 v[68:71], a[188:191], v[128:131], v[68:71]
    v_mul_u32_u24_e64 v5, 57, v4
    v_mfma_f32_16x16x32_bf16 v[88:91], v[228:231], v[128:131], v[88:91]
    v_lshrrev_b32_e64 v5, 10, v5
    v_mfma_f32_16x16x32_bf16 v[32:35], a[44:47], v[132:135], v[32:35]
    ds_read_b128 v[112:115], v21 offset:49152
    v_mfma_f32_16x16x32_bf16 v[52:55], a[116:119], v[132:135], v[52:55]
    v_mul_u32_u24 v5, 3804, v5
    v_mfma_f32_16x16x32_bf16 v[72:75], a[188:191], v[132:135], v[72:75]
    v_mul_u32_u24_e64 v4, 2, v4
    v_mfma_f32_16x16x32_bf16 v[92:95], v[228:231], v[132:135], v[92:95]
    ds_read_b128 v[116:119], v22 offset:12288
    v_mfma_f32_16x16x32_bf16 v[36:39], a[44:47], v[136:139], v[36:39]
    v_mul_u32_u24_e64 v6, 48, v2
    v_mfma_f32_16x16x32_bf16 v[56:59], a[116:119], v[136:139], v[56:59]
    v_add3_u32 v154, v4, v5, v6
    v_mfma_f32_16x16x32_bf16 v[76:79], a[188:191], v[136:139], v[76:79]
    ds_read_b128 v[120:123], v22 offset:30720
    v_mfma_f32_16x16x32_bf16 v[96:99], v[228:231], v[136:139], v[96:99]
    v_add_u32_e64 v154, 0, v154
    v_mfma_f32_16x16x32_bf16 v[40:43], a[44:47], v[140:143], v[40:43]
    v_lshlrev_b32_e64 v4, 2, v3
    v_mfma_f32_16x16x32_bf16 v[60:63], a[116:119], v[140:143], v[60:63]
    v_add_u32_e64 v4, 18, v4
    v_mfma_f32_16x16x32_bf16 v[80:83], a[188:191], v[140:143], v[80:83]
    v_mul_u32_u24_e64 v5, 57, v4
    v_mfma_f32_16x16x32_bf16 v[100:103], v[228:231], v[140:143], v[100:103]
    v_lshrrev_b32 v5, 10, v5
    s_waitcnt lgkmcnt(0)
    s_waitcnt vmcnt(27)
    s_nop 0
    v_mfma_f32_16x16x32_bf16 v[24:27], a[48:51], v[104:107], v[24:27]
    ds_read_b128 v[124:127], v21 offset:13312
    v_mfma_f32_16x16x32_bf16 v[44:47], a[120:123], v[104:107], v[44:47]
    s_add_u32 m0, s27, 6144
    s_add_u32 s13, s13, s26
    s_nop 0
    buffer_load_dwordx4 v144, s[72:75], s13 offen lds
    v_mfma_f32_16x16x32_bf16 v[28:31], a[48:51], v[108:111], v[28:31]
    s_add_u32 m0, s27, 7168
    s_add_u32 s13, s13, s26
    s_nop 0
    buffer_load_dwordx4 v145, s[72:75], s13 offen lds
    v_mfma_f32_16x16x32_bf16 v[48:51], a[120:123], v[108:111], v[48:51]
    ds_read_b128 v[128:131], v21 offset:31744
    v_mfma_f32_16x16x32_bf16 v[68:71], a[192:195], v[108:111], v[68:71]
    s_cmp_eq_u32 s18, 1
    s_cselect_b32 s72, s44, s40
    s_cselect_b32 s73, s45, s41
    s_nop 0
    v_mfma_f32_16x16x32_bf16 v[88:91], v[232:235], v[108:111], v[88:91]
    s_cmp_eq_u32 s18, 2
    s_cselect_b32 s72, s48, s72
    s_cselect_b32 s73, s49, s73
    s_movk_i32 s8, 9216
    s_cselect_b32 s8, 1152, s8
    v_mfma_f32_16x16x32_bf16 v[32:35], a[48:51], v[112:115], v[32:35]
    ds_read_b128 v[132:135], v21 offset:50176
    v_mfma_f32_16x16x32_bf16 v[52:55], a[120:123], v[112:115], v[52:55]
    s_mov_b32 s74, 5308416
    s_cmp_eq_u32 s18, 3
    s_cselect_b32 s74, 0, s74
    s_mov_b32 s75, 0x20000
    v_mfma_f32_16x16x32_bf16 v[72:75], a[192:195], v[112:115], v[72:75]
    v_mul_u32_u24_e64 v147, s8, v146
    v_mfma_f32_16x16x32_bf16 v[92:95], v[232:235], v[112:115], v[92:95]
    ds_read_b128 v[136:139], v22 offset:13312
    v_mfma_f32_16x16x32_bf16 v[36:39], a[48:51], v[116:119], v[36:39]
    v_add_u32_e64 v144, v147, v150
    v_mfma_f32_16x16x32_bf16 v[56:59], a[120:123], v[116:119], v[56:59]
    v_add_u32_e64 v145, v147, v151
    v_mfma_f32_16x16x32_bf16 v[76:79], a[192:195], v[116:119], v[76:79]
    ds_read_b128 v[140:143], v22 offset:31744
    v_mfma_f32_16x16x32_bf16 v[96:99], v[232:235], v[116:119], v[96:99]
    s_lshl_b32 s26, s8, 3
    s_nop 0
    v_mfma_f32_16x16x32_bf16 v[40:43], a[48:51], v[120:123], v[40:43]
    v_mul_u32_u24 v5, 3804, v5
    v_mfma_f32_16x16x32_bf16 v[60:63], a[120:123], v[120:123], v[60:63]
    v_mul_u32_u24_e64 v4, 2, v4
    v_mfma_f32_16x16x32_bf16 v[80:83], a[192:195], v[120:123], v[80:83]
    v_mul_u32_u24_e64 v6, 48, v2
    v_mfma_f32_16x16x32_bf16 v[100:103], v[232:235], v[120:123], v[100:103]
    v_add3_u32 v155, v4, v5, v6
    s_waitcnt lgkmcnt(0)
    s_waitcnt vmcnt(25)
    s_waitcnt vmcnt(8)
    s_mov_b32 s88, 0
L_pw0:
    v_cmp_ne_u32 vcc, s3, v7
    s_nop 2
    s_cbranch_vccz L_pw0_ok
    s_add_u32 s88, s88, 1
    s_cmp_gt_u32 s88, 262144
    s_cbranch_scc1 L_pw0_ok
    s_nop 0
    buffer_load_dword v7, v160, s[64:67], 0 offen sc1
    s_waitcnt vmcnt(0)
    s_branch L_pw0
L_pw0_ok:
    v_mfma_f32_16x16x32_bf16 v[24:27], a[52:55], v[124:127], v[24:27]
    ds_read_b128 v[104:107], v21 offset:14336
    v_mfma_f32_16x16x32_bf16 v[44:47], a[124:127], v[124:127], v[44:47]
    s_add_u32 m0, s27, 8192
    s_nop 0
    s_nop 0
    buffer_load_dwordx4 v144, s[72:75], s16 offen lds
    v_mfma_f32_16x16x32_bf16 v[28:31], a[52:55], v[128:131], v[28:31]
    s_add_u32 m0, s27, 9216
    s_add_u32 s16, s16, s26
    s_nop 0
    buffer_load_dwordx4 v145, s[72:75], s16 offen lds
    v_mfma_f32_16x16x32_bf16 v[48:51], a[124:127], v[128:131], v[48:51]
    ds_read_b128 v[108:111], v21 offset:32768
    v_mfma_f32_16x16x32_bf16 v[68:71], a[196:199], v[128:131], v[68:71]
    v_add_u32_e64 v155, 0, v155
    v_mfma_f32_16x16x32_bf16 v[88:91], v[236:239], v[128:131], v[88:91]
    v_lshlrev_b32_e64 v4, 2, v3
    v_mfma_f32_16x16x32_bf16 v[32:35], a[52:55], v[132:135], v[32:35]
    ds_read_b128 v[112:115], v21 offset:51200
    v_mfma_f32_16x16x32_bf16 v[52:55], a[124:127], v[132:135], v[52:55]
    v_add_u32_e64 v4, 0, v4
    v_mfma_f32_16x16x32_bf16 v[72:75], a[196:199], v[132:135], v[72:75]
    v_mul_u32_u24_e64 v5, 57, v4
    v_mfma_f32_16x16x32_bf16 v[92:95], v[236:239], v[132:135], v[92:95]
    ds_read_b128 v[116:119], v22 offset:14336
    v_mfma_f32_16x16x32_bf16 v[36:39], a[52:55], v[136:139], v[36:39]
    v_lshrrev_b32_e64 v5, 10, v5
    v_mfma_f32_16x16x32_bf16 v[56:59], a[124:127], v[136:139], v[56:59]
    v_mul_u32_u24 v5, 3036, v5
    v_mfma_f32_16x16x32_bf16 v[76:79], a[196:199], v[136:139], v[76:79]
    ds_read_b128 v[120:123], v22 offset:32768
    v_mfma_f32_16x16x32_bf16 v[96:99], v[236:239], v[136:139], v[96:99]
    v_mul_u32_u24_e64 v4, 2, v4
    v_mfma_f32_16x16x32_bf16 v[40:43], a[52:55], v[140:143], v[40:43]
    v_mul_u32_u24_e64 v6, 48, v2
    v_mfma_f32_16x16x32_bf16 v[60:63], a[124:127], v[140:143], v[60:63]
    v_add3_u32 v156, v4, v5, v6
    v_mfma_f32_16x16x32_bf16 v[80:83], a[196:199], v[140:143], v[80:83]
    v_add_u32 v156, 40960, v156
    v_mfma_f32_16x16x32_bf16 v[100:103], v[236:239], v[140:143], v[100:103]
    v_lshlrev_b32 v4, 2, v3
    s_waitcnt lgkmcnt(0)
    v_mfma_f32_16x16x32_bf16 v[24:27], a[56:59], v[104:107], v[24:27]
    ds_read_b128 v[124:127], v21 offset:15360
    v_mfma_f32_16x16x32_bf16 v[44:47], a[128:131], v[104:107], v[44:47]
    s_add_u32 m0, s27, 10240
    s_add_u32 s16, s16, s26
    s_nop 0
    buffer_load_dwordx4 v144, s[72:75], s16 offen lds
    v_mfma_f32_16x16x32_bf16 v[28:31], a[56:59], v[108:111], v[28:31]
    s_add_u32 m0, s27, 11264
    s_add_u32 s16, s16, s26
    s_nop 0
    buffer_load_dwordx4 v145, s[72:75], s16 offen lds
    v_mfma_f32_16x16x32_bf16 v[48:51], a[128:131], v[108:111], v[48:51]
    ds_read_b128 v[128:131], v21 offset:33792
    v_mfma_f32_16x16x32_bf16 v[68:71], a[200:203], v[108:111], v[68:71]
    s_cmp_eq_u32 s21, 1
    s_cselect_b32 s72, s44, s40
    s_cselect_b32 s73, s45, s41
    s_nop 0
    v_mfma_f32_16x16x32_bf16 v[88:91], v[240:243], v[108:111], v[88:91]
    s_cmp_eq_u32 s21, 2
    s_cselect_b32 s72, s48, s72
    s_cselect_b32 s73, s49, s73
    s_movk_i32 s8, 9216
    s_cselect_b32 s8, 1152, s8
    v_mfma_f32_16x16x32_bf16 v[32:35], a[56:59], v[112:115], v[32:35]
    ds_read_b128 v[132:135], v21 offset:52224
    v_mfma_f32_16x16x32_bf16 v[52:55], a[128:131], v[112:115], v[52:55]
    s_mov_b32 s74, 5308416
    s_cmp_eq_u32 s21, 3
    s_cselect_b32 s74, 0, s74
    s_mov_b32 s75, 0x20000
    v_mfma_f32_16x16x32_bf16 v[72:75], a[200:203], v[112:115], v[72:75]
    v_mul_u32_u24_e64 v147, s8, v146
    v_mfma_f32_16x16x32_bf16 v[92:95], v[240:243], v[112:115], v[92:95]
    ds_read_b128 v[136:139], v22 offset:15360
    v_mfma_f32_16x16x32_bf16 v[36:39], a[56:59], v[116:119], v[36:39]
    v_add_u32_e64 v144, v147, v150
    v_mfma_f32_16x16x32_bf16 v[56:59], a[128:131], v[116:119], v[56:59]
    v_add_u32_e64 v145, v147, v151
    v_mfma_f32_16x16x32_bf16 v[76:79], a[200:203], v[116:119], v[76:79]
    ds_read_b128 v[140:143], v22 offset:33792
    v_mfma_f32_16x16x32_bf16 v[96:99], v[240:243], v[116:119], v[96:99]
    s_lshl_b32 s26, s8, 3
    s_nop 0
    v_mfma_f32_16x16x32_bf16 v[40:43], a[56:59], v[120:123], v[40:43]
    v_add_u32_e64 v4, 2, v4
    v_mfma_f32_16x16x32_bf16 v[60:63], a[128:131], v[120:123], v[60:63]
    v_mul_u32_u24_e64 v5, 57, v4
    v_mfma_f32_16x16x32_bf16 v[80:83], a[200:203], v[120:123], v[80:83]
    v_lshrrev_b32_e64 v5, 10, v5
    v_mfma_f32_16x16x32_bf16 v[100:103], v[240:243], v[120:123], v[100:103]
    v_mul_u32_u24 v5, 3036, v5
    s_waitcnt lgkmcnt(0)
    s_nop 0
    v_mfma_f32_16x16x32_bf16 v[24:27], a[60:63], v[124:127], v[24:27]
    ds_read_b128 v[104:107], v21 offset:16384
    v_mfma_f32_16x16x32_bf16 v[44:47], a[132:135], v[124:127], v[44:47]
    s_add_u32 m0, s27, 12288
L_stub_3:
    s_cbranch_execz L_stub_7
    s_nop 0
    buffer_load_dwordx4 v144, s[72:75], s19 offen lds
    v_mfma_f32_16x16x32_bf16 v[28:31], a[60:63], v[128:131], v[28:31]
    s_add_u32 m0, s27, 13312
    s_add_u32 s19, s19, s26
    s_nop 0
    buffer_load_dwordx4 v145, s[72:75], s19 offen lds
    v_mfma_f32_16x16x32_bf16 v[48:51], a[132:135], v[128:131], v[48:51]
    ds_read_b128 v[108:111], v21 offset:34816
    v_mfma_f32_16x16x32_bf16 v[68:71], a[204:207], v[128:131], v[68:71]
    v_mul_u32_u24_e64 v4, 2, v4
    v_mfma_f32_16x16x32_bf16 v[88:91], v[244:247], v[128:131], v[88:91]
    v_mul_u32_u24_e64 v6, 48, v2
    v_mfma_f32_16x16x32_bf16 v[32:35], a[60:63], v[132:135], v[32:35]
    ds_read_b128 v[112:115], v21 offset:53248
    v_mfma_f32_16x16x32_bf16 v[52:55], a[132:135], v[132:135], v[52:55]
    v_add3_u32 v157, v4, v5, v6
    v_mfma_f32_16x16x32_bf16 v[72:75], a[204:207], v[132:135], v[72:75]
    v_add_u32 v157, 40960, v157
    v_mfma_f32_16x16x32_bf16 v[92:95], v[244:247], v[132:135], v[92:95]
    ds_read_b128 v[116:119], v22 offset:16384
    v_mfma_f32_16x16x32_bf16 v[36:39], a[60:63], v[136:139], v[36:39]
    v_lshlrev_b32_e64 v4, 2, v3
    v_mfma_f32_16x16x32_bf16 v[56:59], a[132:135], v[136:139], v[56:59]
    v_add_u32_e64 v4, 16, v4
    v_mfma_f32_16x16x32_bf16 v[76:79], a[204:207], v[136:139], v[76:79]
    ds_read_b128 v[120:123], v22 offset:34816
    v_mfma_f32_16x16x32_bf16 v[96:99], v[244:247], v[136:139], v[96:99]
    v_mul_u32_u24_e64 v5, 57, v4
    v_mfma_f32_16x16x32_bf16 v[40:43], a[60:63], v[140:143], v[40:43]
    v_lshrrev_b32_e64 v5, 10, v5
    v_mfma_f32_16x16x32_bf16 v[60:63], a[132:135], v[140:143], v[60:63]
    v_mul_u32_u24 v5, 3036, v5
    v_mfma_f32_16x16x32_bf16 v[80:83], a[204:207], v[140:143], v[80:83]
    v_mul_u32_u24_e64 v4, 2, v4
    v_mfma_f32_16x16x32_bf16 v[100:103], v[244:247], v[140:143], v[100:103]
    v_mul_u32_u24 v6, 48, v2
    s_waitcnt lgkmcnt(0)
    v_mfma_f32_16x16x32_bf16 v[24:27], a[64:67], v[104:107], v[24:27]
    ds_read_b128 v[124:127], v21 offset:17408
    v_mfma_f32_16x16x32_bf16 v[44:47], a[136:139], v[104:107], v[44:47]
    s_add_u32 m0, s27, 14336
    s_add_u32 s19, s19, s26
    s_nop 0
    buffer_load_dwordx4 v144, s[72:75], s19 offen lds
    v_mfma_f32_16x16x32_bf16 v[28:31], a[64:67], v[108:111], v[28:31]
    s_add_u32 m0, s27, 15360
    s_add_u32 s19, s19, s26
    s_nop 0
    buffer_load_dwordx4 v145, s[72:75], s19 offen lds
    v_mfma_f32_16x16x32_bf16 v[48:51], a[136:139], v[108:111], v[48:51]
    ds_read_b128 v[128:131], v21 offset:35840
    v_mfma_f32_16x16x32_bf16 v[68:71], a[208:211], v[108:111], v[68:71]
    v_add3_u32 v158, v4, v5, v6
    v_mfma_f32_16x16x32_bf16 v[88:91], v[248:251], v[108:111], v[88:91]
    v_add_u32 v158, 40960, v158
    v_mfma_f32_16x16x32_bf16 v[32:35], a[64:67], v[112:115], v[32:35]
    ds_read_b128 v[132:135], v21 offset:54272
    v_mfma_f32_16x16x32_bf16 v[52:55], a[136:139], v[112:115], v[52:55]
    v_lshlrev_b32_e64 v4, 2, v3
    v_mfma_f32_16x16x32_bf16 v[72:75], a[208:211], v[112:115], v[72:75]
    v_add_u32_e64 v4, 18, v4
    v_mfma_f32_16x16x32_bf16 v[92:95], v[248:251], v[112:115], v[92:95]
    ds_read_b128 v[136:139], v22 offset:17408
    v_mfma_f32_16x16x32_bf16 v[36:39], a[64:67], v[116:119], v[36:39]
    v_mul_u32_u24_e64 v5, 57, v4
    v_mfma_f32_16x16x32_bf16 v[56:59], a[136:139], v[116:119], v[56:59]
    v_lshrrev_b32_e64 v5, 10, v5
    v_mfma_f32_16x16x32_bf16 v[76:79], a[208:211], v[116:119], v[76:79]
    ds_read_b128 v[140:143], v22 offset:35840
    v_mfma_f32_16x16x32_bf16 v[96:99], v[248:251], v[116:119], v[96:99]
    v_mul_u32_u24 v5, 3036, v5
    v_mfma_f32_16x16x32_bf16 v[40:43], a[64:67], v[120:123], v[40:43]
    v_mul_u32_u24_e64 v4, 2, v4
    v_mfma_f32_16x16x32_bf16 v[60:63], a[136:139], v[120:123], v[60:63]
    v_mul_u32_u24_e64 v6, 48, v2
    v_mfma_f32_16x16x32_bf16 v[80:83], a[208:211], v[120:123], v[80:83]
    v_add3_u32 v159, v4, v5, v6
    v_mfma_f32_16x16x32_bf16 v[100:103], v[248:251], v[120:123], v[100:103]
    v_add_u32 v159, 40960, v159
    s_waitcnt lgkmcnt(0)
    s_nop 0
    v_mfma_f32_16x16x32_bf16 v[24:27], a[68:71], v[124:127], v[24:27]
    v_mfma_f32_16x16x32_bf16 v[44:47], a[140:143], v[124:127], v[44:47]
    v_mfma_f32_16x16x32_bf16 v[28:31], a[68:71], v[128:131], v[28:31]
    v_mfma_f32_16x16x32_bf16 v[48:51], a[140:143], v[128:131], v[48:51]
    v_mfma_f32_16x16x32_bf16 v[68:71], a[212:215], v[128:131], v[68:71]
    v_mfma_f32_16x16x32_bf16 v[88:91], v[252:255], v[128:131], v[88:91]
    v_mfma_f32_16x16x32_bf16 v[32:35], a[68:71], v[132:135], v[32:35]
    v_mfma_f32_16x16x32_bf16 v[52:55], a[140:143], v[132:135], v[52:55]
    v_mfma_f32_16x16x32_bf16 v[72:75], a[212:215], v[132:135], v[72:75]
    v_mfma_f32_16x16x32_bf16 v[92:95], v[252:255], v[132:135], v[92:95]
    v_mfma_f32_16x16x32_bf16 v[36:39], a[68:71], v[136:139], v[36:39]
    v_mfma_f32_16x16x32_bf16 v[56:59], a[140:143], v[136:139], v[56:59]
    v_mfma_f32_16x16x32_bf16 v[76:79], a[212:215], v[136:139], v[76:79]
    v_mfma_f32_16x16x32_bf16 v[96:99], v[252:255], v[136:139], v[96:99]
    v_mfma_f32_16x16x32_bf16 v[40:43], a[68:71], v[140:143], v[40:43]
    v_mfma_f32_16x16x32_bf16 v[60:63], a[140:143], v[140:143], v[60:63]
    v_mfma_f32_16x16x32_bf16 v[80:83], a[212:215], v[140:143], v[80:83]
    v_mfma_f32_16x16x32_bf16 v[100:103], v[252:255], v[140:143], v[100:103]
    s_barrier
    s_nop 0
    v_cvt_pk_bf16_f32 v4, v24, v25
    ds_write_b32 v152, v4 offset:0
    v_cvt_pk_bf16_f32 v5, v26, v27
    ds_write_b32 v153, v5 offset:0
    v_cvt_pk_bf16_f32 v6, v28, v29
    ds_write_b32 v152, v6 offset:768
    v_cvt_pk_bf16_f32 v4, v30, v31
    ds_write_b32 v153, v4 offset:768
    v_cvt_pk_bf16_f32 v5, v32, v33
    ds_write_b32 v152, v5 offset:1536
    v_cvt_pk_bf16_f32 v6, v34, v35
    ds_write_b32 v153, v6 offset:1536
    v_cvt_pk_bf16_f32 v4, v36, v37
    ds_write_b32 v152, v4 offset:2304
    v_cvt_pk_bf16_f32 v5, v38, v39
    ds_write_b32 v153, v5 offset:2304
    v_cvt_pk_bf16_f32 v6, v40, v41
    ds_write_b32 v152, v6 offset:3072
    v_cvt_pk_bf16_f32 v4, v42, v43
    ds_write_b32 v153, v4 offset:3072
    v_cvt_pk_bf16_f32 v4, v44, v45
    ds_write_b32 v154, v4 offset:0
    v_cvt_pk_bf16_f32 v5, v46, v47
    ds_write_b32 v155, v5 offset:0
    v_cvt_pk_bf16_f32 v6, v48, v49
    ds_write_b32 v154, v6 offset:768
    v_cvt_pk_bf16_f32 v4, v50, v51
    ds_write_b32 v155, v4 offset:768
    v_cvt_pk_bf16_f32 v5, v52, v53
    ds_write_b32 v154, v5 offset:1536
    v_cvt_pk_bf16_f32 v6, v54, v55
    ds_write_b32 v155, v6 offset:1536
    v_cvt_pk_bf16_f32 v4, v56, v57
    ds_write_b32 v154, v4 offset:2304
    v_cvt_pk_bf16_f32 v5, v58, v59
    ds_write_b32 v155, v5 offset:2304
    v_cvt_pk_bf16_f32 v6, v60, v61
    ds_write_b32 v154, v6 offset:3072
    v_cvt_pk_bf16_f32 v4, v62, v63
    ds_write_b32 v155, v4 offset:3072
    v_cvt_pk_bf16_f32 v4, v68, v69
    ds_write_b32 v156, v4 offset:0
    v_cvt_pk_bf16_f32 v5, v70, v71
    ds_write_b32 v157, v5 offset:0
    v_cvt_pk_bf16_f32 v6, v72, v73
    ds_write_b32 v156, v6 offset:768
    v_cvt_pk_bf16_f32 v4, v74, v75
    ds_write_b32 v157, v4 offset:768
    v_cvt_pk_bf16_f32 v5, v76, v77
    ds_write_b32 v156, v5 offset:1536
    v_cvt_pk_bf16_f32 v6, v78, v79
    ds_write_b32 v157, v6 offset:1536
    v_cvt_pk_bf16_f32 v4, v80, v81
    ds_write_b32 v156, v4 offset:2304
    v_cvt_pk_bf16_f32 v5, v82, v83
    ds_write_b32 v157, v5 offset:2304
    v_cvt_pk_bf16_f32 v4, v88, v89
    ds_write_b32 v158, v4 offset:0
    v_cvt_pk_bf16_f32 v5, v90, v91
    ds_write_b32 v159, v5 offset:0
    v_cvt_pk_bf16_f32 v6, v92, v93
    ds_write_b32 v158, v6 offset:768
    v_cvt_pk_bf16_f32 v4, v94, v95
    ds_write_b32 v159, v4 offset:768
    v_cvt_pk_bf16_f32 v5, v96, v97
    ds_write_b32 v158, v5 offset:1536
    v_cvt_pk_bf16_f32 v6, v98, v99
    ds_write_b32 v159, v6 offset:1536
    v_cvt_pk_bf16_f32 v4, v100, v101
    ds_write_b32 v158, v4 offset:2304
    v_cvt_pk_bf16_f32 v5, v102, v103
    ds_write_b32 v159, v5 offset:2304
    s_mov_b64 exec, -1
    s_branch L_gE
L_g1:
    s_cmp_eq_u32 s68, 1
    s_cbranch_scc0 L_g2
    ds_read_b128 v[104:107], v21 offset:0
    ds_read_b128 v[108:111], v21 offset:18432
    ds_read_b128 v[112:115], v21 offset:36864
    ds_read_b128 v[116:119], v22 offset:0
    ds_read_b128 v[120:123], v22 offset:18432
    s_waitcnt lgkmcnt(0)
    s_waitcnt vmcnt(32)
    v_mfma_f32_16x16x32_bf16 v[24:27], a[0:3], v[104:107], 0
    ds_read_b128 v[124:127], v21 offset:1024
    v_mfma_f32_16x16x32_bf16 v[44:47], a[72:75], v[104:107], 0
    s_add_u32 s95, s95, 14336
    s_cmp_eq_u32 s95, 258048
    s_cselect_b32 s95, 0, s95
    s_add_u32 s4, s84, s95
    buffer_load_dwordx4 a[36:39], v10, s[64:67], s4 offen sc1
    v_mfma_f32_16x16x32_bf16 v[28:31], a[0:3], v[108:111], 0
    s_lshr_b32 s22, s2, 3
    s_lshl_b32 s22, s22, 2
    s_add_u32 s22, s22, s68
    s_nop 0
    v_mfma_f32_16x16x32_bf16 v[48:51], a[72:75], v[108:111], 0
    ds_read_b128 v[128:131], v21 offset:19456
    v_mfma_f32_16x16x32_bf16 v[68:71], a[144:147], v[108:111], 0
    buffer_load_dwordx4 a[108:111], v11, s[64:67], s4 offen sc1
    v_mfma_f32_16x16x32_bf16 v[88:91], a[216:219], v[108:111], 0
    s_and_b32 s23, s2, 7
    s_mul_i32 s24, s22, 57
    s_lshr_b32 s24, s24, 11
    s_nop 0
    v_mfma_f32_16x16x32_bf16 v[32:35], a[0:3], v[112:115], 0
    ds_read_b128 v[132:135], v21 offset:37888
    v_mfma_f32_16x16x32_bf16 v[52:55], a[72:75], v[112:115], 0
    buffer_load_dwordx4 a[180:183], v12, s[64:67], s4 offen sc1
    v_mfma_f32_16x16x32_bf16 v[72:75], a[144:147], v[112:115], 0
    s_mul_i32 s25, s24, 36
    s_sub_u32 s25, s22, s25
    v_mfma_f32_16x16x32_bf16 v[92:95], a[216:219], v[112:115], 0
    ds_read_b128 v[136:139], v22 offset:1024
    v_mfma_f32_16x16x32_bf16 v[36:39], a[0:3], v[116:119], 0
    s_cmp_ge_u32 s25, 18
    s_cselect_b32 s26, 18, 0
    s_cselect_b32 s27, 1, 0
    s_nop 0
    v_mfma_f32_16x16x32_bf16 v[56:59], a[72:75], v[116:119], 0
    s_sub_u32 s25, s25, s26
    s_mul_i32 s9, s25, 294912
    s_mul_i32 s26, s23, 1152
    s_nop 0
    v_mfma_f32_16x16x32_bf16 v[76:79], a[144:147], v[116:119], 0
    ds_read_b128 v[140:143], v22 offset:19456
    v_mfma_f32_16x16x32_bf16 v[96:99], a[216:219], v[116:119], 0
    buffer_load_dwordx4 a[252:255], v13, s[64:67], s4 offen sc1
    v_mfma_f32_16x16x32_bf16 v[40:43], a[0:3], v[120:123], 0
    s_add_u32 s9, s9, s26
    s_lshl_b32 s26, s24, 7
    s_add_u32 s9, s9, s26
    s_nop 0
    v_mfma_f32_16x16x32_bf16 v[60:63], a[72:75], v[120:123], 0
    s_mul_i32 s92, s23, 36
    s_lshl_b32 s26, s24, 2
    s_add_u32 s92, s92, s26
    s_nop 0
    v_mfma_f32_16x16x32_bf16 v[80:83], a[144:147], v[120:123], 0
    s_mul_i32 s92, s92, 18
    s_add_u32 s92, s92, s25
    s_lshl_b32 s92, s92, 1
    s_nop 0
    v_mfma_f32_16x16x32_bf16 v[100:103], a[216:219], v[120:123], 0
    s_add_u32 s92, s92, s27
    s_lshl_b32 s92, s92, 10
    s_add_u32 s92, s92, 1048576
    s_waitcnt lgkmcnt(0)
    s_waitcnt vmcnt(32)
    s_cmp_eq_u32 s68, 1
    s_cselect_b32 s93, s2, 0
    s_cmp_ge_u32 s93, 18
    s_cselect_b32 s93, s93, 99
    s_cmp_lt_u32 s93, 54
    s_cbranch_scc0 L_nofm1
    s_lshl_b32 s93, s93, 2
    s_add_u32 s93, s93, 46157752
    v_mov_b32 v147, s3
    s_mov_b64 exec, 1
    buffer_store_dword v147, off, s[64:67], s93 sc1
    s_mov_b64 exec, -1
L_nofm1:
    s_nop 0
    v_mfma_f32_16x16x32_bf16 v[24:27], a[4:7], v[124:127], v[24:27]
    ds_read_b128 v[104:107], v21 offset:2048
    v_mfma_f32_16x16x32_bf16 v[44:47], a[76:79], v[124:127], v[44:47]
    s_add_u32 s95, s95, 14336
    s_cmp_eq_u32 s95, 258048
    s_cselect_b32 s95, 0, s95
    s_add_u32 s4, s84, s95
    buffer_load_dwordx4 a[40:43], v10, s[64:67], s4 offen sc1
    v_mfma_f32_16x16x32_bf16 v[28:31], a[4:7], v[128:131], v[28:31]
    s_add_u32 s10, s9, 0
    s_add_u32 s11, s92, 0
    v_mfma_f32_16x16x32_bf16 v[48:51], a[76:79], v[128:131], v[48:51]
    ds_read_b128 v[108:111], v21 offset:20480
    v_mfma_f32_16x16x32_bf16 v[68:71], a[148:151], v[128:131], v[68:71]
    buffer_load_dwordx4 a[112:115], v11, s[64:67], s4 offen sc1
    v_mfma_f32_16x16x32_bf16 v[88:91], a[220:223], v[128:131], v[88:91]
    s_cmp_ge_u32 s22, 108
    s_cselect_b32 s12, 3, s27
    s_cselect_b32 s11, 0x7ff00000, s11
    s_nop 0
    v_mfma_f32_16x16x32_bf16 v[32:35], a[4:7], v[132:135], v[32:35]
    ds_read_b128 v[112:115], v21 offset:38912
    v_mfma_f32_16x16x32_bf16 v[52:55], a[76:79], v[132:135], v[52:55]
    buffer_load_dwordx4 a[184:187], v12, s[64:67], s4 offen sc1
    v_mfma_f32_16x16x32_bf16 v[72:75], a[148:151], v[132:135], v[72:75]
    s_add_i32 s24, s22, -108
    s_mul_i32 s25, s24, 57
    s_lshr_b32 s25, s25, 9
    v_mfma_f32_16x16x32_bf16 v[92:95], a[220:223], v[132:135], v[92:95]
    ds_read_b128 v[116:119], v22 offset:2048
    v_mfma_f32_16x16x32_bf16 v[36:39], a[4:7], v[136:139], v[36:39]
    s_mul_i32 s26, s25, 9
    s_sub_u32 s24, s24, s26
    s_mul_i32 s6, s23, 663552
    v_mfma_f32_16x16x32_bf16 v[56:59], a[76:79], v[136:139], v[56:59]
    s_mul_i32 s26, s25, 36864
    s_add_u32 s6, s6, s26
    s_lshl_b32 s26, s24, 7
    v_mfma_f32_16x16x32_bf16 v[76:79], a[148:151], v[136:139], v[76:79]
    ds_read_b128 v[120:123], v22 offset:20480
    v_mfma_f32_16x16x32_bf16 v[96:99], a[220:223], v[136:139], v[96:99]
    buffer_load_dwordx4 v[224:227], v13, s[64:67], s4 offen sc1
    v_mfma_f32_16x16x32_bf16 v[40:43], a[4:7], v[140:143], v[40:43]
    s_add_u32 s6, s6, s26
    s_mul_i32 s7, s23, 36
    s_lshl_b32 s26, s24, 2
    s_nop 0
    v_mfma_f32_16x16x32_bf16 v[60:63], a[76:79], v[140:143], v[60:63]
    s_add_u32 s7, s7, s26
    s_mul_i32 s7, s7, 18
    s_add_u32 s7, s7, s25
    s_nop 0
    v_mfma_f32_16x16x32_bf16 v[80:83], a[148:151], v[140:143], v[80:83]
    s_lshl_b32 s7, s7, 10
    s_add_u32 s7, s7, 12582912
    s_add_u32 s13, s9, 384
    s_nop 0
    v_mfma_f32_16x16x32_bf16 v[100:103], a[220:223], v[140:143], v[100:103]
    s_add_u32 s14, s92, 442368
    s_waitcnt lgkmcnt(0)
    s_waitcnt vmcnt(32)
    v_mfma_f32_16x16x32_bf16 v[24:27], a[8:11], v[104:107], v[24:27]
    ds_read_b128 v[124:127], v21 offset:3072
    v_mfma_f32_16x16x32_bf16 v[44:47], a[80:83], v[104:107], v[44:47]
    s_add_u32 s95, s95, 14336
    s_cmp_eq_u32 s95, 258048
    s_cselect_b32 s95, 0, s95
    s_add_u32 s4, s84, s95
    buffer_load_dwordx4 a[44:47], v10, s[64:67], s4 offen sc1
    v_mfma_f32_16x16x32_bf16 v[28:31], a[8:11], v[108:111], v[28:31]
    s_cmp_ge_u32 s22, 108
    s_cselect_b32 s15, 2, s27
    s_cselect_b32 s13, s6, s13
    s_cselect_b32 s14, s7, s14
    s_nop 0
    v_mfma_f32_16x16x32_bf16 v[48:51], a[80:83], v[108:111], v[48:51]
    ds_read_b128 v[128:131], v21 offset:21504
    v_mfma_f32_16x16x32_bf16 v[68:71], a[152:155], v[108:111], v[68:71]
    buffer_load_dwordx4 a[116:119], v11, s[64:67], s4 offen sc1
    v_mfma_f32_16x16x32_bf16 v[88:91], a[224:227], v[108:111], v[88:91]
    s_add_i32 s24, s22, -88
    s_mul_i32 s25, s24, 57
    s_lshr_b32 s25, s25, 9
    v_mfma_f32_16x16x32_bf16 v[32:35], a[8:11], v[112:115], v[32:35]
    ds_read_b128 v[132:135], v21 offset:39936
    v_mfma_f32_16x16x32_bf16 v[52:55], a[80:83], v[112:115], v[52:55]
    buffer_load_dwordx4 a[188:191], v12, s[64:67], s4 offen sc1
    v_mfma_f32_16x16x32_bf16 v[72:75], a[152:155], v[112:115], v[72:75]
    s_mul_i32 s26, s25, 9
    s_sub_u32 s24, s24, s26
    s_mul_i32 s6, s23, 663552
    v_mfma_f32_16x16x32_bf16 v[92:95], a[224:227], v[112:115], v[92:95]
    ds_read_b128 v[136:139], v22 offset:3072
    v_mfma_f32_16x16x32_bf16 v[36:39], a[8:11], v[116:119], v[36:39]
    s_mul_i32 s26, s25, 36864
    s_add_u32 s6, s6, s26
    s_lshl_b32 s26, s24, 7
    v_mfma_f32_16x16x32_bf16 v[56:59], a[80:83], v[116:119], v[56:59]
    s_add_u32 s6, s6, s26
    s_mul_i32 s7, s23, 36
    s_lshl_b32 s26, s24, 2
    s_nop 0
    v_mfma_f32_16x16x32_bf16 v[76:79], a[152:155], v[116:119], v[76:79]
    ds_read_b128 v[140:143], v22 offset:21504
    v_mfma_f32_16x16x32_bf16 v[96:99], a[224:227], v[116:119], v[96:99]
    buffer_load_dwordx4 v[228:231], v13, s[64:67], s4 offen sc1
    v_mfma_f32_16x16x32_bf16 v[40:43], a[8:11], v[120:123], v[40:43]
    s_add_u32 s7, s7, s26
    s_mul_i32 s7, s7, 18
    s_add_u32 s7, s7, s25
    s_nop 0
    v_mfma_f32_16x16x32_bf16 v[60:63], a[80:83], v[120:123], v[60:63]
    s_lshl_b32 s7, s7, 10
    s_add_u32 s7, s7, 12582912
    s_add_u32 s16, s9, 768
    s_nop 0
    v_mfma_f32_16x16x32_bf16 v[80:83], a[152:155], v[120:123], v[80:83]
    s_add_u32 s17, s92, 884736
    v_mfma_f32_16x16x32_bf16 v[100:103], a[224:227], v[120:123], v[100:103]
    s_cmp_ge_u32 s22, 108
    s_cselect_b32 s18, 2, s27
    s_cselect_b32 s16, s6, s16
    s_cselect_b32 s17, s7, s17
    s_waitcnt lgkmcnt(0)
    s_waitcnt vmcnt(32)
    s_nop 0
    v_mfma_f32_16x16x32_bf16 v[24:27], a[12:15], v[124:127], v[24:27]
    ds_read_b128 v[104:107], v21 offset:4096
    v_mfma_f32_16x16x32_bf16 v[44:47], a[84:87], v[124:127], v[44:47]
    s_add_u32 s95, s95, 14336
    s_cmp_eq_u32 s95, 258048
    s_cselect_b32 s95, 0, s95
    s_add_u32 s4, s84, s95
    buffer_load_dwordx4 a[48:51], v10, s[64:67], s4 offen sc1
    v_mfma_f32_16x16x32_bf16 v[28:31], a[12:15], v[128:131], v[28:31]
    s_add_i32 s24, s22, 40
    s_mul_i32 s25, s24, 57
    s_lshr_b32 s25, s25, 9
    s_nop 0
    v_mfma_f32_16x16x32_bf16 v[48:51], a[84:87], v[128:131], v[48:51]
    ds_read_b128 v[108:111], v21 offset:22528
    v_mfma_f32_16x16x32_bf16 v[68:71], a[156:159], v[128:131], v[68:71]
    buffer_load_dwordx4 a[120:123], v11, s[64:67], s4 offen sc1
    v_mfma_f32_16x16x32_bf16 v[88:91], a[228:231], v[128:131], v[88:91]
    s_mul_i32 s26, s25, 9
    s_sub_u32 s24, s24, s26
    s_mul_i32 s6, s23, 663552
    v_mfma_f32_16x16x32_bf16 v[32:35], a[12:15], v[132:135], v[32:35]
    ds_read_b128 v[112:115], v21 offset:40960
    v_mfma_f32_16x16x32_bf16 v[52:55], a[84:87], v[132:135], v[52:55]
    buffer_load_dwordx4 a[192:195], v12, s[64:67], s4 offen sc1
    v_mfma_f32_16x16x32_bf16 v[72:75], a[156:159], v[132:135], v[72:75]
    s_mul_i32 s26, s25, 36864
    s_add_u32 s6, s6, s26
    s_lshl_b32 s26, s24, 7
    v_mfma_f32_16x16x32_bf16 v[92:95], a[228:231], v[132:135], v[92:95]
    ds_read_b128 v[116:119], v22 offset:4096
    v_mfma_f32_16x16x32_bf16 v[36:39], a[12:15], v[136:139], v[36:39]
    s_add_u32 s6, s6, s26
    s_mul_i32 s7, s23, 36
    s_lshl_b32 s26, s24, 2
    s_nop 0
    v_mfma_f32_16x16x32_bf16 v[56:59], a[84:87], v[136:139], v[56:59]
    s_add_u32 s7, s7, s26
    s_mul_i32 s7, s7, 18
    s_add_u32 s7, s7, s25
    s_nop 0
    v_mfma_f32_16x16x32_bf16 v[76:79], a[156:159], v[136:139], v[76:79]
    ds_read_b128 v[120:123], v22 offset:22528
    v_mfma_f32_16x16x32_bf16 v[96:99], a[228:231], v[136:139], v[96:99]
    buffer_load_dwordx4 v[232:235], v13, s[64:67], s4 offen sc1
    v_mfma_f32_16x16x32_bf16 v[40:43], a[12:15], v[140:143], v[40:43]
    s_lshl_b32 s7, s7, 10
    s_add_u32 s7, s7, 12582912
    s_mov_b32 s19, s6
    v_mfma_f32_16x16x32_bf16 v[60:63], a[84:87], v[140:143], v[60:63]
    s_cmp_ge_u32 s22, 122
    s_cselect_b32 s21, 3, 2
    s_cselect_b32 s20, 0x7ff00000, s7
    s_nop 0
    v_mfma_f32_16x16x32_bf16 v[80:83], a[156:159], v[140:143], v[80:83]
    s_and_b32 s5, s2, 63
    s_lshr_b32 s5, s5, 3
    v_mfma_f32_16x16x32_bf16 v[100:103], a[228:231], v[140:143], v[100:103]
    s_mul_i32 s5, s5, 2304
    s_add_u32 s5, s5, 47316992
    s_waitcnt lgkmcnt(0)
    s_waitcnt vmcnt(32)
    v_mfma_f32_16x16x32_bf16 v[24:27], a[16:19], v[104:107], v[24:27]
    ds_read_b128 v[124:127], v21 offset:5120
    v_mfma_f32_16x16x32_bf16 v[44:47], a[88:91], v[104:107], v[44:47]
    s_add_u32 s95, s95, 14336
    s_cmp_eq_u32 s95, 258048
    s_cselect_b32 s95, 0, s95
    s_add_u32 s4, s84, s95
    buffer_load_dwordx4 a[52:55], v10, s[64:67], s4 offen sc1
    v_mfma_f32_16x16x32_bf16 v[28:31], a[16:19], v[108:111], v[28:31]
    v_min_u32_e64 v160, 35, v1
    v_mfma_f32_16x16x32_bf16 v[48:51], a[88:91], v[108:111], v[48:51]
    ds_read_b128 v[128:131], v21 offset:23552
    v_mfma_f32_16x16x32_bf16 v[68:71], a[160:163], v[108:111], v[68:71]
    buffer_load_dwordx4 a[124:127], v11, s[64:67], s4 offen sc1
    v_mfma_f32_16x16x32_bf16 v[88:91], a[232:235], v[108:111], v[88:91]
    v_lshlrev_b32_e64 v160, 2, v160
    v_mfma_f32_16x16x32_bf16 v[32:35], a[16:19], v[112:115], v[32:35]
    ds_read_b128 v[132:135], v21 offset:41984
    v_mfma_f32_16x16x32_bf16 v[52:55], a[88:91], v[112:115], v[52:55]
    buffer_load_dwordx4 a[196:199], v12, s[64:67], s4 offen sc1
    v_mfma_f32_16x16x32_bf16 v[72:75], a[160:163], v[112:115], v[72:75]
    v_add_u32 v160, 46157824, v160
    v_mfma_f32_16x16x32_bf16 v[92:95], a[232:235], v[112:115], v[92:95]
    ds_read_b128 v[136:139], v22 offset:5120
    v_mfma_f32_16x16x32_bf16 v[36:39], a[16:19], v[116:119], v[36:39]
    v_min_u32_e64 v161, 17, v1
    v_mfma_f32_16x16x32_bf16 v[56:59], a[88:91], v[116:119], v[56:59]
    v_lshlrev_b32_e64 v161, 7, v161
    v_mfma_f32_16x16x32_bf16 v[76:79], a[160:163], v[116:119], v[76:79]
    ds_read_b128 v[140:143], v22 offset:23552
    v_mfma_f32_16x16x32_bf16 v[96:99], a[232:235], v[116:119], v[96:99]
    buffer_load_dwordx4 v[236:239], v13, s[64:67], s4 offen sc1
    v_mfma_f32_16x16x32_bf16 v[40:43], a[16:19], v[120:123], v[40:43]
    v_add_u32_e64 v161, s5, v161
    v_mfma_f32_16x16x32_bf16 v[60:63], a[88:91], v[120:123], v[60:63]
    v_lshrrev_b32_e64 v4, 3, v1
    v_mfma_f32_16x16x32_bf16 v[80:83], a[160:163], v[120:123], v[80:83]
    v_lshrrev_b32_e64 v5, 1, v4
    v_mfma_f32_16x16x32_bf16 v[100:103], a[232:235], v[120:123], v[100:103]
    v_xor_b32 v150, v5, v4
    s_waitcnt lgkmcnt(0)
    s_waitcnt vmcnt(32)
    s_nop 0
    v_mfma_f32_16x16x32_bf16 v[24:27], a[20:23], v[124:127], v[24:27]
    ds_read_b128 v[104:107], v21 offset:6144
    v_mfma_f32_16x16x32_bf16 v[44:47], a[92:95], v[124:127], v[44:47]
    s_add_u32 s95, s95, 14336
    s_cmp_eq_u32 s95, 258048
    s_cselect_b32 s95, 0, s95
    s_add_u32 s4, s84, s95
    buffer_load_dwordx4 a[56:59], v10, s[64:67], s4 offen sc1
    v_mfma_f32_16x16x32_bf16 v[28:31], a[20:23], v[128:131], v[28:31]
    v_lshrrev_b32_e64 v150, 2, v150
    v_mfma_f32_16x16x32_bf16 v[48:51], a[92:95], v[128:131], v[48:51]
    ds_read_b128 v[108:111], v21 offset:24576
    v_mfma_f32_16x16x32_bf16 v[68:71], a[164:167], v[128:131], v[68:71]
    buffer_load_dwordx4 a[128:131], v11, s[64:67], s4 offen sc1
    v_mfma_f32_16x16x32_bf16 v[88:91], a[236:239], v[128:131], v[88:91]
    v_and_b32_e64 v150, 1, v150
    v_mfma_f32_16x16x32_bf16 v[32:35], a[20:23], v[132:135], v[32:35]
    ds_read_b128 v[112:115], v21 offset:43008
    v_mfma_f32_16x16x32_bf16 v[52:55], a[92:95], v[132:135], v[52:55]
    buffer_load_dwordx4 a[200:203], v12, s[64:67], s4 offen sc1
    v_mfma_f32_16x16x32_bf16 v[72:75], a[164:167], v[132:135], v[72:75]
    v_and_b32_e64 v5, 1, v5
    v_mfma_f32_16x16x32_bf16 v[92:95], a[236:239], v[132:135], v[92:95]
    ds_read_b128 v[116:119], v22 offset:6144
    v_mfma_f32_16x16x32_bf16 v[36:39], a[20:23], v[136:139], v[36:39]
    v_lshl_or_b32 v150, v150, 1, v5
    v_mfma_f32_16x16x32_bf16 v[56:59], a[92:95], v[136:139], v[56:59]
    v_lshlrev_b32_e64 v150, 1, v150
    v_mfma_f32_16x16x32_bf16 v[76:79], a[164:167], v[136:139], v[76:79]
    ds_read_b128 v[120:123], v22 offset:24576
    v_mfma_f32_16x16x32_bf16 v[96:99], a[236:239], v[136:139], v[96:99]
    buffer_load_dwordx4 v[240:243], v13, s[64:67], s4 offen sc1
    v_mfma_f32_16x16x32_bf16 v[40:43], a[20:23], v[140:143], v[40:43]
    v_and_b32_e64 v5, 7, v1
    v_mfma_f32_16x16x32_bf16 v[60:63], a[92:95], v[140:143], v[60:63]
    v_xor_b32_e64 v150, v150, v5
    v_mfma_f32_16x16x32_bf16 v[80:83], a[164:167], v[140:143], v[80:83]
    v_lshrrev_b32_e64 v4, 3, v1
    v_mfma_f32_16x16x32_bf16 v[100:103], a[236:239], v[140:143], v[100:103]
    v_or_b32 v4, 8, v4
    s_waitcnt lgkmcnt(0)
    s_waitcnt vmcnt(32)
    s_nop 0
    v_mfma_f32_16x16x32_bf16 v[24:27], a[24:27], v[104:107], v[24:27]
    ds_read_b128 v[124:127], v21 offset:7168
    v_mfma_f32_16x16x32_bf16 v[44:47], a[96:99], v[104:107], v[44:47]
    s_add_u32 s95, s95, 14336
    s_cmp_eq_u32 s95, 258048
    s_cselect_b32 s95, 0, s95
    s_add_u32 s4, s84, s95
    buffer_load_dwordx4 a[60:63], v10, s[64:67], s4 offen sc1
    v_mfma_f32_16x16x32_bf16 v[28:31], a[24:27], v[108:111], v[28:31]
    v_lshrrev_b32_e64 v5, 1, v4
    v_mfma_f32_16x16x32_bf16 v[48:51], a[96:99], v[108:111], v[48:51]
    ds_read_b128 v[128:131], v21 offset:25600
    v_mfma_f32_16x16x32_bf16 v[68:71], a[168:171], v[108:111], v[68:71]
    buffer_load_dwordx4 a[132:135], v11, s[64:67], s4 offen sc1
    v_mfma_f32_16x16x32_bf16 v[88:91], a[240:243], v[108:111], v[88:91]
    v_xor_b32_e64 v151, v5, v4
    v_mfma_f32_16x16x32_bf16 v[32:35], a[24:27], v[112:115], v[32:35]
    ds_read_b128 v[132:135], v21 offset:44032
    v_mfma_f32_16x16x32_bf16 v[52:55], a[96:99], v[112:115], v[52:55]
    buffer_load_dwordx4 a[204:207], v12, s[64:67], s4 offen sc1
    v_mfma_f32_16x16x32_bf16 v[72:75], a[168:171], v[112:115], v[72:75]
    v_lshrrev_b32_e64 v151, 2, v151
    v_mfma_f32_16x16x32_bf16 v[92:95], a[240:243], v[112:115], v[92:95]
    ds_read_b128 v[136:139], v22 offset:7168
    v_mfma_f32_16x16x32_bf16 v[36:39], a[24:27], v[116:119], v[36:39]
    v_and_b32_e64 v151, 1, v151
    v_mfma_f32_16x16x32_bf16 v[56:59], a[96:99], v[116:119], v[56:59]
    v_and_b32_e64 v5, 1, v5
    v_mfma_f32_16x16x32_bf16 v[76:79], a[168:171], v[116:119], v[76:79]
    ds_read_b128 v[140:143], v22 offset:25600
    v_mfma_f32_16x16x32_bf16 v[96:99], a[240:243], v[116:119], v[96:99]
    buffer_load_dwordx4 v[244:247], v13, s[64:67], s4 offen sc1
    v_mfma_f32_16x16x32_bf16 v[40:43], a[24:27], v[120:123], v[40:43]
    v_lshl_or_b32 v151, v151, 1, v5
    v_mfma_f32_16x16x32_bf16 v[60:63], a[96:99], v[120:123], v[60:63]
    v_lshlrev_b32_e64 v151, 1, v151
    v_mfma_f32_16x16x32_bf16 v[80:83], a[168:171], v[120:123], v[80:83]
    v_and_b32_e64 v5, 7, v1
    v_mfma_f32_16x16x32_bf16 v[100:103], a[240:243], v[120:123], v[100:103]
    v_xor_b32 v151, v151, v5
    s_waitcnt lgkmcnt(0)
    s_waitcnt vmcnt(32)
    s_nop 0
    v_mfma_f32_16x16x32_bf16 v[24:27], a[28:31], v[124:127], v[24:27]
    ds_read_b128 v[104:107], v21 offset:8192
    v_mfma_f32_16x16x32_bf16 v[44:47], a[100:103], v[124:127], v[44:47]
    s_add_u32 s95, s95, 14336
    s_cmp_eq_u32 s95, 258048
    s_cselect_b32 s95, 0, s95
    s_add_u32 s4, s84, s95
    buffer_load_dwordx4 a[64:67], v10, s[64:67], s4 offen sc1
    v_mfma_f32_16x16x32_bf16 v[28:31], a[28:31], v[128:131], v[28:31]
    v_lshlrev_b32_e64 v150, 4, v150
    v_mfma_f32_16x16x32_bf16 v[48:51], a[100:103], v[128:131], v[48:51]
L_stub_4:
    s_cbranch_execz L_stub_8
    s_nop 0
    ds_read_b128 v[108:111], v21 offset:26624
    v_mfma_f32_16x16x32_bf16 v[68:71], a[172:175], v[128:131], v[68:71]
    buffer_load_dwordx4 a[136:139], v11, s[64:67], s4 offen sc1
    v_mfma_f32_16x16x32_bf16 v[88:91], a[244:247], v[128:131], v[88:91]
    v_lshlrev_b32_e64 v151, 4, v151
    v_mfma_f32_16x16x32_bf16 v[32:35], a[28:31], v[132:135], v[32:35]
    ds_read_b128 v[112:115], v21 offset:45056
    v_mfma_f32_16x16x32_bf16 v[52:55], a[100:103], v[132:135], v[52:55]
    buffer_load_dwordx4 a[208:211], v12, s[64:67], s4 offen sc1
    v_mfma_f32_16x16x32_bf16 v[72:75], a[172:175], v[132:135], v[72:75]
    v_lshrrev_b32_e64 v146, 3, v1
    v_mfma_f32_16x16x32_bf16 v[92:95], a[244:247], v[132:135], v[92:95]
    ds_read_b128 v[116:119], v22 offset:8192
    v_mfma_f32_16x16x32_bf16 v[36:39], a[28:31], v[136:139], v[36:39]
    s_lshl_b32 s27, s68, 14
    s_nop 0
    v_mfma_f32_16x16x32_bf16 v[56:59], a[100:103], v[136:139], v[56:59]
    s_add_u32 s27, s27, 98304
    v_mfma_f32_16x16x32_bf16 v[76:79], a[172:175], v[136:139], v[76:79]
    ds_read_b128 v[120:123], v22 offset:26624
    v_mfma_f32_16x16x32_bf16 v[96:99], a[244:247], v[136:139], v[96:99]
    buffer_load_dwordx4 v[248:251], v13, s[64:67], s4 offen sc1
    v_mfma_f32_16x16x32_bf16 v[40:43], a[28:31], v[140:143], v[40:43]
    v_lshlrev_b32_e64 v4, 2, v3
    v_mfma_f32_16x16x32_bf16 v[60:63], a[100:103], v[140:143], v[60:63]
    v_add_u32_e64 v4, 32, v4
    v_mfma_f32_16x16x32_bf16 v[80:83], a[172:175], v[140:143], v[80:83]
    v_mul_u32_u24_e64 v5, 57, v4
    v_mfma_f32_16x16x32_bf16 v[100:103], a[244:247], v[140:143], v[100:103]
    v_lshrrev_b32 v5, 10, v5
    s_waitcnt lgkmcnt(0)
    s_waitcnt vmcnt(32)
    s_nop 0
    v_mfma_f32_16x16x32_bf16 v[24:27], a[32:35], v[104:107], v[24:27]
    ds_read_b128 v[124:127], v21 offset:9216
    v_mfma_f32_16x16x32_bf16 v[44:47], a[104:107], v[104:107], v[44:47]
    s_add_u32 s95, s95, 14336
    s_cmp_eq_u32 s95, 258048
    s_cselect_b32 s95, 0, s95
    s_add_u32 s4, s84, s95
    buffer_load_dwordx4 a[68:71], v10, s[64:67], s4 offen sc1
    v_mfma_f32_16x16x32_bf16 v[28:31], a[32:35], v[108:111], v[28:31]
    v_mul_u32_u24 v5, 3804, v5
    v_mfma_f32_16x16x32_bf16 v[48:51], a[104:107], v[108:111], v[48:51]
    ds_read_b128 v[128:131], v21 offset:27648
    v_mfma_f32_16x16x32_bf16 v[68:71], a[176:179], v[108:111], v[68:71]
    buffer_load_dwordx4 a[140:143], v11, s[64:67], s4 offen sc1
    v_mfma_f32_16x16x32_bf16 v[88:91], a[248:251], v[108:111], v[88:91]
    v_mul_u32_u24_e64 v4, 2, v4
    v_mfma_f32_16x16x32_bf16 v[32:35], a[32:35], v[112:115], v[32:35]
    ds_read_b128 v[132:135], v21 offset:46080
    v_mfma_f32_16x16x32_bf16 v[52:55], a[104:107], v[112:115], v[52:55]
    buffer_load_dwordx4 a[212:215], v12, s[64:67], s4 offen sc1
    v_mfma_f32_16x16x32_bf16 v[72:75], a[176:179], v[112:115], v[72:75]
    v_mul_u32_u24_e64 v6, 48, v2
    v_mfma_f32_16x16x32_bf16 v[92:95], a[248:251], v[112:115], v[92:95]
    ds_read_b128 v[136:139], v22 offset:9216
    v_mfma_f32_16x16x32_bf16 v[36:39], a[32:35], v[116:119], v[36:39]
    v_add3_u32 v152, v4, v5, v6
    v_mfma_f32_16x16x32_bf16 v[56:59], a[104:107], v[116:119], v[56:59]
    v_add_u32_e64 v152, 0, v152
    v_mfma_f32_16x16x32_bf16 v[76:79], a[176:179], v[116:119], v[76:79]
    ds_read_b128 v[140:143], v22 offset:27648
    v_mfma_f32_16x16x32_bf16 v[96:99], a[248:251], v[116:119], v[96:99]
    buffer_load_dwordx4 v[252:255], v13, s[64:67], s4 offen sc1
    v_mfma_f32_16x16x32_bf16 v[40:43], a[32:35], v[120:123], v[40:43]
    v_lshlrev_b32_e64 v4, 2, v3
    v_mfma_f32_16x16x32_bf16 v[60:63], a[104:107], v[120:123], v[60:63]
    v_add_u32_e64 v4, 34, v4
    v_mfma_f32_16x16x32_bf16 v[80:83], a[176:179], v[120:123], v[80:83]
    v_mul_u32_u24_e64 v5, 57, v4
    v_mfma_f32_16x16x32_bf16 v[100:103], a[248:251], v[120:123], v[100:103]
    v_lshrrev_b32 v5, 10, v5
    s_waitcnt lgkmcnt(0)
    s_waitcnt vmcnt(32)
    s_nop 0
    v_mfma_f32_16x16x32_bf16 v[24:27], a[36:39], v[124:127], v[24:27]
    ds_read_b128 v[104:107], v21 offset:10240
    v_mfma_f32_16x16x32_bf16 v[44:47], a[108:111], v[124:127], v[44:47]
    buffer_load_dword v7, v160, s[64:67], 0 offen sc1
    v_mfma_f32_16x16x32_bf16 v[28:31], a[36:39], v[128:131], v[28:31]
    s_cmp_eq_u32 s12, 1
    s_cselect_b32 s72, s44, s40
    s_cselect_b32 s73, s45, s41
    s_nop 0
    v_mfma_f32_16x16x32_bf16 v[48:51], a[108:111], v[128:131], v[48:51]
    ds_read_b128 v[108:111], v21 offset:28672
    v_mfma_f32_16x16x32_bf16 v[68:71], a[180:183], v[128:131], v[68:71]
    s_cmp_eq_u32 s12, 2
    s_cselect_b32 s72, s48, s72
    s_cselect_b32 s73, s49, s73
    s_movk_i32 s8, 9216
    s_cselect_b32 s8, 1152, s8
    v_mfma_f32_16x16x32_bf16 v[88:91], a[252:255], v[128:131], v[88:91]
    s_mov_b32 s74, 5308416
    s_cmp_eq_u32 s12, 3
    s_cselect_b32 s74, 0, s74
    s_mov_b32 s75, 0x20000
    v_mfma_f32_16x16x32_bf16 v[32:35], a[36:39], v[132:135], v[32:35]
    ds_read_b128 v[112:115], v21 offset:47104
    v_mfma_f32_16x16x32_bf16 v[52:55], a[108:111], v[132:135], v[52:55]
    v_mul_u32_u24_e64 v147, s8, v146
    v_mfma_f32_16x16x32_bf16 v[72:75], a[180:183], v[132:135], v[72:75]
    v_add_u32_e64 v144, v147, v150
    v_mfma_f32_16x16x32_bf16 v[92:95], a[252:255], v[132:135], v[92:95]
    ds_read_b128 v[116:119], v22 offset:10240
    v_mfma_f32_16x16x32_bf16 v[36:39], a[36:39], v[136:139], v[36:39]
    v_add_u32_e64 v145, v147, v151
    v_mfma_f32_16x16x32_bf16 v[56:59], a[108:111], v[136:139], v[56:59]
    s_lshl_b32 s26, s8, 3
    s_nop 0
    v_mfma_f32_16x16x32_bf16 v[76:79], a[180:183], v[136:139], v[76:79]
    ds_read_b128 v[120:123], v22 offset:28672
    v_mfma_f32_16x16x32_bf16 v[96:99], a[252:255], v[136:139], v[96:99]
    v_mul_u32_u24 v5, 3804, v5
    v_mfma_f32_16x16x32_bf16 v[40:43], a[36:39], v[140:143], v[40:43]
    s_add_u32 m0, s27, 0
    s_nop 0
    buffer_load_dwordx4 v144, s[72:75], s10 offen lds
    v_mfma_f32_16x16x32_bf16 v[60:63], a[108:111], v[140:143], v[60:63]
    v_mul_u32_u24_e64 v4, 2, v4
    v_mfma_f32_16x16x32_bf16 v[80:83], a[180:183], v[140:143], v[80:83]
    s_add_u32 m0, s27, 1024
    s_add_u32 s10, s10, s26
    s_nop 0
    buffer_load_dwordx4 v145, s[72:75], s10 offen lds
    v_mfma_f32_16x16x32_bf16 v[100:103], a[252:255], v[140:143], v[100:103]
    v_mul_u32_u24 v6, 48, v2
    s_waitcnt lgkmcnt(0)
    s_waitcnt vmcnt(31)
    s_nop 0
    v_mfma_f32_16x16x32_bf16 v[24:27], a[40:43], v[104:107], v[24:27]
    ds_read_b128 v[124:127], v21 offset:11264
    v_mfma_f32_16x16x32_bf16 v[44:47], a[112:115], v[104:107], v[44:47]
    s_add_u32 m0, s27, 2048
    s_add_u32 s10, s10, s26
    s_nop 0
    buffer_load_dwordx4 v144, s[72:75], s10 offen lds
    v_mfma_f32_16x16x32_bf16 v[28:31], a[40:43], v[108:111], v[28:31]
    s_add_u32 m0, s27, 3072
    s_add_u32 s10, s10, s26
    s_nop 0
    buffer_load_dwordx4 v145, s[72:75], s10 offen lds
    v_mfma_f32_16x16x32_bf16 v[48:51], a[112:115], v[108:111], v[48:51]
    ds_read_b128 v[128:131], v21 offset:29696
    v_mfma_f32_16x16x32_bf16 v[68:71], a[184:187], v[108:111], v[68:71]
    s_cmp_eq_u32 s15, 1
    s_cselect_b32 s72, s44, s40
    s_cselect_b32 s73, s45, s41
    s_nop 0
    v_mfma_f32_16x16x32_bf16 v[88:91], v[224:227], v[108:111], v[88:91]
    s_cmp_eq_u32 s15, 2
    s_cselect_b32 s72, s48, s72
    s_cselect_b32 s73, s49, s73
    s_movk_i32 s8, 9216
    s_cselect_b32 s8, 1152, s8
    v_mfma_f32_16x16x32_bf16 v[32:35], a[40:43], v[112:115], v[32:35]
    ds_read_b128 v[132:135], v21 offset:48128
    v_mfma_f32_16x16x32_bf16 v[52:55], a[112:115], v[112:115], v[52:55]
    s_mov_b32 s74, 5308416
    s_cmp_eq_u32 s15, 3
    s_cselect_b32 s74, 0, s74
    s_mov_b32 s75, 0x20000
    v_mfma_f32_16x16x32_bf16 v[72:75], a[184:187], v[112:115], v[72:75]
    v_mul_u32_u24_e64 v147, s8, v146
    v_mfma_f32_16x16x32_bf16 v[92:95], v[224:227], v[112:115], v[92:95]
    ds_read_b128 v[136:139], v22 offset:11264
    v_mfma_f32_16x16x32_bf16 v[36:39], a[40:43], v[116:119], v[36:39]
    v_add_u32_e64 v144, v147, v150
    v_mfma_f32_16x16x32_bf16 v[56:59], a[112:115], v[116:119], v[56:59]
    v_add_u32_e64 v145, v147, v151
    v_mfma_f32_16x16x32_bf16 v[76:79], a[184:187], v[116:119], v[76:79]
    ds_read_b128 v[140:143], v22 offset:29696
    v_mfma_f32_16x16x32_bf16 v[96:99], v[224:227], v[116:119], v[96:99]
    s_lshl_b32 s26, s8, 3
    s_nop 0
    v_mfma_f32_16x16x32_bf16 v[40:43], a[40:43], v[120:123], v[40:43]
    v_add3_u32 v153, v4, v5, v6
    v_mfma_f32_16x16x32_bf16 v[60:63], a[112:115], v[120:123], v[60:63]
    v_add_u32_e64 v153, 0, v153
    v_mfma_f32_16x16x32_bf16 v[80:83], a[184:187], v[120:123], v[80:83]
    v_lshlrev_b32_e64 v4, 2, v3
    v_mfma_f32_16x16x32_bf16 v[100:103], v[224:227], v[120:123], v[100:103]
    v_add_u32 v4, 48, v4
    s_waitcnt lgkmcnt(0)
    s_waitcnt vmcnt(29)
    s_nop 0
    v_mfma_f32_16x16x32_bf16 v[24:27], a[44:47], v[124:127], v[24:27]
    ds_read_b128 v[104:107], v21 offset:12288
    v_mfma_f32_16x16x32_bf16 v[44:47], a[116:119], v[124:127], v[44:47]
    s_add_u32 m0, s27, 4096
    s_nop 0
    s_nop 0
    buffer_load_dwordx4 v144, s[72:75], s13 offen lds
    v_mfma_f32_16x16x32_bf16 v[28:31], a[44:47], v[128:131], v[28:31]
    s_add_u32 m0, s27, 5120
    s_add_u32 s13, s13, s26
    s_nop 0
    buffer_load_dwordx4 v145, s[72:75], s13 offen lds
    v_mfma_f32_16x16x32_bf16 v[48:51], a[116:119], v[128:131], v[48:51]
    ds_read_b128 v[108:111], v21 offset:30720
    v_mfma_f32_16x16x32_bf16 v[68:71], a[188:191], v[128:131], v[68:71]
    v_mul_u32_u24_e64 v5, 57, v4
    v_mfma_f32_16x16x32_bf16 v[88:91], v[228:231], v[128:131], v[88:91]
    v_lshrrev_b32_e64 v5, 10, v5
    v_mfma_f32_16x16x32_bf16 v[32:35], a[44:47], v[132:135], v[32:35]
    ds_read_b128 v[112:115], v21 offset:49152
    v_mfma_f32_16x16x32_bf16 v[52:55], a[116:119], v[132:135], v[52:55]
    v_mul_u32_u24 v5, 3804, v5
    v_mfma_f32_16x16x32_bf16 v[72:75], a[188:191], v[132:135], v[72:75]
    v_mul_u32_u24_e64 v4, 2, v4
    v_mfma_f32_16x16x32_bf16 v[92:95], v[228:231], v[132:135], v[92:95]
    ds_read_b128 v[116:119], v22 offset:12288
    v_mfma_f32_16x16x32_bf16 v[36:39], a[44:47], v[136:139], v[36:39]
    v_mul_u32_u24_e64 v6, 48, v2
    v_mfma_f32_16x16x32_bf16 v[56:59], a[116:119], v[136:139], v[56:59]
    v_add3_u32 v154, v4, v5, v6
    v_mfma_f32_16x16x32_bf16 v[76:79], a[188:191], v[136:139], v[76:79]
    ds_read_b128 v[120:123], v22 offset:30720
    v_mfma_f32_16x16x32_bf16 v[96:99], v[228:231], v[136:139], v[96:99]
    v_add_u32_e64 v154, 0, v154
    v_mfma_f32_16x16x32_bf16 v[40:43], a[44:47], v[140:143], v[40:43]
    v_lshlrev_b32_e64 v4, 2, v3
    v_mfma_f32_16x16x32_bf16 v[60:63], a[116:119], v[140:143], v[60:63]
    v_add_u32_e64 v4, 50, v4
    v_mfma_f32_16x16x32_bf16 v[80:83], a[188:191], v[140:143], v[80:83]
    v_mul_u32_u24_e64 v5, 57, v4
    v_mfma_f32_16x16x32_bf16 v[100:103], v[228:231], v[140:143], v[100:103]
    v_lshrrev_b32 v5, 10, v5
    s_waitcnt lgkmcnt(0)
    s_waitcnt vmcnt(27)
    s_nop 0
    v_mfma_f32_16x16x32_bf16 v[24:27], a[48:51], v[104:107], v[24:27]
    ds_read_b128 v[124:127], v21 offset:13312
    v_mfma_f32_16x16x32_bf16 v[44:47], a[120:123], v[104:107], v[44:47]
    s_add_u32 m0, s27, 6144
    s_add_u32 s13, s13, s26
    s_nop 0
    buffer_load_dwordx4 v144, s[72:75], s13 offen lds
    v_mfma_f32_16x16x32_bf16 v[28:31], a[48:51], v[108:111], v[28:31]
    s_add_u32 m0, s27, 7168
    s_add_u32 s13, s13, s26
    s_nop 0
    buffer_load_dwordx4 v145, s[72:75], s13 offen lds
    v_mfma_f32_16x16x32_bf16 v[48:51], a[120:123], v[108:111], v[48:51]
    ds_read_b128 v[128:131], v21 offset:31744
    v_mfma_f32_16x16x32_bf16 v[68:71], a[192:195], v[108:111], v[68:71]
    s_cmp_eq_u32 s18, 1
    s_cselect_b32 s72, s44, s40
    s_cselect_b32 s73, s45, s41
    s_nop 0
    v_mfma_f32_16x16x32_bf16 v[88:91], v[232:235], v[108:111], v[88:91]
    s_cmp_eq_u32 s18, 2
    s_cselect_b32 s72, s48, s72
    s_cselect_b32 s73, s49, s73
    s_movk_i32 s8, 9216
    s_cselect_b32 s8, 1152, s8
    v_mfma_f32_16x16x32_bf16 v[32:35], a[48:51], v[112:115], v[32:35]
    ds_read_b128 v[132:135], v21 offset:50176
    v_mfma_f32_16x16x32_bf16 v[52:55], a[120:123], v[112:115], v[52:55]
    s_mov_b32 s74, 5308416
    s_cmp_eq_u32 s18, 3
    s_cselect_b32 s74, 0, s74
    s_mov_b32 s75, 0x20000
    v_mfma_f32_16x16x32_bf16 v[72:75], a[192:195], v[112:115], v[72:75]
    v_mul_u32_u24_e64 v147, s8, v146
    v_mfma_f32_16x16x32_bf16 v[92:95], v[232:235], v[112:115], v[92:95]
    ds_read_b128 v[136:139], v22 offset:13312
    v_mfma_f32_16x16x32_bf16 v[36:39], a[48:51], v[116:119], v[36:39]
    v_add_u32_e64 v144, v147, v150
    v_mfma_f32_16x16x32_bf16 v[56:59], a[120:123], v[116:119], v[56:59]
    v_add_u32_e64 v145, v147, v151
    v_mfma_f32_16x16x32_bf16 v[76:79], a[192:195], v[116:119], v[76:79]
    ds_read_b128 v[140:143], v22 offset:31744
    v_mfma_f32_16x16x32_bf16 v[96:99], v[232:235], v[116:119], v[96:99]
    s_lshl_b32 s26, s8, 3
    s_nop 0
    v_mfma_f32_16x16x32_bf16 v[40:43], a[48:51], v[120:123], v[40:43]
    v_mul_u32_u24 v5, 3804, v5
    v_mfma_f32_16x16x32_bf16 v[60:63], a[120:123], v[120:123], v[60:63]
    v_mul_u32_u24_e64 v4, 2, v4
    v_mfma_f32_16x16x32_bf16 v[80:83], a[192:195], v[120:123], v[80:83]
    v_mul_u32_u24_e64 v6, 48, v2
    v_mfma_f32_16x16x32_bf16 v[100:103], v[232:235], v[120:123], v[100:103]
    v_add3_u32 v155, v4, v5, v6
    s_waitcnt lgkmcnt(0)
    s_waitcnt vmcnt(25)
    s_waitcnt vmcnt(8)
    s_mov_b32 s88, 0
L_pw1:
    v_cmp_ne_u32 vcc, s3, v7
    s_nop 2
    s_cbranch_vccz L_pw1_ok
    s_add_u32 s88, s88, 1
    s_cmp_gt_u32 s88, 262144
    s_cbranch_scc1 L_pw1_ok
    s_nop 0
    buffer_load_dword v7, v160, s[64:67], 0 offen sc1
    s_waitcnt vmcnt(0)
    s_branch L_pw1
L_pw1_ok:
    v_mfma_f32_16x16x32_bf16 v[24:27], a[52:55], v[124:127], v[24:27]
    ds_read_b128 v[104:107], v21 offset:14336
    v_mfma_f32_16x16x32_bf16 v[44:47], a[124:127], v[124:127], v[44:47]
    s_add_u32 m0, s27, 8192
    s_nop 0
    s_nop 0
    buffer_load_dwordx4 v144, s[72:75], s16 offen lds
    v_mfma_f32_16x16x32_bf16 v[28:31], a[52:55], v[128:131], v[28:31]
    s_add_u32 m0, s27, 9216
    s_add_u32 s16, s16, s26
    s_nop 0
    buffer_load_dwordx4 v145, s[72:75], s16 offen lds
    v_mfma_f32_16x16x32_bf16 v[48:51], a[124:127], v[128:131], v[48:51]
    ds_read_b128 v[108:111], v21 offset:32768
    v_mfma_f32_16x16x32_bf16 v[68:71], a[196:199], v[128:131], v[68:71]
    v_add_u32_e64 v155, 0, v155
    v_mfma_f32_16x16x32_bf16 v[88:91], v[236:239], v[128:131], v[88:91]
    v_lshlrev_b32_e64 v4, 2, v3
    v_mfma_f32_16x16x32_bf16 v[32:35], a[52:55], v[132:135], v[32:35]
    ds_read_b128 v[112:115], v21 offset:51200
    v_mfma_f32_16x16x32_bf16 v[52:55], a[124:127], v[132:135], v[52:55]
    v_add_u32_e64 v4, 32, v4
    v_mfma_f32_16x16x32_bf16 v[72:75], a[196:199], v[132:135], v[72:75]
    v_mul_u32_u24_e64 v5, 57, v4
    v_mfma_f32_16x16x32_bf16 v[92:95], v[236:239], v[132:135], v[92:95]
    ds_read_b128 v[116:119], v22 offset:14336
    v_mfma_f32_16x16x32_bf16 v[36:39], a[52:55], v[136:139], v[36:39]
    v_lshrrev_b32_e64 v5, 10, v5
    v_mfma_f32_16x16x32_bf16 v[56:59], a[124:127], v[136:139], v[56:59]
    v_mul_u32_u24 v5, 3036, v5
    v_mfma_f32_16x16x32_bf16 v[76:79], a[196:199], v[136:139], v[76:79]
    ds_read_b128 v[120:123], v22 offset:32768
    v_mfma_f32_16x16x32_bf16 v[96:99], v[236:239], v[136:139], v[96:99]
    v_mul_u32_u24_e64 v4, 2, v4
    v_mfma_f32_16x16x32_bf16 v[40:43], a[52:55], v[140:143], v[40:43]
    v_mul_u32_u24_e64 v6, 48, v2
    v_mfma_f32_16x16x32_bf16 v[60:63], a[124:127], v[140:143], v[60:63]
    v_add3_u32 v156, v4, v5, v6
    v_mfma_f32_16x16x32_bf16 v[80:83], a[196:199], v[140:143], v[80:83]
    v_add_u32 v156, 40960, v156
    v_mfma_f32_16x16x32_bf16 v[100:103], v[236:239], v[140:143], v[100:103]
    v_lshlrev_b32 v4, 2, v3
    s_waitcnt lgkmcnt(0)
    v_mfma_f32_16x16x32_bf16 v[24:27], a[56:59], v[104:107], v[24:27]
    ds_read_b128 v[124:127], v21 offset:15360
    v_mfma_f32_16x16x32_bf16 v[44:47], a[128:131], v[104:107], v[44:47]
    s_add_u32 m0, s27, 10240
    s_add_u32 s16, s16, s26
    s_nop 0
    buffer_load_dwordx4 v144, s[72:75], s16 offen lds
    v_mfma_f32_16x16x32_bf16 v[28:31], a[56:59], v[108:111], v[28:31]
    s_add_u32 m0, s27, 11264
    s_add_u32 s16, s16, s26
    s_nop 0
    buffer_load_dwordx4 v145, s[72:75], s16 offen lds
    v_mfma_f32_16x16x32_bf16 v[48:51], a[128:131], v[108:111], v[48:51]
    ds_read_b128 v[128:131], v21 offset:33792
    v_mfma_f32_16x16x32_bf16 v[68:71], a[200:203], v[108:111], v[68:71]
    s_cmp_eq_u32 s21, 1
    s_cselect_b32 s72, s44, s40
    s_cselect_b32 s73, s45, s41
    s_nop 0
    v_mfma_f32_16x16x32_bf16 v[88:91], v[240:243], v[108:111], v[88:91]
    s_cmp_eq_u32 s21, 2
    s_cselect_b32 s72, s48, s72
    s_cselect_b32 s73, s49, s73
    s_movk_i32 s8, 9216
    s_cselect_b32 s8, 1152, s8
    v_mfma_f32_16x16x32_bf16 v[32:35], a[56:59], v[112:115], v[32:35]
    ds_read_b128 v[132:135], v21 offset:52224
    v_mfma_f32_16x16x32_bf16 v[52:55], a[128:131], v[112:115], v[52:55]
    s_mov_b32 s74, 5308416
    s_cmp_eq_u32 s21, 3
    s_cselect_b32 s74, 0, s74
    s_mov_b32 s75, 0x20000
    v_mfma_f32_16x16x32_bf16 v[72:75], a[200:203], v[112:115], v[72:75]
    v_mul_u32_u24_e64 v147, s8, v146
    v_mfma_f32_16x16x32_bf16 v[92:95], v[240:243], v[112:115], v[92:95]
    ds_read_b128 v[136:139], v22 offset:15360
    v_mfma_f32_16x16x32_bf16 v[36:39], a[56:59], v[116:119], v[36:39]
    v_add_u32_e64 v144, v147, v150
    v_mfma_f32_16x16x32_bf16 v[56:59], a[128:131], v[116:119], v[56:59]
    v_add_u32_e64 v145, v147, v151
    v_mfma_f32_16x16x32_bf16 v[76:79], a[200:203], v[116:119], v[76:79]
    ds_read_b128 v[140:143], v22 offset:33792
    v_mfma_f32_16x16x32_bf16 v[96:99], v[240:243], v[116:119], v[96:99]
    s_lshl_b32 s26, s8, 3
    s_nop 0
    v_mfma_f32_16x16x32_bf16 v[40:43], a[56:59], v[120:123], v[40:43]
    v_add_u32_e64 v4, 34, v4
    v_mfma_f32_16x16x32_bf16 v[60:63], a[128:131], v[120:123], v[60:63]
    v_mul_u32_u24_e64 v5, 57, v4
    v_mfma_f32_16x16x32_bf16 v[80:83], a[200:203], v[120:123], v[80:83]
    v_lshrrev_b32_e64 v5, 10, v5
    v_mfma_f32_16x16x32_bf16 v[100:103], v[240:243], v[120:123], v[100:103]
    v_mul_u32_u24 v5, 3036, v5
    s_waitcnt lgkmcnt(0)
    s_nop 0
    v_mfma_f32_16x16x32_bf16 v[24:27], a[60:63], v[124:127], v[24:27]
    ds_read_b128 v[104:107], v21 offset:16384
    v_mfma_f32_16x16x32_bf16 v[44:47], a[132:135], v[124:127], v[44:47]
    s_add_u32 m0, s27, 12288
    s_nop 0
    s_nop 0
    buffer_load_dwordx4 v144, s[72:75], s19 offen lds
    v_mfma_f32_16x16x32_bf16 v[28:31], a[60:63], v[128:131], v[28:31]
    s_add_u32 m0, s27, 13312
    s_add_u32 s19, s19, s26
    s_nop 0
    buffer_load_dwordx4 v145, s[72:75], s19 offen lds
    v_mfma_f32_16x16x32_bf16 v[48:51], a[132:135], v[128:131], v[48:51]
    ds_read_b128 v[108:111], v21 offset:34816
    v_mfma_f32_16x16x32_bf16 v[68:71], a[204:207], v[128:131], v[68:71]
    v_mul_u32_u24_e64 v4, 2, v4
    v_mfma_f32_16x16x32_bf16 v[88:91], v[244:247], v[128:131], v[88:91]
    v_mul_u32_u24_e64 v6, 48, v2
    v_mfma_f32_16x16x32_bf16 v[32:35], a[60:63], v[132:135], v[32:35]
    ds_read_b128 v[112:115], v21 offset:53248
    v_mfma_f32_16x16x32_bf16 v[52:55], a[132:135], v[132:135], v[52:55]
    v_add3_u32 v157, v4, v5, v6
    v_mfma_f32_16x16x32_bf16 v[72:75], a[204:207], v[132:135], v[72:75]
    v_add_u32 v157, 40960, v157
    v_mfma_f32_16x16x32_bf16 v[92:95], v[244:247], v[132:135], v[92:95]
    ds_read_b128 v[116:119], v22 offset:16384
    v_mfma_f32_16x16x32_bf16 v[36:39], a[60:63], v[136:139], v[36:39]
    v_lshlrev_b32_e64 v4, 2, v3
    v_mfma_f32_16x16x32_bf16 v[56:59], a[132:135], v[136:139], v[56:59]
    v_add_u32_e64 v4, 48, v4
    v_mfma_f32_16x16x32_bf16 v[76:79], a[204:207], v[136:139], v[76:79]
    ds_read_b128 v[120:123], v22 offset:34816
    v_mfma_f32_16x16x32_bf16 v[96:99], v[244:247], v[136:139], v[96:99]
    v_mul_u32_u24_e64 v5, 57, v4
    v_mfma_f32_16x16x32_bf16 v[40:43], a[60:63], v[140:143], v[40:43]
    v_lshrrev_b32_e64 v5, 10, v5
    v_mfma_f32_16x16x32_bf16 v[60:63], a[132:135], v[140:143], v[60:63]
    v_mul_u32_u24 v5, 3036, v5
    v_mfma_f32_16x16x32_bf16 v[80:83], a[204:207], v[140:143], v[80:83]
    v_mul_u32_u24_e64 v4, 2, v4
    v_mfma_f32_16x16x32_bf16 v[100:103], v[244:247], v[140:143], v[100:103]
    v_mul_u32_u24 v6, 48, v2
    s_waitcnt lgkmcnt(0)
    v_mfma_f32_16x16x32_bf16 v[24:27], a[64:67], v[104:107], v[24:27]
    ds_read_b128 v[124:127], v21 offset:17408
    v_mfma_f32_16x16x32_bf16 v[44:47], a[136:139], v[104:107], v[44:47]
    s_add_u32 m0, s27, 14336
    s_add_u32 s19, s19, s26
    s_nop 0
    buffer_load_dwordx4 v144, s[72:75], s19 offen lds
    v_mfma_f32_16x16x32_bf16 v[28:31], a[64:67], v[108:111], v[28:31]
    s_add_u32 m0, s27, 15360
    s_add_u32 s19, s19, s26
    s_nop 0
    buffer_load_dwordx4 v145, s[72:75], s19 offen lds
    v_mfma_f32_16x16x32_bf16 v[48:51], a[136:139], v[108:111], v[48:51]
    ds_read_b128 v[128:131], v21 offset:35840
    v_mfma_f32_16x16x32_bf16 v[68:71], a[208:211], v[108:111], v[68:71]
    v_add3_u32 v158, v4, v5, v6
    v_mfma_f32_16x16x32_bf16 v[88:91], v[248:251], v[108:111], v[88:91]
    v_add_u32 v158, 40960, v158
    v_mfma_f32_16x16x32_bf16 v[32:35], a[64:67], v[112:115], v[32:35]
    ds_read_b128 v[132:135], v21 offset:54272
    v_mfma_f32_16x16x32_bf16 v[52:55], a[136:139], v[112:115], v[52:55]
    v_lshlrev_b32_e64 v4, 2, v3
    v_mfma_f32_16x16x32_bf16 v[72:75], a[208:211], v[112:115], v[72:75]
    v_add_u32_e64 v4, 50, v4
    v_mfma_f32_16x16x32_bf16 v[92:95], v[248:251], v[112:115], v[92:95]
    ds_read_b128 v[136:139], v22 offset:17408
    v_mfma_f32_16x16x32_bf16 v[36:39], a[64:67], v[116:119], v[36:39]
    v_mul_u32_u24_e64 v5, 57, v4
    v_mfma_f32_16x16x32_bf16 v[56:59], a[136:139], v[116:119], v[56:59]
    v_lshrrev_b32_e64 v5, 10, v5
    v_mfma_f32_16x16x32_bf16 v[76:79], a[208:211], v[116:119], v[76:79]
    ds_read_b128 v[140:143], v22 offset:35840
    v_mfma_f32_16x16x32_bf16 v[96:99], v[248:251], v[116:119], v[96:99]
    v_mul_u32_u24 v5, 3036, v5
    v_mfma_f32_16x16x32_bf16 v[40:43], a[64:67], v[120:123], v[40:43]
    v_mul_u32_u24_e64 v4, 2, v4
    v_mfma_f32_16x16x32_bf16 v[60:63], a[136:139], v[120:123], v[60:63]
    v_mul_u32_u24_e64 v6, 48, v2
    v_mfma_f32_16x16x32_bf16 v[80:83], a[208:211], v[120:123], v[80:83]
    v_add3_u32 v159, v4, v5, v6
    v_mfma_f32_16x16x32_bf16 v[100:103], v[248:251], v[120:123], v[100:103]
    v_add_u32 v159, 40960, v159
    s_waitcnt lgkmcnt(0)
    s_nop 0
    v_mfma_f32_16x16x32_bf16 v[24:27], a[68:71], v[124:127], v[24:27]
    v_mfma_f32_16x16x32_bf16 v[44:47], a[140:143], v[124:127], v[44:47]
    v_mfma_f32_16x16x32_bf16 v[28:31], a[68:71], v[128:131], v[28:31]
    v_mfma_f32_16x16x32_bf16 v[48:51], a[140:143], v[128:131], v[48:51]
    v_mfma_f32_16x16x32_bf16 v[68:71], a[212:215], v[128:131], v[68:71]
    v_mfma_f32_16x16x32_bf16 v[88:91], v[252:255], v[128:131], v[88:91]
    v_mfma_f32_16x16x32_bf16 v[32:35], a[68:71], v[132:135], v[32:35]
    v_mfma_f32_16x16x32_bf16 v[52:55], a[140:143], v[132:135], v[52:55]
    v_mfma_f32_16x16x32_bf16 v[72:75], a[212:215], v[132:135], v[72:75]
    v_mfma_f32_16x16x32_bf16 v[92:95], v[252:255], v[132:135], v[92:95]
    v_mfma_f32_16x16x32_bf16 v[36:39], a[68:71], v[136:139], v[36:39]
    v_mfma_f32_16x16x32_bf16 v[56:59], a[140:143], v[136:139], v[56:59]
    v_mfma_f32_16x16x32_bf16 v[76:79], a[212:215], v[136:139], v[76:79]
    v_mfma_f32_16x16x32_bf16 v[96:99], v[252:255], v[136:139], v[96:99]
    v_mfma_f32_16x16x32_bf16 v[40:43], a[68:71], v[140:143], v[40:43]
    v_mfma_f32_16x16x32_bf16 v[60:63], a[140:143], v[140:143], v[60:63]
    v_mfma_f32_16x16x32_bf16 v[80:83], a[212:215], v[140:143], v[80:83]
    v_mfma_f32_16x16x32_bf16 v[100:103], v[252:255], v[140:143], v[100:103]
    s_barrier
    s_nop 0
    v_cvt_pk_bf16_f32 v4, v24, v25
    ds_write_b32 v152, v4 offset:0
    v_cvt_pk_bf16_f32 v5, v26, v27
    ds_write_b32 v153, v5 offset:0
    v_cvt_pk_bf16_f32 v6, v28, v29
    ds_write_b32 v152, v6 offset:768
    v_cvt_pk_bf16_f32 v4, v30, v31
    ds_write_b32 v153, v4 offset:768
    v_cvt_pk_bf16_f32 v5, v32, v33
    ds_write_b32 v152, v5 offset:1536
    v_cvt_pk_bf16_f32 v6, v34, v35
    ds_write_b32 v153, v6 offset:1536
    v_cvt_pk_bf16_f32 v4, v36, v37
    ds_write_b32 v152, v4 offset:2304
    v_cvt_pk_bf16_f32 v5, v38, v39
    ds_write_b32 v153, v5 offset:2304
    v_cvt_pk_bf16_f32 v6, v40, v41
    ds_write_b32 v152, v6 offset:3072
    v_cvt_pk_bf16_f32 v4, v42, v43
    ds_write_b32 v153, v4 offset:3072
    v_cvt_pk_bf16_f32 v4, v44, v45
    ds_write_b32 v154, v4 offset:0
    v_cvt_pk_bf16_f32 v5, v46, v47
    ds_write_b32 v155, v5 offset:0
    v_cvt_pk_bf16_f32 v6, v48, v49
    ds_write_b32 v154, v6 offset:768
    v_cvt_pk_bf16_f32 v4, v50, v51
    ds_write_b32 v155, v4 offset:768
    v_cvt_pk_bf16_f32 v5, v52, v53
    ds_write_b32 v154, v5 offset:1536
    v_cvt_pk_bf16_f32 v6, v54, v55
    ds_write_b32 v155, v6 offset:1536
    v_cvt_pk_bf16_f32 v4, v56, v57
    ds_write_b32 v154, v4 offset:2304
    v_cvt_pk_bf16_f32 v5, v58, v59
    ds_write_b32 v155, v5 offset:2304
    v_cvt_pk_bf16_f32 v6, v60, v61
    ds_write_b32 v154, v6 offset:3072
    v_cvt_pk_bf16_f32 v4, v62, v63
    ds_write_b32 v155, v4 offset:3072
    v_cvt_pk_bf16_f32 v4, v68, v69
    ds_write_b32 v156, v4 offset:0
    v_cvt_pk_bf16_f32 v5, v70, v71
    ds_write_b32 v157, v5 offset:0
    v_cvt_pk_bf16_f32 v6, v72, v73
    ds_write_b32 v156, v6 offset:768
    v_cvt_pk_bf16_f32 v4, v74, v75
    ds_write_b32 v157, v4 offset:768
    v_cvt_pk_bf16_f32 v5, v76, v77
    ds_write_b32 v156, v5 offset:1536
    v_cvt_pk_bf16_f32 v6, v78, v79
    ds_write_b32 v157, v6 offset:1536
    v_cvt_pk_bf16_f32 v4, v80, v81
    ds_write_b32 v156, v4 offset:2304
    v_cvt_pk_bf16_f32 v5, v82, v83
    ds_write_b32 v157, v5 offset:2304
    v_cvt_pk_bf16_f32 v4, v88, v89
    ds_write_b32 v158, v4 offset:0
    v_cvt_pk_bf16_f32 v5, v90, v91
    ds_write_b32 v159, v5 offset:0
    v_cvt_pk_bf16_f32 v6, v92, v93
    ds_write_b32 v158, v6 offset:768
    v_cvt_pk_bf16_f32 v4, v94, v95
    ds_write_b32 v159, v4 offset:768
    v_cvt_pk_bf16_f32 v5, v96, v97
    ds_write_b32 v158, v5 offset:1536
    v_cvt_pk_bf16_f32 v6, v98, v99
    ds_write_b32 v159, v6 offset:1536
    v_cvt_pk_bf16_f32 v4, v100, v101
    ds_write_b32 v158, v4 offset:2304
L_stub_5:
    s_cbranch_execz L_tchret_m0_m1
    s_nop 0
    v_cvt_pk_bf16_f32 v5, v102, v103
    ds_write_b32 v159, v5 offset:2304
    s_mov_b64 exec, -1
    s_branch L_gE
L_g2:
    s_cmp_eq_u32 s68, 2
    s_cbranch_scc0 L_g3
    ds_read_b128 v[104:107], v21 offset:0
    ds_read_b128 v[108:111], v21 offset:18432
    ds_read_b128 v[112:115], v21 offset:36864
    ds_read_b128 v[116:119], v22 offset:0
    ds_read_b128 v[120:123], v22 offset:18432
    s_waitcnt lgkmcnt(0)
    s_waitcnt vmcnt(32)
    s_cmp_ge_u32 s2, 112
    s_cbranch_scc0 L_wo0
    v_lshrrev_b32 v162, 3, v1
    v_lshrrev_b32 v163, 1, v162
    v_xor_b32 v167, v163, v162
    v_lshrrev_b32 v167, 2, v167
    v_and_b32 v167, 1, v167
    v_and_b32_e64 v163, 1, v163
    v_lshl_or_b32 v167, v167, 1, v163
    v_lshlrev_b32 v167, 1, v167
    v_and_b32 v163, 7, v1
    v_xor_b32 v167, v167, v163
    v_lshrrev_b32 v162, 3, v1
    v_or_b32 v162, 8, v162
    v_lshrrev_b32 v163, 1, v162
    v_xor_b32 v168, v163, v162
    v_lshrrev_b32 v168, 2, v168
    v_and_b32 v168, 1, v168
    v_and_b32 v163, 1, v163
    v_lshl_or_b32 v168, v168, 1, v163
    v_lshlrev_b32 v168, 1, v168
    v_and_b32 v163, 7, v1
    v_xor_b32 v168, v168, v163
    s_sub_u32 s52, s2, 112
    s_mul_i32 s53, s52, 57
    s_lshr_b32 s53, s53, 10
    s_mul_i32 s54, s53, 18
    s_sub_u32 s54, s52, s54
    s_mul_i32 s55, s54, 36864
    s_mul_i32 s56, s53, 144
    s_add_u32 s55, s55, s56
    s_mul_i32 s53, s53, 90
    s_add_u32 s53, s53, s54
    s_lshl_b32 s53, s53, 10
    s_add_u32 s57, s53, 0
    v_lshrrev_b32 v162, 3, v1
    v_mul_u32_u24 v162, 1152, v162
    v_lshl_add_u32 v163, v168, 4, v162
    v_lshl_add_u32 v162, v167, 4, v162
    v_mul_u32_u24 v164, 1152, v1
    v_add_u32 v164, 128, v164
    v_mov_b32 v166, 2147483632
    v_cmp_gt_u32 vcc, 32, v1
    s_nop 1
    v_cndmask_b32 v164, v166, v164, vcc
    s_mov_b32 m0, 96256
    s_nop 0
    buffer_load_dwordx4 v164, s[36:39], s55 offen lds
    s_mov_b32 m0, 92160
    s_nop 0
    s_nop 0
    buffer_load_dwordx4 v162, s[36:39], s55 offen lds
    s_add_u32 s55, s55, 9216
    s_mov_b32 m0, 93184
    s_nop 0
    s_nop 0
    buffer_load_dwordx4 v163, s[36:39], s55 offen lds
    s_add_u32 s55, s55, 9216
    s_mov_b32 m0, 94208
    s_nop 0
    s_nop 0
    buffer_load_dwordx4 v162, s[36:39], s55 offen lds
    s_add_u32 s55, s55, 9216
    s_mov_b32 m0, 95232
    s_nop 0
    s_nop 0
    buffer_load_dwordx4 v163, s[36:39], s55 offen lds
L_wo0:
    v_mfma_f32_16x16x32_bf16 v[24:27], a[0:3], v[104:107], 0
    ds_read_b128 v[124:127], v21 offset:1024
    v_mfma_f32_16x16x32_bf16 v[44:47], a[72:75], v[104:107], 0
    s_add_u32 s95, s95, 14336
    s_cmp_eq_u32 s95, 258048
    s_cselect_b32 s95, 0, s95
    s_add_u32 s4, s84, s95
    buffer_load_dwordx4 a[36:39], v10, s[64:67], s4 offen sc1
    v_mfma_f32_16x16x32_bf16 v[64:67], a[144:147], v[104:107], 0
    s_lshr_b32 s22, s2, 3
    s_lshl_b32 s22, s22, 2
    s_add_u32 s22, s22, s68
    s_nop 0
    v_mfma_f32_16x16x32_bf16 v[28:31], a[0:3], v[108:111], 0
    ds_read_b128 v[128:131], v21 offset:19456
    v_mfma_f32_16x16x32_bf16 v[48:51], a[72:75], v[108:111], 0
    buffer_load_dwordx4 a[108:111], v11, s[64:67], s4 offen sc1
    v_mfma_f32_16x16x32_bf16 v[68:71], a[144:147], v[108:111], 0
    s_and_b32 s23, s2, 7
    s_mul_i32 s24, s22, 57
    s_lshr_b32 s24, s24, 11
    s_nop 0
    v_mfma_f32_16x16x32_bf16 v[32:35], a[0:3], v[112:115], 0
    ds_read_b128 v[132:135], v21 offset:37888
    v_mfma_f32_16x16x32_bf16 v[52:55], a[72:75], v[112:115], 0
    buffer_load_dwordx4 a[180:183], v12, s[64:67], s4 offen sc1
    v_mfma_f32_16x16x32_bf16 v[72:75], a[144:147], v[112:115], 0
    s_mul_i32 s25, s24, 36
    s_sub_u32 s25, s22, s25
    v_mfma_f32_16x16x32_bf16 v[36:39], a[0:3], v[116:119], 0
    ds_read_b128 v[136:139], v22 offset:1024
    v_mfma_f32_16x16x32_bf16 v[56:59], a[72:75], v[116:119], 0
    s_cmp_ge_u32 s25, 18
    s_cselect_b32 s26, 18, 0
    s_cselect_b32 s27, 1, 0
    s_nop 0
    v_mfma_f32_16x16x32_bf16 v[76:79], a[144:147], v[116:119], 0
    s_sub_u32 s25, s25, s26
    s_mul_i32 s9, s25, 294912
    s_mul_i32 s26, s23, 1152
    s_nop 0
    v_mfma_f32_16x16x32_bf16 v[40:43], a[0:3], v[120:123], 0
    ds_read_b128 v[140:143], v22 offset:19456
    v_mfma_f32_16x16x32_bf16 v[60:63], a[72:75], v[120:123], 0
    s_add_u32 s9, s9, s26
    s_lshl_b32 s26, s24, 7
    s_add_u32 s9, s9, s26
    s_nop 0
    v_mfma_f32_16x16x32_bf16 v[80:83], a[144:147], v[120:123], 0
    s_mul_i32 s92, s23, 36
    s_lshl_b32 s26, s24, 2
    s_add_u32 s92, s92, s26
    s_waitcnt lgkmcnt(0)
    s_waitcnt vmcnt(31)
    s_cmp_eq_u32 s68, 1
    s_cselect_b32 s93, s2, 0
    s_cmp_ge_u32 s93, 18
    s_cselect_b32 s93, s93, 99
    s_cmp_lt_u32 s93, 54
    s_cbranch_scc0 L_nofm2
    s_lshl_b32 s93, s93, 2
    s_add_u32 s93, s93, 46157752
    v_mov_b32 v147, s3
    s_mov_b64 exec, 1
    s_nop 0
    buffer_store_dword v147, off, s[64:67], s93 sc1
    s_mov_b64 exec, -1
L_nofm2:
    s_nop 0
    v_mfma_f32_16x16x32_bf16 v[24:27], a[4:7], v[124:127], v[24:27]
    ds_read_b128 v[104:107], v21 offset:2048
    v_mfma_f32_16x16x32_bf16 v[44:47], a[76:79], v[124:127], v[44:47]
    s_add_u32 s95, s95, 14336
    s_cmp_eq_u32 s95, 258048
    s_cselect_b32 s95, 0, s95
    s_add_u32 s4, s84, s95
    buffer_load_dwordx4 a[40:43], v10, s[64:67], s4 offen sc1
    v_mfma_f32_16x16x32_bf16 v[64:67], a[148:151], v[124:127], v[64:67]
    s_mul_i32 s92, s92, 18
    s_add_u32 s92, s92, s25
    s_lshl_b32 s92, s92, 1
    s_nop 0
    v_mfma_f32_16x16x32_bf16 v[28:31], a[4:7], v[128:131], v[28:31]
    ds_read_b128 v[108:111], v21 offset:20480
    v_mfma_f32_16x16x32_bf16 v[48:51], a[76:79], v[128:131], v[48:51]
    buffer_load_dwordx4 a[112:115], v11, s[64:67], s4 offen sc1
    v_mfma_f32_16x16x32_bf16 v[68:71], a[148:151], v[128:131], v[68:71]
    s_add_u32 s92, s92, s27
    s_lshl_b32 s92, s92, 10
    s_add_u32 s92, s92, 1048576
    v_mfma_f32_16x16x32_bf16 v[32:35], a[4:7], v[132:135], v[32:35]
    ds_read_b128 v[112:115], v21 offset:38912
    v_mfma_f32_16x16x32_bf16 v[52:55], a[76:79], v[132:135], v[52:55]
    buffer_load_dwordx4 a[184:187], v12, s[64:67], s4 offen sc1
    v_mfma_f32_16x16x32_bf16 v[72:75], a[148:151], v[132:135], v[72:75]
    s_add_u32 s10, s9, 0
    s_add_u32 s11, s92, 0
    v_mfma_f32_16x16x32_bf16 v[36:39], a[4:7], v[136:139], v[36:39]
    ds_read_b128 v[116:119], v22 offset:2048
    v_mfma_f32_16x16x32_bf16 v[56:59], a[76:79], v[136:139], v[56:59]
    s_cmp_ge_u32 s22, 108
    s_cselect_b32 s12, 3, s27
    s_cselect_b32 s11, 0x7ff00000, s11
    s_nop 0
    v_mfma_f32_16x16x32_bf16 v[76:79], a[148:151], v[136:139], v[76:79]
    s_add_i32 s24, s22, -108
    s_mul_i32 s25, s24, 57
    s_lshr_b32 s25, s25, 9
    v_mfma_f32_16x16x32_bf16 v[40:43], a[4:7], v[140:143], v[40:43]
    ds_read_b128 v[120:123], v22 offset:20480
    v_mfma_f32_16x16x32_bf16 v[60:63], a[76:79], v[140:143], v[60:63]
    s_mul_i32 s26, s25, 9
    s_sub_u32 s24, s24, s26
    s_mul_i32 s6, s23, 663552
    v_mfma_f32_16x16x32_bf16 v[80:83], a[148:151], v[140:143], v[80:83]
    s_mul_i32 s26, s25, 36864
    s_add_u32 s6, s6, s26
    s_lshl_b32 s26, s24, 7
    s_waitcnt lgkmcnt(0)
    s_waitcnt vmcnt(30)
    v_mfma_f32_16x16x32_bf16 v[24:27], a[8:11], v[104:107], v[24:27]
    ds_read_b128 v[124:127], v21 offset:3072
    v_mfma_f32_16x16x32_bf16 v[44:47], a[80:83], v[104:107], v[44:47]
    s_add_u32 s95, s95, 14336
    s_cmp_eq_u32 s95, 258048
    s_cselect_b32 s95, 0, s95
    s_add_u32 s4, s84, s95
    buffer_load_dwordx4 a[44:47], v10, s[64:67], s4 offen sc1
    v_mfma_f32_16x16x32_bf16 v[64:67], a[152:155], v[104:107], v[64:67]
    s_add_u32 s6, s6, s26
    s_mul_i32 s7, s23, 36
    s_lshl_b32 s26, s24, 2
    s_nop 0
    v_mfma_f32_16x16x32_bf16 v[28:31], a[8:11], v[108:111], v[28:31]
    ds_read_b128 v[128:131], v21 offset:21504
    v_mfma_f32_16x16x32_bf16 v[48:51], a[80:83], v[108:111], v[48:51]
    buffer_load_dwordx4 a[116:119], v11, s[64:67], s4 offen sc1
    v_mfma_f32_16x16x32_bf16 v[68:71], a[152:155], v[108:111], v[68:71]
    s_add_u32 s7, s7, s26
    s_mul_i32 s7, s7, 18
    s_add_u32 s7, s7, s25
    s_nop 0
    v_mfma_f32_16x16x32_bf16 v[32:35], a[8:11], v[112:115], v[32:35]
    ds_read_b128 v[132:135], v21 offset:39936
    v_mfma_f32_16x16x32_bf16 v[52:55], a[80:83], v[112:115], v[52:55]
    buffer_load_dwordx4 a[188:191], v12, s[64:67], s4 offen sc1
    v_mfma_f32_16x16x32_bf16 v[72:75], a[152:155], v[112:115], v[72:75]
    s_lshl_b32 s7, s7, 10
    s_add_u32 s7, s7, 12582912
    s_add_u32 s13, s9, 384
    s_nop 0
    v_mfma_f32_16x16x32_bf16 v[36:39], a[8:11], v[116:119], v[36:39]
    ds_read_b128 v[136:139], v22 offset:3072
    v_mfma_f32_16x16x32_bf16 v[56:59], a[80:83], v[116:119], v[56:59]
    s_add_u32 s14, s92, 442368
    v_mfma_f32_16x16x32_bf16 v[76:79], a[152:155], v[116:119], v[76:79]
    s_cmp_ge_u32 s22, 108
    s_cselect_b32 s15, 2, s27
    s_cselect_b32 s13, s6, s13
    s_cselect_b32 s14, s7, s14
    s_nop 0
    v_mfma_f32_16x16x32_bf16 v[40:43], a[8:11], v[120:123], v[40:43]
    ds_read_b128 v[140:143], v22 offset:21504
    v_mfma_f32_16x16x32_bf16 v[60:63], a[80:83], v[120:123], v[60:63]
    s_add_i32 s24, s22, -88
    s_mul_i32 s25, s24, 57
    s_lshr_b32 s25, s25, 9
    v_mfma_f32_16x16x32_bf16 v[80:83], a[152:155], v[120:123], v[80:83]
    s_mul_i32 s26, s25, 9
    s_sub_u32 s24, s24, s26
    s_mul_i32 s6, s23, 663552
    s_waitcnt lgkmcnt(0)
    s_waitcnt vmcnt(29)
    v_mfma_f32_16x16x32_bf16 v[24:27], a[12:15], v[124:127], v[24:27]
    ds_read_b128 v[104:107], v21 offset:4096
    v_mfma_f32_16x16x32_bf16 v[44:47], a[84:87], v[124:127], v[44:47]
    s_add_u32 s95, s95, 14336
    s_cmp_eq_u32 s95, 258048
    s_cselect_b32 s95, 0, s95
    s_add_u32 s4, s84, s95
    buffer_load_dwordx4 a[48:51], v10, s[64:67], s4 offen sc1
    v_mfma_f32_16x16x32_bf16 v[64:67], a[156:159], v[124:127], v[64:67]
    s_mul_i32 s26, s25, 36864
    s_add_u32 s6, s6, s26
    s_lshl_b32 s26, s24, 7
    v_mfma_f32_16x16x32_bf16 v[28:31], a[12:15], v[128:131], v[28:31]
    ds_read_b128 v[108:111], v21 offset:22528
    v_mfma_f32_16x16x32_bf16 v[48:51], a[84:87], v[128:131], v[48:51]
    buffer_load_dwordx4 a[120:123], v11, s[64:67], s4 offen sc1
    v_mfma_f32_16x16x32_bf16 v[68:71], a[156:159], v[128:131], v[68:71]
    s_add_u32 s6, s6, s26
    s_mul_i32 s7, s23, 36
    s_lshl_b32 s26, s24, 2
    s_nop 0
    v_mfma_f32_16x16x32_bf16 v[32:35], a[12:15], v[132:135], v[32:35]
    ds_read_b128 v[112:115], v21 offset:40960
    v_mfma_f32_16x16x32_bf16 v[52:55], a[84:87], v[132:135], v[52:55]
    buffer_load_dwordx4 a[192:195], v12, s[64:67], s4 offen sc1
    v_mfma_f32_16x16x32_bf16 v[72:75], a[156:159], v[132:135], v[72:75]
    s_add_u32 s7, s7, s26
    s_mul_i32 s7, s7, 18
    s_add_u32 s7, s7, s25
    s_nop 0
    v_mfma_f32_16x16x32_bf16 v[36:39], a[12:15], v[136:139], v[36:39]
    ds_read_b128 v[116:119], v22 offset:4096
    v_mfma_f32_16x16x32_bf16 v[56:59], a[84:87], v[136:139], v[56:59]
    s_lshl_b32 s7, s7, 10
    s_add_u32 s7, s7, 12582912
    s_add_u32 s16, s9, 768
    s_nop 0
    v_mfma_f32_16x16x32_bf16 v[76:79], a[156:159], v[136:139], v[76:79]
    s_add_u32 s17, s92, 884736
    v_mfma_f32_16x16x32_bf16 v[40:43], a[12:15], v[140:143], v[40:43]
    ds_read_b128 v[120:123], v22 offset:22528
    v_mfma_f32_16x16x32_bf16 v[60:63], a[84:87], v[140:143], v[60:63]
    s_cmp_ge_u32 s22, 108
    s_cselect_b32 s18, 2, s27
    s_cselect_b32 s16, s6, s16
    s_cselect_b32 s17, s7, s17
    s_nop 0
    v_mfma_f32_16x16x32_bf16 v[80:83], a[156:159], v[140:143], v[80:83]
    s_add_i32 s24, s22, 40
    s_mul_i32 s25, s24, 57
    s_lshr_b32 s25, s25, 9
    s_waitcnt lgkmcnt(0)
    s_waitcnt vmcnt(28)
    s_cmp_ge_u32 s2, 112
    s_cbranch_scc0 L_wo4
    s_waitcnt vmcnt(12)
    v_lshrrev_b32 v164, 2, v2
    v_lshl_add_u32 v165, v3, 3, v164
    v_lshrrev_b32 v163, 1, v165
    v_xor_b32 v162, v163, v165
    v_lshrrev_b32 v162, 2, v162
    v_and_b32 v162, 1, v162
    v_and_b32_e64 v163, 1, v163
    v_lshl_or_b32 v162, v162, 1, v163
    v_lshlrev_b32 v162, 1, v162
    v_and_b32 v163, 3, v2
    v_xor_b32 v162, v162, v163
    v_lshlrev_b32 v162, 4, v162
    v_lshl_or_b32 v162, v165, 7, v162
    v_add_u32 v166, 92160, v162
    v_xor_b32 v168, 64, v166
    v_and_b32 v163, 1, v163
    v_lshlrev_b32_e64 v163, 3, v163
    v_lshl_or_b32 v163, v165, 4, v163
    v_add_u32 v170, 96256, v163
    v_add_u32 v165, 4, v165
    v_lshrrev_b32 v163, 1, v165
    v_xor_b32 v162, v163, v165
    v_lshrrev_b32 v162, 2, v162
    v_and_b32 v162, 1, v162
    v_and_b32 v163, 1, v163
    v_lshl_or_b32 v162, v162, 1, v163
    v_lshlrev_b32 v162, 1, v162
    v_and_b32 v163, 3, v2
    v_xor_b32 v162, v162, v163
    v_lshlrev_b32 v162, 4, v162
    v_lshl_or_b32 v162, v165, 7, v162
    v_add_u32 v167, 92160, v162
    v_xor_b32 v169, 64, v167
    v_and_b32 v163, 1, v163
    v_lshlrev_b32_e64 v163, 3, v163
    v_lshl_or_b32 v163, v165, 4, v163
    v_add_u32 v171, 96256, v163
    ds_read_b64_tr_b16 v[172:173], v166 offset:0
    ds_read_b64_tr_b16 v[174:175], v167 offset:0
    ds_read_b64_tr_b16 v[176:177], v166 offset:8
    ds_read_b64_tr_b16 v[178:179], v167 offset:8
    ds_read_b64_tr_b16 v[180:181], v168 offset:0
    ds_read_b64_tr_b16 v[182:183], v169 offset:0
    ds_read_b64_tr_b16 v[184:185], v168 offset:8
    ds_read_b64_tr_b16 v[186:187], v169 offset:8
    ds_read_b64_tr_b16 v[188:189], v170
    ds_read_b64_tr_b16 v[190:191], v171
    s_waitcnt lgkmcnt(0)
    s_nop 0
    buffer_store_dwordx4 v[172:175], v21, s[64:67], s57 offen sc1
    s_add_u32 s57, s57, 18432
    buffer_store_dwordx4 v[176:179], v21, s[64:67], s57 offen sc1
    s_add_u32 s57, s57, 18432
    buffer_store_dwordx4 v[180:183], v21, s[64:67], s57 offen sc1
    s_add_u32 s57, s57, 18432
    buffer_store_dwordx4 v[184:187], v21, s[64:67], s57 offen sc1
    s_add_u32 s57, s57, 18432
    buffer_store_dwordx4 v[188:191], v21, s[64:67], s57 offen sc1
L_wo4:
    v_mfma_f32_16x16x32_bf16 v[24:27], a[16:19], v[104:107], v[24:27]
    ds_read_b128 v[124:127], v21 offset:5120
    v_mfma_f32_16x16x32_bf16 v[44:47], a[88:91], v[104:107], v[44:47]
    s_add_u32 s95, s95, 14336
    s_cmp_eq_u32 s95, 258048
    s_cselect_b32 s95, 0, s95
    s_add_u32 s4, s84, s95
    buffer_load_dwordx4 a[52:55], v10, s[64:67], s4 offen sc1
    v_mfma_f32_16x16x32_bf16 v[64:67], a[160:163], v[104:107], v[64:67]
    s_mul_i32 s26, s25, 9
    s_sub_u32 s24, s24, s26
    s_mul_i32 s6, s23, 663552
    v_mfma_f32_16x16x32_bf16 v[28:31], a[16:19], v[108:111], v[28:31]
    ds_read_b128 v[128:131], v21 offset:23552
    v_mfma_f32_16x16x32_bf16 v[48:51], a[88:91], v[108:111], v[48:51]
    buffer_load_dwordx4 a[124:127], v11, s[64:67], s4 offen sc1
    v_mfma_f32_16x16x32_bf16 v[68:71], a[160:163], v[108:111], v[68:71]
    s_mul_i32 s26, s25, 36864
    s_add_u32 s6, s6, s26
    s_lshl_b32 s26, s24, 7
    v_mfma_f32_16x16x32_bf16 v[32:35], a[16:19], v[112:115], v[32:35]
    ds_read_b128 v[132:135], v21 offset:41984
    v_mfma_f32_16x16x32_bf16 v[52:55], a[88:91], v[112:115], v[52:55]
    buffer_load_dwordx4 a[196:199], v12, s[64:67], s4 offen sc1
    v_mfma_f32_16x16x32_bf16 v[72:75], a[160:163], v[112:115], v[72:75]
    s_add_u32 s6, s6, s26
    s_mul_i32 s7, s23, 36
    s_lshl_b32 s26, s24, 2
    s_nop 0
    v_mfma_f32_16x16x32_bf16 v[36:39], a[16:19], v[116:119], v[36:39]
    ds_read_b128 v[136:139], v22 offset:5120
    v_mfma_f32_16x16x32_bf16 v[56:59], a[88:91], v[116:119], v[56:59]
    s_add_u32 s7, s7, s26
    s_mul_i32 s7, s7, 18
    s_add_u32 s7, s7, s25
    s_nop 0
    v_mfma_f32_16x16x32_bf16 v[76:79], a[160:163], v[116:119], v[76:79]
    s_lshl_b32 s7, s7, 10
    s_add_u32 s7, s7, 12582912
    s_mov_b32 s19, s6
    v_mfma_f32_16x16x32_bf16 v[40:43], a[16:19], v[120:123], v[40:43]
    ds_read_b128 v[140:143], v22 offset:23552
    v_mfma_f32_16x16x32_bf16 v[60:63], a[88:91], v[120:123], v[60:63]
    s_cmp_ge_u32 s22, 122
    s_cselect_b32 s21, 3, 2
    s_cselect_b32 s20, 0x7ff00000, s7
    s_nop 0
    v_mfma_f32_16x16x32_bf16 v[80:83], a[160:163], v[120:123], v[80:83]
    s_and_b32 s5, s2, 63
    s_lshr_b32 s5, s5, 3
    s_waitcnt lgkmcnt(0)
    s_waitcnt vmcnt(27)
    v_mfma_f32_16x16x32_bf16 v[24:27], a[20:23], v[124:127], v[24:27]
    ds_read_b128 v[104:107], v21 offset:6144
    v_mfma_f32_16x16x32_bf16 v[44:47], a[92:95], v[124:127], v[44:47]
    s_add_u32 s95, s95, 14336
    s_cmp_eq_u32 s95, 258048
    s_cselect_b32 s95, 0, s95
    s_add_u32 s4, s84, s95
    buffer_load_dwordx4 a[56:59], v10, s[64:67], s4 offen sc1
    v_mfma_f32_16x16x32_bf16 v[64:67], a[164:167], v[124:127], v[64:67]
    s_mul_i32 s5, s5, 2304
    s_add_u32 s5, s5, 47316992
    v_min_u32_e64 v160, 35, v1
    v_mfma_f32_16x16x32_bf16 v[28:31], a[20:23], v[128:131], v[28:31]
    ds_read_b128 v[108:111], v21 offset:24576
    v_mfma_f32_16x16x32_bf16 v[48:51], a[92:95], v[128:131], v[48:51]
    buffer_load_dwordx4 a[128:131], v11, s[64:67], s4 offen sc1
    v_mfma_f32_16x16x32_bf16 v[68:71], a[164:167], v[128:131], v[68:71]
    v_lshlrev_b32_e64 v160, 2, v160
    v_add_u32 v160, 46157824, v160
    v_mfma_f32_16x16x32_bf16 v[32:35], a[20:23], v[132:135], v[32:35]
    ds_read_b128 v[112:115], v21 offset:43008
    v_mfma_f32_16x16x32_bf16 v[52:55], a[92:95], v[132:135], v[52:55]
    buffer_load_dwordx4 a[200:203], v12, s[64:67], s4 offen sc1
    v_mfma_f32_16x16x32_bf16 v[72:75], a[164:167], v[132:135], v[72:75]
    v_min_u32 v161, 17, v1
    v_lshlrev_b32 v161, 7, v161
    v_mfma_f32_16x16x32_bf16 v[36:39], a[20:23], v[136:139], v[36:39]
    ds_read_b128 v[116:119], v22 offset:6144
    v_mfma_f32_16x16x32_bf16 v[56:59], a[92:95], v[136:139], v[56:59]
    v_add_u32 v161, s5, v161
    v_lshrrev_b32 v4, 3, v1
    v_mfma_f32_16x16x32_bf16 v[76:79], a[164:167], v[136:139], v[76:79]
    v_lshrrev_b32 v5, 1, v4
    v_xor_b32 v150, v5, v4
    v_mfma_f32_16x16x32_bf16 v[40:43], a[20:23], v[140:143], v[40:43]
    ds_read_b128 v[120:123], v22 offset:24576
    v_mfma_f32_16x16x32_bf16 v[60:63], a[92:95], v[140:143], v[60:63]
    v_lshrrev_b32 v150, 2, v150
    v_and_b32 v150, 1, v150
    v_mfma_f32_16x16x32_bf16 v[80:83], a[164:167], v[140:143], v[80:83]
    v_and_b32_e64 v5, 1, v5
    v_lshl_or_b32 v150, v150, 1, v5
    s_waitcnt lgkmcnt(0)
    s_waitcnt vmcnt(26)
    v_mfma_f32_16x16x32_bf16 v[24:27], a[24:27], v[104:107], v[24:27]
    ds_read_b128 v[124:127], v21 offset:7168
    v_mfma_f32_16x16x32_bf16 v[44:47], a[96:99], v[104:107], v[44:47]
    s_add_u32 s95, s95, 14336
    s_cmp_eq_u32 s95, 258048
    s_cselect_b32 s95, 0, s95
    s_add_u32 s4, s84, s95
    buffer_load_dwordx4 a[60:63], v10, s[64:67], s4 offen sc1
    v_mfma_f32_16x16x32_bf16 v[64:67], a[168:171], v[104:107], v[64:67]
    v_lshlrev_b32 v150, 1, v150
    v_and_b32 v5, 7, v1
    v_mfma_f32_16x16x32_bf16 v[28:31], a[24:27], v[108:111], v[28:31]
    ds_read_b128 v[128:131], v21 offset:25600
    v_mfma_f32_16x16x32_bf16 v[48:51], a[96:99], v[108:111], v[48:51]
    buffer_load_dwordx4 a[132:135], v11, s[64:67], s4 offen sc1
    v_mfma_f32_16x16x32_bf16 v[68:71], a[168:171], v[108:111], v[68:71]
    v_xor_b32 v150, v150, v5
    v_lshrrev_b32 v4, 3, v1
    v_mfma_f32_16x16x32_bf16 v[32:35], a[24:27], v[112:115], v[32:35]
    ds_read_b128 v[132:135], v21 offset:44032
    v_mfma_f32_16x16x32_bf16 v[52:55], a[96:99], v[112:115], v[52:55]
    buffer_load_dwordx4 a[204:207], v12, s[64:67], s4 offen sc1
    v_mfma_f32_16x16x32_bf16 v[72:75], a[168:171], v[112:115], v[72:75]
    v_or_b32 v4, 8, v4
    v_lshrrev_b32 v5, 1, v4
    v_mfma_f32_16x16x32_bf16 v[36:39], a[24:27], v[116:119], v[36:39]
    ds_read_b128 v[136:139], v22 offset:7168
    v_mfma_f32_16x16x32_bf16 v[56:59], a[96:99], v[116:119], v[56:59]
    v_xor_b32 v151, v5, v4
    v_lshrrev_b32 v151, 2, v151
    v_mfma_f32_16x16x32_bf16 v[76:79], a[168:171], v[116:119], v[76:79]
    v_and_b32 v151, 1, v151
    v_and_b32 v5, 1, v5
    v_mfma_f32_16x16x32_bf16 v[40:43], a[24:27], v[120:123], v[40:43]
    ds_read_b128 v[140:143], v22 offset:25600
    v_mfma_f32_16x16x32_bf16 v[60:63], a[96:99], v[120:123], v[60:63]
    v_lshl_or_b32 v151, v151, 1, v5
    v_lshlrev_b32_e64 v151, 1, v151
    v_mfma_f32_16x16x32_bf16 v[80:83], a[168:171], v[120:123], v[80:83]
    v_and_b32 v5, 7, v1
    v_xor_b32 v151, v151, v5
    s_waitcnt lgkmcnt(0)
    s_waitcnt vmcnt(25)
    v_mfma_f32_16x16x32_bf16 v[24:27], a[28:31], v[124:127], v[24:27]
    ds_read_b128 v[104:107], v21 offset:8192
    v_mfma_f32_16x16x32_bf16 v[44:47], a[100:103], v[124:127], v[44:47]
    s_add_u32 s95, s95, 14336
    s_cmp_eq_u32 s95, 258048
    s_cselect_b32 s95, 0, s95
    s_add_u32 s4, s84, s95
    buffer_load_dwordx4 a[64:67], v10, s[64:67], s4 offen sc1
    v_mfma_f32_16x16x32_bf16 v[64:67], a[172:175], v[124:127], v[64:67]
    v_lshlrev_b32 v150, 4, v150
    v_lshlrev_b32 v151, 4, v151
    v_mfma_f32_16x16x32_bf16 v[28:31], a[28:31], v[128:131], v[28:31]
    ds_read_b128 v[108:111], v21 offset:26624
    v_mfma_f32_16x16x32_bf16 v[48:51], a[100:103], v[128:131], v[48:51]
    buffer_load_dwordx4 a[136:139], v11, s[64:67], s4 offen sc1
    v_mfma_f32_16x16x32_bf16 v[68:71], a[172:175], v[128:131], v[68:71]
    v_lshrrev_b32_e64 v146, 3, v1
    v_mfma_f32_16x16x32_bf16 v[32:35], a[28:31], v[132:135], v[32:35]
    ds_read_b128 v[112:115], v21 offset:45056
    v_mfma_f32_16x16x32_bf16 v[52:55], a[100:103], v[132:135], v[52:55]
    buffer_load_dwordx4 a[208:211], v12, s[64:67], s4 offen sc1
    v_mfma_f32_16x16x32_bf16 v[72:75], a[172:175], v[132:135], v[72:75]
    s_lshl_b32 s27, s68, 14
    s_nop 0
    v_mfma_f32_16x16x32_bf16 v[36:39], a[28:31], v[136:139], v[36:39]
    ds_read_b128 v[116:119], v22 offset:8192
    v_mfma_f32_16x16x32_bf16 v[56:59], a[100:103], v[136:139], v[56:59]
    s_add_u32 s27, s27, 98304
    v_lshlrev_b32_e64 v4, 2, v3
    v_mfma_f32_16x16x32_bf16 v[76:79], a[172:175], v[136:139], v[76:79]
    v_add_u32 v4, 8, v4
    v_mul_u32_u24 v5, 57, v4
    v_mfma_f32_16x16x32_bf16 v[40:43], a[28:31], v[140:143], v[40:43]
    ds_read_b128 v[120:123], v22 offset:26624
    v_mfma_f32_16x16x32_bf16 v[60:63], a[100:103], v[140:143], v[60:63]
    v_lshrrev_b32_e64 v5, 10, v5
    v_mul_u32_u24 v5, 6328, v5
    v_mfma_f32_16x16x32_bf16 v[80:83], a[172:175], v[140:143], v[80:83]
    v_mul_u32_u24_e64 v4, 4, v4
    v_mul_u32_u24 v6, 80, v2
    s_waitcnt lgkmcnt(0)
    s_waitcnt vmcnt(24)
    v_mfma_f32_16x16x32_bf16 v[24:27], a[32:35], v[104:107], v[24:27]
    ds_read_b128 v[124:127], v21 offset:9216
    v_mfma_f32_16x16x32_bf16 v[44:47], a[104:107], v[104:107], v[44:47]
    s_add_u32 s95, s95, 14336
    s_cmp_eq_u32 s95, 258048
    s_cselect_b32 s95, 0, s95
    s_add_u32 s4, s84, s95
    buffer_load_dwordx4 a[68:71], v10, s[64:67], s4 offen sc1
    v_mfma_f32_16x16x32_bf16 v[64:67], a[176:179], v[104:107], v[64:67]
    v_add3_u32 v152, v4, v5, v6
    v_add_u32 v152, 15360, v152
    v_mfma_f32_16x16x32_bf16 v[28:31], a[32:35], v[108:111], v[28:31]
    ds_read_b128 v[128:131], v21 offset:27648
    v_mfma_f32_16x16x32_bf16 v[48:51], a[104:107], v[108:111], v[48:51]
    buffer_load_dwordx4 a[140:143], v11, s[64:67], s4 offen sc1
    v_mfma_f32_16x16x32_bf16 v[68:71], a[176:179], v[108:111], v[68:71]
    v_lshlrev_b32 v4, 2, v3
    v_add_u32 v4, 10, v4
    v_mfma_f32_16x16x32_bf16 v[32:35], a[32:35], v[112:115], v[32:35]
    ds_read_b128 v[132:135], v21 offset:46080
    v_mfma_f32_16x16x32_bf16 v[52:55], a[104:107], v[112:115], v[52:55]
    buffer_load_dwordx4 a[212:215], v12, s[64:67], s4 offen sc1
    v_mfma_f32_16x16x32_bf16 v[72:75], a[176:179], v[112:115], v[72:75]
    v_mul_u32_u24 v5, 57, v4
    v_lshrrev_b32 v5, 10, v5
    v_mfma_f32_16x16x32_bf16 v[36:39], a[32:35], v[116:119], v[36:39]
    ds_read_b128 v[136:139], v22 offset:9216
    v_mfma_f32_16x16x32_bf16 v[56:59], a[104:107], v[116:119], v[56:59]
    v_mul_u32_u24 v5, 6328, v5
    v_mul_u32_u24_e64 v4, 4, v4
    v_mfma_f32_16x16x32_bf16 v[76:79], a[176:179], v[116:119], v[76:79]
    v_mul_u32_u24 v6, 80, v2
    v_add3_u32 v153, v4, v5, v6
    v_mfma_f32_16x16x32_bf16 v[40:43], a[32:35], v[120:123], v[40:43]
    ds_read_b128 v[140:143], v22 offset:27648
    v_mfma_f32_16x16x32_bf16 v[60:63], a[104:107], v[120:123], v[60:63]
    v_add_u32 v153, 15360, v153
    v_lshlrev_b32_e64 v4, 2, v3
    v_mfma_f32_16x16x32_bf16 v[80:83], a[176:179], v[120:123], v[80:83]
    v_add_u32 v4, 24, v4
    v_mul_u32_u24 v5, 57, v4
    s_waitcnt lgkmcnt(0)
    s_waitcnt vmcnt(24)
    s_cmp_ge_u32 s2, 112
    s_cbranch_scc0 L_wo9
    s_waitcnt vmcnt(15)
    s_lshl_b32 s52, s2, 7
    s_add_u32 s52, s52, 47302656
    v_mov_b32 v162, s3
    s_mov_b64 exec, 1
    s_nop 0
    buffer_store_dword v162, off, s[64:67], s52 sc1
    s_mov_b64 exec, -1
L_wo9:
    s_nop 0
    v_mfma_f32_16x16x32_bf16 v[24:27], a[36:39], v[124:127], v[24:27]
    ds_read_b128 v[104:107], v21 offset:10240
    v_mfma_f32_16x16x32_bf16 v[44:47], a[108:111], v[124:127], v[44:47]
    buffer_load_dword v7, v160, s[64:67], 0 offen sc1
    v_mfma_f32_16x16x32_bf16 v[64:67], a[180:183], v[124:127], v[64:67]
    s_cmp_eq_u32 s12, 1
    s_cselect_b32 s72, s44, s40
    s_cselect_b32 s73, s45, s41
    s_nop 0
    v_mfma_f32_16x16x32_bf16 v[28:31], a[36:39], v[128:131], v[28:31]
    ds_read_b128 v[108:111], v21 offset:28672
    v_mfma_f32_16x16x32_bf16 v[48:51], a[108:111], v[128:131], v[48:51]
    s_cmp_eq_u32 s12, 2
    s_cselect_b32 s72, s48, s72
    s_cselect_b32 s73, s49, s73
    s_movk_i32 s8, 9216
    s_cselect_b32 s8, 1152, s8
    v_mfma_f32_16x16x32_bf16 v[68:71], a[180:183], v[128:131], v[68:71]
    s_mov_b32 s74, 5308416
    s_cmp_eq_u32 s12, 3
    s_cselect_b32 s74, 0, s74
    s_mov_b32 s75, 0x20000
    v_mfma_f32_16x16x32_bf16 v[32:35], a[36:39], v[132:135], v[32:35]
    ds_read_b128 v[112:115], v21 offset:47104
    v_mfma_f32_16x16x32_bf16 v[52:55], a[108:111], v[132:135], v[52:55]
    v_mul_u32_u24_e64 v147, s8, v146
    v_mfma_f32_16x16x32_bf16 v[72:75], a[180:183], v[132:135], v[72:75]
    v_add_u32_e64 v144, v147, v150
    v_mfma_f32_16x16x32_bf16 v[36:39], a[36:39], v[136:139], v[36:39]
    ds_read_b128 v[116:119], v22 offset:10240
    v_mfma_f32_16x16x32_bf16 v[56:59], a[108:111], v[136:139], v[56:59]
    v_add_u32_e64 v145, v147, v151
    v_mfma_f32_16x16x32_bf16 v[76:79], a[180:183], v[136:139], v[76:79]
    s_lshl_b32 s26, s8, 3
    s_nop 0
    v_mfma_f32_16x16x32_bf16 v[40:43], a[36:39], v[140:143], v[40:43]
    ds_read_b128 v[120:123], v22 offset:28672
    v_mfma_f32_16x16x32_bf16 v[60:63], a[108:111], v[140:143], v[60:63]
    v_lshrrev_b32_e64 v5, 10, v5
    v_mul_u32_u24 v5, 6328, v5
    v_mfma_f32_16x16x32_bf16 v[80:83], a[180:183], v[140:143], v[80:83]
    s_add_u32 m0, s27, 0
    s_nop 0
    buffer_load_dwordx4 v144, s[72:75], s10 offen lds
L_stub_6:
    s_cbranch_execz L_tchret_m0_m1
    s_waitcnt lgkmcnt(0)
    s_waitcnt vmcnt(23)
    s_nop 0
    v_mfma_f32_16x16x32_bf16 v[24:27], a[40:43], v[104:107], v[24:27]
    ds_read_b128 v[124:127], v21 offset:11264
    v_mfma_f32_16x16x32_bf16 v[44:47], a[112:115], v[104:107], v[44:47]
    s_add_u32 m0, s27, 1024
    s_add_u32 s10, s10, s26
    s_nop 0
    buffer_load_dwordx4 v145, s[72:75], s10 offen lds
    v_mfma_f32_16x16x32_bf16 v[64:67], a[184:187], v[104:107], v[64:67]
    s_add_u32 m0, s27, 2048
    s_add_u32 s10, s10, s26
    s_nop 0
    buffer_load_dwordx4 v144, s[72:75], s10 offen lds
    v_mfma_f32_16x16x32_bf16 v[28:31], a[40:43], v[108:111], v[28:31]
    ds_read_b128 v[128:131], v21 offset:29696
    v_mfma_f32_16x16x32_bf16 v[48:51], a[112:115], v[108:111], v[48:51]
    v_mul_u32_u24_e64 v4, 4, v4
    v_mul_u32_u24 v6, 80, v2
    v_mfma_f32_16x16x32_bf16 v[68:71], a[184:187], v[108:111], v[68:71]
    v_add3_u32 v154, v4, v5, v6
    v_add_u32 v154, 15360, v154
    v_mfma_f32_16x16x32_bf16 v[32:35], a[40:43], v[112:115], v[32:35]
    ds_read_b128 v[132:135], v21 offset:48128
    v_mfma_f32_16x16x32_bf16 v[52:55], a[112:115], v[112:115], v[52:55]
    v_lshlrev_b32 v4, 2, v3
    v_add_u32 v4, 26, v4
    v_mfma_f32_16x16x32_bf16 v[72:75], a[184:187], v[112:115], v[72:75]
    v_mul_u32_u24 v5, 57, v4
    v_lshrrev_b32 v5, 10, v5
    v_mfma_f32_16x16x32_bf16 v[36:39], a[40:43], v[116:119], v[36:39]
    ds_read_b128 v[136:139], v22 offset:11264
    v_mfma_f32_16x16x32_bf16 v[56:59], a[112:115], v[116:119], v[56:59]
    v_mul_u32_u24 v5, 6328, v5
    v_mul_u32_u24_e64 v4, 4, v4
    v_mfma_f32_16x16x32_bf16 v[76:79], a[184:187], v[116:119], v[76:79]
    v_mul_u32_u24 v6, 80, v2
    v_add3_u32 v155, v4, v5, v6
    v_mfma_f32_16x16x32_bf16 v[40:43], a[40:43], v[120:123], v[40:43]
    ds_read_b128 v[140:143], v22 offset:29696
    v_mfma_f32_16x16x32_bf16 v[60:63], a[112:115], v[120:123], v[60:63]
    v_add_u32 v155, 15360, v155
    v_lshlrev_b32_e64 v4, 2, v3
    v_mfma_f32_16x16x32_bf16 v[80:83], a[184:187], v[120:123], v[80:83]
    v_add_u32 v4, 64, v4
    v_mul_u32_u24 v5, 57, v4
    s_waitcnt lgkmcnt(0)
    s_waitcnt vmcnt(22)
    v_mfma_f32_16x16x32_bf16 v[24:27], a[44:47], v[124:127], v[24:27]
    ds_read_b128 v[104:107], v21 offset:12288
    v_mfma_f32_16x16x32_bf16 v[44:47], a[116:119], v[124:127], v[44:47]
    s_add_u32 m0, s27, 3072
    s_add_u32 s10, s10, s26
    s_nop 0
    buffer_load_dwordx4 v145, s[72:75], s10 offen lds
    v_mfma_f32_16x16x32_bf16 v[64:67], a[188:191], v[124:127], v[64:67]
    s_cmp_eq_u32 s15, 1
    s_cselect_b32 s72, s44, s40
    s_cselect_b32 s73, s45, s41
    s_nop 0
    v_mfma_f32_16x16x32_bf16 v[28:31], a[44:47], v[128:131], v[28:31]
    ds_read_b128 v[108:111], v21 offset:30720
    v_mfma_f32_16x16x32_bf16 v[48:51], a[116:119], v[128:131], v[48:51]
    s_cmp_eq_u32 s15, 2
    s_cselect_b32 s72, s48, s72
    s_cselect_b32 s73, s49, s73
    s_movk_i32 s8, 9216
    s_cselect_b32 s8, 1152, s8
    v_mfma_f32_16x16x32_bf16 v[68:71], a[188:191], v[128:131], v[68:71]
    s_mov_b32 s74, 5308416
    s_cmp_eq_u32 s15, 3
    s_cselect_b32 s74, 0, s74
    s_mov_b32 s75, 0x20000
    v_mfma_f32_16x16x32_bf16 v[32:35], a[44:47], v[132:135], v[32:35]
    ds_read_b128 v[112:115], v21 offset:49152
    v_mfma_f32_16x16x32_bf16 v[52:55], a[116:119], v[132:135], v[52:55]
    v_mul_u32_u24_e64 v147, s8, v146
    v_mfma_f32_16x16x32_bf16 v[72:75], a[188:191], v[132:135], v[72:75]
    v_add_u32_e64 v144, v147, v150
    v_mfma_f32_16x16x32_bf16 v[36:39], a[44:47], v[136:139], v[36:39]
    ds_read_b128 v[116:119], v22 offset:12288
    v_mfma_f32_16x16x32_bf16 v[56:59], a[116:119], v[136:139], v[56:59]
    v_add_u32_e64 v145, v147, v151
    v_mfma_f32_16x16x32_bf16 v[76:79], a[188:191], v[136:139], v[76:79]
    s_lshl_b32 s26, s8, 3
    s_nop 0
    v_mfma_f32_16x16x32_bf16 v[40:43], a[44:47], v[140:143], v[40:43]
    ds_read_b128 v[120:123], v22 offset:30720
    v_mfma_f32_16x16x32_bf16 v[60:63], a[116:119], v[140:143], v[60:63]
    v_lshrrev_b32_e64 v5, 10, v5
    v_mul_u32_u24 v5, 3804, v5
    v_mfma_f32_16x16x32_bf16 v[80:83], a[188:191], v[140:143], v[80:83]
    s_add_u32 m0, s27, 4096
    s_nop 0
    s_nop 0
    buffer_load_dwordx4 v144, s[72:75], s13 offen lds
    s_waitcnt lgkmcnt(0)
    s_waitcnt vmcnt(21)
    v_mfma_f32_16x16x32_bf16 v[24:27], a[48:51], v[104:107], v[24:27]
    ds_read_b128 v[124:127], v21 offset:13312
    v_mfma_f32_16x16x32_bf16 v[44:47], a[120:123], v[104:107], v[44:47]
    s_add_u32 m0, s27, 5120
    s_add_u32 s13, s13, s26
    s_nop 0
    buffer_load_dwordx4 v145, s[72:75], s13 offen lds
    v_mfma_f32_16x16x32_bf16 v[64:67], a[192:195], v[104:107], v[64:67]
    s_add_u32 m0, s27, 6144
    s_add_u32 s13, s13, s26
    s_nop 0
    buffer_load_dwordx4 v144, s[72:75], s13 offen lds
    v_mfma_f32_16x16x32_bf16 v[28:31], a[48:51], v[108:111], v[28:31]
    ds_read_b128 v[128:131], v21 offset:31744
    v_mfma_f32_16x16x32_bf16 v[48:51], a[120:123], v[108:111], v[48:51]
    v_mul_u32_u24 v4, 2, v4
    v_mul_u32_u24 v6, 48, v2
    v_mfma_f32_16x16x32_bf16 v[68:71], a[192:195], v[108:111], v[68:71]
    v_add3_u32 v156, v4, v5, v6
    v_add_u32_e64 v156, 0, v156
    v_mfma_f32_16x16x32_bf16 v[32:35], a[48:51], v[112:115], v[32:35]
    ds_read_b128 v[132:135], v21 offset:50176
    v_mfma_f32_16x16x32_bf16 v[52:55], a[120:123], v[112:115], v[52:55]
    v_lshlrev_b32_e64 v4, 2, v3
    v_add_u32 v4, 66, v4
    v_mfma_f32_16x16x32_bf16 v[72:75], a[192:195], v[112:115], v[72:75]
    v_mul_u32_u24 v5, 57, v4
    v_lshrrev_b32 v5, 10, v5
    v_mfma_f32_16x16x32_bf16 v[36:39], a[48:51], v[116:119], v[36:39]
    ds_read_b128 v[136:139], v22 offset:13312
    v_mfma_f32_16x16x32_bf16 v[56:59], a[120:123], v[116:119], v[56:59]
    v_mul_u32_u24 v5, 3804, v5
    v_mul_u32_u24_e64 v4, 2, v4
    v_mfma_f32_16x16x32_bf16 v[76:79], a[192:195], v[116:119], v[76:79]
    v_mul_u32_u24_e64 v6, 48, v2
    v_add3_u32 v157, v4, v5, v6
    v_mfma_f32_16x16x32_bf16 v[40:43], a[48:51], v[120:123], v[40:43]
    ds_read_b128 v[140:143], v22 offset:31744
    v_mfma_f32_16x16x32_bf16 v[60:63], a[120:123], v[120:123], v[60:63]
    v_add_u32 v157, 0, v157
    v_lshlrev_b32 v4, 2, v3
    v_mfma_f32_16x16x32_bf16 v[80:83], a[192:195], v[120:123], v[80:83]
    v_add_u32 v4, -8, v4
    v_mul_u32_u24 v5, 57, v4
    s_waitcnt lgkmcnt(0)
    s_waitcnt vmcnt(20)
    s_waitcnt vmcnt(7)
    s_mov_b32 s88, 0
L_pw2:
    v_cmp_ne_u32 vcc, s3, v7
    s_nop 2
    s_cbranch_vccz L_pw2_ok
    s_add_u32 s88, s88, 1
    s_cmp_gt_u32 s88, 262144
    s_cbranch_scc1 L_pw2_ok
    s_nop 0
    buffer_load_dword v7, v160, s[64:67], 0 offen sc1
    s_waitcnt vmcnt(0)
    s_branch L_pw2
L_pw2_ok:
    v_mfma_f32_16x16x32_bf16 v[24:27], a[52:55], v[124:127], v[24:27]
    ds_read_b128 v[104:107], v21 offset:14336
    v_mfma_f32_16x16x32_bf16 v[44:47], a[124:127], v[124:127], v[44:47]
    s_add_u32 m0, s27, 7168
    s_add_u32 s13, s13, s26
    s_nop 0
    buffer_load_dwordx4 v145, s[72:75], s13 offen lds
    v_mfma_f32_16x16x32_bf16 v[64:67], a[196:199], v[124:127], v[64:67]
    s_cmp_eq_u32 s18, 1
    s_cselect_b32 s72, s44, s40
    s_cselect_b32 s73, s45, s41
    s_nop 0
    v_mfma_f32_16x16x32_bf16 v[28:31], a[52:55], v[128:131], v[28:31]
    ds_read_b128 v[108:111], v21 offset:32768
    v_mfma_f32_16x16x32_bf16 v[48:51], a[124:127], v[128:131], v[48:51]
    s_cmp_eq_u32 s18, 2
    s_cselect_b32 s72, s48, s72
    s_cselect_b32 s73, s49, s73
    s_movk_i32 s8, 9216
    s_cselect_b32 s8, 1152, s8
    v_mfma_f32_16x16x32_bf16 v[68:71], a[196:199], v[128:131], v[68:71]
    s_mov_b32 s74, 5308416
    s_cmp_eq_u32 s18, 3
    s_cselect_b32 s74, 0, s74
    s_mov_b32 s75, 0x20000
    v_mfma_f32_16x16x32_bf16 v[32:35], a[52:55], v[132:135], v[32:35]
    ds_read_b128 v[112:115], v21 offset:51200
    v_mfma_f32_16x16x32_bf16 v[52:55], a[124:127], v[132:135], v[52:55]
    v_mul_u32_u24_e64 v147, s8, v146
    v_mfma_f32_16x16x32_bf16 v[72:75], a[196:199], v[132:135], v[72:75]
    v_add_u32_e64 v144, v147, v150
    v_mfma_f32_16x16x32_bf16 v[36:39], a[52:55], v[136:139], v[36:39]
    ds_read_b128 v[116:119], v22 offset:14336
    v_mfma_f32_16x16x32_bf16 v[56:59], a[124:127], v[136:139], v[56:59]
    v_add_u32_e64 v145, v147, v151
    v_mfma_f32_16x16x32_bf16 v[76:79], a[196:199], v[136:139], v[76:79]
    s_lshl_b32 s26, s8, 3
    s_nop 0
    v_mfma_f32_16x16x32_bf16 v[40:43], a[52:55], v[140:143], v[40:43]
    ds_read_b128 v[120:123], v22 offset:32768
    v_mfma_f32_16x16x32_bf16 v[60:63], a[124:127], v[140:143], v[60:63]
    v_lshrrev_b32_e64 v5, 10, v5
    v_mul_u32_u24 v5, 6328, v5
    v_mfma_f32_16x16x32_bf16 v[80:83], a[196:199], v[140:143], v[80:83]
    s_add_u32 m0, s27, 8192
    s_nop 0
    s_nop 0
    buffer_load_dwordx4 v144, s[72:75], s16 offen lds
    s_waitcnt lgkmcnt(0)
    s_nop 0
    v_mfma_f32_16x16x32_bf16 v[24:27], a[56:59], v[104:107], v[24:27]
    ds_read_b128 v[124:127], v21 offset:15360
    v_mfma_f32_16x16x32_bf16 v[44:47], a[128:131], v[104:107], v[44:47]
    s_add_u32 m0, s27, 9216
    s_add_u32 s16, s16, s26
    s_nop 0
    buffer_load_dwordx4 v145, s[72:75], s16 offen lds
    v_mfma_f32_16x16x32_bf16 v[64:67], a[200:203], v[104:107], v[64:67]
    s_add_u32 m0, s27, 10240
    s_add_u32 s16, s16, s26
    s_nop 0
    buffer_load_dwordx4 v144, s[72:75], s16 offen lds
    v_mfma_f32_16x16x32_bf16 v[28:31], a[56:59], v[108:111], v[28:31]
    ds_read_b128 v[128:131], v21 offset:33792
    v_mfma_f32_16x16x32_bf16 v[48:51], a[128:131], v[108:111], v[48:51]
    v_mul_u32_u24_e64 v4, 4, v4
    v_mul_u32_u24 v6, 80, v2
    v_mfma_f32_16x16x32_bf16 v[68:71], a[200:203], v[108:111], v[68:71]
    v_add3_u32 v158, v4, v5, v6
    v_add_u32 v158, 15360, v158
    v_mfma_f32_16x16x32_bf16 v[32:35], a[56:59], v[112:115], v[32:35]
    ds_read_b128 v[132:135], v21 offset:52224
    v_mfma_f32_16x16x32_bf16 v[52:55], a[128:131], v[112:115], v[52:55]
    v_lshlrev_b32 v4, 2, v3
    v_add_u32 v4, -6, v4
    v_mfma_f32_16x16x32_bf16 v[72:75], a[200:203], v[112:115], v[72:75]
    v_mul_u32_u24 v5, 57, v4
    v_lshrrev_b32 v5, 10, v5
    v_mfma_f32_16x16x32_bf16 v[36:39], a[56:59], v[116:119], v[36:39]
    ds_read_b128 v[136:139], v22 offset:15360
    v_mfma_f32_16x16x32_bf16 v[56:59], a[128:131], v[116:119], v[56:59]
    v_mul_u32_u24 v5, 6328, v5
    v_mul_u32_u24_e64 v4, 4, v4
    v_mfma_f32_16x16x32_bf16 v[76:79], a[200:203], v[116:119], v[76:79]
    v_mul_u32_u24 v6, 80, v2
    v_add3_u32 v159, v4, v5, v6
    v_mfma_f32_16x16x32_bf16 v[40:43], a[56:59], v[120:123], v[40:43]
    ds_read_b128 v[140:143], v22 offset:33792
    v_mfma_f32_16x16x32_bf16 v[60:63], a[128:131], v[120:123], v[60:63]
    v_add_u32 v159, 15360, v159
    v_mfma_f32_16x16x32_bf16 v[80:83], a[200:203], v[120:123], v[80:83]
    s_waitcnt lgkmcnt(0)
    s_nop 0
    v_mfma_f32_16x16x32_bf16 v[24:27], a[60:63], v[124:127], v[24:27]
    ds_read_b128 v[104:107], v21 offset:16384
    v_mfma_f32_16x16x32_bf16 v[44:47], a[132:135], v[124:127], v[44:47]
    s_add_u32 m0, s27, 11264
    s_add_u32 s16, s16, s26
    s_nop 0
    buffer_load_dwordx4 v145, s[72:75], s16 offen lds
    v_mfma_f32_16x16x32_bf16 v[64:67], a[204:207], v[124:127], v[64:67]
    s_cmp_eq_u32 s21, 1
    s_cselect_b32 s72, s44, s40
    s_cselect_b32 s73, s45, s41
    s_nop 0
    v_mfma_f32_16x16x32_bf16 v[28:31], a[60:63], v[128:131], v[28:31]
    ds_read_b128 v[108:111], v21 offset:34816
    v_mfma_f32_16x16x32_bf16 v[48:51], a[132:135], v[128:131], v[48:51]
    s_cmp_eq_u32 s21, 2
    s_cselect_b32 s72, s48, s72
    s_cselect_b32 s73, s49, s73
    s_movk_i32 s8, 9216
    s_cselect_b32 s8, 1152, s8
    v_mfma_f32_16x16x32_bf16 v[68:71], a[204:207], v[128:131], v[68:71]
    s_mov_b32 s74, 5308416
    s_cmp_eq_u32 s21, 3
    s_cselect_b32 s74, 0, s74
    s_mov_b32 s75, 0x20000
    v_mfma_f32_16x16x32_bf16 v[32:35], a[60:63], v[132:135], v[32:35]
    ds_read_b128 v[112:115], v21 offset:53248
    v_mfma_f32_16x16x32_bf16 v[52:55], a[132:135], v[132:135], v[52:55]
    v_mul_u32_u24_e64 v147, s8, v146
    v_mfma_f32_16x16x32_bf16 v[72:75], a[204:207], v[132:135], v[72:75]
    v_add_u32_e64 v144, v147, v150
    v_mfma_f32_16x16x32_bf16 v[36:39], a[60:63], v[136:139], v[36:39]
    ds_read_b128 v[116:119], v22 offset:16384
    v_mfma_f32_16x16x32_bf16 v[56:59], a[132:135], v[136:139], v[56:59]
    v_add_u32_e64 v145, v147, v151
    v_mfma_f32_16x16x32_bf16 v[76:79], a[204:207], v[136:139], v[76:79]
    s_lshl_b32 s26, s8, 3
    s_nop 0
    v_mfma_f32_16x16x32_bf16 v[40:43], a[60:63], v[140:143], v[40:43]
    ds_read_b128 v[120:123], v22 offset:34816
    v_mfma_f32_16x16x32_bf16 v[60:63], a[132:135], v[140:143], v[60:63]
    v_mfma_f32_16x16x32_bf16 v[80:83], a[204:207], v[140:143], v[80:83]
    s_add_u32 m0, s27, 12288
    s_nop 0
    s_nop 0
    buffer_load_dwordx4 v144, s[72:75], s19 offen lds
    s_waitcnt lgkmcnt(0)
    s_nop 0
    v_mfma_f32_16x16x32_bf16 v[24:27], a[64:67], v[104:107], v[24:27]
    ds_read_b128 v[124:127], v21 offset:17408
    v_mfma_f32_16x16x32_bf16 v[44:47], a[136:139], v[104:107], v[44:47]
    s_add_u32 m0, s27, 13312
    s_add_u32 s19, s19, s26
    s_nop 0
    buffer_load_dwordx4 v145, s[72:75], s19 offen lds
    v_mfma_f32_16x16x32_bf16 v[64:67], a[208:211], v[104:107], v[64:67]
    s_add_u32 m0, s27, 14336
    s_add_u32 s19, s19, s26
    s_nop 0
    buffer_load_dwordx4 v144, s[72:75], s19 offen lds
    v_mfma_f32_16x16x32_bf16 v[28:31], a[64:67], v[108:111], v[28:31]
    ds_read_b128 v[128:131], v21 offset:35840
    v_mfma_f32_16x16x32_bf16 v[48:51], a[136:139], v[108:111], v[48:51]
    v_mfma_f32_16x16x32_bf16 v[68:71], a[208:211], v[108:111], v[68:71]
    v_mfma_f32_16x16x32_bf16 v[32:35], a[64:67], v[112:115], v[32:35]
    ds_read_b128 v[132:135], v21 offset:54272
    v_mfma_f32_16x16x32_bf16 v[52:55], a[136:139], v[112:115], v[52:55]
    v_mfma_f32_16x16x32_bf16 v[72:75], a[208:211], v[112:115], v[72:75]
    v_mfma_f32_16x16x32_bf16 v[36:39], a[64:67], v[116:119], v[36:39]
    ds_read_b128 v[136:139], v22 offset:17408
    v_mfma_f32_16x16x32_bf16 v[56:59], a[136:139], v[116:119], v[56:59]
    v_mfma_f32_16x16x32_bf16 v[76:79], a[208:211], v[116:119], v[76:79]
    v_mfma_f32_16x16x32_bf16 v[40:43], a[64:67], v[120:123], v[40:43]
    ds_read_b128 v[140:143], v22 offset:35840
    v_mfma_f32_16x16x32_bf16 v[60:63], a[136:139], v[120:123], v[60:63]
    v_mfma_f32_16x16x32_bf16 v[80:83], a[208:211], v[120:123], v[80:83]
    s_waitcnt lgkmcnt(0)
    s_nop 0
    v_mfma_f32_16x16x32_bf16 v[24:27], a[68:71], v[124:127], v[24:27]
    v_mfma_f32_16x16x32_bf16 v[44:47], a[140:143], v[124:127], v[44:47]
    s_add_u32 m0, s27, 15360
    s_add_u32 s19, s19, s26
    s_nop 0
    buffer_load_dwordx4 v145, s[72:75], s19 offen lds
    v_mfma_f32_16x16x32_bf16 v[64:67], a[212:215], v[124:127], v[64:67]
    v_mfma_f32_16x16x32_bf16 v[28:31], a[68:71], v[128:131], v[28:31]
    v_mfma_f32_16x16x32_bf16 v[48:51], a[140:143], v[128:131], v[48:51]
    v_mfma_f32_16x16x32_bf16 v[68:71], a[212:215], v[128:131], v[68:71]
    v_mfma_f32_16x16x32_bf16 v[32:35], a[68:71], v[132:135], v[32:35]
    v_mfma_f32_16x16x32_bf16 v[52:55], a[140:143], v[132:135], v[52:55]
    v_mfma_f32_16x16x32_bf16 v[72:75], a[212:215], v[132:135], v[72:75]
    v_mfma_f32_16x16x32_bf16 v[36:39], a[68:71], v[136:139], v[36:39]
    v_mfma_f32_16x16x32_bf16 v[56:59], a[140:143], v[136:139], v[56:59]
    v_mfma_f32_16x16x32_bf16 v[76:79], a[212:215], v[136:139], v[76:79]
    v_mfma_f32_16x16x32_bf16 v[40:43], a[68:71], v[140:143], v[40:43]
    v_mfma_f32_16x16x32_bf16 v[60:63], a[140:143], v[140:143], v[60:63]
    v_mfma_f32_16x16x32_bf16 v[80:83], a[212:215], v[140:143], v[80:83]
    s_barrier
    s_nop 0
    ds_write_b64 v152, v[44:45] offset:0
    ds_write_b64 v153, v[46:47] offset:0
    ds_write_b64 v152, v[48:49] offset:1280
    ds_write_b64 v153, v[50:51] offset:1280
    ds_write_b64 v152, v[52:53] offset:2560
    ds_write_b64 v153, v[54:55] offset:2560
    ds_write_b64 v152, v[56:57] offset:3840
    ds_write_b64 v153, v[58:59] offset:3840
    ds_write_b64 v152, v[60:61] offset:5120
    ds_write_b64 v153, v[62:63] offset:5120
    ds_write_b64 v154, v[64:65] offset:0
    ds_write_b64 v155, v[66:67] offset:0
    ds_write_b64 v154, v[68:69] offset:1280
    ds_write_b64 v155, v[70:71] offset:1280
    ds_write_b64 v154, v[72:73] offset:2560
    ds_write_b64 v155, v[74:75] offset:2560
    ds_write_b64 v154, v[76:77] offset:3840
    ds_write_b64 v155, v[78:79] offset:3840
    ds_write_b64 v154, v[80:81] offset:5120
    ds_write_b64 v155, v[82:83] offset:5120
    s_mov_b32 exec_lo, -1
    s_mov_b32 exec_hi, 0
    v_cvt_pk_bf16_f32 v4, v24, v25
    ds_write_b32 v156, v4 offset:0
    v_cvt_pk_bf16_f32 v5, v26, v27
    ds_write_b32 v157, v5 offset:0
    v_cvt_pk_bf16_f32 v6, v28, v29
    ds_write_b32 v156, v6 offset:768
    v_cvt_pk_bf16_f32 v4, v30, v31
    ds_write_b32 v157, v4 offset:768
    v_cvt_pk_bf16_f32 v5, v32, v33
    ds_write_b32 v156, v5 offset:1536
    v_cvt_pk_bf16_f32 v6, v34, v35
    ds_write_b32 v157, v6 offset:1536
    v_cvt_pk_bf16_f32 v4, v36, v37
    ds_write_b32 v156, v4 offset:2304
    v_cvt_pk_bf16_f32 v5, v38, v39
    ds_write_b32 v157, v5 offset:2304
    v_cvt_pk_bf16_f32 v6, v40, v41
    ds_write_b32 v156, v6 offset:3072
    v_cvt_pk_bf16_f32 v4, v42, v43
    ds_write_b32 v157, v4 offset:3072
    s_mov_b32 exec_lo, 0
    s_mov_b32 exec_hi, -1
    ds_write_b64 v158, v[24:25] offset:0
    ds_write_b64 v159, v[26:27] offset:0
    ds_write_b64 v158, v[28:29] offset:1280
    ds_write_b64 v159, v[30:31] offset:1280
    ds_write_b64 v158, v[32:33] offset:2560
    ds_write_b64 v159, v[34:35] offset:2560
    ds_write_b64 v158, v[36:37] offset:3840
    ds_write_b64 v159, v[38:39] offset:3840
    ds_write_b64 v158, v[40:41] offset:5120
    ds_write_b64 v159, v[42:43] offset:5120
    s_mov_b64 exec, -1
    s_branch L_gE
L_g3:
    ds_read_b128 v[104:107], v21 offset:0
    ds_read_b128 v[108:111], v21 offset:18432
    ds_read_b128 v[112:115], v21 offset:36864
    ds_read_b128 v[116:119], v22 offset:0
    ds_read_b128 v[120:123], v22 offset:18432
    s_waitcnt lgkmcnt(0)
    s_waitcnt vmcnt(32)
    v_mfma_f32_16x16x32_bf16 v[24:27], a[0:3], v[104:107], 0
    ds_read_b128 v[124:127], v21 offset:1024
    v_mfma_f32_16x16x32_bf16 v[44:47], a[72:75], v[104:107], 0
    s_add_u32 s95, s95, 14336
    s_cmp_eq_u32 s95, 258048
    s_cselect_b32 s95, 0, s95
    s_add_u32 s4, s84, s95
    buffer_load_dwordx4 a[36:39], v10, s[64:67], s4 offen sc1
    v_mfma_f32_16x16x32_bf16 v[64:67], a[144:147], v[104:107], 0
    s_lshr_b32 s22, s2, 3
    s_lshl_b32 s22, s22, 2
    s_add_u32 s22, s22, s68
    s_nop 0
    v_mfma_f32_16x16x32_bf16 v[28:31], a[0:3], v[108:111], 0
    ds_read_b128 v[128:131], v21 offset:19456
    v_mfma_f32_16x16x32_bf16 v[48:51], a[72:75], v[108:111], 0
    buffer_load_dwordx4 a[108:111], v11, s[64:67], s4 offen sc1
    v_mfma_f32_16x16x32_bf16 v[68:71], a[144:147], v[108:111], 0
    s_and_b32 s23, s2, 7
    s_mul_i32 s24, s22, 57
    s_lshr_b32 s24, s24, 11
    s_nop 0
    v_mfma_f32_16x16x32_bf16 v[32:35], a[0:3], v[112:115], 0
    ds_read_b128 v[132:135], v21 offset:37888
    v_mfma_f32_16x16x32_bf16 v[52:55], a[72:75], v[112:115], 0
    buffer_load_dwordx4 a[180:183], v12, s[64:67], s4 offen sc1
    v_mfma_f32_16x16x32_bf16 v[72:75], a[144:147], v[112:115], 0
    s_mul_i32 s25, s24, 36
    s_sub_u32 s25, s22, s25
    v_mfma_f32_16x16x32_bf16 v[36:39], a[0:3], v[116:119], 0
    ds_read_b128 v[136:139], v22 offset:1024
    v_mfma_f32_16x16x32_bf16 v[56:59], a[72:75], v[116:119], 0
    s_cmp_ge_u32 s25, 18
    s_cselect_b32 s26, 18, 0
    s_cselect_b32 s27, 1, 0
    s_nop 0
    v_mfma_f32_16x16x32_bf16 v[76:79], a[144:147], v[116:119], 0
    s_sub_u32 s25, s25, s26
    s_mul_i32 s9, s25, 294912
    s_mul_i32 s26, s23, 1152
    s_nop 0
    v_mfma_f32_16x16x32_bf16 v[40:43], a[0:3], v[120:123], 0
    ds_read_b128 v[140:143], v22 offset:19456
    v_mfma_f32_16x16x32_bf16 v[60:63], a[72:75], v[120:123], 0
    s_add_u32 s9, s9, s26
    s_lshl_b32 s26, s24, 7
    s_add_u32 s9, s9, s26
    s_nop 0
    v_mfma_f32_16x16x32_bf16 v[80:83], a[144:147], v[120:123], 0
    s_mul_i32 s92, s23, 36
    s_lshl_b32 s26, s24, 2
    s_add_u32 s92, s92, s26
    s_waitcnt lgkmcnt(0)
    s_waitcnt vmcnt(31)
    s_cmp_eq_u32 s68, 1
    s_cselect_b32 s93, s2, 0
    s_cmp_ge_u32 s93, 18
    s_cselect_b32 s93, s93, 99
    s_cmp_lt_u32 s93, 54
    s_cbranch_scc0 L_nofm3
    s_lshl_b32 s93, s93, 2
    s_add_u32 s93, s93, 46157752
    v_mov_b32 v147, s3
    s_mov_b64 exec, 1
    s_nop 0
    buffer_store_dword v147, off, s[64:67], s93 sc1
    s_mov_b64 exec, -1
L_nofm3:
    s_nop 0
    v_mfma_f32_16x16x32_bf16 v[24:27], a[4:7], v[124:127], v[24:27]
    ds_read_b128 v[104:107], v21 offset:2048
    v_mfma_f32_16x16x32_bf16 v[44:47], a[76:79], v[124:127], v[44:47]
    s_add_u32 s95, s95, 14336
    s_cmp_eq_u32 s95, 258048
    s_cselect_b32 s95, 0, s95
    s_add_u32 s4, s84, s95
    buffer_load_dwordx4 a[40:43], v10, s[64:67], s4 offen sc1
    v_mfma_f32_16x16x32_bf16 v[64:67], a[148:151], v[124:127], v[64:67]
    s_mul_i32 s92, s92, 18
    s_add_u32 s92, s92, s25
    s_lshl_b32 s92, s92, 1
    s_nop 0
    v_mfma_f32_16x16x32_bf16 v[28:31], a[4:7], v[128:131], v[28:31]
    ds_read_b128 v[108:111], v21 offset:20480
    v_mfma_f32_16x16x32_bf16 v[48:51], a[76:79], v[128:131], v[48:51]
    buffer_load_dwordx4 a[112:115], v11, s[64:67], s4 offen sc1
    v_mfma_f32_16x16x32_bf16 v[68:71], a[148:151], v[128:131], v[68:71]
    s_add_u32 s92, s92, s27
    s_lshl_b32 s92, s92, 10
    s_add_u32 s92, s92, 1048576
    v_mfma_f32_16x16x32_bf16 v[32:35], a[4:7], v[132:135], v[32:35]
    ds_read_b128 v[112:115], v21 offset:38912
    v_mfma_f32_16x16x32_bf16 v[52:55], a[76:79], v[132:135], v[52:55]
    buffer_load_dwordx4 a[184:187], v12, s[64:67], s4 offen sc1
    v_mfma_f32_16x16x32_bf16 v[72:75], a[148:151], v[132:135], v[72:75]
    s_add_u32 s10, s9, 0
    s_add_u32 s11, s92, 0
    v_mfma_f32_16x16x32_bf16 v[36:39], a[4:7], v[136:139], v[36:39]
    ds_read_b128 v[116:119], v22 offset:2048
    v_mfma_f32_16x16x32_bf16 v[56:59], a[76:79], v[136:139], v[56:59]
    s_cmp_ge_u32 s22, 108
    s_cselect_b32 s12, 3, s27
    s_cselect_b32 s11, 0x7ff00000, s11
    s_nop 0
    v_mfma_f32_16x16x32_bf16 v[76:79], a[148:151], v[136:139], v[76:79]
    s_add_i32 s24, s22, -108
    s_mul_i32 s25, s24, 57
    s_lshr_b32 s25, s25, 9
    v_mfma_f32_16x16x32_bf16 v[40:43], a[4:7], v[140:143], v[40:43]
    ds_read_b128 v[120:123], v22 offset:20480
    v_mfma_f32_16x16x32_bf16 v[60:63], a[76:79], v[140:143], v[60:63]
    s_mul_i32 s26, s25, 9
    s_sub_u32 s24, s24, s26
    s_mul_i32 s6, s23, 663552
    v_mfma_f32_16x16x32_bf16 v[80:83], a[148:151], v[140:143], v[80:83]
    s_mul_i32 s26, s25, 36864
    s_add_u32 s6, s6, s26
    s_lshl_b32 s26, s24, 7
    s_waitcnt lgkmcnt(0)
    s_waitcnt vmcnt(30)
    v_mfma_f32_16x16x32_bf16 v[24:27], a[8:11], v[104:107], v[24:27]
    ds_read_b128 v[124:127], v21 offset:3072
    v_mfma_f32_16x16x32_bf16 v[44:47], a[80:83], v[104:107], v[44:47]
    s_add_u32 s95, s95, 14336
    s_cmp_eq_u32 s95, 258048
    s_cselect_b32 s95, 0, s95
    s_add_u32 s4, s84, s95
    buffer_load_dwordx4 a[44:47], v10, s[64:67], s4 offen sc1
    v_mfma_f32_16x16x32_bf16 v[64:67], a[152:155], v[104:107], v[64:67]
    s_add_u32 s6, s6, s26
    s_mul_i32 s7, s23, 36
    s_lshl_b32 s26, s24, 2
    s_nop 0
    v_mfma_f32_16x16x32_bf16 v[28:31], a[8:11], v[108:111], v[28:31]
    ds_read_b128 v[128:131], v21 offset:21504
    v_mfma_f32_16x16x32_bf16 v[48:51], a[80:83], v[108:111], v[48:51]
    buffer_load_dwordx4 a[116:119], v11, s[64:67], s4 offen sc1
    v_mfma_f32_16x16x32_bf16 v[68:71], a[152:155], v[108:111], v[68:71]
    s_add_u32 s7, s7, s26
    s_mul_i32 s7, s7, 18
    s_add_u32 s7, s7, s25
    s_nop 0
    v_mfma_f32_16x16x32_bf16 v[32:35], a[8:11], v[112:115], v[32:35]
    ds_read_b128 v[132:135], v21 offset:39936
    v_mfma_f32_16x16x32_bf16 v[52:55], a[80:83], v[112:115], v[52:55]
    buffer_load_dwordx4 a[188:191], v12, s[64:67], s4 offen sc1
    v_mfma_f32_16x16x32_bf16 v[72:75], a[152:155], v[112:115], v[72:75]
    s_lshl_b32 s7, s7, 10
    s_add_u32 s7, s7, 12582912
    s_add_u32 s13, s9, 384
    s_nop 0
    v_mfma_f32_16x16x32_bf16 v[36:39], a[8:11], v[116:119], v[36:39]
    ds_read_b128 v[136:139], v22 offset:3072
    v_mfma_f32_16x16x32_bf16 v[56:59], a[80:83], v[116:119], v[56:59]
    s_add_u32 s14, s92, 442368
    v_mfma_f32_16x16x32_bf16 v[76:79], a[152:155], v[116:119], v[76:79]
    s_cmp_ge_u32 s22, 108
    s_cselect_b32 s15, 2, s27
    s_cselect_b32 s13, s6, s13
    s_cselect_b32 s14, s7, s14
    s_nop 0
    v_mfma_f32_16x16x32_bf16 v[40:43], a[8:11], v[120:123], v[40:43]
    ds_read_b128 v[140:143], v22 offset:21504
    v_mfma_f32_16x16x32_bf16 v[60:63], a[80:83], v[120:123], v[60:63]
    s_add_i32 s24, s22, -88
    s_mul_i32 s25, s24, 57
    s_lshr_b32 s25, s25, 9
    v_mfma_f32_16x16x32_bf16 v[80:83], a[152:155], v[120:123], v[80:83]
    s_mul_i32 s26, s25, 9
    s_sub_u32 s24, s24, s26
    s_mul_i32 s6, s23, 663552
    s_waitcnt lgkmcnt(0)
    s_waitcnt vmcnt(29)
    v_mfma_f32_16x16x32_bf16 v[24:27], a[12:15], v[124:127], v[24:27]
    ds_read_b128 v[104:107], v21 offset:4096
    v_mfma_f32_16x16x32_bf16 v[44:47], a[84:87], v[124:127], v[44:47]
    s_add_u32 s95, s95, 14336
    s_cmp_eq_u32 s95, 258048
    s_cselect_b32 s95, 0, s95
    s_add_u32 s4, s84, s95
    buffer_load_dwordx4 a[48:51], v10, s[64:67], s4 offen sc1
    v_mfma_f32_16x16x32_bf16 v[64:67], a[156:159], v[124:127], v[64:67]
    s_mul_i32 s26, s25, 36864
    s_add_u32 s6, s6, s26
    s_lshl_b32 s26, s24, 7
    v_mfma_f32_16x16x32_bf16 v[28:31], a[12:15], v[128:131], v[28:31]
    ds_read_b128 v[108:111], v21 offset:22528
    v_mfma_f32_16x16x32_bf16 v[48:51], a[84:87], v[128:131], v[48:51]
    buffer_load_dwordx4 a[120:123], v11, s[64:67], s4 offen sc1
    v_mfma_f32_16x16x32_bf16 v[68:71], a[156:159], v[128:131], v[68:71]
    s_add_u32 s6, s6, s26
    s_mul_i32 s7, s23, 36
    s_lshl_b32 s26, s24, 2
    s_nop 0
    v_mfma_f32_16x16x32_bf16 v[32:35], a[12:15], v[132:135], v[32:35]
    ds_read_b128 v[112:115], v21 offset:40960
    v_mfma_f32_16x16x32_bf16 v[52:55], a[84:87], v[132:135], v[52:55]
    buffer_load_dwordx4 a[192:195], v12, s[64:67], s4 offen sc1
    v_mfma_f32_16x16x32_bf16 v[72:75], a[156:159], v[132:135], v[72:75]
    s_add_u32 s7, s7, s26
    s_mul_i32 s7, s7, 18
    s_add_u32 s7, s7, s25
    s_nop 0
    v_mfma_f32_16x16x32_bf16 v[36:39], a[12:15], v[136:139], v[36:39]
    ds_read_b128 v[116:119], v22 offset:4096
    v_mfma_f32_16x16x32_bf16 v[56:59], a[84:87], v[136:139], v[56:59]
    s_lshl_b32 s7, s7, 10
    s_add_u32 s7, s7, 12582912
L_stub_7:
    s_cbranch_execz L_tchret_m0_m1
    s_add_u32 s16, s9, 768
    v_mfma_f32_16x16x32_bf16 v[76:79], a[156:159], v[136:139], v[76:79]
    s_add_u32 s17, s92, 884736
    v_mfma_f32_16x16x32_bf16 v[40:43], a[12:15], v[140:143], v[40:43]
    ds_read_b128 v[120:123], v22 offset:22528
    v_mfma_f32_16x16x32_bf16 v[60:63], a[84:87], v[140:143], v[60:63]
    s_cmp_ge_u32 s22, 108
    s_cselect_b32 s18, 2, s27
    s_cselect_b32 s16, s6, s16
    s_cselect_b32 s17, s7, s17
    s_nop 0
    v_mfma_f32_16x16x32_bf16 v[80:83], a[156:159], v[140:143], v[80:83]
    s_add_i32 s24, s22, 40
    s_mul_i32 s25, s24, 57
    s_lshr_b32 s25, s25, 9
    s_waitcnt lgkmcnt(0)
    s_waitcnt vmcnt(28)
    s_nop 0
    v_mfma_f32_16x16x32_bf16 v[24:27], a[16:19], v[104:107], v[24:27]
    ds_read_b128 v[124:127], v21 offset:5120
    v_mfma_f32_16x16x32_bf16 v[44:47], a[88:91], v[104:107], v[44:47]
    s_add_u32 s95, s95, 14336
    s_cmp_eq_u32 s95, 258048
    s_cselect_b32 s95, 0, s95
    s_add_u32 s4, s84, s95
    buffer_load_dwordx4 a[52:55], v10, s[64:67], s4 offen sc1
    v_mfma_f32_16x16x32_bf16 v[64:67], a[160:163], v[104:107], v[64:67]
    s_mul_i32 s26, s25, 9
    s_sub_u32 s24, s24, s26
    s_mul_i32 s6, s23, 663552
    v_mfma_f32_16x16x32_bf16 v[28:31], a[16:19], v[108:111], v[28:31]
    ds_read_b128 v[128:131], v21 offset:23552
    v_mfma_f32_16x16x32_bf16 v[48:51], a[88:91], v[108:111], v[48:51]
    buffer_load_dwordx4 a[124:127], v11, s[64:67], s4 offen sc1
    v_mfma_f32_16x16x32_bf16 v[68:71], a[160:163], v[108:111], v[68:71]
    s_mul_i32 s26, s25, 36864
    s_add_u32 s6, s6, s26
    s_lshl_b32 s26, s24, 7
    v_mfma_f32_16x16x32_bf16 v[32:35], a[16:19], v[112:115], v[32:35]
    ds_read_b128 v[132:135], v21 offset:41984
    v_mfma_f32_16x16x32_bf16 v[52:55], a[88:91], v[112:115], v[52:55]
    buffer_load_dwordx4 a[196:199], v12, s[64:67], s4 offen sc1
    v_mfma_f32_16x16x32_bf16 v[72:75], a[160:163], v[112:115], v[72:75]
    s_add_u32 s6, s6, s26
    s_mul_i32 s7, s23, 36
    s_lshl_b32 s26, s24, 2
    s_nop 0
    v_mfma_f32_16x16x32_bf16 v[36:39], a[16:19], v[116:119], v[36:39]
    ds_read_b128 v[136:139], v22 offset:5120
    v_mfma_f32_16x16x32_bf16 v[56:59], a[88:91], v[116:119], v[56:59]
    s_add_u32 s7, s7, s26
    s_mul_i32 s7, s7, 18
    s_add_u32 s7, s7, s25
    s_nop 0
    v_mfma_f32_16x16x32_bf16 v[76:79], a[160:163], v[116:119], v[76:79]
    s_lshl_b32 s7, s7, 10
    s_add_u32 s7, s7, 12582912
    s_mov_b32 s19, s6
    v_mfma_f32_16x16x32_bf16 v[40:43], a[16:19], v[120:123], v[40:43]
    ds_read_b128 v[140:143], v22 offset:23552
    v_mfma_f32_16x16x32_bf16 v[60:63], a[88:91], v[120:123], v[60:63]
    s_cmp_ge_u32 s22, 122
    s_cselect_b32 s21, 3, 2
    s_cselect_b32 s20, 0x7ff00000, s7
    s_nop 0
    v_mfma_f32_16x16x32_bf16 v[80:83], a[160:163], v[120:123], v[80:83]
    s_and_b32 s5, s2, 63
    s_lshr_b32 s5, s5, 3
    s_waitcnt lgkmcnt(0)
    s_waitcnt vmcnt(27)
    v_mfma_f32_16x16x32_bf16 v[24:27], a[20:23], v[124:127], v[24:27]
    ds_read_b128 v[104:107], v21 offset:6144
    v_mfma_f32_16x16x32_bf16 v[44:47], a[92:95], v[124:127], v[44:47]
    s_add_u32 s95, s95, 14336
    s_cmp_eq_u32 s95, 258048
    s_cselect_b32 s95, 0, s95
    s_add_u32 s4, s84, s95
    buffer_load_dwordx4 a[56:59], v10, s[64:67], s4 offen sc1
    v_mfma_f32_16x16x32_bf16 v[64:67], a[164:167], v[124:127], v[64:67]
    s_mul_i32 s5, s5, 2304
    s_add_u32 s5, s5, 47316992
    v_min_u32_e64 v160, 35, v1
    v_mfma_f32_16x16x32_bf16 v[28:31], a[20:23], v[128:131], v[28:31]
    ds_read_b128 v[108:111], v21 offset:24576
    v_mfma_f32_16x16x32_bf16 v[48:51], a[92:95], v[128:131], v[48:51]
    buffer_load_dwordx4 a[128:131], v11, s[64:67], s4 offen sc1
    v_mfma_f32_16x16x32_bf16 v[68:71], a[164:167], v[128:131], v[68:71]
    v_lshlrev_b32_e64 v160, 2, v160
    v_add_u32 v160, 46157824, v160
    v_mfma_f32_16x16x32_bf16 v[32:35], a[20:23], v[132:135], v[32:35]
    ds_read_b128 v[112:115], v21 offset:43008
    v_mfma_f32_16x16x32_bf16 v[52:55], a[92:95], v[132:135], v[52:55]
    buffer_load_dwordx4 a[200:203], v12, s[64:67], s4 offen sc1
    v_mfma_f32_16x16x32_bf16 v[72:75], a[164:167], v[132:135], v[72:75]
    v_min_u32 v161, 17, v1
    v_lshlrev_b32 v161, 7, v161
    v_mfma_f32_16x16x32_bf16 v[36:39], a[20:23], v[136:139], v[36:39]
    ds_read_b128 v[116:119], v22 offset:6144
    v_mfma_f32_16x16x32_bf16 v[56:59], a[92:95], v[136:139], v[56:59]
    v_add_u32 v161, s5, v161
    v_lshrrev_b32 v4, 3, v1
    v_mfma_f32_16x16x32_bf16 v[76:79], a[164:167], v[136:139], v[76:79]
    v_lshrrev_b32 v5, 1, v4
    v_xor_b32 v150, v5, v4
    v_mfma_f32_16x16x32_bf16 v[40:43], a[20:23], v[140:143], v[40:43]
    ds_read_b128 v[120:123], v22 offset:24576
    v_mfma_f32_16x16x32_bf16 v[60:63], a[92:95], v[140:143], v[60:63]
    v_lshrrev_b32 v150, 2, v150
    v_and_b32 v150, 1, v150
    v_mfma_f32_16x16x32_bf16 v[80:83], a[164:167], v[140:143], v[80:83]
    v_and_b32_e64 v5, 1, v5
    v_lshl_or_b32 v150, v150, 1, v5
    s_waitcnt lgkmcnt(0)
    s_waitcnt vmcnt(26)
    v_mfma_f32_16x16x32_bf16 v[24:27], a[24:27], v[104:107], v[24:27]
    ds_read_b128 v[124:127], v21 offset:7168
    v_mfma_f32_16x16x32_bf16 v[44:47], a[96:99], v[104:107], v[44:47]
    s_add_u32 s95, s95, 14336
    s_cmp_eq_u32 s95, 258048
    s_cselect_b32 s95, 0, s95
    s_add_u32 s4, s84, s95
    buffer_load_dwordx4 a[60:63], v10, s[64:67], s4 offen sc1
    v_mfma_f32_16x16x32_bf16 v[64:67], a[168:171], v[104:107], v[64:67]
    v_lshlrev_b32 v150, 1, v150
    v_and_b32 v5, 7, v1
    v_mfma_f32_16x16x32_bf16 v[28:31], a[24:27], v[108:111], v[28:31]
    ds_read_b128 v[128:131], v21 offset:25600
    v_mfma_f32_16x16x32_bf16 v[48:51], a[96:99], v[108:111], v[48:51]
    buffer_load_dwordx4 a[132:135], v11, s[64:67], s4 offen sc1
    v_mfma_f32_16x16x32_bf16 v[68:71], a[168:171], v[108:111], v[68:71]
    v_xor_b32 v150, v150, v5
    v_lshrrev_b32 v4, 3, v1
    v_mfma_f32_16x16x32_bf16 v[32:35], a[24:27], v[112:115], v[32:35]
    ds_read_b128 v[132:135], v21 offset:44032
    v_mfma_f32_16x16x32_bf16 v[52:55], a[96:99], v[112:115], v[52:55]
    buffer_load_dwordx4 a[204:207], v12, s[64:67], s4 offen sc1
    v_mfma_f32_16x16x32_bf16 v[72:75], a[168:171], v[112:115], v[72:75]
    v_or_b32 v4, 8, v4
    v_lshrrev_b32 v5, 1, v4
    v_mfma_f32_16x16x32_bf16 v[36:39], a[24:27], v[116:119], v[36:39]
    ds_read_b128 v[136:139], v22 offset:7168
    v_mfma_f32_16x16x32_bf16 v[56:59], a[96:99], v[116:119], v[56:59]
    v_xor_b32 v151, v5, v4
    v_lshrrev_b32 v151, 2, v151
    v_mfma_f32_16x16x32_bf16 v[76:79], a[168:171], v[116:119], v[76:79]
    v_and_b32 v151, 1, v151
    v_and_b32 v5, 1, v5
    v_mfma_f32_16x16x32_bf16 v[40:43], a[24:27], v[120:123], v[40:43]
    ds_read_b128 v[140:143], v22 offset:25600
    v_mfma_f32_16x16x32_bf16 v[60:63], a[96:99], v[120:123], v[60:63]
    v_lshl_or_b32 v151, v151, 1, v5
    v_lshlrev_b32_e64 v151, 1, v151
    v_mfma_f32_16x16x32_bf16 v[80:83], a[168:171], v[120:123], v[80:83]
    v_and_b32 v5, 7, v1
    v_xor_b32 v151, v151, v5
    s_waitcnt lgkmcnt(0)
    s_waitcnt vmcnt(25)
    v_mfma_f32_16x16x32_bf16 v[24:27], a[28:31], v[124:127], v[24:27]
    ds_read_b128 v[104:107], v21 offset:8192
    v_mfma_f32_16x16x32_bf16 v[44:47], a[100:103], v[124:127], v[44:47]
    s_add_u32 s95, s95, 14336
    s_cmp_eq_u32 s95, 258048
    s_cselect_b32 s95, 0, s95
    s_add_u32 s4, s84, s95
    buffer_load_dwordx4 a[64:67], v10, s[64:67], s4 offen sc1
    v_mfma_f32_16x16x32_bf16 v[64:67], a[172:175], v[124:127], v[64:67]
    v_lshlrev_b32 v150, 4, v150
    v_lshlrev_b32 v151, 4, v151
    v_mfma_f32_16x16x32_bf16 v[28:31], a[28:31], v[128:131], v[28:31]
    ds_read_b128 v[108:111], v21 offset:26624
    v_mfma_f32_16x16x32_bf16 v[48:51], a[100:103], v[128:131], v[48:51]
    buffer_load_dwordx4 a[136:139], v11, s[64:67], s4 offen sc1
    v_mfma_f32_16x16x32_bf16 v[68:71], a[172:175], v[128:131], v[68:71]
    v_lshrrev_b32_e64 v146, 3, v1
    v_mfma_f32_16x16x32_bf16 v[32:35], a[28:31], v[132:135], v[32:35]
    ds_read_b128 v[112:115], v21 offset:45056
    v_mfma_f32_16x16x32_bf16 v[52:55], a[100:103], v[132:135], v[52:55]
    buffer_load_dwordx4 a[208:211], v12, s[64:67], s4 offen sc1
    v_mfma_f32_16x16x32_bf16 v[72:75], a[172:175], v[132:135], v[72:75]
    s_lshl_b32 s27, s68, 14
    s_nop 0
    v_mfma_f32_16x16x32_bf16 v[36:39], a[28:31], v[136:139], v[36:39]
    ds_read_b128 v[116:119], v22 offset:8192
    v_mfma_f32_16x16x32_bf16 v[56:59], a[100:103], v[136:139], v[56:59]
    s_add_u32 s27, s27, 98304
    v_lshlrev_b32_e64 v4, 2, v3
    v_mfma_f32_16x16x32_bf16 v[76:79], a[172:175], v[136:139], v[76:79]
    v_add_u32 v4, 40, v4
    v_mul_u32_u24 v5, 57, v4
    v_mfma_f32_16x16x32_bf16 v[40:43], a[28:31], v[140:143], v[40:43]
    ds_read_b128 v[120:123], v22 offset:26624
    v_mfma_f32_16x16x32_bf16 v[60:63], a[100:103], v[140:143], v[60:63]
    v_lshrrev_b32_e64 v5, 10, v5
    v_mul_u32_u24 v5, 6328, v5
    v_mfma_f32_16x16x32_bf16 v[80:83], a[172:175], v[140:143], v[80:83]
    v_mul_u32_u24_e64 v4, 4, v4
    v_mul_u32_u24 v6, 80, v2
    s_waitcnt lgkmcnt(0)
    s_waitcnt vmcnt(24)
    v_mfma_f32_16x16x32_bf16 v[24:27], a[32:35], v[104:107], v[24:27]
    ds_read_b128 v[124:127], v21 offset:9216
    v_mfma_f32_16x16x32_bf16 v[44:47], a[104:107], v[104:107], v[44:47]
    s_add_u32 s95, s95, 14336
    s_cmp_eq_u32 s95, 258048
    s_cselect_b32 s95, 0, s95
    s_add_u32 s4, s84, s95
    buffer_load_dwordx4 a[68:71], v10, s[64:67], s4 offen sc1
    v_mfma_f32_16x16x32_bf16 v[64:67], a[176:179], v[104:107], v[64:67]
    v_add3_u32 v152, v4, v5, v6
    v_add_u32 v152, 15360, v152
    v_mfma_f32_16x16x32_bf16 v[28:31], a[32:35], v[108:111], v[28:31]
    ds_read_b128 v[128:131], v21 offset:27648
    v_mfma_f32_16x16x32_bf16 v[48:51], a[104:107], v[108:111], v[48:51]
    buffer_load_dwordx4 a[140:143], v11, s[64:67], s4 offen sc1
    v_mfma_f32_16x16x32_bf16 v[68:71], a[176:179], v[108:111], v[68:71]
    v_lshlrev_b32 v4, 2, v3
    v_add_u32 v4, 42, v4
    v_mfma_f32_16x16x32_bf16 v[32:35], a[32:35], v[112:115], v[32:35]
    ds_read_b128 v[132:135], v21 offset:46080
    v_mfma_f32_16x16x32_bf16 v[52:55], a[104:107], v[112:115], v[52:55]
    buffer_load_dwordx4 a[212:215], v12, s[64:67], s4 offen sc1
    v_mfma_f32_16x16x32_bf16 v[72:75], a[176:179], v[112:115], v[72:75]
    v_mul_u32_u24 v5, 57, v4
    v_lshrrev_b32 v5, 10, v5
    v_mfma_f32_16x16x32_bf16 v[36:39], a[32:35], v[116:119], v[36:39]
    ds_read_b128 v[136:139], v22 offset:9216
    v_mfma_f32_16x16x32_bf16 v[56:59], a[104:107], v[116:119], v[56:59]
    v_mul_u32_u24 v5, 6328, v5
    v_mul_u32_u24_e64 v4, 4, v4
    v_mfma_f32_16x16x32_bf16 v[76:79], a[176:179], v[116:119], v[76:79]
    v_mul_u32_u24 v6, 80, v2
    v_add3_u32 v153, v4, v5, v6
    v_mfma_f32_16x16x32_bf16 v[40:43], a[32:35], v[120:123], v[40:43]
    ds_read_b128 v[140:143], v22 offset:27648
    v_mfma_f32_16x16x32_bf16 v[60:63], a[104:107], v[120:123], v[60:63]
    v_add_u32 v153, 15360, v153
    v_lshlrev_b32_e64 v4, 2, v3
    v_mfma_f32_16x16x32_bf16 v[80:83], a[176:179], v[120:123], v[80:83]
    v_add_u32 v4, 56, v4
    v_mul_u32_u24 v5, 57, v4
    s_waitcnt lgkmcnt(0)
    s_waitcnt vmcnt(24)
    v_mfma_f32_16x16x32_bf16 v[24:27], a[36:39], v[124:127], v[24:27]
    ds_read_b128 v[104:107], v21 offset:10240
    v_mfma_f32_16x16x32_bf16 v[44:47], a[108:111], v[124:127], v[44:47]
    buffer_load_dword v7, v160, s[64:67], 0 offen sc1
    v_mfma_f32_16x16x32_bf16 v[64:67], a[180:183], v[124:127], v[64:67]
    s_cmp_eq_u32 s12, 1
    s_cselect_b32 s72, s44, s40
    s_cselect_b32 s73, s45, s41
    s_nop 0
    v_mfma_f32_16x16x32_bf16 v[28:31], a[36:39], v[128:131], v[28:31]
    ds_read_b128 v[108:111], v21 offset:28672
    v_mfma_f32_16x16x32_bf16 v[48:51], a[108:111], v[128:131], v[48:51]
    s_cmp_eq_u32 s12, 2
    s_cselect_b32 s72, s48, s72
    s_cselect_b32 s73, s49, s73
    s_movk_i32 s8, 9216
    s_cselect_b32 s8, 1152, s8
    v_mfma_f32_16x16x32_bf16 v[68:71], a[180:183], v[128:131], v[68:71]
    s_mov_b32 s74, 5308416
    s_cmp_eq_u32 s12, 3
    s_cselect_b32 s74, 0, s74
    s_mov_b32 s75, 0x20000
    v_mfma_f32_16x16x32_bf16 v[32:35], a[36:39], v[132:135], v[32:35]
    ds_read_b128 v[112:115], v21 offset:47104
    v_mfma_f32_16x16x32_bf16 v[52:55], a[108:111], v[132:135], v[52:55]
    v_mul_u32_u24_e64 v147, s8, v146
    v_mfma_f32_16x16x32_bf16 v[72:75], a[180:183], v[132:135], v[72:75]
    v_add_u32_e64 v144, v147, v150
    v_mfma_f32_16x16x32_bf16 v[36:39], a[36:39], v[136:139], v[36:39]
    ds_read_b128 v[116:119], v22 offset:10240
    v_mfma_f32_16x16x32_bf16 v[56:59], a[108:111], v[136:139], v[56:59]
    v_add_u32_e64 v145, v147, v151
    v_mfma_f32_16x16x32_bf16 v[76:79], a[180:183], v[136:139], v[76:79]
    s_lshl_b32 s26, s8, 3
    s_nop 0
    v_mfma_f32_16x16x32_bf16 v[40:43], a[36:39], v[140:143], v[40:43]
    ds_read_b128 v[120:123], v22 offset:28672
    v_mfma_f32_16x16x32_bf16 v[60:63], a[108:111], v[140:143], v[60:63]
    v_lshrrev_b32_e64 v5, 10, v5
    v_mul_u32_u24 v5, 6328, v5
    v_mfma_f32_16x16x32_bf16 v[80:83], a[180:183], v[140:143], v[80:83]
    s_add_u32 m0, s27, 0
    s_nop 0
    buffer_load_dwordx4 v144, s[72:75], s10 offen lds
    s_waitcnt lgkmcnt(0)
    s_waitcnt vmcnt(23)
    v_mfma_f32_16x16x32_bf16 v[24:27], a[40:43], v[104:107], v[24:27]
    ds_read_b128 v[124:127], v21 offset:11264
    v_mfma_f32_16x16x32_bf16 v[44:47], a[112:115], v[104:107], v[44:47]
    s_add_u32 m0, s27, 1024
    s_add_u32 s10, s10, s26
    s_nop 0
    buffer_load_dwordx4 v145, s[72:75], s10 offen lds
    v_mfma_f32_16x16x32_bf16 v[64:67], a[184:187], v[104:107], v[64:67]
    s_add_u32 m0, s27, 2048
    s_add_u32 s10, s10, s26
    s_nop 0
    buffer_load_dwordx4 v144, s[72:75], s10 offen lds
    v_mfma_f32_16x16x32_bf16 v[28:31], a[40:43], v[108:111], v[28:31]
    ds_read_b128 v[128:131], v21 offset:29696
    v_mfma_f32_16x16x32_bf16 v[48:51], a[112:115], v[108:111], v[48:51]
    v_mul_u32_u24_e64 v4, 4, v4
    v_mul_u32_u24 v6, 80, v2
    v_mfma_f32_16x16x32_bf16 v[68:71], a[184:187], v[108:111], v[68:71]
    v_add3_u32 v154, v4, v5, v6
    v_add_u32 v154, 15360, v154
    v_mfma_f32_16x16x32_bf16 v[32:35], a[40:43], v[112:115], v[32:35]
    ds_read_b128 v[132:135], v21 offset:48128
    v_mfma_f32_16x16x32_bf16 v[52:55], a[112:115], v[112:115], v[52:55]
    v_lshlrev_b32 v4, 2, v3
    v_add_u32 v4, 58, v4
    v_mfma_f32_16x16x32_bf16 v[72:75], a[184:187], v[112:115], v[72:75]
    v_mul_u32_u24 v5, 57, v4
    v_lshrrev_b32 v5, 10, v5
    v_mfma_f32_16x16x32_bf16 v[36:39], a[40:43], v[116:119], v[36:39]
    ds_read_b128 v[136:139], v22 offset:11264
    v_mfma_f32_16x16x32_bf16 v[56:59], a[112:115], v[116:119], v[56:59]
    v_mul_u32_u24 v5, 6328, v5
    v_mul_u32_u24_e64 v4, 4, v4
    v_mfma_f32_16x16x32_bf16 v[76:79], a[184:187], v[116:119], v[76:79]
    v_mul_u32_u24 v6, 80, v2
    v_add3_u32 v155, v4, v5, v6
    v_mfma_f32_16x16x32_bf16 v[40:43], a[40:43], v[120:123], v[40:43]
    ds_read_b128 v[140:143], v22 offset:29696
    v_mfma_f32_16x16x32_bf16 v[60:63], a[112:115], v[120:123], v[60:63]
    v_add_u32 v155, 15360, v155
    v_lshlrev_b32_e64 v4, 2, v3
    v_mfma_f32_16x16x32_bf16 v[80:83], a[184:187], v[120:123], v[80:83]
    v_add_u32 v4, 64, v4
    v_mul_u32_u24 v5, 57, v4
    s_waitcnt lgkmcnt(0)
    s_waitcnt vmcnt(22)
    v_mfma_f32_16x16x32_bf16 v[24:27], a[44:47], v[124:127], v[24:27]
    ds_read_b128 v[104:107], v21 offset:12288
    v_mfma_f32_16x16x32_bf16 v[44:47], a[116:119], v[124:127], v[44:47]
    s_add_u32 m0, s27, 3072
    s_add_u32 s10, s10, s26
    s_nop 0
    buffer_load_dwordx4 v145, s[72:75], s10 offen lds
    v_mfma_f32_16x16x32_bf16 v[64:67], a[188:191], v[124:127], v[64:67]
    s_cmp_eq_u32 s15, 1
    s_cselect_b32 s72, s44, s40
    s_cselect_b32 s73, s45, s41
    s_nop 0
    v_mfma_f32_16x16x32_bf16 v[28:31], a[44:47], v[128:131], v[28:31]
    ds_read_b128 v[108:111], v21 offset:30720
    v_mfma_f32_16x16x32_bf16 v[48:51], a[116:119], v[128:131], v[48:51]
    s_cmp_eq_u32 s15, 2
    s_cselect_b32 s72, s48, s72
    s_cselect_b32 s73, s49, s73
    s_movk_i32 s8, 9216
    s_cselect_b32 s8, 1152, s8
    v_mfma_f32_16x16x32_bf16 v[68:71], a[188:191], v[128:131], v[68:71]
    s_mov_b32 s74, 5308416
    s_cmp_eq_u32 s15, 3
    s_cselect_b32 s74, 0, s74
    s_mov_b32 s75, 0x20000
    v_mfma_f32_16x16x32_bf16 v[32:35], a[44:47], v[132:135], v[32:35]
    ds_read_b128 v[112:115], v21 offset:49152
    v_mfma_f32_16x16x32_bf16 v[52:55], a[116:119], v[132:135], v[52:55]
    v_mul_u32_u24_e64 v147, s8, v146
    v_mfma_f32_16x16x32_bf16 v[72:75], a[188:191], v[132:135], v[72:75]
    v_add_u32_e64 v144, v147, v150
    v_mfma_f32_16x16x32_bf16 v[36:39], a[44:47], v[136:139], v[36:39]
    ds_read_b128 v[116:119], v22 offset:12288
    v_mfma_f32_16x16x32_bf16 v[56:59], a[116:119], v[136:139], v[56:59]
    v_add_u32_e64 v145, v147, v151
    v_mfma_f32_16x16x32_bf16 v[76:79], a[188:191], v[136:139], v[76:79]
    s_lshl_b32 s26, s8, 3
    s_nop 0
    v_mfma_f32_16x16x32_bf16 v[40:43], a[44:47], v[140:143], v[40:43]
    ds_read_b128 v[120:123], v22 offset:30720
    v_mfma_f32_16x16x32_bf16 v[60:63], a[116:119], v[140:143], v[60:63]
    v_lshrrev_b32_e64 v5, 10, v5
    v_mul_u32_u24 v5, 3036, v5
    v_mfma_f32_16x16x32_bf16 v[80:83], a[188:191], v[140:143], v[80:83]
    s_add_u32 m0, s27, 4096
    s_nop 0
    s_nop 0
    buffer_load_dwordx4 v144, s[72:75], s13 offen lds
    s_waitcnt lgkmcnt(0)
    s_waitcnt vmcnt(21)
    v_mfma_f32_16x16x32_bf16 v[24:27], a[48:51], v[104:107], v[24:27]
    ds_read_b128 v[124:127], v21 offset:13312
    v_mfma_f32_16x16x32_bf16 v[44:47], a[120:123], v[104:107], v[44:47]
    s_add_u32 m0, s27, 5120
    s_add_u32 s13, s13, s26
    s_nop 0
    buffer_load_dwordx4 v145, s[72:75], s13 offen lds
    v_mfma_f32_16x16x32_bf16 v[64:67], a[192:195], v[104:107], v[64:67]
    s_add_u32 m0, s27, 6144
    s_add_u32 s13, s13, s26
    s_nop 0
    buffer_load_dwordx4 v144, s[72:75], s13 offen lds
    v_mfma_f32_16x16x32_bf16 v[28:31], a[48:51], v[108:111], v[28:31]
    ds_read_b128 v[128:131], v21 offset:31744
    v_mfma_f32_16x16x32_bf16 v[48:51], a[120:123], v[108:111], v[48:51]
    v_mul_u32_u24 v4, 2, v4
    v_mul_u32_u24 v6, 48, v2
    v_mfma_f32_16x16x32_bf16 v[68:71], a[192:195], v[108:111], v[68:71]
    v_add3_u32 v156, v4, v5, v6
    v_add_u32 v156, 40960, v156
    v_mfma_f32_16x16x32_bf16 v[32:35], a[48:51], v[112:115], v[32:35]
    ds_read_b128 v[132:135], v21 offset:50176
    v_mfma_f32_16x16x32_bf16 v[52:55], a[120:123], v[112:115], v[52:55]
    v_lshlrev_b32_e64 v4, 2, v3
    v_add_u32 v4, 66, v4
    v_mfma_f32_16x16x32_bf16 v[72:75], a[192:195], v[112:115], v[72:75]
    v_mul_u32_u24 v5, 57, v4
    v_lshrrev_b32 v5, 10, v5
    v_mfma_f32_16x16x32_bf16 v[36:39], a[48:51], v[116:119], v[36:39]
    ds_read_b128 v[136:139], v22 offset:13312
    v_mfma_f32_16x16x32_bf16 v[56:59], a[120:123], v[116:119], v[56:59]
    v_mul_u32_u24 v5, 3036, v5
    v_mul_u32_u24_e64 v4, 2, v4
    v_mfma_f32_16x16x32_bf16 v[76:79], a[192:195], v[116:119], v[76:79]
    v_mul_u32_u24_e64 v6, 48, v2
    v_add3_u32 v157, v4, v5, v6
    v_mfma_f32_16x16x32_bf16 v[40:43], a[48:51], v[120:123], v[40:43]
    ds_read_b128 v[140:143], v22 offset:31744
    v_mfma_f32_16x16x32_bf16 v[60:63], a[120:123], v[120:123], v[60:63]
    v_add_u32 v157, 40960, v157
    v_mfma_f32_16x16x32_bf16 v[80:83], a[192:195], v[120:123], v[80:83]
    s_waitcnt lgkmcnt(0)
    s_waitcnt vmcnt(20)
    s_waitcnt vmcnt(7)
    s_mov_b32 s88, 0
L_pw3:
    v_cmp_ne_u32 vcc, s3, v7
    s_nop 2
    s_cbranch_vccz L_pw3_ok
    s_add_u32 s88, s88, 1
    s_cmp_gt_u32 s88, 262144
    s_cbranch_scc1 L_pw3_ok
    s_nop 0
    buffer_load_dword v7, v160, s[64:67], 0 offen sc1
    s_waitcnt vmcnt(0)
    s_branch L_pw3
L_pw3_ok:
    v_mfma_f32_16x16x32_bf16 v[24:27], a[52:55], v[124:127], v[24:27]
    ds_read_b128 v[104:107], v21 offset:14336
    v_mfma_f32_16x16x32_bf16 v[44:47], a[124:127], v[124:127], v[44:47]
    s_add_u32 m0, s27, 7168
    s_add_u32 s13, s13, s26
    s_nop 0
    buffer_load_dwordx4 v145, s[72:75], s13 offen lds
    v_mfma_f32_16x16x32_bf16 v[64:67], a[196:199], v[124:127], v[64:67]
    s_cmp_eq_u32 s18, 1
    s_cselect_b32 s72, s44, s40
    s_cselect_b32 s73, s45, s41
    s_nop 0
    v_mfma_f32_16x16x32_bf16 v[28:31], a[52:55], v[128:131], v[28:31]
    ds_read_b128 v[108:111], v21 offset:32768
    v_mfma_f32_16x16x32_bf16 v[48:51], a[124:127], v[128:131], v[48:51]
    s_cmp_eq_u32 s18, 2
    s_cselect_b32 s72, s48, s72
    s_cselect_b32 s73, s49, s73
    s_movk_i32 s8, 9216
    s_cselect_b32 s8, 1152, s8
    v_mfma_f32_16x16x32_bf16 v[68:71], a[196:199], v[128:131], v[68:71]
    s_mov_b32 s74, 5308416
    s_cmp_eq_u32 s18, 3
    s_cselect_b32 s74, 0, s74
    s_mov_b32 s75, 0x20000
    v_mfma_f32_16x16x32_bf16 v[32:35], a[52:55], v[132:135], v[32:35]
    ds_read_b128 v[112:115], v21 offset:51200
    v_mfma_f32_16x16x32_bf16 v[52:55], a[124:127], v[132:135], v[52:55]
    v_mul_u32_u24_e64 v147, s8, v146
    v_mfma_f32_16x16x32_bf16 v[72:75], a[196:199], v[132:135], v[72:75]
    v_add_u32_e64 v144, v147, v150
    v_mfma_f32_16x16x32_bf16 v[36:39], a[52:55], v[136:139], v[36:39]
    ds_read_b128 v[116:119], v22 offset:14336
    v_mfma_f32_16x16x32_bf16 v[56:59], a[124:127], v[136:139], v[56:59]
    v_add_u32_e64 v145, v147, v151
    v_mfma_f32_16x16x32_bf16 v[76:79], a[196:199], v[136:139], v[76:79]
    s_lshl_b32 s26, s8, 3
    s_nop 0
    v_mfma_f32_16x16x32_bf16 v[40:43], a[52:55], v[140:143], v[40:43]
    ds_read_b128 v[120:123], v22 offset:32768
    v_mfma_f32_16x16x32_bf16 v[60:63], a[124:127], v[140:143], v[60:63]
    v_mfma_f32_16x16x32_bf16 v[80:83], a[196:199], v[140:143], v[80:83]
    s_add_u32 m0, s27, 8192
    s_nop 0
    s_nop 0
    buffer_load_dwordx4 v144, s[72:75], s16 offen lds
    s_waitcnt lgkmcnt(0)
    s_nop 0
    v_mfma_f32_16x16x32_bf16 v[24:27], a[56:59], v[104:107], v[24:27]
    ds_read_b128 v[124:127], v21 offset:15360
    v_mfma_f32_16x16x32_bf16 v[44:47], a[128:131], v[104:107], v[44:47]
    s_add_u32 m0, s27, 9216
    s_add_u32 s16, s16, s26
    s_nop 0
    buffer_load_dwordx4 v145, s[72:75], s16 offen lds
    v_mfma_f32_16x16x32_bf16 v[64:67], a[200:203], v[104:107], v[64:67]
    s_add_u32 m0, s27, 10240
    s_add_u32 s16, s16, s26
    s_nop 0
    buffer_load_dwordx4 v144, s[72:75], s16 offen lds
    v_mfma_f32_16x16x32_bf16 v[28:31], a[56:59], v[108:111], v[28:31]
    ds_read_b128 v[128:131], v21 offset:33792
    v_mfma_f32_16x16x32_bf16 v[48:51], a[128:131], v[108:111], v[48:51]
    v_mfma_f32_16x16x32_bf16 v[68:71], a[200:203], v[108:111], v[68:71]
    v_mfma_f32_16x16x32_bf16 v[32:35], a[56:59], v[112:115], v[32:35]
    ds_read_b128 v[132:135], v21 offset:52224
    v_mfma_f32_16x16x32_bf16 v[52:55], a[128:131], v[112:115], v[52:55]
    v_mfma_f32_16x16x32_bf16 v[72:75], a[200:203], v[112:115], v[72:75]
    v_mfma_f32_16x16x32_bf16 v[36:39], a[56:59], v[116:119], v[36:39]
    ds_read_b128 v[136:139], v22 offset:15360
    v_mfma_f32_16x16x32_bf16 v[56:59], a[128:131], v[116:119], v[56:59]
    v_mfma_f32_16x16x32_bf16 v[76:79], a[200:203], v[116:119], v[76:79]
    v_mfma_f32_16x16x32_bf16 v[40:43], a[56:59], v[120:123], v[40:43]
    ds_read_b128 v[140:143], v22 offset:33792
    v_mfma_f32_16x16x32_bf16 v[60:63], a[128:131], v[120:123], v[60:63]
    v_mfma_f32_16x16x32_bf16 v[80:83], a[200:203], v[120:123], v[80:83]
    s_waitcnt lgkmcnt(0)
    s_nop 0
    v_mfma_f32_16x16x32_bf16 v[24:27], a[60:63], v[124:127], v[24:27]
    ds_read_b128 v[104:107], v21 offset:16384
    v_mfma_f32_16x16x32_bf16 v[44:47], a[132:135], v[124:127], v[44:47]
    s_add_u32 m0, s27, 11264
    s_add_u32 s16, s16, s26
    s_nop 0
    buffer_load_dwordx4 v145, s[72:75], s16 offen lds
    v_mfma_f32_16x16x32_bf16 v[64:67], a[204:207], v[124:127], v[64:67]
    s_cmp_eq_u32 s21, 1
    s_cselect_b32 s72, s44, s40
    s_cselect_b32 s73, s45, s41
    s_nop 0
    v_mfma_f32_16x16x32_bf16 v[28:31], a[60:63], v[128:131], v[28:31]
    ds_read_b128 v[108:111], v21 offset:34816
    v_mfma_f32_16x16x32_bf16 v[48:51], a[132:135], v[128:131], v[48:51]
    s_cmp_eq_u32 s21, 2
    s_cselect_b32 s72, s48, s72
    s_cselect_b32 s73, s49, s73
    s_movk_i32 s8, 9216
    s_cselect_b32 s8, 1152, s8
    v_mfma_f32_16x16x32_bf16 v[68:71], a[204:207], v[128:131], v[68:71]
    s_mov_b32 s74, 5308416
    s_cmp_eq_u32 s21, 3
    s_cselect_b32 s74, 0, s74
    s_mov_b32 s75, 0x20000
    v_mfma_f32_16x16x32_bf16 v[32:35], a[60:63], v[132:135], v[32:35]
    ds_read_b128 v[112:115], v21 offset:53248
    v_mfma_f32_16x16x32_bf16 v[52:55], a[132:135], v[132:135], v[52:55]
    v_mul_u32_u24_e64 v147, s8, v146
    v_mfma_f32_16x16x32_bf16 v[72:75], a[204:207], v[132:135], v[72:75]
    v_add_u32_e64 v144, v147, v150
    v_mfma_f32_16x16x32_bf16 v[36:39], a[60:63], v[136:139], v[36:39]
    ds_read_b128 v[116:119], v22 offset:16384
    v_mfma_f32_16x16x32_bf16 v[56:59], a[132:135], v[136:139], v[56:59]
    v_add_u32_e64 v145, v147, v151
    v_mfma_f32_16x16x32_bf16 v[76:79], a[204:207], v[136:139], v[76:79]
    s_lshl_b32 s26, s8, 3
    s_nop 0
    v_mfma_f32_16x16x32_bf16 v[40:43], a[60:63], v[140:143], v[40:43]
    ds_read_b128 v[120:123], v22 offset:34816
    v_mfma_f32_16x16x32_bf16 v[60:63], a[132:135], v[140:143], v[60:63]
    v_mfma_f32_16x16x32_bf16 v[80:83], a[204:207], v[140:143], v[80:83]
    s_add_u32 m0, s27, 12288
    s_nop 0
    s_nop 0
    buffer_load_dwordx4 v144, s[72:75], s19 offen lds
    s_waitcnt lgkmcnt(0)
    s_nop 0
    v_mfma_f32_16x16x32_bf16 v[24:27], a[64:67], v[104:107], v[24:27]
    ds_read_b128 v[124:127], v21 offset:17408
    v_mfma_f32_16x16x32_bf16 v[44:47], a[136:139], v[104:107], v[44:47]
    s_add_u32 m0, s27, 13312
    s_add_u32 s19, s19, s26
    s_nop 0
    buffer_load_dwordx4 v145, s[72:75], s19 offen lds
    v_mfma_f32_16x16x32_bf16 v[64:67], a[208:211], v[104:107], v[64:67]
    s_add_u32 m0, s27, 14336
    s_add_u32 s19, s19, s26
    s_nop 0
    buffer_load_dwordx4 v144, s[72:75], s19 offen lds
    v_mfma_f32_16x16x32_bf16 v[28:31], a[64:67], v[108:111], v[28:31]
    ds_read_b128 v[128:131], v21 offset:35840
    v_mfma_f32_16x16x32_bf16 v[48:51], a[136:139], v[108:111], v[48:51]
    v_mfma_f32_16x16x32_bf16 v[68:71], a[208:211], v[108:111], v[68:71]
    v_mfma_f32_16x16x32_bf16 v[32:35], a[64:67], v[112:115], v[32:35]
    ds_read_b128 v[132:135], v21 offset:54272
    v_mfma_f32_16x16x32_bf16 v[52:55], a[136:139], v[112:115], v[52:55]
    v_mfma_f32_16x16x32_bf16 v[72:75], a[208:211], v[112:115], v[72:75]
    v_mfma_f32_16x16x32_bf16 v[36:39], a[64:67], v[116:119], v[36:39]
    ds_read_b128 v[136:139], v22 offset:17408
    v_mfma_f32_16x16x32_bf16 v[56:59], a[136:139], v[116:119], v[56:59]
    v_mfma_f32_16x16x32_bf16 v[76:79], a[208:211], v[116:119], v[76:79]
    v_mfma_f32_16x16x32_bf16 v[40:43], a[64:67], v[120:123], v[40:43]
    ds_read_b128 v[140:143], v22 offset:35840
    v_mfma_f32_16x16x32_bf16 v[60:63], a[136:139], v[120:123], v[60:63]
    v_mfma_f32_16x16x32_bf16 v[80:83], a[208:211], v[120:123], v[80:83]
    s_waitcnt lgkmcnt(0)
    s_nop 0
    v_mfma_f32_16x16x32_bf16 v[24:27], a[68:71], v[124:127], v[24:27]
    v_mfma_f32_16x16x32_bf16 v[44:47], a[140:143], v[124:127], v[44:47]
    s_add_u32 m0, s27, 15360
    s_add_u32 s19, s19, s26
    s_nop 0
    buffer_load_dwordx4 v145, s[72:75], s19 offen lds
    v_mfma_f32_16x16x32_bf16 v[64:67], a[212:215], v[124:127], v[64:67]
    v_mfma_f32_16x16x32_bf16 v[28:31], a[68:71], v[128:131], v[28:31]
    v_mfma_f32_16x16x32_bf16 v[48:51], a[140:143], v[128:131], v[48:51]
    v_mfma_f32_16x16x32_bf16 v[68:71], a[212:215], v[128:131], v[68:71]
    v_mfma_f32_16x16x32_bf16 v[32:35], a[68:71], v[132:135], v[32:35]
    v_mfma_f32_16x16x32_bf16 v[52:55], a[140:143], v[132:135], v[52:55]
    v_mfma_f32_16x16x32_bf16 v[72:75], a[212:215], v[132:135], v[72:75]
    v_mfma_f32_16x16x32_bf16 v[36:39], a[68:71], v[136:139], v[36:39]
L_stub_8:
    s_cbranch_execz L_tchret_m0_m1
    s_nop 0
    v_mfma_f32_16x16x32_bf16 v[56:59], a[140:143], v[136:139], v[56:59]
    v_mfma_f32_16x16x32_bf16 v[76:79], a[212:215], v[136:139], v[76:79]
    v_mfma_f32_16x16x32_bf16 v[40:43], a[68:71], v[140:143], v[40:43]
    v_mfma_f32_16x16x32_bf16 v[60:63], a[140:143], v[140:143], v[60:63]
    v_mfma_f32_16x16x32_bf16 v[80:83], a[212:215], v[140:143], v[80:83]
    s_barrier
    s_nop 0
    ds_write_b64 v152, v[24:25] offset:0
    ds_write_b64 v153, v[26:27] offset:0
    ds_write_b64 v152, v[28:29] offset:1280
    ds_write_b64 v153, v[30:31] offset:1280
    ds_write_b64 v152, v[32:33] offset:2560
    ds_write_b64 v153, v[34:35] offset:2560
    ds_write_b64 v152, v[36:37] offset:3840
    ds_write_b64 v153, v[38:39] offset:3840
    ds_write_b64 v152, v[40:41] offset:5120
    ds_write_b64 v153, v[42:43] offset:5120
    ds_write_b64 v154, v[44:45] offset:0
    ds_write_b64 v155, v[46:47] offset:0
    ds_write_b64 v154, v[48:49] offset:1280
    ds_write_b64 v155, v[50:51] offset:1280
    ds_write_b64 v154, v[52:53] offset:2560
    ds_write_b64 v155, v[54:55] offset:2560
    ds_write_b64 v154, v[56:57] offset:3840
    ds_write_b64 v155, v[58:59] offset:3840
    ds_write_b64 v154, v[60:61] offset:5120
    ds_write_b64 v155, v[62:63] offset:5120
    s_mov_b32 exec_lo, -1
    s_mov_b32 exec_hi, 0
    v_cvt_pk_bf16_f32 v4, v68, v69
    ds_write_b32 v156, v4 offset:0
    v_cvt_pk_bf16_f32 v5, v70, v71
    ds_write_b32 v157, v5 offset:0
    v_cvt_pk_bf16_f32 v6, v72, v73
    ds_write_b32 v156, v6 offset:768
    v_cvt_pk_bf16_f32 v4, v74, v75
    ds_write_b32 v157, v4 offset:768
    v_cvt_pk_bf16_f32 v5, v76, v77
    ds_write_b32 v156, v5 offset:1536
    v_cvt_pk_bf16_f32 v6, v78, v79
    ds_write_b32 v157, v6 offset:1536
    v_cvt_pk_bf16_f32 v4, v80, v81
    ds_write_b32 v156, v4 offset:2304
    v_cvt_pk_bf16_f32 v5, v82, v83
    ds_write_b32 v157, v5 offset:2304
    s_mov_b64 exec, -1
L_gE:
    s_waitcnt lgkmcnt(0)
    s_barrier
    s_nop 0
    buffer_load_dword a64, v161, s[64:67], 0 offen sc1
    s_and_b32 s22, s2, 7
    s_lshl_b32 s22, s22, 2
    s_lshr_b32 s23, s2, 6
    s_add_u32 s22, s22, s23
    s_bfe_u32 s24, s2, 0x30003
    s_lshl_b32 s4, s22, 6
    s_lshl_b32 s5, s68, 4
    s_add_u32 s4, s4, s5
    v_add_u32 v11, s4, v2
    v_mul_u32_u24 v11, 1152, v11
    s_mul_i32 s5, s24, 144
    v_add_u32_e64 v11, s5, v11
    v_lshl_add_u32 v23, v3, 4, v11
    v_lshl_add_u32 v11, v3, 3, v11
    s_mul_i32 s25, s24, 288
    s_add_u32 s25, s25, 18878976
    s_lshl_b32 s26, s23, 2
    s_add_u32 s26, s26, s68
    s_mul_i32 s26, s26, 5760
    s_mul_i32 s24, s24, 92160
    s_add_u32 s26, s26, s24
    s_add_u32 s26, s26, 0
    v_min_u32 v22, 44, v1
    v_lshlrev_b32 v22, 7, v22
    s_lshl_b32 s4, s68, 6
    v_add_u32 v4, s4, v1
    v_mul_u32_u24_e64 v8, 48, v4
    v_add_u32 v8, 40960, v8
    s_mul_i32 s4, s68, 80
    s_add_u32 s4, s4, 2
    v_add_u32 v4, s4, v1
    v_mul_u32_u24_e64 v9, 48, v4
    v_mul_u32_u24 v10, 80, v4
    v_add_u32 v10, 15360, v10
    ds_read_b128 v[12:15], v8
    ds_read_b128 v[16:19], v8 offset:16
    ds_read_b32 v20, v8 offset:32
    ds_read_b128 v[24:27], v9 offset:672
    ds_read_b128 v[28:31], v9 offset:688
    ds_read_b32 v32, v9 offset:704
    ds_read_b128 v[36:39], v9 offset:576
    ds_read_b128 v[40:43], v9 offset:592
    ds_read_b32 v44, v9 offset:608
    ds_read_b128 v[48:51], v9 offset:480
    ds_read_b128 v[52:55], v9 offset:496
    ds_read_b32 v56, v9 offset:512
    s_waitcnt lgkmcnt(9)
    s_waitcnt lgkmcnt(6)
    v_dot2_f32_bf16 v120, v12, v24, 0
    s_waitcnt lgkmcnt(3)
    s_nop 0
    v_dot2_f32_bf16 v121, v12, v36, 0
    ds_read_b128 v[60:63], v9 offset:384
    v_dot2_f32_bf16 v120, v13, v25, v120
    v_dot2_f32_bf16 v121, v13, v37, v121
    ds_read_b128 v[64:67], v9 offset:400
    v_dot2_f32_bf16 v120, v14, v26, v120
    v_dot2_f32_bf16 v121, v14, v38, v121
    ds_read_b32 v68, v9 offset:416
    v_dot2_f32_bf16 v120, v15, v27, v120
    v_dot2_f32_bf16 v121, v15, v39, v121
    buffer_load_dword v22, v22, s[64:67], s26 offen sc1
    ds_read_b128 v[72:75], v9 offset:288
    v_dot2_f32_bf16 v120, v16, v28, v120
    v_dot2_f32_bf16 v121, v16, v40, v121
    ds_read_b128 v[76:79], v9 offset:304
    v_dot2_f32_bf16 v120, v17, v29, v120
    v_dot2_f32_bf16 v121, v17, v41, v121
    ds_read_b32 v80, v9 offset:320
    v_dot2_f32_bf16 v120, v18, v30, v120
    v_dot2_f32_bf16 v121, v18, v42, v121
    ds_read_b128 v[84:87], v9 offset:192
    v_dot2_f32_bf16 v120, v19, v31, v120
    v_dot2_f32_bf16 v121, v19, v43, v121
    ds_read_b128 v[88:91], v9 offset:208
    v_dot2_f32_bf16 v120, v20, v32, v120
    v_dot2_f32_bf16 v121, v20, v44, v121
    ds_read_b32 v92, v9 offset:224
    s_waitcnt lgkmcnt(9)
    s_nop 0
    v_dot2_f32_bf16 v122, v12, v48, 0
    s_waitcnt lgkmcnt(6)
    s_nop 0
    v_dot2_f32_bf16 v123, v12, v60, 0
    ds_read_b128 v[96:99], v9 offset:96
    v_dot2_f32_bf16 v122, v13, v49, v122
    v_dot2_f32_bf16 v123, v13, v61, v123
    ds_read_b128 v[100:103], v9 offset:112
    v_dot2_f32_bf16 v122, v14, v50, v122
    v_dot2_f32_bf16 v123, v14, v62, v123
    ds_read_b32 v104, v9 offset:128
    v_dot2_f32_bf16 v122, v15, v51, v122
    v_dot2_f32_bf16 v123, v15, v63, v123
    ds_read_b128 v[108:111], v9 offset:0
    v_dot2_f32_bf16 v122, v16, v52, v122
    v_dot2_f32_bf16 v123, v16, v64, v123
    buffer_load_dwordx4 v[226:229], v23, s[28:31], 0 offen
    ds_read_b128 v[112:115], v9 offset:16
    v_dot2_f32_bf16 v122, v17, v53, v122
    v_dot2_f32_bf16 v123, v17, v65, v123
    ds_read_b32 v116, v9 offset:32
    v_dot2_f32_bf16 v122, v18, v54, v122
    v_dot2_f32_bf16 v123, v18, v66, v123
    ds_read_b128 v[128:131], v10 offset:1120
    v_dot2_f32_bf16 v122, v19, v55, v122
    v_dot2_f32_bf16 v123, v19, v67, v123
    ds_read_b128 v[132:135], v10 offset:1136
    v_dot2_f32_bf16 v122, v20, v56, v122
    v_dot2_f32_bf16 v123, v20, v68, v123
    ds_read_b128 v[136:139], v10 offset:1152
    s_waitcnt lgkmcnt(12)
    s_nop 0
    v_dot2_f32_bf16 v124, v12, v72, 0
    s_waitcnt lgkmcnt(9)
    s_nop 0
    v_dot2_f32_bf16 v125, v12, v84, 0
    ds_read_b128 v[140:143], v10 offset:1168
    v_dot2_f32_bf16 v124, v13, v73, v124
    v_dot2_f32_bf16 v125, v13, v85, v125
    ds_read_b64 v[144:145], v10 offset:1184
    v_dot2_f32_bf16 v124, v14, v74, v124
    v_dot2_f32_bf16 v125, v14, v86, v125
    ds_read_b128 v[148:151], v10 offset:960
    v_dot2_f32_bf16 v124, v15, v75, v124
    v_dot2_f32_bf16 v125, v15, v87, v125
    ds_read_b128 v[152:155], v10 offset:976
    v_dot2_f32_bf16 v124, v16, v76, v124
    v_dot2_f32_bf16 v125, v16, v88, v125
    ds_read_b128 v[156:159], v10 offset:992
    v_dot2_f32_bf16 v124, v17, v77, v124
    v_dot2_f32_bf16 v125, v17, v89, v125
    buffer_load_dwordx4 v[230:233], v23, s[28:31], 0 offen offset:64
    ds_read_b128 v[160:163], v10 offset:1008
    v_dot2_f32_bf16 v124, v18, v78, v124
    v_dot2_f32_bf16 v125, v18, v90, v125
    ds_read_b64 v[164:165], v10 offset:1024
    v_dot2_f32_bf16 v124, v19, v79, v124
    v_dot2_f32_bf16 v125, v19, v91, v125
    ds_read_b128 v[168:171], v10 offset:800
    v_dot2_f32_bf16 v124, v20, v80, v124
    v_dot2_f32_bf16 v125, v20, v92, v125
    ds_read_b128 v[172:175], v10 offset:816
    s_waitcnt lgkmcnt(15)
    s_nop 0
    v_dot2_f32_bf16 v126, v12, v96, 0
    s_waitcnt lgkmcnt(12)
    s_nop 0
    v_dot2_f32_bf16 v127, v12, v108, 0
    ds_read_b128 v[176:179], v10 offset:832
    v_dot2_f32_bf16 v126, v13, v97, v126
    v_dot2_f32_bf16 v127, v13, v109, v127
    ds_read_b128 v[180:183], v10 offset:848
    v_dot2_f32_bf16 v126, v14, v98, v126
    v_dot2_f32_bf16 v127, v14, v110, v127
    ds_read_b64 v[184:185], v10 offset:864
    v_dot2_f32_bf16 v126, v15, v99, v126
    v_dot2_f32_bf16 v127, v15, v111, v127
    ds_read_b128 v[188:191], v10 offset:640
    v_dot2_f32_bf16 v126, v16, v100, v126
    v_dot2_f32_bf16 v127, v16, v112, v127
    ds_read_b128 v[192:195], v10 offset:656
    v_dot2_f32_bf16 v126, v17, v101, v126
    v_dot2_f32_bf16 v127, v17, v113, v127
    ds_read_b128 v[196:199], v10 offset:672
    v_dot2_f32_bf16 v126, v18, v102, v126
    v_dot2_f32_bf16 v127, v18, v114, v127
    buffer_load_dwordx2 v[234:235], v11, s[28:31], 0 offen offset:128
    ds_read_b128 v[200:203], v10 offset:688
    v_dot2_f32_bf16 v126, v19, v103, v126
    v_dot2_f32_bf16 v127, v19, v115, v127
    ds_read_b64 v[204:205], v10 offset:704
    v_dot2_f32_bf16 v126, v20, v104, v126
    v_dot2_f32_bf16 v127, v20, v116, v127
    ds_read_b128 v[24:27], v10 offset:480
    s_cmp_eq_u32 s69, 0
    s_cbranch_scc0 L_p1_nomask
    v_mov_b32 v5, 0xce6e6b28
    v_cmp_le_u32 vcc, 2, v1
    s_nop 1
    v_cndmask_b32 v121, v5, v121, vcc
    v_cmp_le_u32 vcc, 4, v1
    s_nop 1
    v_cndmask_b32 v122, v5, v122, vcc
    v_cmp_le_u32 vcc, 6, v1
    s_nop 1
    v_cndmask_b32 v123, v5, v123, vcc
    v_cmp_le_u32 vcc, 8, v1
    s_nop 1
    v_cndmask_b32 v124, v5, v124, vcc
    v_cmp_le_u32 vcc, 10, v1
    s_nop 1
    v_cndmask_b32 v125, v5, v125, vcc
    v_cmp_le_u32 vcc, 12, v1
    s_nop 1
    v_cndmask_b32 v126, v5, v126, vcc
    v_cmp_le_u32 vcc, 14, v1
    s_nop 1
    v_cndmask_b32 v127, v5, v127, vcc
L_p1_nomask:
    s_mov_b32 s4, 0x3eae1a93
    s_nop 0
    ds_read_b128 v[28:31], v10 offset:496
    v_max3_f32 v4, v120, v121, v122
    v_max3_f32 v5, v123, v124, v125
    ds_read_b128 v[32:35], v10 offset:512
    v_max3_f32 v4, v4, v126, v127
    v_max_f32_e64 v4, v4, v5
    ds_read_b128 v[36:39], v10 offset:528
    v_mul_f32_e64 v4, s4, v4
    v_fma_f32 v120, v120, s4, -v4
    ds_read_b64 v[40:41], v10 offset:544
    v_fma_f32 v121, v121, s4, -v4
    v_fma_f32 v122, v122, s4, -v4
    ds_read_b128 v[44:47], v10 offset:320
    v_fma_f32 v123, v123, s4, -v4
    v_fma_f32 v124, v124, s4, -v4
    ds_read_b128 v[48:51], v10 offset:336
    v_fma_f32 v125, v125, s4, -v4
    v_fma_f32 v126, v126, s4, -v4
    ds_read_b128 v[52:55], v10 offset:352
    v_fma_f32 v127, v127, s4, -v4
    v_exp_f32_e64 v120, v120
    ds_read_b128 v[56:59], v10 offset:368
    v_exp_f32 v121, v121
    v_lshlrev_b32 v23, 5, v3
    buffer_load_dwordx4 v[236:239], v23, s[64:67], s25 offen offset:0 sc1
    v_exp_f32_e64 v122, v122
    ds_read_b64 v[60:61], v10 offset:384
    v_exp_f32 v123, v123
    v_exp_f32 v124, v124
    ds_read_b128 v[64:67], v10 offset:160
    v_exp_f32 v125, v125
    v_exp_f32 v126, v126
    ds_read_b128 v[68:71], v10 offset:176
    v_exp_f32 v127, v127
    v_add_f32 v4, v120, v121
    ds_read_b128 v[72:75], v10 offset:192
    v_add_f32 v5, v122, v123
    v_add_f32 v6, v124, v125
    ds_read_b128 v[76:79], v10 offset:208
    v_add_f32 v7, v126, v127
    v_add_f32 v4, v4, v5
    ds_read_b64 v[80:81], v10 offset:224
    v_add_f32 v6, v6, v7
    v_add_f32 v4, v4, v6
    ds_read_b128 v[84:87], v10 offset:0
    v_rcp_f32 v6, v4
    s_waitcnt lgkmcnt(15)
    v_pk_mul_f32 v[208:209], v[128:129], v[120:121] op_sel:[0,0] op_sel_hi:[1,0]
    ds_read_b128 v[88:91], v10 offset:16
    v_pk_mul_f32 v[210:211], v[130:131], v[120:121] op_sel:[0,0] op_sel_hi:[1,0]
    v_pk_mul_f32 v[212:213], v[132:133], v[120:121] op_sel:[0,0] op_sel_hi:[1,0]
    ds_read_b128 v[92:95], v10 offset:32
    v_pk_mul_f32 v[214:215], v[134:135], v[120:121] op_sel:[0,0] op_sel_hi:[1,0]
    v_pk_mul_f32 v[216:217], v[136:137], v[120:121] op_sel:[0,0] op_sel_hi:[1,0]
    ds_read_b128 v[96:99], v10 offset:48
    v_pk_mul_f32 v[218:219], v[138:139], v[120:121] op_sel:[0,0] op_sel_hi:[1,0]
    buffer_load_dwordx4 v[240:243], v23, s[64:67], s25 offen offset:16 sc1
    v_pk_mul_f32 v[220:221], v[140:141], v[120:121] op_sel:[0,0] op_sel_hi:[1,0]
    ds_read_b64 v[100:101], v10 offset:64
    v_pk_mul_f32 v[222:223], v[142:143], v[120:121] op_sel:[0,0] op_sel_hi:[1,0]
    v_pk_mul_f32 v[224:225], v[144:145], v[120:121] op_sel:[0,0] op_sel_hi:[1,0]
    v_pk_fma_f32 v[208:209], v[148:149], v[120:121], v[208:209] op_sel:[0,1,0] op_sel_hi:[1,1,1]
    v_pk_fma_f32 v[210:211], v[150:151], v[120:121], v[210:211] op_sel:[0,1,0] op_sel_hi:[1,1,1]
    v_pk_fma_f32 v[212:213], v[152:153], v[120:121], v[212:213] op_sel:[0,1,0] op_sel_hi:[1,1,1]
    v_pk_fma_f32 v[214:215], v[154:155], v[120:121], v[214:215] op_sel:[0,1,0] op_sel_hi:[1,1,1]
    v_pk_fma_f32 v[216:217], v[156:157], v[120:121], v[216:217] op_sel:[0,1,0] op_sel_hi:[1,1,1]
    v_pk_fma_f32 v[218:219], v[158:159], v[120:121], v[218:219] op_sel:[0,1,0] op_sel_hi:[1,1,1]
    v_pk_fma_f32 v[220:221], v[160:161], v[120:121], v[220:221] op_sel:[0,1,0] op_sel_hi:[1,1,1]
    v_pk_fma_f32 v[222:223], v[162:163], v[120:121], v[222:223] op_sel:[0,1,0] op_sel_hi:[1,1,1]
    v_pk_fma_f32 v[224:225], v[164:165], v[120:121], v[224:225] op_sel:[0,1,0] op_sel_hi:[1,1,1]
    v_pk_fma_f32 v[208:209], v[168:169], v[122:123], v[208:209] op_sel:[0,0,0] op_sel_hi:[1,0,1]
    v_pk_fma_f32 v[210:211], v[170:171], v[122:123], v[210:211] op_sel:[0,0,0] op_sel_hi:[1,0,1]
    v_pk_fma_f32 v[212:213], v[172:173], v[122:123], v[212:213] op_sel:[0,0,0] op_sel_hi:[1,0,1]
    v_pk_fma_f32 v[214:215], v[174:175], v[122:123], v[214:215] op_sel:[0,0,0] op_sel_hi:[1,0,1]
    v_pk_fma_f32 v[216:217], v[176:177], v[122:123], v[216:217] op_sel:[0,0,0] op_sel_hi:[1,0,1]
    v_pk_fma_f32 v[218:219], v[178:179], v[122:123], v[218:219] op_sel:[0,0,0] op_sel_hi:[1,0,1]
    v_pk_fma_f32 v[220:221], v[180:181], v[122:123], v[220:221] op_sel:[0,0,0] op_sel_hi:[1,0,1]
    v_pk_fma_f32 v[222:223], v[182:183], v[122:123], v[222:223] op_sel:[0,0,0] op_sel_hi:[1,0,1]
    v_pk_fma_f32 v[224:225], v[184:185], v[122:123], v[224:225] op_sel:[0,0,0] op_sel_hi:[1,0,1]
    v_pk_fma_f32 v[208:209], v[188:189], v[122:123], v[208:209] op_sel:[0,1,0] op_sel_hi:[1,1,1]
    v_pk_fma_f32 v[210:211], v[190:191], v[122:123], v[210:211] op_sel:[0,1,0] op_sel_hi:[1,1,1]
    v_pk_fma_f32 v[212:213], v[192:193], v[122:123], v[212:213] op_sel:[0,1,0] op_sel_hi:[1,1,1]
    v_pk_fma_f32 v[214:215], v[194:195], v[122:123], v[214:215] op_sel:[0,1,0] op_sel_hi:[1,1,1]
    v_pk_fma_f32 v[216:217], v[196:197], v[122:123], v[216:217] op_sel:[0,1,0] op_sel_hi:[1,1,1]
    v_pk_fma_f32 v[218:219], v[198:199], v[122:123], v[218:219] op_sel:[0,1,0] op_sel_hi:[1,1,1]
    v_pk_fma_f32 v[220:221], v[200:201], v[122:123], v[220:221] op_sel:[0,1,0] op_sel_hi:[1,1,1]
    v_pk_fma_f32 v[222:223], v[202:203], v[122:123], v[222:223] op_sel:[0,1,0] op_sel_hi:[1,1,1]
    buffer_load_dwordx4 v[244:247], v23, s[64:67], s25 offen offset:128 sc1
    v_pk_fma_f32 v[224:225], v[204:205], v[122:123], v[224:225] op_sel:[0,1,0] op_sel_hi:[1,1,1]
    s_waitcnt lgkmcnt(15)
    s_nop 0
    v_pk_fma_f32 v[208:209], v[24:25], v[124:125], v[208:209] op_sel:[0,0,0] op_sel_hi:[1,0,1]
    v_pk_fma_f32 v[210:211], v[26:27], v[124:125], v[210:211] op_sel:[0,0,0] op_sel_hi:[1,0,1]
    v_pk_fma_f32 v[212:213], v[28:29], v[124:125], v[212:213] op_sel:[0,0,0] op_sel_hi:[1,0,1]
    v_pk_fma_f32 v[214:215], v[30:31], v[124:125], v[214:215] op_sel:[0,0,0] op_sel_hi:[1,0,1]
    v_pk_fma_f32 v[216:217], v[32:33], v[124:125], v[216:217] op_sel:[0,0,0] op_sel_hi:[1,0,1]
    v_pk_fma_f32 v[218:219], v[34:35], v[124:125], v[218:219] op_sel:[0,0,0] op_sel_hi:[1,0,1]
    v_pk_fma_f32 v[220:221], v[36:37], v[124:125], v[220:221] op_sel:[0,0,0] op_sel_hi:[1,0,1]
    v_pk_fma_f32 v[222:223], v[38:39], v[124:125], v[222:223] op_sel:[0,0,0] op_sel_hi:[1,0,1]
    v_pk_fma_f32 v[224:225], v[40:41], v[124:125], v[224:225] op_sel:[0,0,0] op_sel_hi:[1,0,1]
    s_waitcnt lgkmcnt(10)
    s_nop 0
    v_pk_fma_f32 v[208:209], v[44:45], v[124:125], v[208:209] op_sel:[0,1,0] op_sel_hi:[1,1,1]
    v_pk_fma_f32 v[210:211], v[46:47], v[124:125], v[210:211] op_sel:[0,1,0] op_sel_hi:[1,1,1]
    v_pk_fma_f32 v[212:213], v[48:49], v[124:125], v[212:213] op_sel:[0,1,0] op_sel_hi:[1,1,1]
    v_pk_fma_f32 v[214:215], v[50:51], v[124:125], v[214:215] op_sel:[0,1,0] op_sel_hi:[1,1,1]
    v_pk_fma_f32 v[216:217], v[52:53], v[124:125], v[216:217] op_sel:[0,1,0] op_sel_hi:[1,1,1]
    v_pk_fma_f32 v[218:219], v[54:55], v[124:125], v[218:219] op_sel:[0,1,0] op_sel_hi:[1,1,1]
    v_pk_fma_f32 v[220:221], v[56:57], v[124:125], v[220:221] op_sel:[0,1,0] op_sel_hi:[1,1,1]
    v_pk_fma_f32 v[222:223], v[58:59], v[124:125], v[222:223] op_sel:[0,1,0] op_sel_hi:[1,1,1]
    v_pk_fma_f32 v[224:225], v[60:61], v[124:125], v[224:225] op_sel:[0,1,0] op_sel_hi:[1,1,1]
    s_waitcnt lgkmcnt(5)
    s_nop 0
    v_pk_fma_f32 v[208:209], v[64:65], v[126:127], v[208:209] op_sel:[0,0,0] op_sel_hi:[1,0,1]
    v_pk_fma_f32 v[210:211], v[66:67], v[126:127], v[210:211] op_sel:[0,0,0] op_sel_hi:[1,0,1]
    v_pk_fma_f32 v[212:213], v[68:69], v[126:127], v[212:213] op_sel:[0,0,0] op_sel_hi:[1,0,1]
    v_pk_fma_f32 v[214:215], v[70:71], v[126:127], v[214:215] op_sel:[0,0,0] op_sel_hi:[1,0,1]
    v_pk_fma_f32 v[216:217], v[72:73], v[126:127], v[216:217] op_sel:[0,0,0] op_sel_hi:[1,0,1]
    v_pk_fma_f32 v[218:219], v[74:75], v[126:127], v[218:219] op_sel:[0,0,0] op_sel_hi:[1,0,1]
    v_pk_fma_f32 v[220:221], v[76:77], v[126:127], v[220:221] op_sel:[0,0,0] op_sel_hi:[1,0,1]
    v_pk_fma_f32 v[222:223], v[78:79], v[126:127], v[222:223] op_sel:[0,0,0] op_sel_hi:[1,0,1]
    v_pk_fma_f32 v[224:225], v[80:81], v[126:127], v[224:225] op_sel:[0,0,0] op_sel_hi:[1,0,1]
    s_waitcnt lgkmcnt(0)
    s_nop 0
    v_pk_fma_f32 v[208:209], v[84:85], v[126:127], v[208:209] op_sel:[0,1,0] op_sel_hi:[1,1,1]
    v_pk_fma_f32 v[210:211], v[86:87], v[126:127], v[210:211] op_sel:[0,1,0] op_sel_hi:[1,1,1]
    buffer_load_dwordx4 v[248:251], v23, s[64:67], s25 offen offset:144 sc1
    v_pk_fma_f32 v[212:213], v[88:89], v[126:127], v[212:213] op_sel:[0,1,0] op_sel_hi:[1,1,1]
    v_pk_fma_f32 v[214:215], v[90:91], v[126:127], v[214:215] op_sel:[0,1,0] op_sel_hi:[1,1,1]
    v_pk_fma_f32 v[216:217], v[92:93], v[126:127], v[216:217] op_sel:[0,1,0] op_sel_hi:[1,1,1]
    v_pk_fma_f32 v[218:219], v[94:95], v[126:127], v[218:219] op_sel:[0,1,0] op_sel_hi:[1,1,1]
    v_pk_fma_f32 v[220:221], v[96:97], v[126:127], v[220:221] op_sel:[0,1,0] op_sel_hi:[1,1,1]
    v_pk_fma_f32 v[222:223], v[98:99], v[126:127], v[222:223] op_sel:[0,1,0] op_sel_hi:[1,1,1]
    v_pk_fma_f32 v[224:225], v[100:101], v[126:127], v[224:225] op_sel:[0,1,0] op_sel_hi:[1,1,1]
    v_pk_mul_f32 v[208:209], v[208:209], v[6:7] op_sel:[0,0] op_sel_hi:[1,0]
    v_pk_mul_f32 v[210:211], v[210:211], v[6:7] op_sel:[0,0] op_sel_hi:[1,0]
    v_pk_mul_f32 v[212:213], v[212:213], v[6:7] op_sel:[0,0] op_sel_hi:[1,0]
    v_pk_mul_f32 v[214:215], v[214:215], v[6:7] op_sel:[0,0] op_sel_hi:[1,0]
    v_pk_mul_f32 v[216:217], v[216:217], v[6:7] op_sel:[0,0] op_sel_hi:[1,0]
    v_pk_mul_f32 v[218:219], v[218:219], v[6:7] op_sel:[0,0] op_sel_hi:[1,0]
    v_pk_mul_f32 v[220:221], v[220:221], v[6:7] op_sel:[0,0] op_sel_hi:[1,0]
    v_pk_mul_f32 v[222:223], v[222:223], v[6:7] op_sel:[0,0] op_sel_hi:[1,0]
    v_pk_mul_f32 v[224:225], v[224:225], v[6:7] op_sel:[0,0] op_sel_hi:[1,0]
    v_cvt_pk_bf16_f32 v12, v208, v209
    v_cvt_pk_bf16_f32 v13, v210, v211
    v_cvt_pk_bf16_f32 v14, v212, v213
    v_cvt_pk_bf16_f32 v15, v214, v215
    v_cvt_pk_bf16_f32 v16, v216, v217
    v_cvt_pk_bf16_f32 v17, v218, v219
    v_cvt_pk_bf16_f32 v18, v220, v221
    v_cvt_pk_bf16_f32 v19, v222, v223
    v_cvt_pk_bf16_f32 v20, v224, v225
    s_mul_i32 s4, s68, 36
    s_add_u32 s4, s4, 53248
    s_nop 0
    v_mul_u32_u24 v4, 144, v1
    v_add_u32_e64 v4, s4, v4
    ds_write2_b32 v4, v12, v13 offset0:0 offset1:1
    ds_write2_b32 v4, v14, v15 offset0:2 offset1:3
    ds_write2_b32 v4, v16, v17 offset0:4 offset1:5
    v_lshlrev_b32_e64 v23, 4, v3
    buffer_load_dwordx4 v[252:255], v23, s[64:67], s25 offen offset:256 sc1
    ds_write2_b32 v4, v18, v19 offset0:6 offset1:7
    ds_write_b32 v4, v20 offset:32
    s_waitcnt lgkmcnt(0)
    s_barrier
    s_lshl_b32 s4, s68, 4
    v_add_u32 v4, s4, v2
    v_mul_u32_u24 v4, 144, v4
    v_lshl_add_u32 v4, v3, 4, v4
    v_add_u32 v4, 53248, v4
    ds_read_b128 v[12:15], v4
    ds_read_b128 v[16:19], v4 offset:64
    ds_read_b128 v[24:27], v4 offset:128
    s_lshl_b32 s4, s69, 2
    s_add_u32 s4, s4, s68
    s_mul_i32 s4, s4, 72
    s_mul_i32 s5, s70, 9
    s_add_u32 s4, s4, s5
    s_lshl_b32 s4, s4, 8
    s_add_u32 s4, s4, 19922944
    v_lshlrev_b32 v5, 4, v1
    v_mov_b32 v6, 0x7ffffff0
    v_cmp_gt_u32 vcc, 16, v1
    s_nop 1
    v_cndmask_b32 v6, v6, v5, vcc
    s_waitcnt lgkmcnt(2)
    buffer_store_dwordx4 v[12:15], v5, s[64:67], s4 offen sc1
    s_waitcnt lgkmcnt(1)
    s_nop 0
    buffer_store_dwordx4 v[16:19], v5, s[64:67], s4 offen offset:1024 sc1
    s_waitcnt lgkmcnt(0)
    s_nop 0
    buffer_store_dwordx4 v[24:27], v6, s[64:67], s4 offen offset:2048 sc1
    s_lshl_b32 s22, s69, 7
    s_lshl_b32 s23, s70, 2
    s_add_u32 s22, s22, s23
    s_add_u32 s22, s22, 46137344
    s_and_b32 s69, s2, 7
    s_lshl_b32 s69, s69, 2
    s_lshr_b32 s4, s2, 6
    s_add_u32 s69, s69, s4
    s_lshr_b32 s70, s2, 3
    s_and_b32 s70, s70, 7
    v_lshrrev_b32 v6, 2, v2
    v_lshl_add_u32 v7, v3, 3, v6
    v_lshrrev_b32 v5, 1, v7
    v_xor_b32 v4, v5, v7
    v_lshrrev_b32 v4, 2, v4
    v_and_b32 v4, 1, v4
    v_and_b32_e64 v5, 1, v5
    v_lshl_or_b32 v4, v4, 1, v5
    v_lshlrev_b32_e64 v4, 5, v4
    v_lshl_or_b32 v8, v7, 7, v4
    v_and_b32_e64 v5, 3, v2
    v_lshl_or_b32 v8, v5, 3, v8
    v_add_u32 v7, 4, v7
    v_lshrrev_b32 v5, 1, v7
    v_xor_b32 v4, v5, v7
    v_lshrrev_b32 v4, 2, v4
    v_and_b32 v4, 1, v4
    v_and_b32 v5, 1, v5
    v_lshl_or_b32 v4, v4, 1, v5
    v_lshlrev_b32_e64 v4, 5, v4
    v_lshl_or_b32 v9, v7, 7, v4
    v_and_b32_e64 v5, 3, v2
    v_lshl_or_b32 v9, v5, 3, v9
    v_lshl_add_u32 v7, v3, 2, v6
    v_lshrrev_b32 v5, 1, v7
    v_xor_b32 v4, v5, v7
    v_lshrrev_b32 v4, 2, v4
    v_and_b32 v4, 1, v4
    v_and_b32_e64 v5, 1, v5
    v_lshl_or_b32 v4, v4, 1, v5
    v_lshlrev_b32_e64 v4, 5, v4
    v_lshl_or_b32 v10, v7, 7, v4
    v_and_b32_e64 v5, 3, v2
    v_lshl_or_b32 v10, v5, 3, v10
    v_add_u32 v7, 16, v7
    v_lshrrev_b32 v5, 1, v7
    v_xor_b32 v4, v5, v7
    v_lshrrev_b32 v4, 2, v4
    v_and_b32 v4, 1, v4
    v_and_b32 v5, 1, v5
    v_lshl_or_b32 v4, v4, 1, v5
    v_lshlrev_b32_e64 v4, 5, v4
    v_lshl_or_b32 v11, v7, 7, v4
    v_and_b32_e64 v5, 3, v2
    v_lshl_or_b32 v11, v5, 3, v11
    s_lshl_b32 s27, s68, 14
    s_add_u32 s27, s27, 98304
    v_add_u32 v8, s27, v8
    v_add_u32 v9, s27, v9
    v_add_u32 v10, s27, v10
    v_add_u32 v11, s27, v11
    s_cmp_eq_u32 s12, 2
    s_cselect_b64 vcc, -1, 0
    v_cndmask_b32 v24, v8, v10, vcc
    v_cndmask_b32 v25, v9, v11, vcc
    v_xor_b32 v26, 32, v24
    v_xor_b32 v27, 32, v25
    v_xor_b32 v28, 64, v24
    v_xor_b32_e64 v29, 64, v25
    v_xor_b32 v30, 96, v24
    v_xor_b32 v31, 96, v25
    s_cmp_eq_u32 s12, 2
    s_mov_b32 s12, 36864
    s_cselect_b32 s12, 18432, s12
    s_cmp_eq_u32 s15, 2
    s_cselect_b64 vcc, -1, 0
    v_cndmask_b32 v32, v8, v10, vcc
    v_cndmask_b32 v33, v9, v11, vcc
    v_xor_b32 v34, 32, v32
    v_xor_b32 v35, 32, v33
    v_xor_b32 v36, 64, v32
    v_xor_b32_e64 v37, 64, v33
    v_xor_b32 v38, 96, v32
    v_xor_b32 v39, 96, v33
    s_cmp_eq_u32 s15, 2
    s_mov_b32 s15, 36864
    s_cselect_b32 s15, 18432, s15
    s_cmp_eq_u32 s18, 2
    s_cselect_b64 vcc, -1, 0
    v_cndmask_b32 v40, v8, v10, vcc
    v_cndmask_b32 v41, v9, v11, vcc
    v_xor_b32 v42, 32, v40
    v_xor_b32 v43, 32, v41
    v_xor_b32 v44, 64, v40
    v_xor_b32_e64 v45, 64, v41
    v_xor_b32 v46, 96, v40
    v_xor_b32 v47, 96, v41
    s_cmp_eq_u32 s18, 2
    s_mov_b32 s18, 36864
    s_cselect_b32 s18, 18432, s18
    s_cmp_eq_u32 s21, 2
    s_cselect_b64 vcc, -1, 0
    v_cndmask_b32 v48, v8, v10, vcc
    v_cndmask_b32 v49, v9, v11, vcc
    v_xor_b32 v50, 32, v48
    v_xor_b32 v51, 32, v49
    v_xor_b32 v52, 64, v48
    v_xor_b32_e64 v53, 64, v49
    v_xor_b32 v54, 96, v48
    v_xor_b32 v55, 96, v49
    s_cmp_eq_u32 s21, 2
    s_mov_b32 s21, 36864
    s_cselect_b32 s21, 18432, s21
    s_mul_i32 s5, s70, 2304
    s_add_u32 s5, s5, 47316992
    v_min_u32 v6, 17, v1
    v_lshl_add_u32 v6, v6, 7, s5
    s_waitcnt vmcnt(3)
    s_nop 0
    ds_read_b64_tr_b16 a[0:1], v24 offset:0
    ds_read_b64_tr_b16 a[2:3], v25 offset:0
    ds_read_b64_tr_b16 a[4:5], v26 offset:0
    ds_read_b64_tr_b16 a[6:7], v27 offset:0
    ds_read_b64_tr_b16 a[8:9], v28 offset:0
    ds_read_b64_tr_b16 a[10:11], v29 offset:0
    ds_read_b64_tr_b16 a[12:13], v30 offset:0
    ds_read_b64_tr_b16 a[14:15], v31 offset:0
    ds_read_b64_tr_b16 a[16:17], v32 offset:4096
    ds_read_b64_tr_b16 a[18:19], v33 offset:4096
    ds_read_b64_tr_b16 a[20:21], v34 offset:4096
    ds_read_b64_tr_b16 a[22:23], v35 offset:4096
    ds_read_b64_tr_b16 a[24:25], v36 offset:4096
    ds_read_b64_tr_b16 a[26:27], v37 offset:4096
    ds_read_b64_tr_b16 a[28:29], v38 offset:4096
    ds_read_b64_tr_b16 a[30:31], v39 offset:4096
    ds_read_b64_tr_b16 a[32:33], v40 offset:8192
    ds_read_b64_tr_b16 a[34:35], v41 offset:8192
    ds_read_b64_tr_b16 a[36:37], v42 offset:8192
    ds_read_b64_tr_b16 a[38:39], v43 offset:8192
    ds_read_b64_tr_b16 a[40:41], v44 offset:8192
    ds_read_b64_tr_b16 a[42:43], v45 offset:8192
    ds_read_b64_tr_b16 a[44:45], v46 offset:8192
    ds_read_b64_tr_b16 a[46:47], v47 offset:8192
    ds_read_b64_tr_b16 a[48:49], v48 offset:12288
    ds_read_b64_tr_b16 a[50:51], v49 offset:12288
    ds_read_b64_tr_b16 a[52:53], v50 offset:12288
    ds_read_b64_tr_b16 a[54:55], v51 offset:12288
    ds_read_b64_tr_b16 a[56:57], v52 offset:12288
    ds_read_b64_tr_b16 a[58:59], v53 offset:12288
    ds_read_b64_tr_b16 a[60:61], v54 offset:12288
    ds_read_b64_tr_b16 a[62:63], v55 offset:12288
    v_accvgpr_read_b32 v7, a64
    s_mov_b32 s88, 0
L_pwo:
    v_cmp_ne_u32 vcc, s3, v7
    s_nop 2
    s_cbranch_vccz L_pwo_ok
    s_add_u32 s88, s88, 1
    s_cmp_gt_u32 s88, 262144
    s_cbranch_scc1 L_pwo_ok
    buffer_load_dword v7, v6, s[64:67], 0 offen sc1
L_stub_9:
    s_cbranch_execz L_tchret_m1_m2
    s_waitcnt vmcnt(0)
    s_branch L_pwo
L_pwo_ok:
    s_mov_b32 s40, s11
    s_mov_b32 s41, s12
    s_mov_b32 s42, s14
    s_mov_b32 s43, s15
    s_mov_b32 s44, s17
    s_mov_b32 s45, s18
    s_mov_b32 s46, s20
    s_mov_b32 s47, s21
    s_mul_i32 s8, s70, 90
    s_add_u32 s8, s8, s68
    s_lshl_b32 s8, s8, 10
    s_add_u32 s8, s8, 0
    s_lshl_b32 s9, s68, 10
    s_add_u32 s9, s9, 62464
    s_waitcnt lgkmcnt(0)
    s_barrier
    s_add_u32 m0, s9, 0
    s_add_u32 s20, s8, 0
    s_nop 0
    buffer_load_dwordx4 v21, s[64:67], s20 offen sc1 lds
    s_add_u32 m0, s9, 4096
    s_add_u32 s20, s8, 4096
    buffer_load_dwordx4 v21, s[64:67], s20 offen sc1 lds
    s_add_u32 m0, s9, 8192
    s_add_u32 s20, s8, 8192
    buffer_load_dwordx4 v21, s[64:67], s20 offen sc1 lds
    s_add_u32 m0, s9, 12288
    s_add_u32 s20, s8, 12288
    buffer_load_dwordx4 v21, s[64:67], s20 offen sc1 lds
    s_waitcnt vmcnt(4)
    s_barrier
    s_cmp_eq_u32 s68, 0
    s_cbranch_scc0 L_fl_2
    v_mov_b32 v4, s3
    s_mov_b64 exec, 1
    buffer_store_dword v4, off, s[64:67], s22 sc1
    s_mov_b64 exec, -1
L_fl_2:
    s_lshl_b32 s22, s69, 7
    s_add_u32 s22, s22, 46137344
    s_add_u32 m0, s9, 16384
    s_add_u32 s20, s8, 16384
    buffer_load_dwordx4 v21, s[64:67], s20 offen sc1 lds
    s_add_u32 m0, s9, 20480
    s_add_u32 s20, s8, 20480
    buffer_load_dwordx4 v21, s[64:67], s20 offen sc1 lds
    s_add_u32 m0, s9, 24576
    s_add_u32 s20, s8, 24576
    buffer_load_dwordx4 v21, s[64:67], s20 offen sc1 lds
    s_add_u32 m0, s9, 28672
    s_add_u32 s20, s8, 28672
    buffer_load_dwordx4 v21, s[64:67], s20 offen sc1 lds
    s_add_u32 m0, s9, 32768
    s_add_u32 s20, s8, 32768
    buffer_load_dwordx4 v21, s[64:67], s20 offen sc1 lds
    s_add_u32 m0, s9, 36864
    s_add_u32 s20, s8, 36864
    buffer_load_dwordx4 v21, s[64:67], s20 offen sc1 lds
    s_add_u32 m0, s9, 40960
    s_add_u32 s20, s8, 40960
    buffer_load_dwordx4 v21, s[64:67], s20 offen sc1 lds
    s_add_u32 m0, s9, 45056
    s_add_u32 s20, s8, 45056
    buffer_load_dwordx4 v21, s[64:67], s20 offen sc1 lds
    s_add_u32 m0, s9, 49152
    s_add_u32 s20, s8, 49152
    buffer_load_dwordx4 v21, s[64:67], s20 offen sc1 lds
    s_add_u32 m0, s9, 53248
    s_add_u32 s20, s8, 53248
    buffer_load_dwordx4 v21, s[64:67], s20 offen sc1 lds
    s_add_u32 m0, s9, 57344
    s_add_u32 s20, s8, 57344
    buffer_load_dwordx4 v21, s[64:67], s20 offen sc1 lds
    s_add_u32 m0, s9, 61440
    s_add_u32 s20, s8, 61440
    buffer_load_dwordx4 v21, s[64:67], s20 offen sc1 lds
    s_add_u32 m0, s9, 65536
    s_add_u32 s20, s8, 65536
    buffer_load_dwordx4 v21, s[64:67], s20 offen sc1 lds
    s_add_u32 m0, s9, 69632
    s_add_u32 s20, s8, 69632
    buffer_load_dwordx4 v21, s[64:67], s20 offen sc1 lds
    s_add_u32 m0, s9, 73728
    s_add_u32 s20, s8, 73728
    buffer_load_dwordx4 v21, s[64:67], s20 offen sc1 lds
    s_add_u32 m0, s9, 77824
    s_add_u32 s20, s8, 77824
    buffer_load_dwordx4 v21, s[64:67], s20 offen sc1 lds
    s_add_u32 m0, s9, 81920
    s_add_u32 s20, s8, 81920
    buffer_load_dwordx4 v21, s[64:67], s20 offen sc1 lds
    s_add_u32 m0, s9, 86016
    s_add_u32 s20, s8, 86016
    buffer_load_dwordx4 v21, s[64:67], s20 offen sc1 lds
    s_add_u32 m0, s9, 90112
    s_add_u32 s20, s8, 90112
    buffer_load_dwordx4 v21, s[64:67], s20 offen sc1 lds
    s_add_u32 s86, s64, s22
    s_addc_u32 s87, s65, 0
    s_cmp_eq_u32 s68, 1
    s_cbranch_scc0 L_si_3
    s_load_dwordx8 s[52:59], s[86:87], 0 glc
L_si_3:
    s_cmp_eq_u32 s68, 1
    s_cbranch_scc0 L_po_skip
    s_mov_b32 s89, 0
    s_branch L_po_chk
L_po:
    s_load_dwordx8 s[52:59], s[86:87], 0 glc
    s_add_u32 s89, s89, 1
    s_cmp_gt_u32 s89, 262144
    s_cbranch_scc1 L_po_to
L_po_chk:
    s_waitcnt lgkmcnt(0)
    s_xor_b32 s52, s52, s3
    s_xor_b32 s53, s53, s3
    s_xor_b32 s54, s54, s3
    s_xor_b32 s55, s55, s3
    s_xor_b32 s56, s56, s3
    s_xor_b32 s57, s57, s3
    s_xor_b32 s58, s58, s3
    s_xor_b32 s59, s59, s3
    s_or_b32 s52, s52, s53
    s_or_b32 s54, s54, s55
    s_or_b32 s56, s56, s57
    s_or_b32 s58, s58, s59
    s_or_b32 s52, s52, s54
    s_or_b32 s56, s56, s58
    s_or_b32 s52, s52, s56
    s_cbranch_scc1 L_po
L_po_to:
    s_waitcnt lgkmcnt(0)
L_po_skip:
    s_waitcnt vmcnt(0)
    s_barrier
    s_lshl_b32 s4, s69, 2
    s_add_u32 s4, s4, s68
    s_mul_i32 s4, s4, 18432
    s_add_u32 s4, s4, 19922944
    buffer_load_dwordx4 v[80:83], v21, s[64:67], s4 offen offset:0 sc1
    buffer_load_dwordx4 v[84:87], v21, s[64:67], s4 offen offset:1024 sc1
    buffer_load_dwordx4 v[88:91], v21, s[64:67], s4 offen offset:2048 sc1
    buffer_load_dwordx4 v[92:95], v21, s[64:67], s4 offen offset:3072 sc1
    s_add_u32 s4, s4, 4096
    buffer_load_dwordx4 v[96:99], v21, s[64:67], s4 offen offset:0 sc1
    buffer_load_dwordx4 v[100:103], v21, s[64:67], s4 offen offset:1024 sc1
    buffer_load_dwordx4 v[104:107], v21, s[64:67], s4 offen offset:2048 sc1
    buffer_load_dwordx4 v[108:111], v21, s[64:67], s4 offen offset:3072 sc1
    v_add_u32 v22, 62464, v21
    v_add_u32 v23, 117760, v21
    ds_read_b128 v[152:155], v22 offset:0
    ds_read_b128 v[156:159], v22 offset:18432
    ds_read_b128 v[160:163], v22 offset:36864
    ds_read_b128 v[164:167], v23 offset:0
    ds_read_b128 v[168:171], v23 offset:18432
    ds_read_b128 v[172:175], v22 offset:1024
    ds_read_b128 v[176:179], v22 offset:19456
    ds_read_b128 v[180:183], v22 offset:37888
    ds_read_b128 v[184:187], v23 offset:1024
    ds_read_b128 v[188:191], v23 offset:19456
    s_waitcnt lgkmcnt(5)
    s_waitcnt vmcnt(7)
    v_mfma_f32_16x16x32_bf16 v[56:59], v[152:155], v[80:83], 0
    ds_read_b128 v[192:195], v22 offset:2048
    v_mfma_f32_16x16x32_bf16 v[60:63], v[156:159], v[80:83], 0
    ds_read_b128 v[196:199], v22 offset:20480
    s_add_u32 s4, s4, 4096
    buffer_load_dwordx4 v[112:115], v21, s[64:67], s4 offen offset:0 sc1
    v_mfma_f32_16x16x32_bf16 v[64:67], v[160:163], v[80:83], 0
    ds_read_b128 v[200:203], v22 offset:38912
    v_mfma_f32_16x16x32_bf16 v[68:71], v[164:167], v[80:83], 0
    ds_read_b128 v[204:207], v23 offset:2048
    buffer_load_dwordx4 v[116:119], v21, s[64:67], s4 offen offset:1024 sc1
    v_mfma_f32_16x16x32_bf16 v[72:75], v[168:171], v[80:83], 0
    ds_read_b128 v[208:211], v23 offset:20480
    s_waitcnt lgkmcnt(5)
    s_waitcnt vmcnt(8)
    v_mfma_f32_16x16x32_bf16 v[56:59], v[172:175], v[84:87], v[56:59]
    ds_read_b128 v[152:155], v22 offset:3072
    v_mfma_f32_16x16x32_bf16 v[60:63], v[176:179], v[84:87], v[60:63]
    ds_read_b128 v[156:159], v22 offset:21504
    buffer_load_dwordx4 v[120:123], v21, s[64:67], s4 offen offset:2048 sc1
    v_mfma_f32_16x16x32_bf16 v[64:67], v[180:183], v[84:87], v[64:67]
    ds_read_b128 v[160:163], v22 offset:39936
    v_mfma_f32_16x16x32_bf16 v[68:71], v[184:187], v[84:87], v[68:71]
    ds_read_b128 v[164:167], v23 offset:3072
    buffer_load_dwordx4 v[124:127], v21, s[64:67], s4 offen offset:3072 sc1
    v_mfma_f32_16x16x32_bf16 v[72:75], v[188:191], v[84:87], v[72:75]
    ds_read_b128 v[168:171], v23 offset:21504
    s_waitcnt lgkmcnt(5)
    s_waitcnt vmcnt(9)
    v_mfma_f32_16x16x32_bf16 v[56:59], v[192:195], v[88:91], v[56:59]
    ds_read_b128 v[172:175], v22 offset:4096
    v_mfma_f32_16x16x32_bf16 v[60:63], v[196:199], v[88:91], v[60:63]
    ds_read_b128 v[176:179], v22 offset:22528
    s_add_u32 s4, s4, 4096
    buffer_load_dwordx4 v[128:131], v21, s[64:67], s4 offen offset:0 sc1
    v_mfma_f32_16x16x32_bf16 v[64:67], v[200:203], v[88:91], v[64:67]
    ds_read_b128 v[180:183], v22 offset:40960
    v_mfma_f32_16x16x32_bf16 v[68:71], v[204:207], v[88:91], v[68:71]
    ds_read_b128 v[184:187], v23 offset:4096
    buffer_load_dwordx4 v[132:135], v21, s[64:67], s4 offen offset:1024 sc1
    v_mfma_f32_16x16x32_bf16 v[72:75], v[208:211], v[88:91], v[72:75]
    ds_read_b128 v[188:191], v23 offset:22528
    s_waitcnt lgkmcnt(5)
    s_waitcnt vmcnt(10)
    v_mfma_f32_16x16x32_bf16 v[56:59], v[152:155], v[92:95], v[56:59]
    ds_read_b128 v[192:195], v22 offset:5120
    v_mfma_f32_16x16x32_bf16 v[60:63], v[156:159], v[92:95], v[60:63]
    ds_read_b128 v[196:199], v22 offset:23552
    buffer_load_dwordx4 v[136:139], v21, s[64:67], s4 offen offset:2048 sc1
    v_mfma_f32_16x16x32_bf16 v[64:67], v[160:163], v[92:95], v[64:67]
    ds_read_b128 v[200:203], v22 offset:41984
    v_mfma_f32_16x16x32_bf16 v[68:71], v[164:167], v[92:95], v[68:71]
    ds_read_b128 v[204:207], v23 offset:5120
    buffer_load_dwordx4 v[140:143], v21, s[64:67], s4 offen offset:3072 sc1
    v_mfma_f32_16x16x32_bf16 v[72:75], v[168:171], v[92:95], v[72:75]
    ds_read_b128 v[208:211], v23 offset:23552
    s_waitcnt lgkmcnt(5)
    s_waitcnt vmcnt(11)
    v_mfma_f32_16x16x32_bf16 v[56:59], v[172:175], v[96:99], v[56:59]
    ds_read_b128 v[152:155], v22 offset:6144
    v_mfma_f32_16x16x32_bf16 v[60:63], v[176:179], v[96:99], v[60:63]
    ds_read_b128 v[156:159], v22 offset:24576
    s_add_u32 s4, s4, 4096
    buffer_load_dwordx4 v[144:147], v21, s[64:67], s4 offen offset:0 sc1
    v_mfma_f32_16x16x32_bf16 v[64:67], v[180:183], v[96:99], v[64:67]
    ds_read_b128 v[160:163], v22 offset:43008
    v_mfma_f32_16x16x32_bf16 v[68:71], v[184:187], v[96:99], v[68:71]
    ds_read_b128 v[164:167], v23 offset:6144
    buffer_load_dwordx4 v[148:151], v21, s[64:67], s4 offen offset:1024 sc1
    v_mfma_f32_16x16x32_bf16 v[72:75], v[188:191], v[96:99], v[72:75]
    ds_read_b128 v[168:171], v23 offset:24576
    s_waitcnt lgkmcnt(5)
    s_waitcnt vmcnt(12)
    v_mfma_f32_16x16x32_bf16 v[56:59], v[192:195], v[100:103], v[56:59]
    ds_read_b128 v[172:175], v22 offset:7168
    v_mfma_f32_16x16x32_bf16 v[60:63], v[196:199], v[100:103], v[60:63]
    ds_read_b128 v[176:179], v22 offset:25600
    buffer_store_dwordx4 a[0:3], v21, s[64:67], s40 offen sc1
    v_mfma_f32_16x16x32_bf16 v[64:67], v[200:203], v[100:103], v[64:67]
    ds_read_b128 v[180:183], v22 offset:44032
    v_mfma_f32_16x16x32_bf16 v[68:71], v[204:207], v[100:103], v[68:71]
    ds_read_b128 v[184:187], v23 offset:7168
    v_mfma_f32_16x16x32_bf16 v[72:75], v[208:211], v[100:103], v[72:75]
    ds_read_b128 v[188:191], v23 offset:25600
    s_waitcnt lgkmcnt(5)
    s_waitcnt vmcnt(12)
    v_mfma_f32_16x16x32_bf16 v[56:59], v[152:155], v[104:107], v[56:59]
    ds_read_b128 v[192:195], v22 offset:8192
    v_mfma_f32_16x16x32_bf16 v[60:63], v[156:159], v[104:107], v[60:63]
    ds_read_b128 v[196:199], v22 offset:26624
    s_add_u32 s40, s40, s41
    s_nop 0
    buffer_store_dwordx4 a[4:7], v21, s[64:67], s40 offen sc1
    v_mfma_f32_16x16x32_bf16 v[64:67], v[160:163], v[104:107], v[64:67]
    ds_read_b128 v[200:203], v22 offset:45056
    v_mfma_f32_16x16x32_bf16 v[68:71], v[164:167], v[104:107], v[68:71]
    ds_read_b128 v[204:207], v23 offset:8192
    v_mfma_f32_16x16x32_bf16 v[72:75], v[168:171], v[104:107], v[72:75]
    ds_read_b128 v[208:211], v23 offset:26624
    s_waitcnt lgkmcnt(5)
    s_waitcnt vmcnt(12)
    v_mfma_f32_16x16x32_bf16 v[56:59], v[172:175], v[108:111], v[56:59]
    ds_read_b128 v[152:155], v22 offset:9216
    v_mfma_f32_16x16x32_bf16 v[60:63], v[176:179], v[108:111], v[60:63]
    ds_read_b128 v[156:159], v22 offset:27648
    s_add_u32 s40, s40, s41
    s_nop 0
    buffer_store_dwordx4 a[8:11], v21, s[64:67], s40 offen sc1
    v_mfma_f32_16x16x32_bf16 v[64:67], v[180:183], v[108:111], v[64:67]
    ds_read_b128 v[160:163], v22 offset:46080
    v_mfma_f32_16x16x32_bf16 v[68:71], v[184:187], v[108:111], v[68:71]
    ds_read_b128 v[164:167], v23 offset:9216
    v_mfma_f32_16x16x32_bf16 v[72:75], v[188:191], v[108:111], v[72:75]
    ds_read_b128 v[168:171], v23 offset:27648
    s_waitcnt lgkmcnt(5)
    s_waitcnt vmcnt(12)
    v_mfma_f32_16x16x32_bf16 v[56:59], v[192:195], v[112:115], v[56:59]
    ds_read_b128 v[172:175], v22 offset:10240
    v_mfma_f32_16x16x32_bf16 v[60:63], v[196:199], v[112:115], v[60:63]
    ds_read_b128 v[176:179], v22 offset:28672
    s_add_u32 s40, s40, s41
    s_nop 0
    buffer_store_dwordx4 a[12:15], v21, s[64:67], s40 offen sc1
    v_mfma_f32_16x16x32_bf16 v[64:67], v[200:203], v[112:115], v[64:67]
    ds_read_b128 v[180:183], v22 offset:47104
    v_mfma_f32_16x16x32_bf16 v[68:71], v[204:207], v[112:115], v[68:71]
    ds_read_b128 v[184:187], v23 offset:10240
    v_mfma_f32_16x16x32_bf16 v[72:75], v[208:211], v[112:115], v[72:75]
    ds_read_b128 v[188:191], v23 offset:28672
    s_waitcnt lgkmcnt(5)
    s_waitcnt vmcnt(12)
    v_mfma_f32_16x16x32_bf16 v[56:59], v[152:155], v[116:119], v[56:59]
    ds_read_b128 v[192:195], v22 offset:11264
    v_mfma_f32_16x16x32_bf16 v[60:63], v[156:159], v[116:119], v[60:63]
    ds_read_b128 v[196:199], v22 offset:29696
    v_mfma_f32_16x16x32_bf16 v[64:67], v[160:163], v[116:119], v[64:67]
    ds_read_b128 v[200:203], v22 offset:48128
    v_mfma_f32_16x16x32_bf16 v[68:71], v[164:167], v[116:119], v[68:71]
    ds_read_b128 v[204:207], v23 offset:11264
    v_mfma_f32_16x16x32_bf16 v[72:75], v[168:171], v[116:119], v[72:75]
    ds_read_b128 v[208:211], v23 offset:29696
    s_waitcnt lgkmcnt(5)
    s_waitcnt vmcnt(11)
    v_mfma_f32_16x16x32_bf16 v[56:59], v[172:175], v[120:123], v[56:59]
    ds_read_b128 v[152:155], v22 offset:12288
    v_mfma_f32_16x16x32_bf16 v[60:63], v[176:179], v[120:123], v[60:63]
    ds_read_b128 v[156:159], v22 offset:30720
    v_mfma_f32_16x16x32_bf16 v[64:67], v[180:183], v[120:123], v[64:67]
    ds_read_b128 v[160:163], v22 offset:49152
    v_mfma_f32_16x16x32_bf16 v[68:71], v[184:187], v[120:123], v[68:71]
    ds_read_b128 v[164:167], v23 offset:12288
    v_mfma_f32_16x16x32_bf16 v[72:75], v[188:191], v[120:123], v[72:75]
    ds_read_b128 v[168:171], v23 offset:30720
    s_waitcnt lgkmcnt(5)
    s_waitcnt vmcnt(10)
    v_mfma_f32_16x16x32_bf16 v[56:59], v[192:195], v[124:127], v[56:59]
    ds_read_b128 v[172:175], v22 offset:13312
    v_mfma_f32_16x16x32_bf16 v[60:63], v[196:199], v[124:127], v[60:63]
    ds_read_b128 v[176:179], v22 offset:31744
    v_mfma_f32_16x16x32_bf16 v[64:67], v[200:203], v[124:127], v[64:67]
    ds_read_b128 v[180:183], v22 offset:50176
    v_mfma_f32_16x16x32_bf16 v[68:71], v[204:207], v[124:127], v[68:71]
    ds_read_b128 v[184:187], v23 offset:13312
    v_mfma_f32_16x16x32_bf16 v[72:75], v[208:211], v[124:127], v[72:75]
    ds_read_b128 v[188:191], v23 offset:31744
    s_waitcnt lgkmcnt(5)
    s_waitcnt vmcnt(9)
    v_mfma_f32_16x16x32_bf16 v[56:59], v[152:155], v[128:131], v[56:59]
    ds_read_b128 v[192:195], v22 offset:14336
    v_mfma_f32_16x16x32_bf16 v[60:63], v[156:159], v[128:131], v[60:63]
    ds_read_b128 v[196:199], v22 offset:32768
    v_mfma_f32_16x16x32_bf16 v[64:67], v[160:163], v[128:131], v[64:67]
    ds_read_b128 v[200:203], v22 offset:51200
    v_mfma_f32_16x16x32_bf16 v[68:71], v[164:167], v[128:131], v[68:71]
    ds_read_b128 v[204:207], v23 offset:14336
    v_mfma_f32_16x16x32_bf16 v[72:75], v[168:171], v[128:131], v[72:75]
    ds_read_b128 v[208:211], v23 offset:32768
    s_waitcnt lgkmcnt(5)
    s_waitcnt vmcnt(8)
    v_mfma_f32_16x16x32_bf16 v[56:59], v[172:175], v[132:135], v[56:59]
    ds_read_b128 v[152:155], v22 offset:15360
    v_mfma_f32_16x16x32_bf16 v[60:63], v[176:179], v[132:135], v[60:63]
    ds_read_b128 v[156:159], v22 offset:33792
    v_mfma_f32_16x16x32_bf16 v[64:67], v[180:183], v[132:135], v[64:67]
    ds_read_b128 v[160:163], v22 offset:52224
    v_mfma_f32_16x16x32_bf16 v[68:71], v[184:187], v[132:135], v[68:71]
    ds_read_b128 v[164:167], v23 offset:15360
    v_mfma_f32_16x16x32_bf16 v[72:75], v[188:191], v[132:135], v[72:75]
    ds_read_b128 v[168:171], v23 offset:33792
    s_waitcnt lgkmcnt(5)
    s_waitcnt vmcnt(7)
    v_mfma_f32_16x16x32_bf16 v[56:59], v[192:195], v[136:139], v[56:59]
    ds_read_b128 v[172:175], v22 offset:16384
    v_mfma_f32_16x16x32_bf16 v[60:63], v[196:199], v[136:139], v[60:63]
    ds_read_b128 v[176:179], v22 offset:34816
    v_mfma_f32_16x16x32_bf16 v[64:67], v[200:203], v[136:139], v[64:67]
    ds_read_b128 v[180:183], v22 offset:53248
    v_mfma_f32_16x16x32_bf16 v[68:71], v[204:207], v[136:139], v[68:71]
    ds_read_b128 v[184:187], v23 offset:16384
    v_mfma_f32_16x16x32_bf16 v[72:75], v[208:211], v[136:139], v[72:75]
    ds_read_b128 v[188:191], v23 offset:34816
    s_waitcnt lgkmcnt(5)
    s_waitcnt vmcnt(6)
    v_mfma_f32_16x16x32_bf16 v[56:59], v[152:155], v[140:143], v[56:59]
    ds_read_b128 v[192:195], v22 offset:17408
    v_mfma_f32_16x16x32_bf16 v[60:63], v[156:159], v[140:143], v[60:63]
    ds_read_b128 v[196:199], v22 offset:35840
    v_mfma_f32_16x16x32_bf16 v[64:67], v[160:163], v[140:143], v[64:67]
    ds_read_b128 v[200:203], v22 offset:54272
    v_mfma_f32_16x16x32_bf16 v[68:71], v[164:167], v[140:143], v[68:71]
    ds_read_b128 v[204:207], v23 offset:17408
    v_mfma_f32_16x16x32_bf16 v[72:75], v[168:171], v[140:143], v[72:75]
    ds_read_b128 v[208:211], v23 offset:35840
    s_waitcnt lgkmcnt(5)
    s_waitcnt vmcnt(5)
    v_mfma_f32_16x16x32_bf16 v[56:59], v[172:175], v[144:147], v[56:59]
    v_mfma_f32_16x16x32_bf16 v[60:63], v[176:179], v[144:147], v[60:63]
    v_mfma_f32_16x16x32_bf16 v[64:67], v[180:183], v[144:147], v[64:67]
    v_mfma_f32_16x16x32_bf16 v[68:71], v[184:187], v[144:147], v[68:71]
    v_mfma_f32_16x16x32_bf16 v[72:75], v[188:191], v[144:147], v[72:75]
    s_waitcnt lgkmcnt(0)
    s_waitcnt vmcnt(4)
    v_mfma_f32_16x16x32_bf16 v[56:59], v[192:195], v[148:151], v[56:59]
    v_mfma_f32_16x16x32_bf16 v[60:63], v[196:199], v[148:151], v[60:63]
    v_mfma_f32_16x16x32_bf16 v[64:67], v[200:203], v[148:151], v[64:67]
    v_mfma_f32_16x16x32_bf16 v[68:71], v[204:207], v[148:151], v[68:71]
    v_mfma_f32_16x16x32_bf16 v[72:75], v[208:211], v[148:151], v[72:75]
    s_lshl_b32 s4, s69, 2
    s_add_u32 s4, s4, s68
    s_mul_i32 s4, s4, 72
    s_mul_i32 s5, s70, 9
    s_add_u32 s4, s4, s5
    s_lshl_b32 s4, s4, 8
    s_add_u32 s4, s4, 23068672
    v_lshlrev_b32 v6, 4, v2
    v_lshl_add_u32 v6, v3, 3, v6
    v_mov_b32 v7, 0x7ffffff0
    v_cmp_gt_u32 vcc, 32, v1
    s_nop 1
    v_cndmask_b32 v6, v7, v6, vcc
    v_lshlrev_b32 v80, 16, v226
    v_and_b32 v81, s90, v226
    v_lshlrev_b32 v82, 16, v227
    v_and_b32 v83, s90, v227
    v_lshlrev_b32 v84, 16, v228
    v_and_b32 v85, s90, v228
    v_lshlrev_b32 v86, 16, v229
    v_and_b32_e64 v87, s90, v229
    v_pk_fma_f32 v[80:81], v[56:57], v[236:237], v[80:81]
    v_pk_fma_f32 v[82:83], v[58:59], v[238:239], v[82:83]
    v_pk_fma_f32 v[84:85], v[60:61], v[240:241], v[84:85]
    v_pk_fma_f32 v[86:87], v[62:63], v[242:243], v[86:87]
    v_cvt_pk_bf16_f32 v226, v80, v81
    v_cvt_pk_bf16_f32 v227, v82, v83
    v_cvt_pk_bf16_f32 v228, v84, v85
    v_cvt_pk_bf16_f32 v229, v86, v87
    buffer_store_dwordx4 v[226:229], v21, s[64:67], s4 offen offset:0 sc1
    v_lshlrev_b32 v80, 16, v230
    v_and_b32 v81, s90, v230
    v_lshlrev_b32 v82, 16, v231
    v_and_b32 v83, s90, v231
    v_lshlrev_b32 v84, 16, v232
    v_and_b32 v85, s90, v232
    v_lshlrev_b32 v86, 16, v233
    v_and_b32 v87, s90, v233
    v_pk_fma_f32 v[80:81], v[64:65], v[244:245], v[80:81]
    v_pk_fma_f32 v[82:83], v[66:67], v[246:247], v[82:83]
    v_pk_fma_f32 v[84:85], v[68:69], v[248:249], v[84:85]
    v_pk_fma_f32 v[86:87], v[70:71], v[250:251], v[86:87]
    v_cvt_pk_bf16_f32 v230, v80, v81
    v_cvt_pk_bf16_f32 v231, v82, v83
    v_cvt_pk_bf16_f32 v232, v84, v85
    v_cvt_pk_bf16_f32 v233, v86, v87
    buffer_store_dwordx4 v[230:233], v21, s[64:67], s4 offen offset:1024 sc1
    v_lshlrev_b32 v80, 16, v234
    v_and_b32 v81, s90, v234
    v_lshlrev_b32 v82, 16, v235
    v_and_b32 v83, s90, v235
    v_pk_fma_f32 v[80:81], v[72:73], v[252:253], v[80:81]
    v_pk_fma_f32 v[82:83], v[74:75], v[254:255], v[82:83]
    v_cvt_pk_bf16_f32 v234, v80, v81
    v_cvt_pk_bf16_f32 v235, v82, v83
    buffer_store_dwordx2 v[234:235], v6, s[64:67], s4 offen offset:2048 sc1
    s_lshl_b32 s22, s69, 7
    s_lshl_b32 s23, s70, 2
    s_add_u32 s22, s22, s23
    s_add_u32 s22, s22, 46141440
    s_and_b32 s23, s2, 7
    s_lshl_b32 s23, s23, 5
    s_lshr_b32 s24, s2, 3
    s_add_u32 s23, s23, s24
    s_lshl_b32 s23, s23, 7
    s_add_u32 s10, s23, 46268416
    s_add_u32 s93, s10, 32768
    s_and_b32 s4, s2, 1
    s_lshl_b32 s69, s4, 4
    s_lshr_b32 s4, s2, 4
    s_add_u32 s69, s69, s4
    s_and_b32 s70, s2, 6
    s_bfe_u32 s4, s2, 0x10003
    s_add_u32 s70, s70, s4
    s_waitcnt vmcnt(0)
    s_barrier
    s_cmp_eq_u32 s68, 0
    s_cbranch_scc0 L_fl_4
    v_mov_b32 v4, s3
    s_mov_b64 exec, 1
    buffer_store_dword v4, off, s[64:67], s22 sc1
    buffer_store_dword v4, off, s[64:67], s10 sc1
    s_mov_b64 exec, -1
L_fl_4:
    s_lshl_b32 s91, s69, 7
    s_add_u32 s91, s91, 46141440
    s_lshl_b32 s88, s68, 10
    s_add_u32 m0, s88, 77824
    s_add_u32 s88, s88, 18881280
    s_nop 0
    buffer_load_dwordx4 v21, s[64:67], s88 offen sc1 lds
    s_mov_b32 m0, 81920
    s_mov_b32 s88, 18885376
    buffer_load_dwordx4 v21, s[64:67], s88 offen sc1 lds
    s_mul_i32 s27, s70, 36
    s_add_u32 s27, s27, s68
    s_mul_i32 s4, s27, 36864
    s_add_u32 s4, s4, 1048576
    s_mul_i32 s26, s69, 72
    s_add_u32 s26, s26, s70
    s_mov_b32 s88, 8
    s_lshl_b32 s89, s88, 2
    s_add_u32 s89, s89, s27
    s_mul_i32 s89, s89, 18432
    s_add_u32 s13, s89, 12582912
    s_lshl_b32 s88, s88, 3
    s_add_u32 s88, s88, s26
    s_lshl_b32 s88, s88, 2
    s_add_u32 s88, s88, s68
    s_lshl_b32 s88, s88, 11
    s_add_u32 s32, s88, 26214400
    s_add_u32 s88, s70, 1
    s_and_b32 s88, s88, 7
    s_lshl_b32 s89, s88, 2
    s_add_u32 s89, s89, s27
    s_mul_i32 s89, s89, 18432
    s_add_u32 s14, s89, 12582912
    s_lshl_b32 s88, s88, 3
    s_add_u32 s88, s88, s26
    s_lshl_b32 s88, s88, 2
    s_add_u32 s88, s88, s68
    s_lshl_b32 s88, s88, 11
    s_add_u32 s33, s88, 26214400
    s_add_u32 s88, s70, 2
    s_and_b32 s88, s88, 7
    s_lshl_b32 s89, s88, 2
    s_add_u32 s89, s89, s27
    s_mul_i32 s89, s89, 18432
    s_add_u32 s15, s89, 12582912
    s_lshl_b32 s88, s88, 3
    s_add_u32 s88, s88, s26
    s_lshl_b32 s88, s88, 2
    s_add_u32 s88, s88, s68
    s_lshl_b32 s88, s88, 11
    s_add_u32 s34, s88, 26214400
    s_add_u32 s88, s70, 3
    s_and_b32 s88, s88, 7
    s_lshl_b32 s89, s88, 2
    s_add_u32 s89, s89, s27
    s_mul_i32 s89, s89, 18432
    s_add_u32 s16, s89, 12582912
    s_lshl_b32 s88, s88, 3
    s_add_u32 s88, s88, s26
    s_lshl_b32 s88, s88, 2
    s_add_u32 s88, s88, s68
    s_lshl_b32 s88, s88, 11
    s_add_u32 s35, s88, 26214400
    s_add_u32 s88, s70, 4
    s_and_b32 s88, s88, 7
    s_lshl_b32 s89, s88, 2
    s_add_u32 s89, s89, s27
    s_mul_i32 s89, s89, 18432
    s_add_u32 s17, s89, 12582912
    s_lshl_b32 s88, s88, 3
    s_add_u32 s88, s88, s26
    s_lshl_b32 s88, s88, 2
    s_add_u32 s88, s88, s68
    s_lshl_b32 s88, s88, 11
    s_add_u32 s36, s88, 26214400
    s_add_u32 s88, s70, 5
    s_and_b32 s88, s88, 7
    s_lshl_b32 s89, s88, 2
    s_add_u32 s89, s89, s27
    s_mul_i32 s89, s89, 18432
    s_add_u32 s18, s89, 12582912
    s_lshl_b32 s88, s88, 3
    s_add_u32 s88, s88, s26
    s_lshl_b32 s88, s88, 2
    s_add_u32 s88, s88, s68
    s_lshl_b32 s88, s88, 11
    s_add_u32 s37, s88, 26214400
    s_add_u32 s88, s70, 6
    s_and_b32 s88, s88, 7
    s_lshl_b32 s89, s88, 2
    s_add_u32 s89, s89, s27
    s_mul_i32 s89, s89, 18432
    s_add_u32 s19, s89, 12582912
    s_lshl_b32 s88, s88, 3
    s_add_u32 s88, s88, s26
    s_lshl_b32 s88, s88, 2
    s_add_u32 s88, s88, s68
    s_lshl_b32 s88, s88, 11
    s_add_u32 s38, s88, 26214400
    s_add_u32 s88, s70, 7
    s_and_b32 s88, s88, 7
    s_lshl_b32 s89, s88, 2
    s_add_u32 s89, s89, s27
    s_mul_i32 s89, s89, 18432
    s_add_u32 s20, s89, 12582912
    s_lshl_b32 s88, s88, 3
    s_add_u32 s88, s88, s26
    s_lshl_b32 s88, s88, 2
    s_add_u32 s88, s88, s68
    s_lshl_b32 s88, s88, 11
    s_add_u32 s39, s88, 26214400
    s_add_u32 s88, s70, 8
    s_and_b32 s88, s88, 7
    s_lshl_b32 s89, s88, 2
    s_add_u32 s89, s89, s27
    s_mul_i32 s89, s89, 18432
    s_add_u32 s21, s89, 12582912
    s_lshl_b32 s88, s88, 3
    s_add_u32 s88, s88, s26
    s_lshl_b32 s88, s88, 2
    s_add_u32 s88, s88, s68
    s_lshl_b32 s88, s88, 11
    s_add_u32 s71, s88, 26214400
    v_add_u32 v8, 0, v21
    v_add_u32 v9, 4096, v21
    v_add_u32 v10, 8192, v21
    v_add_u32 v11, 12288, v21
    v_add_u32 v12, 16384, v21
    v_add_u32 v13, 20480, v21
    v_add_u32 v14, 24576, v21
    v_add_u32 v15, 28672, v21
    v_add_u32 v16, 32768, v21
    s_cmp_lt_u32 s68, 2
    s_cselect_b32 s88, 0, 0x7ff00000
    v_add_u32 v17, s88, v12
    s_lshl_b32 s88, s68, 10
    v_add_u32 v18, s88, v21
    v_add_u32 v19, 55296, v18
    v_add_u32 v22, 55296, v21
    s_lshl_b32 s88, s68, 7
    s_add_u32 s88, s88, 77824
    v_lshlrev_b32 v23, 5, v3
    v_add_u32 v23, s88, v23
    s_lshl_b32 s92, s70, 12
    s_add_u32 s92, s92, 46268416
    v_and_b32 v20, 31, v1
    v_lshlrev_b32 v20, 7, v20
    v_add_u32 v20, s92, v20
    v_mov_b32 v24, -1
    v_mov_b32 v25, -1
    v_mov_b32 v26, -1
    v_mov_b32_e64 v27, -1
    buffer_store_dwordx4 v[24:27], v21, s[64:67], s39 offen offset:0 sc1
    buffer_store_dwordx4 v[24:27], v21, s[64:67], s39 offen offset:1024 sc1
    s_mov_b64 exec, 0
    s_cmp_eq_u32 s68, 0
    s_cbranch_scc1 L_stub_10
    s_cmp_eq_u32 s68, 1
    s_cbranch_scc1 L_stub_11
    s_cmp_eq_u32 s68, 2
    s_cbranch_scc1 L_stub_12
    s_branch L_stub_13
L_tchret_m2_m3:
    s_mov_b64 exec, -1
    s_add_u32 s86, s64, s91
    s_addc_u32 s87, s65, 0
    s_cmp_eq_u32 s68, 1
    s_cbranch_scc0 L_si_5
    s_load_dwordx8 s[52:59], s[86:87], 0 glc
L_si_5:
    s_cmp_eq_u32 s68, 1
    s_cbranch_scc0 L_px_skip
    s_mov_b32 s89, 0
    s_branch L_px_chk
L_px:
    s_load_dwordx8 s[52:59], s[86:87], 0 glc
    s_add_u32 s89, s89, 1
    s_cmp_gt_u32 s89, 262144
    s_cbranch_scc1 L_px_to
L_px_chk:
    s_waitcnt lgkmcnt(0)
    s_xor_b32 s52, s52, s3
    s_xor_b32 s53, s53, s3
    s_xor_b32 s54, s54, s3
    s_xor_b32 s55, s55, s3
L_stub_10:
    s_cbranch_execz L_stub_14
    s_xor_b32 s56, s56, s3
    s_xor_b32 s57, s57, s3
    s_xor_b32 s58, s58, s3
    s_xor_b32 s59, s59, s3
    s_or_b32 s52, s52, s53
    s_or_b32 s54, s54, s55
    s_or_b32 s56, s56, s57
    s_or_b32 s58, s58, s59
    s_or_b32 s52, s52, s54
    s_or_b32 s56, s56, s58
    s_or_b32 s52, s52, s56
    s_cbranch_scc1 L_px
L_px_to:
    s_waitcnt lgkmcnt(0)
L_px_skip:
    s_waitcnt vmcnt(0)
    s_barrier
    s_lshl_b32 s88, s69, 2
    s_mul_i32 s88, s88, 18432
    s_lshl_b32 s89, s68, 10
    s_add_u32 s88, s88, s89
    s_add_u32 s88, s88, 23068672
    s_bfe_u32 s89, s2, 0x10003
    s_mul_i32 s89, s89, 36864
    s_add_u32 s22, s88, s89
    s_add_u32 s23, s88, 36864
    s_sub_u32 s23, s23, s89
    s_nop 0
    v_add_u32 v19, 36864, v18
    v_subrev_u32 v19, s89, v19
    v_add_u32 v18, s89, v18
    buffer_load_dwordx4 v[144:147], v8, s[64:67], s22 offen sc1
    buffer_load_dwordx4 v[148:151], v9, s[64:67], s22 offen sc1
    buffer_load_dwordx4 v[152:155], v10, s[64:67], s22 offen sc1
    buffer_load_dwordx4 v[156:159], v11, s[64:67], s22 offen sc1
    buffer_load_dwordx4 v[160:163], v17, s[64:67], s22 offen sc1
    s_add_u32 s22, s22, 18432
    buffer_load_dwordx4 v[164:167], v8, s[64:67], s22 offen sc1
    buffer_load_dwordx4 v[168:171], v9, s[64:67], s22 offen sc1
    buffer_load_dwordx4 v[172:175], v10, s[64:67], s22 offen sc1
    buffer_load_dwordx4 v[176:179], v11, s[64:67], s22 offen sc1
    buffer_load_dwordx4 v[180:183], v17, s[64:67], s22 offen sc1
    buffer_load_dwordx4 v[184:187], v8, s[64:67], s23 offen sc1
    buffer_load_dwordx4 v[188:191], v9, s[64:67], s23 offen sc1
    buffer_load_dwordx4 v[192:195], v10, s[64:67], s23 offen sc1
    buffer_load_dwordx4 v[196:199], v11, s[64:67], s23 offen sc1
    buffer_load_dwordx4 v[200:203], v17, s[64:67], s23 offen sc1
    s_add_u32 s23, s23, 18432
    buffer_load_dwordx4 v[204:207], v8, s[64:67], s23 offen sc1
    buffer_load_dwordx4 v[208:211], v9, s[64:67], s23 offen sc1
    buffer_load_dwordx4 v[212:215], v10, s[64:67], s23 offen sc1
    buffer_load_dwordx4 v[216:219], v11, s[64:67], s23 offen sc1
    buffer_load_dwordx4 v[220:223], v17, s[64:67], s23 offen sc1
    buffer_load_dword v6, v20, s[64:67], 0 offen sc1
    v_mov_b32 v92, 0x3f803f80
    v_mov_b32 v93, 0x3f803f80
    v_mov_b32 v94, 0x3f803f80
    v_mov_b32 v95, 0x3f803f80
    s_waitcnt vmcnt(16)
    s_nop 0
    v_mfma_f32_16x16x32_bf16 v[24:27], v[92:95], v[144:147], 0
    v_mfma_f32_16x16x32_bf16 v[28:31], v[144:147], v[144:147], 0
    v_mfma_f32_16x16x32_bf16 v[24:27], v[92:95], v[148:151], v[24:27]
    v_mfma_f32_16x16x32_bf16 v[28:31], v[148:151], v[148:151], v[28:31]
    v_mfma_f32_16x16x32_bf16 v[24:27], v[92:95], v[152:155], v[24:27]
    v_mfma_f32_16x16x32_bf16 v[28:31], v[152:155], v[152:155], v[28:31]
    v_mfma_f32_16x16x32_bf16 v[24:27], v[92:95], v[156:159], v[24:27]
    v_mfma_f32_16x16x32_bf16 v[28:31], v[156:159], v[156:159], v[28:31]
    v_mfma_f32_16x16x32_bf16 v[24:27], v[92:95], v[160:163], v[24:27]
    v_mfma_f32_16x16x32_bf16 v[28:31], v[160:163], v[160:163], v[28:31]
    s_waitcnt vmcnt(11)
    s_nop 0
    v_mfma_f32_16x16x32_bf16 v[32:35], v[92:95], v[164:167], 0
    v_mfma_f32_16x16x32_bf16 v[36:39], v[164:167], v[164:167], 0
    v_mfma_f32_16x16x32_bf16 v[32:35], v[92:95], v[168:171], v[32:35]
    v_mfma_f32_16x16x32_bf16 v[36:39], v[168:171], v[168:171], v[36:39]
    v_mfma_f32_16x16x32_bf16 v[32:35], v[92:95], v[172:175], v[32:35]
    v_mfma_f32_16x16x32_bf16 v[36:39], v[172:175], v[172:175], v[36:39]
    v_mfma_f32_16x16x32_bf16 v[32:35], v[92:95], v[176:179], v[32:35]
    v_mfma_f32_16x16x32_bf16 v[36:39], v[176:179], v[176:179], v[36:39]
    v_mfma_f32_16x16x32_bf16 v[32:35], v[92:95], v[180:183], v[32:35]
    v_mfma_f32_16x16x32_bf16 v[36:39], v[180:183], v[180:183], v[36:39]
    s_waitcnt vmcnt(6)
    s_nop 0
    v_mfma_f32_16x16x32_bf16 v[40:43], v[92:95], v[184:187], 0
    v_mfma_f32_16x16x32_bf16 v[44:47], v[184:187], v[184:187], 0
    v_mfma_f32_16x16x32_bf16 v[40:43], v[92:95], v[188:191], v[40:43]
    v_mfma_f32_16x16x32_bf16 v[44:47], v[188:191], v[188:191], v[44:47]
    v_mfma_f32_16x16x32_bf16 v[40:43], v[92:95], v[192:195], v[40:43]
    v_mfma_f32_16x16x32_bf16 v[44:47], v[192:195], v[192:195], v[44:47]
    v_mfma_f32_16x16x32_bf16 v[40:43], v[92:95], v[196:199], v[40:43]
    v_mfma_f32_16x16x32_bf16 v[44:47], v[196:199], v[196:199], v[44:47]
    v_mfma_f32_16x16x32_bf16 v[40:43], v[92:95], v[200:203], v[40:43]
    v_mfma_f32_16x16x32_bf16 v[44:47], v[200:203], v[200:203], v[44:47]
    s_waitcnt vmcnt(1)
    s_nop 0
    v_mfma_f32_16x16x32_bf16 v[48:51], v[92:95], v[204:207], 0
    v_mfma_f32_16x16x32_bf16 v[52:55], v[204:207], v[204:207], 0
    v_mfma_f32_16x16x32_bf16 v[48:51], v[92:95], v[208:211], v[48:51]
    v_mfma_f32_16x16x32_bf16 v[52:55], v[208:211], v[208:211], v[52:55]
    v_mfma_f32_16x16x32_bf16 v[48:51], v[92:95], v[212:215], v[48:51]
    v_mfma_f32_16x16x32_bf16 v[52:55], v[212:215], v[212:215], v[52:55]
    v_mfma_f32_16x16x32_bf16 v[48:51], v[92:95], v[216:219], v[48:51]
    v_mfma_f32_16x16x32_bf16 v[52:55], v[216:219], v[216:219], v[52:55]
    v_mfma_f32_16x16x32_bf16 v[48:51], v[92:95], v[220:223], v[48:51]
    v_mfma_f32_16x16x32_bf16 v[52:55], v[220:223], v[220:223], v[52:55]
    s_waitcnt vmcnt(0)
    s_mov_b32 s88, 0
L_ps0:
    v_cmp_ne_u32 vcc, s3, v6
    s_nop 2
    s_cbranch_vccz L_ps0_ok
    s_add_u32 s88, s88, 1
    s_cmp_gt_u32 s88, 262144
    s_cbranch_scc1 L_ps0_ok
    s_nop 0
    buffer_load_dword v6, v20, s[64:67], 0 offen sc1
    s_waitcnt vmcnt(0)
    s_branch L_ps0
L_ps0_ok:
    buffer_load_dwordx4 v[96:99], v8, s[64:67], s4 offen offset:0 sc1
    buffer_load_dwordx4 v[100:103], v8, s[64:67], s4 offen offset:1024 sc1
    buffer_load_dwordx4 v[104:107], v8, s[64:67], s4 offen offset:2048 sc1
    buffer_load_dwordx4 v[108:111], v8, s[64:67], s4 offen offset:3072 sc1
    buffer_load_dwordx4 v[112:115], v9, s[64:67], s4 offen offset:0 sc1
    buffer_load_dwordx4 v[116:119], v9, s[64:67], s4 offen offset:1024 sc1
    s_mul_i32 s89, s68, 512
    s_add_u32 s89, s89, 73728
    v_lshlrev_b32_e64 v5, 3, v2
    buffer_load_dwordx4 v[120:123], v9, s[64:67], s4 offen offset:2048 sc1
    v_add_u32 v6, 73728, v5
    v_add_u32_e64 v5, s89, v5
    v_cndmask_b32 v25, v28, v29, s[76:77]
    v_cndmask_b32 v25, v25, v30, s[78:79]
    v_cndmask_b32 v25, v25, v31, s[80:81]
    v_cndmask_b32 v33, v36, v37, s[76:77]
    v_cndmask_b32 v33, v33, v38, s[78:79]
    buffer_load_dwordx4 v[124:127], v9, s[64:67], s4 offen offset:3072 sc1
    v_cndmask_b32 v33, v33, v39, s[80:81]
    v_cndmask_b32 v41, v44, v45, s[76:77]
    v_cndmask_b32 v41, v41, v46, s[78:79]
    v_cndmask_b32 v41, v41, v47, s[80:81]
    v_cndmask_b32 v49, v52, v53, s[76:77]
    v_cndmask_b32 v49, v49, v54, s[78:79]
    v_cndmask_b32 v49, v49, v55, s[80:81]
    s_mov_b64 exec, s[82:83]
    s_nop 0
    ds_write_b64 v5, v[24:25] offset:0
    ds_write_b64 v5, v[32:33] offset:128
    ds_write_b64 v5, v[40:41] offset:256
    ds_write_b64 v5, v[48:49] offset:384
    s_mov_b64 exec, -1
    s_waitcnt lgkmcnt(0)
    s_barrier
    s_nop 0
    v_lshl_add_u32 v5, v3, 7, v6
    ds_read_b64 v[56:57], v5 offset:0
    ds_read_b64 v[58:59], v5 offset:512
    ds_read_b64 v[60:61], v5 offset:1024
    ds_read_b64 v[62:63], v5 offset:1536
    buffer_load_dwordx4 v[128:131], v10, s[64:67], s4 offen offset:0 sc1
    buffer_load_dwordx4 v[132:135], v10, s[64:67], s4 offen offset:1024 sc1
    s_waitcnt lgkmcnt(0)
    s_nop 0
    v_pk_add_f32 v[56:57], v[56:57], v[58:59]
    buffer_load_dwordx4 v[136:139], v10, s[64:67], s4 offen offset:2048 sc1
    v_pk_add_f32 v[60:61], v[60:61], v[62:63]
    v_pk_add_f32 v[56:57], v[56:57], v[60:61]
    v_mul_f32 v56, 0x3ae38e39, v56
    v_mul_f32 v57, 0x3ae38e39, v57
    v_fma_f32 v57, -v56, v56, v57
    v_max_f32_e64 v57, 0, v57
    v_cvt_pk_bf16_f32 v56, v56, v56
    buffer_load_dwordx4 v[140:143], v10, s[64:67], s4 offen offset:3072 sc1
    v_and_b32_e64 v56, s90, v56
    v_cvt_pk_bf16_f32 v57, v57, v57
    v_and_b32_e64 v57, s90, v57
    v_add_f32 v57, 0x3727c5ac, v57
    v_cvt_pk_bf16_f32 v57, v57, v57
    v_and_b32 v57, s90, v57
    v_sqrt_f32 v57, v57
    s_nop 0
    s_nop 0
    v_cvt_pk_bf16_f32 v57, v57, v57
    buffer_store_dwordx4 a[16:19], v21, s[64:67], s42 offen sc1
    v_and_b32 v57, s90, v57
    v_rcp_f32 v88, v57
    s_nop 0
    s_nop 0
    v_mul_f32 v89, -v56, v88
    v_mov_b32 v90, v88
    v_mov_b32 v91, v89
    s_nop 0
    v_permlane16_swap_b32 v88, v90
    v_permlane16_swap_b32 v89, v91
    v_mov_b32 v92, v88
    s_add_u32 s42, s42, s43
    s_nop 0
    buffer_store_dwordx4 a[20:23], v21, s[64:67], s42 offen sc1
    v_mov_b32 v93, v89
    v_mov_b32 v94, v90
    v_mov_b32 v95, v91
    v_permlane32_swap_b32 v88, v92
    v_permlane32_swap_b32 v89, v93
    v_permlane32_swap_b32 v90, v94
    v_permlane32_swap_b32 v91, v95
    s_nop 0
    ds_read_b128 v[24:27], v23 offset:2304
    ds_read_b128 v[28:31], v23 offset:2320
    ds_read_b128 v[32:35], v23 offset:0
    ds_read_b128 v[36:39], v23 offset:16
    ds_read_b128 v[40:43], v23 offset:2816
    ds_read_b128 v[44:47], v23 offset:2832
    ds_read_b128 v[48:51], v23 offset:512
    ds_read_b128 v[52:55], v23 offset:528
    v_lshlrev_b32 v56, 16, v144
    v_and_b32 v57, s90, v144
    v_lshlrev_b32 v58, 16, v145
    v_and_b32 v59, s90, v145
    v_lshlrev_b32 v60, 16, v146
    v_and_b32 v61, s90, v146
    v_lshlrev_b32 v62, 16, v147
    v_and_b32 v63, s90, v147
    s_add_u32 s42, s42, s43
    s_nop 0
    buffer_store_dwordx4 a[24:27], v21, s[64:67], s42 offen sc1
    v_pk_fma_f32 v[56:57], v[56:57], v[88:89], v[88:89] op_sel:[0,0,1] op_sel_hi:[1,0,1]
    v_pk_fma_f32 v[58:59], v[58:59], v[88:89], v[88:89] op_sel:[0,0,1] op_sel_hi:[1,0,1]
    v_pk_fma_f32 v[60:61], v[60:61], v[88:89], v[88:89] op_sel:[0,0,1] op_sel_hi:[1,0,1]
    v_pk_fma_f32 v[62:63], v[62:63], v[88:89], v[88:89] op_sel:[0,0,1] op_sel_hi:[1,0,1]
    s_waitcnt lgkmcnt(4)
    s_nop 0
    v_pk_fma_f32 v[56:57], v[56:57], v[24:25], v[32:33]
    v_pk_fma_f32 v[58:59], v[58:59], v[26:27], v[34:35]
    v_pk_fma_f32 v[60:61], v[60:61], v[28:29], v[36:37]
    v_pk_fma_f32 v[62:63], v[62:63], v[30:31], v[38:39]
    v_cvt_pk_bf16_f32 v72, v56, v57
    v_cvt_pk_bf16_f32 v73, v58, v59
    v_cvt_pk_bf16_f32 v74, v60, v61
    v_cvt_pk_bf16_f32 v75, v62, v63
    ds_write_b128 v18, v[72:75] offset:0
    v_lshlrev_b32 v64, 16, v164
    v_and_b32 v65, s90, v164
    v_lshlrev_b32 v66, 16, v165
    v_and_b32 v67, s90, v165
    v_lshlrev_b32 v68, 16, v166
    v_and_b32 v69, s90, v166
    v_lshlrev_b32 v70, 16, v167
    v_and_b32 v71, s90, v167
    s_add_u32 s42, s42, s43
    s_nop 0
    buffer_store_dwordx4 a[28:31], v21, s[64:67], s42 offen sc1
    v_pk_fma_f32 v[64:65], v[64:65], v[90:91], v[90:91] op_sel:[0,0,1] op_sel_hi:[1,0,1]
    v_pk_fma_f32 v[66:67], v[66:67], v[90:91], v[90:91] op_sel:[0,0,1] op_sel_hi:[1,0,1]
    v_pk_fma_f32 v[68:69], v[68:69], v[90:91], v[90:91] op_sel:[0,0,1] op_sel_hi:[1,0,1]
    v_pk_fma_f32 v[70:71], v[70:71], v[90:91], v[90:91] op_sel:[0,0,1] op_sel_hi:[1,0,1]
    v_pk_fma_f32 v[64:65], v[64:65], v[24:25], v[32:33]
    v_pk_fma_f32 v[66:67], v[66:67], v[26:27], v[34:35]
    v_pk_fma_f32 v[68:69], v[68:69], v[28:29], v[36:37]
    v_pk_fma_f32 v[70:71], v[70:71], v[30:31], v[38:39]
    v_cvt_pk_bf16_f32 v76, v64, v65
    v_cvt_pk_bf16_f32 v77, v66, v67
    v_cvt_pk_bf16_f32 v78, v68, v69
    v_cvt_pk_bf16_f32 v79, v70, v71
    ds_write_b128 v18, v[76:79] offset:18432
    v_lshlrev_b32 v56, 16, v184
    v_and_b32 v57, s90, v184
    v_lshlrev_b32 v58, 16, v185
    v_and_b32 v59, s90, v185
    v_lshlrev_b32 v60, 16, v186
    v_and_b32 v61, s90, v186
    v_lshlrev_b32 v62, 16, v187
    v_and_b32 v63, s90, v187
    buffer_store_dwordx4 a[32:35], v21, s[64:67], s44 offen sc1
    v_pk_fma_f32 v[56:57], v[56:57], v[92:93], v[92:93] op_sel:[0,0,1] op_sel_hi:[1,0,1]
    v_pk_fma_f32 v[58:59], v[58:59], v[92:93], v[92:93] op_sel:[0,0,1] op_sel_hi:[1,0,1]
    v_pk_fma_f32 v[60:61], v[60:61], v[92:93], v[92:93] op_sel:[0,0,1] op_sel_hi:[1,0,1]
    v_pk_fma_f32 v[62:63], v[62:63], v[92:93], v[92:93] op_sel:[0,0,1] op_sel_hi:[1,0,1]
    v_pk_fma_f32 v[56:57], v[56:57], v[24:25], v[32:33]
    v_pk_fma_f32 v[58:59], v[58:59], v[26:27], v[34:35]
    v_pk_fma_f32 v[60:61], v[60:61], v[28:29], v[36:37]
    v_pk_fma_f32 v[62:63], v[62:63], v[30:31], v[38:39]
    v_cvt_pk_bf16_f32 v72, v56, v57
    v_cvt_pk_bf16_f32 v73, v58, v59
    v_cvt_pk_bf16_f32 v74, v60, v61
    v_cvt_pk_bf16_f32 v75, v62, v63
    ds_write_b128 v19, v[72:75] offset:0
    v_lshlrev_b32 v64, 16, v204
    v_and_b32 v65, s90, v204
    v_lshlrev_b32 v66, 16, v205
    v_and_b32 v67, s90, v205
    v_lshlrev_b32 v68, 16, v206
    v_and_b32 v69, s90, v206
    v_lshlrev_b32 v70, 16, v207
    v_and_b32 v71, s90, v207
    s_add_u32 s44, s44, s45
    s_nop 0
    buffer_store_dwordx4 a[36:39], v21, s[64:67], s44 offen sc1
    v_pk_fma_f32 v[64:65], v[64:65], v[94:95], v[94:95] op_sel:[0,0,1] op_sel_hi:[1,0,1]
    v_pk_fma_f32 v[66:67], v[66:67], v[94:95], v[94:95] op_sel:[0,0,1] op_sel_hi:[1,0,1]
    v_pk_fma_f32 v[68:69], v[68:69], v[94:95], v[94:95] op_sel:[0,0,1] op_sel_hi:[1,0,1]
    v_pk_fma_f32 v[70:71], v[70:71], v[94:95], v[94:95] op_sel:[0,0,1] op_sel_hi:[1,0,1]
    v_pk_fma_f32 v[64:65], v[64:65], v[24:25], v[32:33]
    v_pk_fma_f32 v[66:67], v[66:67], v[26:27], v[34:35]
    v_pk_fma_f32 v[68:69], v[68:69], v[28:29], v[36:37]
    v_pk_fma_f32 v[70:71], v[70:71], v[30:31], v[38:39]
    v_cvt_pk_bf16_f32 v76, v64, v65
    v_cvt_pk_bf16_f32 v77, v66, v67
    v_cvt_pk_bf16_f32 v78, v68, v69
    v_cvt_pk_bf16_f32 v79, v70, v71
    ds_write_b128 v19, v[76:79] offset:18432
    ds_read_b128 v[24:27], v23 offset:3328
    ds_read_b128 v[28:31], v23 offset:3344
    ds_read_b128 v[32:35], v23 offset:1024
    ds_read_b128 v[36:39], v23 offset:1040
    v_lshlrev_b32 v56, 16, v148
    v_and_b32 v57, s90, v148
    v_lshlrev_b32 v58, 16, v149
    v_and_b32 v59, s90, v149
    v_lshlrev_b32 v60, 16, v150
    v_and_b32 v61, s90, v150
    v_lshlrev_b32 v62, 16, v151
    v_and_b32 v63, s90, v151
    s_add_u32 s44, s44, s45
    s_nop 0
    buffer_store_dwordx4 a[40:43], v21, s[64:67], s44 offen sc1
    v_pk_fma_f32 v[56:57], v[56:57], v[88:89], v[88:89] op_sel:[0,0,1] op_sel_hi:[1,0,1]
    v_pk_fma_f32 v[58:59], v[58:59], v[88:89], v[88:89] op_sel:[0,0,1] op_sel_hi:[1,0,1]
    v_pk_fma_f32 v[60:61], v[60:61], v[88:89], v[88:89] op_sel:[0,0,1] op_sel_hi:[1,0,1]
    v_pk_fma_f32 v[62:63], v[62:63], v[88:89], v[88:89] op_sel:[0,0,1] op_sel_hi:[1,0,1]
    s_waitcnt lgkmcnt(8)
    s_nop 0
    v_pk_fma_f32 v[56:57], v[56:57], v[40:41], v[48:49]
    v_pk_fma_f32 v[58:59], v[58:59], v[42:43], v[50:51]
    v_pk_fma_f32 v[60:61], v[60:61], v[44:45], v[52:53]
    v_pk_fma_f32 v[62:63], v[62:63], v[46:47], v[54:55]
    v_cvt_pk_bf16_f32 v72, v56, v57
    v_cvt_pk_bf16_f32 v73, v58, v59
    v_cvt_pk_bf16_f32 v74, v60, v61
    v_cvt_pk_bf16_f32 v75, v62, v63
    ds_write_b128 v18, v[72:75] offset:4096
    v_lshlrev_b32 v64, 16, v168
    v_and_b32 v65, s90, v168
    v_lshlrev_b32 v66, 16, v169
    v_and_b32 v67, s90, v169
    v_lshlrev_b32 v68, 16, v170
    v_and_b32 v69, s90, v170
    v_lshlrev_b32 v70, 16, v171
    v_and_b32 v71, s90, v171
    s_add_u32 s44, s44, s45
    s_nop 0
    buffer_store_dwordx4 a[44:47], v21, s[64:67], s44 offen sc1
    v_pk_fma_f32 v[64:65], v[64:65], v[90:91], v[90:91] op_sel:[0,0,1] op_sel_hi:[1,0,1]
    v_pk_fma_f32 v[66:67], v[66:67], v[90:91], v[90:91] op_sel:[0,0,1] op_sel_hi:[1,0,1]
    v_pk_fma_f32 v[68:69], v[68:69], v[90:91], v[90:91] op_sel:[0,0,1] op_sel_hi:[1,0,1]
    v_pk_fma_f32 v[70:71], v[70:71], v[90:91], v[90:91] op_sel:[0,0,1] op_sel_hi:[1,0,1]
    v_pk_fma_f32 v[64:65], v[64:65], v[40:41], v[48:49]
    v_pk_fma_f32 v[66:67], v[66:67], v[42:43], v[50:51]
    v_pk_fma_f32 v[68:69], v[68:69], v[44:45], v[52:53]
    v_pk_fma_f32 v[70:71], v[70:71], v[46:47], v[54:55]
    v_cvt_pk_bf16_f32 v76, v64, v65
    v_cvt_pk_bf16_f32 v77, v66, v67
    v_cvt_pk_bf16_f32 v78, v68, v69
    v_cvt_pk_bf16_f32 v79, v70, v71
    ds_write_b128 v18, v[76:79] offset:22528
    v_lshlrev_b32 v56, 16, v188
    v_and_b32 v57, s90, v188
    v_lshlrev_b32 v58, 16, v189
    v_and_b32 v59, s90, v189
    v_lshlrev_b32 v60, 16, v190
    v_and_b32 v61, s90, v190
    v_lshlrev_b32 v62, 16, v191
    v_and_b32 v63, s90, v191
    buffer_store_dwordx4 a[48:51], v21, s[64:67], s46 offen sc1
    v_pk_fma_f32 v[56:57], v[56:57], v[92:93], v[92:93] op_sel:[0,0,1] op_sel_hi:[1,0,1]
    v_pk_fma_f32 v[58:59], v[58:59], v[92:93], v[92:93] op_sel:[0,0,1] op_sel_hi:[1,0,1]
    v_pk_fma_f32 v[60:61], v[60:61], v[92:93], v[92:93] op_sel:[0,0,1] op_sel_hi:[1,0,1]
    v_pk_fma_f32 v[62:63], v[62:63], v[92:93], v[92:93] op_sel:[0,0,1] op_sel_hi:[1,0,1]
    v_pk_fma_f32 v[56:57], v[56:57], v[40:41], v[48:49]
    v_pk_fma_f32 v[58:59], v[58:59], v[42:43], v[50:51]
    v_pk_fma_f32 v[60:61], v[60:61], v[44:45], v[52:53]
    v_pk_fma_f32 v[62:63], v[62:63], v[46:47], v[54:55]
    v_cvt_pk_bf16_f32 v72, v56, v57
    v_cvt_pk_bf16_f32 v73, v58, v59
    v_cvt_pk_bf16_f32 v74, v60, v61
    v_cvt_pk_bf16_f32 v75, v62, v63
    ds_write_b128 v19, v[72:75] offset:4096
    v_lshlrev_b32 v64, 16, v208
    v_and_b32 v65, s90, v208
    v_lshlrev_b32 v66, 16, v209
    v_and_b32 v67, s90, v209
    v_lshlrev_b32 v68, 16, v210
    v_and_b32 v69, s90, v210
    v_lshlrev_b32 v70, 16, v211
    v_and_b32 v71, s90, v211
    s_add_u32 s46, s46, s47
    s_nop 0
    buffer_store_dwordx4 a[52:55], v21, s[64:67], s46 offen sc1
    v_pk_fma_f32 v[64:65], v[64:65], v[94:95], v[94:95] op_sel:[0,0,1] op_sel_hi:[1,0,1]
    v_pk_fma_f32 v[66:67], v[66:67], v[94:95], v[94:95] op_sel:[0,0,1] op_sel_hi:[1,0,1]
    v_pk_fma_f32 v[68:69], v[68:69], v[94:95], v[94:95] op_sel:[0,0,1] op_sel_hi:[1,0,1]
    v_pk_fma_f32 v[70:71], v[70:71], v[94:95], v[94:95] op_sel:[0,0,1] op_sel_hi:[1,0,1]
    v_pk_fma_f32 v[64:65], v[64:65], v[40:41], v[48:49]
    v_pk_fma_f32 v[66:67], v[66:67], v[42:43], v[50:51]
    v_pk_fma_f32 v[68:69], v[68:69], v[44:45], v[52:53]
    v_pk_fma_f32 v[70:71], v[70:71], v[46:47], v[54:55]
    v_cvt_pk_bf16_f32 v76, v64, v65
    v_cvt_pk_bf16_f32 v77, v66, v67
    v_cvt_pk_bf16_f32 v78, v68, v69
    v_cvt_pk_bf16_f32 v79, v70, v71
    ds_write_b128 v19, v[76:79] offset:22528
    ds_read_b128 v[40:43], v23 offset:3840
    ds_read_b128 v[44:47], v23 offset:3856
    ds_read_b128 v[48:51], v23 offset:1536
    ds_read_b128 v[52:55], v23 offset:1552
    v_lshlrev_b32 v56, 16, v152
    v_and_b32 v57, s90, v152
    v_lshlrev_b32 v58, 16, v153
    v_and_b32 v59, s90, v153
    v_lshlrev_b32 v60, 16, v154
    v_and_b32 v61, s90, v154
    v_lshlrev_b32 v62, 16, v155
    v_and_b32 v63, s90, v155
    s_add_u32 s46, s46, s47
    s_nop 0
    buffer_store_dwordx4 a[56:59], v21, s[64:67], s46 offen sc1
    buffer_load_dwordx4 v[144:147], v11, s[64:67], s4 offen offset:0 sc1
    v_pk_fma_f32 v[56:57], v[56:57], v[88:89], v[88:89] op_sel:[0,0,1] op_sel_hi:[1,0,1]
    v_pk_fma_f32 v[58:59], v[58:59], v[88:89], v[88:89] op_sel:[0,0,1] op_sel_hi:[1,0,1]
    v_pk_fma_f32 v[60:61], v[60:61], v[88:89], v[88:89] op_sel:[0,0,1] op_sel_hi:[1,0,1]
    v_pk_fma_f32 v[62:63], v[62:63], v[88:89], v[88:89] op_sel:[0,0,1] op_sel_hi:[1,0,1]
    s_waitcnt lgkmcnt(8)
    s_nop 0
    v_pk_fma_f32 v[56:57], v[56:57], v[24:25], v[32:33]
    v_pk_fma_f32 v[58:59], v[58:59], v[26:27], v[34:35]
    v_pk_fma_f32 v[60:61], v[60:61], v[28:29], v[36:37]
    v_pk_fma_f32 v[62:63], v[62:63], v[30:31], v[38:39]
    v_cvt_pk_bf16_f32 v72, v56, v57
    v_cvt_pk_bf16_f32 v73, v58, v59
    v_cvt_pk_bf16_f32 v74, v60, v61
    v_cvt_pk_bf16_f32 v75, v62, v63
    ds_write_b128 v18, v[72:75] offset:8192
    v_lshlrev_b32 v64, 16, v172
    v_and_b32 v65, s90, v172
    v_lshlrev_b32 v66, 16, v173
    v_and_b32 v67, s90, v173
    v_lshlrev_b32 v68, 16, v174
    v_and_b32 v69, s90, v174
    v_lshlrev_b32 v70, 16, v175
    v_and_b32 v71, s90, v175
    s_add_u32 s46, s46, s47
    s_nop 0
    buffer_store_dwordx4 a[60:63], v21, s[64:67], s46 offen sc1
    buffer_load_dwordx4 v[164:167], v11, s[64:67], s4 offen offset:1024 sc1
    v_pk_fma_f32 v[64:65], v[64:65], v[90:91], v[90:91] op_sel:[0,0,1] op_sel_hi:[1,0,1]
    v_pk_fma_f32 v[66:67], v[66:67], v[90:91], v[90:91] op_sel:[0,0,1] op_sel_hi:[1,0,1]
    v_pk_fma_f32 v[68:69], v[68:69], v[90:91], v[90:91] op_sel:[0,0,1] op_sel_hi:[1,0,1]
    v_pk_fma_f32 v[70:71], v[70:71], v[90:91], v[90:91] op_sel:[0,0,1] op_sel_hi:[1,0,1]
    v_pk_fma_f32 v[64:65], v[64:65], v[24:25], v[32:33]
    v_pk_fma_f32 v[66:67], v[66:67], v[26:27], v[34:35]
    v_pk_fma_f32 v[68:69], v[68:69], v[28:29], v[36:37]
    v_pk_fma_f32 v[70:71], v[70:71], v[30:31], v[38:39]
    v_cvt_pk_bf16_f32 v76, v64, v65
    v_cvt_pk_bf16_f32 v77, v66, v67
    v_cvt_pk_bf16_f32 v78, v68, v69
    v_cvt_pk_bf16_f32 v79, v70, v71
    ds_write_b128 v18, v[76:79] offset:26624
    v_lshlrev_b32 v56, 16, v192
    v_and_b32 v57, s90, v192
    v_lshlrev_b32 v58, 16, v193
    v_and_b32 v59, s90, v193
    v_lshlrev_b32 v60, 16, v194
    v_and_b32 v61, s90, v194
    v_lshlrev_b32 v62, 16, v195
    v_and_b32 v63, s90, v195
    buffer_load_dwordx4 v[184:187], v11, s[64:67], s4 offen offset:2048 sc1
    v_pk_fma_f32 v[56:57], v[56:57], v[92:93], v[92:93] op_sel:[0,0,1] op_sel_hi:[1,0,1]
    v_pk_fma_f32 v[58:59], v[58:59], v[92:93], v[92:93] op_sel:[0,0,1] op_sel_hi:[1,0,1]
    v_pk_fma_f32 v[60:61], v[60:61], v[92:93], v[92:93] op_sel:[0,0,1] op_sel_hi:[1,0,1]
    v_pk_fma_f32 v[62:63], v[62:63], v[92:93], v[92:93] op_sel:[0,0,1] op_sel_hi:[1,0,1]
    v_pk_fma_f32 v[56:57], v[56:57], v[24:25], v[32:33]
    v_pk_fma_f32 v[58:59], v[58:59], v[26:27], v[34:35]
    v_pk_fma_f32 v[60:61], v[60:61], v[28:29], v[36:37]
    v_pk_fma_f32 v[62:63], v[62:63], v[30:31], v[38:39]
    v_cvt_pk_bf16_f32 v72, v56, v57
    v_cvt_pk_bf16_f32 v73, v58, v59
    v_cvt_pk_bf16_f32 v74, v60, v61
    v_cvt_pk_bf16_f32 v75, v62, v63
    ds_write_b128 v19, v[72:75] offset:8192
    v_lshlrev_b32 v64, 16, v212
    v_and_b32 v65, s90, v212
    v_lshlrev_b32 v66, 16, v213
    v_and_b32 v67, s90, v213
    v_lshlrev_b32 v68, 16, v214
    v_and_b32 v69, s90, v214
    v_lshlrev_b32 v70, 16, v215
    v_and_b32 v71, s90, v215
    buffer_load_dwordx4 v[204:207], v11, s[64:67], s4 offen offset:3072 sc1
    v_pk_fma_f32 v[64:65], v[64:65], v[94:95], v[94:95] op_sel:[0,0,1] op_sel_hi:[1,0,1]
    v_pk_fma_f32 v[66:67], v[66:67], v[94:95], v[94:95] op_sel:[0,0,1] op_sel_hi:[1,0,1]
    v_pk_fma_f32 v[68:69], v[68:69], v[94:95], v[94:95] op_sel:[0,0,1] op_sel_hi:[1,0,1]
    v_pk_fma_f32 v[70:71], v[70:71], v[94:95], v[94:95] op_sel:[0,0,1] op_sel_hi:[1,0,1]
    v_pk_fma_f32 v[64:65], v[64:65], v[24:25], v[32:33]
    v_pk_fma_f32 v[66:67], v[66:67], v[26:27], v[34:35]
    v_pk_fma_f32 v[68:69], v[68:69], v[28:29], v[36:37]
    v_pk_fma_f32 v[70:71], v[70:71], v[30:31], v[38:39]
    v_cvt_pk_bf16_f32 v76, v64, v65
    v_cvt_pk_bf16_f32 v77, v66, v67
    v_cvt_pk_bf16_f32 v78, v68, v69
    v_cvt_pk_bf16_f32 v79, v70, v71
    ds_write_b128 v19, v[76:79] offset:26624
    ds_read_b128 v[24:27], v23 offset:4352
    ds_read_b128 v[28:31], v23 offset:4368
    ds_read_b128 v[32:35], v23 offset:2048
    ds_read_b128 v[36:39], v23 offset:2064
    v_lshlrev_b32 v56, 16, v156
    v_and_b32 v57, s90, v156
    v_lshlrev_b32 v58, 16, v157
    v_and_b32 v59, s90, v157
    v_lshlrev_b32 v60, 16, v158
    v_and_b32 v61, s90, v158
    v_lshlrev_b32 v62, 16, v159
    v_and_b32 v63, s90, v159
    buffer_load_dwordx4 v[148:151], v12, s[64:67], s4 offen offset:0 sc1
    v_pk_fma_f32 v[56:57], v[56:57], v[88:89], v[88:89] op_sel:[0,0,1] op_sel_hi:[1,0,1]
    v_pk_fma_f32 v[58:59], v[58:59], v[88:89], v[88:89] op_sel:[0,0,1] op_sel_hi:[1,0,1]
    v_pk_fma_f32 v[60:61], v[60:61], v[88:89], v[88:89] op_sel:[0,0,1] op_sel_hi:[1,0,1]
    v_pk_fma_f32 v[62:63], v[62:63], v[88:89], v[88:89] op_sel:[0,0,1] op_sel_hi:[1,0,1]
    s_waitcnt lgkmcnt(8)
    s_nop 0
    v_pk_fma_f32 v[56:57], v[56:57], v[40:41], v[48:49]
    v_pk_fma_f32 v[58:59], v[58:59], v[42:43], v[50:51]
    v_pk_fma_f32 v[60:61], v[60:61], v[44:45], v[52:53]
    v_pk_fma_f32 v[62:63], v[62:63], v[46:47], v[54:55]
    v_cvt_pk_bf16_f32 v72, v56, v57
    v_cvt_pk_bf16_f32 v73, v58, v59
    v_cvt_pk_bf16_f32 v74, v60, v61
    v_cvt_pk_bf16_f32 v75, v62, v63
    ds_write_b128 v18, v[72:75] offset:12288
    v_lshlrev_b32 v64, 16, v176
    v_and_b32 v65, s90, v176
    v_lshlrev_b32 v66, 16, v177
    v_and_b32 v67, s90, v177
    v_lshlrev_b32 v68, 16, v178
    v_and_b32 v69, s90, v178
    v_lshlrev_b32 v70, 16, v179
    v_and_b32 v71, s90, v179
    buffer_load_dwordx4 v[168:171], v12, s[64:67], s4 offen offset:1024 sc1
    v_pk_fma_f32 v[64:65], v[64:65], v[90:91], v[90:91] op_sel:[0,0,1] op_sel_hi:[1,0,1]
    v_pk_fma_f32 v[66:67], v[66:67], v[90:91], v[90:91] op_sel:[0,0,1] op_sel_hi:[1,0,1]
    v_pk_fma_f32 v[68:69], v[68:69], v[90:91], v[90:91] op_sel:[0,0,1] op_sel_hi:[1,0,1]
    v_pk_fma_f32 v[70:71], v[70:71], v[90:91], v[90:91] op_sel:[0,0,1] op_sel_hi:[1,0,1]
    v_pk_fma_f32 v[64:65], v[64:65], v[40:41], v[48:49]
    v_pk_fma_f32 v[66:67], v[66:67], v[42:43], v[50:51]
    v_pk_fma_f32 v[68:69], v[68:69], v[44:45], v[52:53]
    v_pk_fma_f32 v[70:71], v[70:71], v[46:47], v[54:55]
    v_cvt_pk_bf16_f32 v76, v64, v65
    v_cvt_pk_bf16_f32 v77, v66, v67
    v_cvt_pk_bf16_f32 v78, v68, v69
    v_cvt_pk_bf16_f32 v79, v70, v71
    ds_write_b128 v18, v[76:79] offset:30720
    v_lshlrev_b32 v56, 16, v196
    v_and_b32 v57, s90, v196
    v_lshlrev_b32 v58, 16, v197
    v_and_b32 v59, s90, v197
    v_lshlrev_b32 v60, 16, v198
    v_and_b32 v61, s90, v198
    v_lshlrev_b32 v62, 16, v199
    v_and_b32 v63, s90, v199
    buffer_load_dwordx4 v[188:191], v12, s[64:67], s4 offen offset:2048 sc1
    v_pk_fma_f32 v[56:57], v[56:57], v[92:93], v[92:93] op_sel:[0,0,1] op_sel_hi:[1,0,1]
    v_pk_fma_f32 v[58:59], v[58:59], v[92:93], v[92:93] op_sel:[0,0,1] op_sel_hi:[1,0,1]
    v_pk_fma_f32 v[60:61], v[60:61], v[92:93], v[92:93] op_sel:[0,0,1] op_sel_hi:[1,0,1]
    v_pk_fma_f32 v[62:63], v[62:63], v[92:93], v[92:93] op_sel:[0,0,1] op_sel_hi:[1,0,1]
    v_pk_fma_f32 v[56:57], v[56:57], v[40:41], v[48:49]
    v_pk_fma_f32 v[58:59], v[58:59], v[42:43], v[50:51]
    v_pk_fma_f32 v[60:61], v[60:61], v[44:45], v[52:53]
    v_pk_fma_f32 v[62:63], v[62:63], v[46:47], v[54:55]
    v_cvt_pk_bf16_f32 v72, v56, v57
    v_cvt_pk_bf16_f32 v73, v58, v59
    v_cvt_pk_bf16_f32 v74, v60, v61
    v_cvt_pk_bf16_f32 v75, v62, v63
    ds_write_b128 v19, v[72:75] offset:12288
    v_lshlrev_b32 v64, 16, v216
    v_and_b32 v65, s90, v216
    v_lshlrev_b32 v66, 16, v217
    v_and_b32 v67, s90, v217
    v_lshlrev_b32 v68, 16, v218
    v_and_b32 v69, s90, v218
    v_lshlrev_b32 v70, 16, v219
    v_and_b32 v71, s90, v219
    buffer_load_dwordx4 v[208:211], v12, s[64:67], s4 offen offset:3072 sc1
    v_pk_fma_f32 v[64:65], v[64:65], v[94:95], v[94:95] op_sel:[0,0,1] op_sel_hi:[1,0,1]
    v_pk_fma_f32 v[66:67], v[66:67], v[94:95], v[94:95] op_sel:[0,0,1] op_sel_hi:[1,0,1]
    v_pk_fma_f32 v[68:69], v[68:69], v[94:95], v[94:95] op_sel:[0,0,1] op_sel_hi:[1,0,1]
    v_pk_fma_f32 v[70:71], v[70:71], v[94:95], v[94:95] op_sel:[0,0,1] op_sel_hi:[1,0,1]
    v_pk_fma_f32 v[64:65], v[64:65], v[40:41], v[48:49]
    v_pk_fma_f32 v[66:67], v[66:67], v[42:43], v[50:51]
    v_pk_fma_f32 v[68:69], v[68:69], v[44:45], v[52:53]
    v_pk_fma_f32 v[70:71], v[70:71], v[46:47], v[54:55]
    v_cvt_pk_bf16_f32 v76, v64, v65
    v_cvt_pk_bf16_f32 v77, v66, v67
    v_cvt_pk_bf16_f32 v78, v68, v69
    v_cvt_pk_bf16_f32 v79, v70, v71
    ds_write_b128 v19, v[76:79] offset:30720
    s_cmp_lt_u32 s68, 2
    s_cbranch_scc0 L_m2_e
    v_lshlrev_b32 v56, 16, v160
    v_and_b32 v57, s90, v160
    v_lshlrev_b32 v58, 16, v161
    v_and_b32 v59, s90, v161
    v_lshlrev_b32 v60, 16, v162
    v_and_b32 v61, s90, v162
    v_lshlrev_b32 v62, 16, v163
    v_and_b32 v63, s90, v163
    v_pk_fma_f32 v[56:57], v[56:57], v[88:89], v[88:89] op_sel:[0,0,1] op_sel_hi:[1,0,1]
    v_pk_fma_f32 v[58:59], v[58:59], v[88:89], v[88:89] op_sel:[0,0,1] op_sel_hi:[1,0,1]
    v_pk_fma_f32 v[60:61], v[60:61], v[88:89], v[88:89] op_sel:[0,0,1] op_sel_hi:[1,0,1]
    v_pk_fma_f32 v[62:63], v[62:63], v[88:89], v[88:89] op_sel:[0,0,1] op_sel_hi:[1,0,1]
    s_waitcnt lgkmcnt(4)
    s_nop 0
    v_pk_fma_f32 v[56:57], v[56:57], v[24:25], v[32:33]
    v_pk_fma_f32 v[58:59], v[58:59], v[26:27], v[34:35]
    v_pk_fma_f32 v[60:61], v[60:61], v[28:29], v[36:37]
    v_pk_fma_f32 v[62:63], v[62:63], v[30:31], v[38:39]
    v_cvt_pk_bf16_f32 v72, v56, v57
    v_cvt_pk_bf16_f32 v73, v58, v59
    v_cvt_pk_bf16_f32 v74, v60, v61
    v_cvt_pk_bf16_f32 v75, v62, v63
    ds_write_b128 v18, v[72:75] offset:16384
    v_lshlrev_b32 v64, 16, v180
    v_and_b32 v65, s90, v180
    v_lshlrev_b32 v66, 16, v181
    v_and_b32 v67, s90, v181
    v_lshlrev_b32 v68, 16, v182
    v_and_b32 v69, s90, v182
    v_lshlrev_b32 v70, 16, v183
    v_and_b32 v71, s90, v183
L_stub_11:
    s_cbranch_execz L_stub_15
    s_nop 0
    v_pk_fma_f32 v[64:65], v[64:65], v[90:91], v[90:91] op_sel:[0,0,1] op_sel_hi:[1,0,1]
    v_pk_fma_f32 v[66:67], v[66:67], v[90:91], v[90:91] op_sel:[0,0,1] op_sel_hi:[1,0,1]
    v_pk_fma_f32 v[68:69], v[68:69], v[90:91], v[90:91] op_sel:[0,0,1] op_sel_hi:[1,0,1]
    v_pk_fma_f32 v[70:71], v[70:71], v[90:91], v[90:91] op_sel:[0,0,1] op_sel_hi:[1,0,1]
    v_pk_fma_f32 v[64:65], v[64:65], v[24:25], v[32:33]
    v_pk_fma_f32 v[66:67], v[66:67], v[26:27], v[34:35]
    v_pk_fma_f32 v[68:69], v[68:69], v[28:29], v[36:37]
    v_pk_fma_f32 v[70:71], v[70:71], v[30:31], v[38:39]
    v_cvt_pk_bf16_f32 v76, v64, v65
    v_cvt_pk_bf16_f32 v77, v66, v67
    v_cvt_pk_bf16_f32 v78, v68, v69
    v_cvt_pk_bf16_f32 v79, v70, v71
    ds_write_b128 v18, v[76:79] offset:34816
    v_lshlrev_b32 v56, 16, v200
    v_and_b32 v57, s90, v200
    v_lshlrev_b32 v58, 16, v201
    v_and_b32 v59, s90, v201
    v_lshlrev_b32 v60, 16, v202
    v_and_b32 v61, s90, v202
    v_lshlrev_b32 v62, 16, v203
    v_and_b32 v63, s90, v203
    v_pk_fma_f32 v[56:57], v[56:57], v[92:93], v[92:93] op_sel:[0,0,1] op_sel_hi:[1,0,1]
    v_pk_fma_f32 v[58:59], v[58:59], v[92:93], v[92:93] op_sel:[0,0,1] op_sel_hi:[1,0,1]
    v_pk_fma_f32 v[60:61], v[60:61], v[92:93], v[92:93] op_sel:[0,0,1] op_sel_hi:[1,0,1]
    v_pk_fma_f32 v[62:63], v[62:63], v[92:93], v[92:93] op_sel:[0,0,1] op_sel_hi:[1,0,1]
    v_pk_fma_f32 v[56:57], v[56:57], v[24:25], v[32:33]
    v_pk_fma_f32 v[58:59], v[58:59], v[26:27], v[34:35]
    v_pk_fma_f32 v[60:61], v[60:61], v[28:29], v[36:37]
    v_pk_fma_f32 v[62:63], v[62:63], v[30:31], v[38:39]
    v_cvt_pk_bf16_f32 v72, v56, v57
    v_cvt_pk_bf16_f32 v73, v58, v59
    v_cvt_pk_bf16_f32 v74, v60, v61
    v_cvt_pk_bf16_f32 v75, v62, v63
    ds_write_b128 v19, v[72:75] offset:16384
    v_lshlrev_b32 v64, 16, v220
    v_and_b32 v65, s90, v220
    v_lshlrev_b32 v66, 16, v221
    v_and_b32 v67, s90, v221
    v_lshlrev_b32 v68, 16, v222
    v_and_b32 v69, s90, v222
    v_lshlrev_b32 v70, 16, v223
    v_and_b32 v71, s90, v223
    v_pk_fma_f32 v[64:65], v[64:65], v[94:95], v[94:95] op_sel:[0,0,1] op_sel_hi:[1,0,1]
    v_pk_fma_f32 v[66:67], v[66:67], v[94:95], v[94:95] op_sel:[0,0,1] op_sel_hi:[1,0,1]
    v_pk_fma_f32 v[68:69], v[68:69], v[94:95], v[94:95] op_sel:[0,0,1] op_sel_hi:[1,0,1]
    v_pk_fma_f32 v[70:71], v[70:71], v[94:95], v[94:95] op_sel:[0,0,1] op_sel_hi:[1,0,1]
    v_pk_fma_f32 v[64:65], v[64:65], v[24:25], v[32:33]
    v_pk_fma_f32 v[66:67], v[66:67], v[26:27], v[34:35]
    v_pk_fma_f32 v[68:69], v[68:69], v[28:29], v[36:37]
    v_pk_fma_f32 v[70:71], v[70:71], v[30:31], v[38:39]
    v_cvt_pk_bf16_f32 v76, v64, v65
    v_cvt_pk_bf16_f32 v77, v66, v67
    v_cvt_pk_bf16_f32 v78, v68, v69
    v_cvt_pk_bf16_f32 v79, v70, v71
    ds_write_b128 v19, v[76:79] offset:34816
    s_waitcnt lgkmcnt(0)
L_m2_e:
    s_waitcnt lgkmcnt(0)
    buffer_load_dwordx4 v[152:155], v13, s[64:67], s4 offen offset:0 sc1
    buffer_load_dwordx4 v[172:175], v13, s[64:67], s4 offen offset:1024 sc1
    buffer_load_dwordx4 v[192:195], v13, s[64:67], s4 offen offset:2048 sc1
    buffer_load_dwordx4 v[212:215], v13, s[64:67], s4 offen offset:3072 sc1
    buffer_load_dwordx4 v[156:159], v14, s[64:67], s4 offen offset:0 sc1
    buffer_load_dwordx4 v[176:179], v14, s[64:67], s4 offen offset:1024 sc1
    s_and_b32 s88, s68, 1
    s_lshl_b32 s88, s88, 3
    s_lshr_b32 s89, s68, 1
    s_lshl_b32 s89, s89, 10
    s_add_u32 s88, s88, s89
    s_add_u32 s88, s88, 73728
    v_add_u32 v18, s88, v21
    v_add_u32 v19, 55296, v18
    v_and_b32 v23, 31, v1
    v_lshlrev_b32 v23, 7, v23
    s_waitcnt vmcnt(13)
    s_barrier
    s_cmp_eq_u32 s68, 0
    s_cbranch_scc0 L_fl_6
    v_mov_b32 v4, s3
    s_mov_b64 exec, 1
    buffer_store_dword v4, off, s[64:67], s93 sc1
    s_mov_b64 exec, -1
L_fl_6:
    s_mov_b32 s89, 0xbfb8aa3b
    s_nop 0
    ds_read_b128 a[0:3], v21 offset:0
    ds_read_b128 a[4:7], v21 offset:18432
    ds_read_b128 a[8:11], v21 offset:36864
    ds_read_b128 a[12:15], v22 offset:0
    ds_read_b128 a[16:19], v21 offset:1024
    ds_read_b128 a[20:23], v21 offset:19456
    ds_read_b128 a[24:27], v21 offset:37888
    ds_read_b128 a[28:31], v22 offset:1024
    ds_read_b128 a[32:35], v21 offset:2048
    ds_read_b128 a[36:39], v21 offset:20480
    ds_read_b128 a[40:43], v21 offset:38912
    ds_read_b128 a[44:47], v22 offset:2048
    s_waitcnt lgkmcnt(8)
    s_nop 0
    v_mfma_f32_16x16x32_bf16 v[24:27], v[96:99], a[0:3], 0
    ds_read_b128 a[48:51], v21 offset:3072
    v_mfma_f32_16x16x32_bf16 v[28:31], v[100:103], a[0:3], 0
    buffer_load_dwordx4 v[196:199], v14, s[64:67], s4 offen offset:2048 sc1
    v_mfma_f32_16x16x32_bf16 v[32:35], v[96:99], a[4:7], 0
    ds_read_b128 a[52:55], v21 offset:21504
    v_mfma_f32_16x16x32_bf16 v[36:39], v[100:103], a[4:7], 0
    ds_read_b128 a[56:59], v21 offset:39936
    v_mfma_f32_16x16x32_bf16 v[40:43], v[96:99], a[8:11], 0
    buffer_load_dwordx4 v[216:219], v14, s[64:67], s4 offen offset:3072 sc1
    v_mfma_f32_16x16x32_bf16 v[44:47], v[100:103], a[8:11], 0
    ds_read_b128 a[60:63], v22 offset:3072
    v_mfma_f32_16x16x32_bf16 v[48:51], v[96:99], a[12:15], 0
    v_mfma_f32_16x16x32_bf16 v[52:55], v[100:103], a[12:15], 0
    s_waitcnt lgkmcnt(8)
    s_nop 0
    v_mfma_f32_16x16x32_bf16 v[24:27], v[104:107], a[16:19], v[24:27]
    ds_read_b128 a[64:67], v21 offset:4096
    v_mfma_f32_16x16x32_bf16 v[28:31], v[108:111], a[16:19], v[28:31]
    buffer_load_dwordx4 v[160:163], v15, s[64:67], s4 offen offset:0 sc1
    v_mfma_f32_16x16x32_bf16 v[32:35], v[104:107], a[20:23], v[32:35]
    ds_read_b128 a[68:71], v21 offset:22528
    v_mfma_f32_16x16x32_bf16 v[36:39], v[108:111], a[20:23], v[36:39]
    ds_read_b128 a[72:75], v21 offset:40960
    v_mfma_f32_16x16x32_bf16 v[40:43], v[104:107], a[24:27], v[40:43]
    buffer_load_dwordx4 v[180:183], v15, s[64:67], s4 offen offset:1024 sc1
    v_mfma_f32_16x16x32_bf16 v[44:47], v[108:111], a[24:27], v[44:47]
    ds_read_b128 a[76:79], v22 offset:4096
    v_mfma_f32_16x16x32_bf16 v[48:51], v[104:107], a[28:31], v[48:51]
    v_mfma_f32_16x16x32_bf16 v[52:55], v[108:111], a[28:31], v[52:55]
    s_waitcnt lgkmcnt(8)
    s_nop 0
    v_mfma_f32_16x16x32_bf16 v[24:27], v[112:115], a[32:35], v[24:27]
    ds_read_b128 a[80:83], v21 offset:5120
    v_mfma_f32_16x16x32_bf16 v[28:31], v[116:119], a[32:35], v[28:31]
    buffer_load_dwordx4 v[200:203], v15, s[64:67], s4 offen offset:2048 sc1
    v_mfma_f32_16x16x32_bf16 v[32:35], v[112:115], a[36:39], v[32:35]
    ds_read_b128 a[84:87], v21 offset:23552
    v_mfma_f32_16x16x32_bf16 v[36:39], v[116:119], a[36:39], v[36:39]
    ds_read_b128 a[88:91], v21 offset:41984
    v_mfma_f32_16x16x32_bf16 v[40:43], v[112:115], a[40:43], v[40:43]
    buffer_load_dwordx4 v[220:223], v15, s[64:67], s4 offen offset:3072 sc1
    v_mfma_f32_16x16x32_bf16 v[44:47], v[116:119], a[40:43], v[44:47]
    ds_read_b128 a[92:95], v22 offset:5120
    v_mfma_f32_16x16x32_bf16 v[48:51], v[112:115], a[44:47], v[48:51]
    v_mfma_f32_16x16x32_bf16 v[52:55], v[116:119], a[44:47], v[52:55]
    s_waitcnt lgkmcnt(8)
    s_nop 0
    v_mfma_f32_16x16x32_bf16 v[24:27], v[120:123], a[48:51], v[24:27]
    ds_read_b128 a[96:99], v21 offset:6144
    v_mfma_f32_16x16x32_bf16 v[28:31], v[124:127], a[48:51], v[28:31]
    buffer_load_dwordx4 v[96:99], v16, s[64:67], s4 offen offset:0 sc1
    v_mfma_f32_16x16x32_bf16 v[32:35], v[120:123], a[52:55], v[32:35]
    ds_read_b128 a[100:103], v21 offset:24576
    v_mfma_f32_16x16x32_bf16 v[36:39], v[124:127], a[52:55], v[36:39]
    ds_read_b128 a[104:107], v21 offset:43008
    v_mfma_f32_16x16x32_bf16 v[40:43], v[120:123], a[56:59], v[40:43]
    buffer_load_dwordx4 v[100:103], v16, s[64:67], s4 offen offset:1024 sc1
    v_mfma_f32_16x16x32_bf16 v[44:47], v[124:127], a[56:59], v[44:47]
    ds_read_b128 a[108:111], v22 offset:6144
    v_mfma_f32_16x16x32_bf16 v[48:51], v[120:123], a[60:63], v[48:51]
    v_mfma_f32_16x16x32_bf16 v[52:55], v[124:127], a[60:63], v[52:55]
    s_waitcnt lgkmcnt(8)
    s_nop 0
    v_mfma_f32_16x16x32_bf16 v[24:27], v[128:131], a[64:67], v[24:27]
    ds_read_b128 a[112:115], v21 offset:7168
    v_mfma_f32_16x16x32_bf16 v[28:31], v[132:135], a[64:67], v[28:31]
    buffer_load_dwordx4 v[104:107], v16, s[64:67], s4 offen offset:2048 sc1
    v_mfma_f32_16x16x32_bf16 v[32:35], v[128:131], a[68:71], v[32:35]
    ds_read_b128 a[116:119], v21 offset:25600
    v_mfma_f32_16x16x32_bf16 v[36:39], v[132:135], a[68:71], v[36:39]
    ds_read_b128 a[120:123], v21 offset:44032
    v_mfma_f32_16x16x32_bf16 v[40:43], v[128:131], a[72:75], v[40:43]
    buffer_load_dwordx4 v[108:111], v16, s[64:67], s4 offen offset:3072 sc1
    v_mfma_f32_16x16x32_bf16 v[44:47], v[132:135], a[72:75], v[44:47]
    ds_read_b128 a[124:127], v22 offset:7168
    v_mfma_f32_16x16x32_bf16 v[48:51], v[128:131], a[76:79], v[48:51]
    v_mfma_f32_16x16x32_bf16 v[52:55], v[132:135], a[76:79], v[52:55]
    s_waitcnt lgkmcnt(8)
    s_nop 0
    v_mfma_f32_16x16x32_bf16 v[24:27], v[136:139], a[80:83], v[24:27]
    ds_read_b128 a[128:131], v21 offset:8192
    v_mfma_f32_16x16x32_bf16 v[28:31], v[140:143], a[80:83], v[28:31]
    s_add_u32 s4, s4, 147456
    buffer_load_dwordx4 v[112:115], v8, s[64:67], s4 offen offset:0 sc1
    v_mfma_f32_16x16x32_bf16 v[32:35], v[136:139], a[84:87], v[32:35]
    ds_read_b128 a[132:135], v21 offset:26624
    v_mfma_f32_16x16x32_bf16 v[36:39], v[140:143], a[84:87], v[36:39]
    ds_read_b128 a[136:139], v21 offset:45056
    v_mfma_f32_16x16x32_bf16 v[40:43], v[136:139], a[88:91], v[40:43]
    buffer_load_dwordx4 v[116:119], v8, s[64:67], s4 offen offset:1024 sc1
    v_mfma_f32_16x16x32_bf16 v[44:47], v[140:143], a[88:91], v[44:47]
    ds_read_b128 a[140:143], v22 offset:8192
    v_mfma_f32_16x16x32_bf16 v[48:51], v[136:139], a[92:95], v[48:51]
    v_mfma_f32_16x16x32_bf16 v[52:55], v[140:143], a[92:95], v[52:55]
    s_waitcnt lgkmcnt(8)
    s_waitcnt vmcnt(24)
    v_mfma_f32_16x16x32_bf16 v[24:27], v[144:147], a[96:99], v[24:27]
    ds_read_b128 a[144:147], v21 offset:9216
    v_mfma_f32_16x16x32_bf16 v[28:31], v[164:167], a[96:99], v[28:31]
    buffer_load_dwordx4 v[120:123], v8, s[64:67], s4 offen offset:2048 sc1
    v_mfma_f32_16x16x32_bf16 v[32:35], v[144:147], a[100:103], v[32:35]
    ds_read_b128 a[148:151], v21 offset:27648
    v_mfma_f32_16x16x32_bf16 v[36:39], v[164:167], a[100:103], v[36:39]
    ds_read_b128 a[152:155], v21 offset:46080
    v_mfma_f32_16x16x32_bf16 v[40:43], v[144:147], a[104:107], v[40:43]
    buffer_load_dwordx4 v[124:127], v8, s[64:67], s4 offen offset:3072 sc1
    v_mfma_f32_16x16x32_bf16 v[44:47], v[164:167], a[104:107], v[44:47]
    ds_read_b128 a[156:159], v22 offset:9216
    v_mfma_f32_16x16x32_bf16 v[48:51], v[144:147], a[108:111], v[48:51]
    v_mfma_f32_16x16x32_bf16 v[52:55], v[164:167], a[108:111], v[52:55]
    s_waitcnt lgkmcnt(8)
    s_waitcnt vmcnt(24)
    v_mfma_f32_16x16x32_bf16 v[24:27], v[184:187], a[112:115], v[24:27]
    ds_read_b128 a[160:163], v21 offset:10240
    v_mfma_f32_16x16x32_bf16 v[28:31], v[204:207], a[112:115], v[28:31]
    buffer_load_dwordx4 v[128:131], v9, s[64:67], s4 offen offset:0 sc1
    v_mfma_f32_16x16x32_bf16 v[32:35], v[184:187], a[116:119], v[32:35]
    ds_read_b128 a[164:167], v21 offset:28672
    v_mfma_f32_16x16x32_bf16 v[36:39], v[204:207], a[116:119], v[36:39]
    ds_read_b128 a[168:171], v21 offset:47104
    v_mfma_f32_16x16x32_bf16 v[40:43], v[184:187], a[120:123], v[40:43]
    buffer_load_dwordx4 v[132:135], v9, s[64:67], s4 offen offset:1024 sc1
    v_mfma_f32_16x16x32_bf16 v[44:47], v[204:207], a[120:123], v[44:47]
    ds_read_b128 a[172:175], v22 offset:10240
    v_mfma_f32_16x16x32_bf16 v[48:51], v[184:187], a[124:127], v[48:51]
    v_mfma_f32_16x16x32_bf16 v[52:55], v[204:207], a[124:127], v[52:55]
    s_waitcnt lgkmcnt(8)
    s_waitcnt vmcnt(24)
    v_mfma_f32_16x16x32_bf16 v[24:27], v[148:151], a[128:131], v[24:27]
    ds_read_b128 a[176:179], v21 offset:11264
    v_mfma_f32_16x16x32_bf16 v[28:31], v[168:171], a[128:131], v[28:31]
    buffer_load_dwordx4 v[136:139], v9, s[64:67], s4 offen offset:2048 sc1
    v_mfma_f32_16x16x32_bf16 v[32:35], v[148:151], a[132:135], v[32:35]
    ds_read_b128 a[180:183], v21 offset:29696
    v_mfma_f32_16x16x32_bf16 v[36:39], v[168:171], a[132:135], v[36:39]
    ds_read_b128 a[184:187], v21 offset:48128
    v_mfma_f32_16x16x32_bf16 v[40:43], v[148:151], a[136:139], v[40:43]
    buffer_load_dwordx4 v[140:143], v9, s[64:67], s4 offen offset:3072 sc1
    v_mfma_f32_16x16x32_bf16 v[44:47], v[168:171], a[136:139], v[44:47]
    ds_read_b128 a[188:191], v22 offset:11264
    v_mfma_f32_16x16x32_bf16 v[48:51], v[148:151], a[140:143], v[48:51]
    v_mfma_f32_16x16x32_bf16 v[52:55], v[168:171], a[140:143], v[52:55]
    s_waitcnt lgkmcnt(8)
    s_waitcnt vmcnt(24)
    v_mfma_f32_16x16x32_bf16 v[24:27], v[188:191], a[144:147], v[24:27]
    ds_read_b128 a[192:195], v21 offset:12288
    v_mfma_f32_16x16x32_bf16 v[28:31], v[208:211], a[144:147], v[28:31]
    buffer_load_dwordx4 v[144:147], v10, s[64:67], s4 offen offset:0 sc1
    v_mfma_f32_16x16x32_bf16 v[32:35], v[188:191], a[148:151], v[32:35]
    ds_read_b128 a[196:199], v21 offset:30720
    v_mfma_f32_16x16x32_bf16 v[36:39], v[208:211], a[148:151], v[36:39]
    ds_read_b128 a[200:203], v21 offset:49152
    v_mfma_f32_16x16x32_bf16 v[40:43], v[188:191], a[152:155], v[40:43]
    buffer_load_dwordx4 v[164:167], v10, s[64:67], s4 offen offset:1024 sc1
    v_mfma_f32_16x16x32_bf16 v[44:47], v[208:211], a[152:155], v[44:47]
    ds_read_b128 a[204:207], v22 offset:12288
    v_mfma_f32_16x16x32_bf16 v[48:51], v[188:191], a[156:159], v[48:51]
    v_mfma_f32_16x16x32_bf16 v[52:55], v[208:211], a[156:159], v[52:55]
    s_waitcnt lgkmcnt(8)
    s_waitcnt vmcnt(24)
    v_mfma_f32_16x16x32_bf16 v[24:27], v[152:155], a[160:163], v[24:27]
    ds_read_b128 a[208:211], v21 offset:13312
    v_mfma_f32_16x16x32_bf16 v[28:31], v[172:175], a[160:163], v[28:31]
    buffer_load_dwordx4 v[184:187], v10, s[64:67], s4 offen offset:2048 sc1
    v_mfma_f32_16x16x32_bf16 v[32:35], v[152:155], a[164:167], v[32:35]
    ds_read_b128 a[212:215], v21 offset:31744
    v_mfma_f32_16x16x32_bf16 v[36:39], v[172:175], a[164:167], v[36:39]
    ds_read_b128 a[216:219], v21 offset:50176
    v_mfma_f32_16x16x32_bf16 v[40:43], v[152:155], a[168:171], v[40:43]
    buffer_load_dwordx4 v[204:207], v10, s[64:67], s4 offen offset:3072 sc1
    v_mfma_f32_16x16x32_bf16 v[44:47], v[172:175], a[168:171], v[44:47]
    ds_read_b128 a[220:223], v22 offset:13312
    v_mfma_f32_16x16x32_bf16 v[48:51], v[152:155], a[172:175], v[48:51]
    v_mfma_f32_16x16x32_bf16 v[52:55], v[172:175], a[172:175], v[52:55]
    s_waitcnt lgkmcnt(8)
    s_waitcnt vmcnt(24)
    v_mfma_f32_16x16x32_bf16 v[24:27], v[192:195], a[176:179], v[24:27]
    ds_read_b128 a[224:227], v21 offset:14336
    v_mfma_f32_16x16x32_bf16 v[28:31], v[212:215], a[176:179], v[28:31]
    buffer_load_dwordx4 v[148:151], v11, s[64:67], s4 offen offset:0 sc1
    v_mfma_f32_16x16x32_bf16 v[32:35], v[192:195], a[180:183], v[32:35]
    ds_read_b128 a[228:231], v21 offset:32768
    v_mfma_f32_16x16x32_bf16 v[36:39], v[212:215], a[180:183], v[36:39]
    ds_read_b128 a[232:235], v21 offset:51200
    v_mfma_f32_16x16x32_bf16 v[40:43], v[192:195], a[184:187], v[40:43]
    buffer_load_dwordx4 v[168:171], v11, s[64:67], s4 offen offset:1024 sc1
    v_mfma_f32_16x16x32_bf16 v[44:47], v[212:215], a[184:187], v[44:47]
    ds_read_b128 a[236:239], v22 offset:14336
    v_mfma_f32_16x16x32_bf16 v[48:51], v[192:195], a[188:191], v[48:51]
    v_mfma_f32_16x16x32_bf16 v[52:55], v[212:215], a[188:191], v[52:55]
    s_waitcnt lgkmcnt(8)
    s_waitcnt vmcnt(24)
    v_mfma_f32_16x16x32_bf16 v[24:27], v[156:159], a[192:195], v[24:27]
    ds_read_b128 a[240:243], v21 offset:15360
    v_mfma_f32_16x16x32_bf16 v[28:31], v[176:179], a[192:195], v[28:31]
    buffer_load_dwordx4 v[188:191], v11, s[64:67], s4 offen offset:2048 sc1
    v_mfma_f32_16x16x32_bf16 v[32:35], v[156:159], a[196:199], v[32:35]
    ds_read_b128 a[244:247], v21 offset:33792
    v_mfma_f32_16x16x32_bf16 v[36:39], v[176:179], a[196:199], v[36:39]
    ds_read_b128 a[248:251], v21 offset:52224
    v_mfma_f32_16x16x32_bf16 v[40:43], v[156:159], a[200:203], v[40:43]
    buffer_load_dwordx4 v[208:211], v11, s[64:67], s4 offen offset:3072 sc1
    v_mfma_f32_16x16x32_bf16 v[44:47], v[176:179], a[200:203], v[44:47]
    ds_read_b128 a[252:255], v22 offset:15360
    v_mfma_f32_16x16x32_bf16 v[48:51], v[156:159], a[204:207], v[48:51]
    v_mfma_f32_16x16x32_bf16 v[52:55], v[176:179], a[204:207], v[52:55]
    s_waitcnt lgkmcnt(8)
    s_waitcnt vmcnt(24)
    v_mfma_f32_16x16x32_bf16 v[24:27], v[196:199], a[208:211], v[24:27]
    ds_read_b128 v[224:227], v21 offset:16384
    v_mfma_f32_16x16x32_bf16 v[28:31], v[216:219], a[208:211], v[28:31]
    buffer_load_dwordx4 v[152:155], v12, s[64:67], s4 offen offset:0 sc1
    v_mfma_f32_16x16x32_bf16 v[32:35], v[196:199], a[212:215], v[32:35]
    ds_read_b128 v[228:231], v21 offset:34816
    v_mfma_f32_16x16x32_bf16 v[36:39], v[216:219], a[212:215], v[36:39]
    ds_read_b128 v[232:235], v21 offset:53248
    v_mfma_f32_16x16x32_bf16 v[40:43], v[196:199], a[216:219], v[40:43]
    buffer_load_dwordx4 v[172:175], v12, s[64:67], s4 offen offset:1024 sc1
    v_mfma_f32_16x16x32_bf16 v[44:47], v[216:219], a[216:219], v[44:47]
    ds_read_b128 v[236:239], v22 offset:16384
    v_mfma_f32_16x16x32_bf16 v[48:51], v[196:199], a[220:223], v[48:51]
    v_mfma_f32_16x16x32_bf16 v[52:55], v[216:219], a[220:223], v[52:55]
    s_waitcnt lgkmcnt(8)
    s_waitcnt vmcnt(24)
    v_mfma_f32_16x16x32_bf16 v[24:27], v[160:163], a[224:227], v[24:27]
    ds_read_b128 v[240:243], v21 offset:17408
    v_mfma_f32_16x16x32_bf16 v[28:31], v[180:183], a[224:227], v[28:31]
    buffer_load_dwordx4 v[192:195], v12, s[64:67], s4 offen offset:2048 sc1
    v_mfma_f32_16x16x32_bf16 v[32:35], v[160:163], a[228:231], v[32:35]
    ds_read_b128 v[244:247], v21 offset:35840
    v_mfma_f32_16x16x32_bf16 v[36:39], v[180:183], a[228:231], v[36:39]
    ds_read_b128 v[248:251], v21 offset:54272
    v_mfma_f32_16x16x32_bf16 v[40:43], v[160:163], a[232:235], v[40:43]
    buffer_load_dwordx4 v[212:215], v12, s[64:67], s4 offen offset:3072 sc1
    v_mfma_f32_16x16x32_bf16 v[44:47], v[180:183], a[232:235], v[44:47]
    ds_read_b128 v[252:255], v22 offset:17408
    v_mfma_f32_16x16x32_bf16 v[48:51], v[160:163], a[236:239], v[48:51]
    v_mfma_f32_16x16x32_bf16 v[52:55], v[180:183], a[236:239], v[52:55]
    s_waitcnt lgkmcnt(8)
    s_waitcnt vmcnt(24)
    v_mfma_f32_16x16x32_bf16 v[24:27], v[200:203], a[240:243], v[24:27]
    v_mfma_f32_16x16x32_bf16 v[28:31], v[220:223], a[240:243], v[28:31]
    buffer_load_dwordx4 v[156:159], v13, s[64:67], s4 offen offset:0 sc1
    v_mfma_f32_16x16x32_bf16 v[32:35], v[200:203], a[244:247], v[32:35]
    v_mfma_f32_16x16x32_bf16 v[36:39], v[220:223], a[244:247], v[36:39]
    v_mfma_f32_16x16x32_bf16 v[40:43], v[200:203], a[248:251], v[40:43]
    buffer_load_dwordx4 v[176:179], v13, s[64:67], s4 offen offset:1024 sc1
    v_mfma_f32_16x16x32_bf16 v[44:47], v[220:223], a[248:251], v[44:47]
    v_mfma_f32_16x16x32_bf16 v[48:51], v[200:203], a[252:255], v[48:51]
    v_mfma_f32_16x16x32_bf16 v[52:55], v[220:223], a[252:255], v[52:55]
    s_waitcnt lgkmcnt(4)
    s_waitcnt vmcnt(24)
    v_mfma_f32_16x16x32_bf16 v[24:27], v[96:99], v[224:227], v[24:27]
    v_mfma_f32_16x16x32_bf16 v[28:31], v[100:103], v[224:227], v[28:31]
    buffer_load_dwordx4 v[196:199], v13, s[64:67], s4 offen offset:2048 sc1
    v_mfma_f32_16x16x32_bf16 v[32:35], v[96:99], v[228:231], v[32:35]
    v_mfma_f32_16x16x32_bf16 v[36:39], v[100:103], v[228:231], v[36:39]
    v_mfma_f32_16x16x32_bf16 v[40:43], v[96:99], v[232:235], v[40:43]
    buffer_load_dwordx4 v[216:219], v13, s[64:67], s4 offen offset:3072 sc1
    v_mfma_f32_16x16x32_bf16 v[44:47], v[100:103], v[232:235], v[44:47]
    v_mfma_f32_16x16x32_bf16 v[48:51], v[96:99], v[236:239], v[48:51]
    v_mfma_f32_16x16x32_bf16 v[52:55], v[100:103], v[236:239], v[52:55]
    s_waitcnt lgkmcnt(0)
    s_waitcnt vmcnt(24)
    v_mfma_f32_16x16x32_bf16 v[24:27], v[104:107], v[240:243], v[24:27]
    v_mfma_f32_16x16x32_bf16 v[28:31], v[108:111], v[240:243], v[28:31]
    buffer_load_dwordx4 v[160:163], v14, s[64:67], s4 offen offset:0 sc1
    v_mfma_f32_16x16x32_bf16 v[32:35], v[104:107], v[244:247], v[32:35]
    v_mfma_f32_16x16x32_bf16 v[36:39], v[108:111], v[244:247], v[36:39]
    v_mfma_f32_16x16x32_bf16 v[40:43], v[104:107], v[248:251], v[40:43]
    buffer_load_dwordx4 v[180:183], v14, s[64:67], s4 offen offset:1024 sc1
    v_mfma_f32_16x16x32_bf16 v[44:47], v[108:111], v[248:251], v[44:47]
    v_mfma_f32_16x16x32_bf16 v[48:51], v[104:107], v[252:255], v[48:51]
    v_mfma_f32_16x16x32_bf16 v[52:55], v[108:111], v[252:255], v[52:55]
    s_waitcnt vmcnt(24)
    s_nop 0
    v_mfma_f32_16x16x32_bf16 v[56:59], v[112:115], a[0:3], 0
    v_mfma_f32_16x16x32_bf16 v[60:63], v[116:119], a[0:3], 0
    buffer_load_dwordx4 v[200:203], v14, s[64:67], s4 offen offset:2048 sc1
    v_mfma_f32_16x16x32_bf16 v[64:67], v[112:115], a[4:7], 0
    v_mfma_f32_16x16x32_bf16 v[68:71], v[116:119], a[4:7], 0
    v_mfma_f32_16x16x32_bf16 v[72:75], v[112:115], a[8:11], 0
    buffer_load_dwordx4 v[220:223], v14, s[64:67], s4 offen offset:3072 sc1
    v_mfma_f32_16x16x32_bf16 v[76:79], v[116:119], a[8:11], 0
    v_mul_f32 v88, s89, v24
    v_mul_f32 v89, s89, v25
    v_mfma_f32_16x16x32_bf16 v[80:83], v[112:115], a[12:15], 0
    v_mul_f32_e64 v90, s89, v26
    v_mfma_f32_16x16x32_bf16 v[84:87], v[116:119], a[12:15], 0
    v_mul_f32 v91, s89, v27
    s_waitcnt vmcnt(24)
    v_mfma_f32_16x16x32_bf16 v[56:59], v[120:123], a[16:19], v[56:59]
    v_exp_f32_e64 v88, v88
    v_mfma_f32_16x16x32_bf16 v[60:63], v[124:127], a[16:19], v[60:63]
    buffer_load_dwordx4 v[96:99], v15, s[64:67], s4 offen offset:0 sc1
    v_mfma_f32_16x16x32_bf16 v[64:67], v[120:123], a[20:23], v[64:67]
    v_exp_f32_e64 v89, v89
    v_mfma_f32_16x16x32_bf16 v[68:71], v[124:127], a[20:23], v[68:71]
    v_mfma_f32_16x16x32_bf16 v[72:75], v[120:123], a[24:27], v[72:75]
    buffer_load_dwordx4 v[100:103], v15, s[64:67], s4 offen offset:1024 sc1
    v_mfma_f32_16x16x32_bf16 v[76:79], v[124:127], a[24:27], v[76:79]
    v_exp_f32_e64 v90, v90
    v_mfma_f32_16x16x32_bf16 v[80:83], v[120:123], a[28:31], v[80:83]
    v_exp_f32_e64 v91, v91
    v_mfma_f32_16x16x32_bf16 v[84:87], v[124:127], a[28:31], v[84:87]
    s_add_u32 s92, s92, 32768
    buffer_load_dword v6, v23, s[64:67], s92 offen sc1
    s_waitcnt vmcnt(25)
    s_nop 0
    v_mfma_f32_16x16x32_bf16 v[56:59], v[128:131], a[32:35], v[56:59]
    v_add_f32_e64 v88, 1.0, v88
    v_mfma_f32_16x16x32_bf16 v[60:63], v[132:135], a[32:35], v[60:63]
    buffer_load_dwordx4 v[104:107], v15, s[64:67], s4 offen offset:2048 sc1
    v_mfma_f32_16x16x32_bf16 v[64:67], v[128:131], a[36:39], v[64:67]
    v_add_f32 v89, 1.0, v89
    v_add_f32 v90, 1.0, v90
    v_mfma_f32_16x16x32_bf16 v[68:71], v[132:135], a[36:39], v[68:71]
    v_add_f32_e64 v91, 1.0, v91
    v_mfma_f32_16x16x32_bf16 v[72:75], v[128:131], a[40:43], v[72:75]
    buffer_load_dwordx4 v[108:111], v15, s[64:67], s4 offen offset:3072 sc1
    v_mfma_f32_16x16x32_bf16 v[76:79], v[132:135], a[40:43], v[76:79]
    v_rcp_f32_e64 v88, v88
    v_mfma_f32_16x16x32_bf16 v[80:83], v[128:131], a[44:47], v[80:83]
    v_mfma_f32_16x16x32_bf16 v[84:87], v[132:135], a[44:47], v[84:87]
    s_waitcnt vmcnt(25)
    s_nop 0
    v_mfma_f32_16x16x32_bf16 v[56:59], v[136:139], a[48:51], v[56:59]
    v_rcp_f32_e64 v89, v89
    v_mfma_f32_16x16x32_bf16 v[60:63], v[140:143], a[48:51], v[60:63]
    buffer_load_dwordx4 v[112:115], v16, s[64:67], s4 offen offset:0 sc1
    v_mfma_f32_16x16x32_bf16 v[64:67], v[136:139], a[52:55], v[64:67]
    v_rcp_f32_e64 v90, v90
    v_mfma_f32_16x16x32_bf16 v[68:71], v[140:143], a[52:55], v[68:71]
    v_rcp_f32_e64 v91, v91
    v_mfma_f32_16x16x32_bf16 v[72:75], v[136:139], a[56:59], v[72:75]
    buffer_load_dwordx4 v[116:119], v16, s[64:67], s4 offen offset:1024 sc1
    v_mfma_f32_16x16x32_bf16 v[76:79], v[140:143], a[56:59], v[76:79]
    v_mul_f32_e64 v88, v88, v28
    v_mfma_f32_16x16x32_bf16 v[80:83], v[136:139], a[60:63], v[80:83]
    v_mul_f32_e64 v89, v89, v29
    v_mfma_f32_16x16x32_bf16 v[84:87], v[140:143], a[60:63], v[84:87]
    v_mul_f32 v90, v90, v30
    s_waitcnt vmcnt(25)
    v_mfma_f32_16x16x32_bf16 v[56:59], v[144:147], a[64:67], v[56:59]
    v_mul_f32_e64 v91, v91, v31
    v_mfma_f32_16x16x32_bf16 v[60:63], v[164:167], a[64:67], v[60:63]
    buffer_load_dwordx4 v[120:123], v16, s[64:67], s4 offen offset:2048 sc1
    v_mfma_f32_16x16x32_bf16 v[64:67], v[144:147], a[68:71], v[64:67]
    v_cvt_pk_bf16_f32 v88, v88, v89
    v_cvt_pk_bf16_f32 v89, v90, v91
    v_mfma_f32_16x16x32_bf16 v[68:71], v[164:167], a[68:71], v[68:71]
    ds_write_b64 v18, v[88:89] offset:0
    v_mfma_f32_16x16x32_bf16 v[72:75], v[144:147], a[72:75], v[72:75]
    buffer_load_dwordx4 v[124:127], v16, s[64:67], s4 offen offset:3072 sc1
    v_mfma_f32_16x16x32_bf16 v[76:79], v[164:167], a[72:75], v[76:79]
    v_mul_f32_e64 v92, s89, v32
    v_mfma_f32_16x16x32_bf16 v[80:83], v[144:147], a[76:79], v[80:83]
    v_mul_f32_e64 v93, s89, v33
    v_mfma_f32_16x16x32_bf16 v[84:87], v[164:167], a[76:79], v[84:87]
    v_mul_f32 v94, s89, v34
    s_waitcnt vmcnt(25)
    v_mfma_f32_16x16x32_bf16 v[56:59], v[184:187], a[80:83], v[56:59]
    v_mul_f32_e64 v95, s89, v35
    v_mfma_f32_16x16x32_bf16 v[60:63], v[204:207], a[80:83], v[60:63]
    s_add_u32 s4, s4, 147456
    buffer_load_dwordx4 v[128:131], v8, s[64:67], s4 offen offset:0 sc1
    v_mfma_f32_16x16x32_bf16 v[64:67], v[184:187], a[84:87], v[64:67]
    v_exp_f32_e64 v92, v92
    v_mfma_f32_16x16x32_bf16 v[68:71], v[204:207], a[84:87], v[68:71]
    v_exp_f32_e64 v93, v93
    v_mfma_f32_16x16x32_bf16 v[72:75], v[184:187], a[88:91], v[72:75]
    buffer_load_dwordx4 v[132:135], v8, s[64:67], s4 offen offset:1024 sc1
    v_mfma_f32_16x16x32_bf16 v[76:79], v[204:207], a[88:91], v[76:79]
    v_exp_f32_e64 v94, v94
    v_mfma_f32_16x16x32_bf16 v[80:83], v[184:187], a[92:95], v[80:83]
    v_mfma_f32_16x16x32_bf16 v[84:87], v[204:207], a[92:95], v[84:87]
    s_waitcnt vmcnt(25)
    s_nop 0
    v_mfma_f32_16x16x32_bf16 v[56:59], v[148:151], a[96:99], v[56:59]
    v_exp_f32_e64 v95, v95
    v_mfma_f32_16x16x32_bf16 v[60:63], v[168:171], a[96:99], v[60:63]
    buffer_load_dwordx4 v[136:139], v8, s[64:67], s4 offen offset:2048 sc1
    v_mfma_f32_16x16x32_bf16 v[64:67], v[148:151], a[100:103], v[64:67]
    v_add_f32 v92, 1.0, v92
    v_add_f32 v93, 1.0, v93
    v_mfma_f32_16x16x32_bf16 v[68:71], v[168:171], a[100:103], v[68:71]
    v_add_f32_e64 v94, 1.0, v94
    v_mfma_f32_16x16x32_bf16 v[72:75], v[148:151], a[104:107], v[72:75]
    buffer_load_dwordx4 v[140:143], v8, s[64:67], s4 offen offset:3072 sc1
    v_mfma_f32_16x16x32_bf16 v[76:79], v[168:171], a[104:107], v[76:79]
    v_add_f32_e64 v95, 1.0, v95
    v_mfma_f32_16x16x32_bf16 v[80:83], v[148:151], a[108:111], v[80:83]
    v_rcp_f32_e64 v92, v92
    v_mfma_f32_16x16x32_bf16 v[84:87], v[168:171], a[108:111], v[84:87]
    s_waitcnt vmcnt(25)
    s_nop 0
    v_mfma_f32_16x16x32_bf16 v[56:59], v[188:191], a[112:115], v[56:59]
    v_rcp_f32_e64 v93, v93
    v_mfma_f32_16x16x32_bf16 v[60:63], v[208:211], a[112:115], v[60:63]
    buffer_load_dwordx4 v[144:147], v9, s[64:67], s4 offen offset:0 sc1
    v_mfma_f32_16x16x32_bf16 v[64:67], v[188:191], a[116:119], v[64:67]
    v_rcp_f32_e64 v94, v94
    v_mfma_f32_16x16x32_bf16 v[68:71], v[208:211], a[116:119], v[68:71]
    v_mfma_f32_16x16x32_bf16 v[72:75], v[188:191], a[120:123], v[72:75]
    buffer_load_dwordx4 v[164:167], v9, s[64:67], s4 offen offset:1024 sc1
    v_mfma_f32_16x16x32_bf16 v[76:79], v[208:211], a[120:123], v[76:79]
    v_rcp_f32_e64 v95, v95
    v_mfma_f32_16x16x32_bf16 v[80:83], v[188:191], a[124:127], v[80:83]
    v_mul_f32_e64 v92, v92, v36
    v_mfma_f32_16x16x32_bf16 v[84:87], v[208:211], a[124:127], v[84:87]
    v_mul_f32 v93, v93, v37
    s_waitcnt vmcnt(25)
    v_mfma_f32_16x16x32_bf16 v[56:59], v[152:155], a[128:131], v[56:59]
    v_mul_f32_e64 v94, v94, v38
    v_mfma_f32_16x16x32_bf16 v[60:63], v[172:175], a[128:131], v[60:63]
    buffer_load_dwordx4 v[184:187], v9, s[64:67], s4 offen offset:2048 sc1
    v_mfma_f32_16x16x32_bf16 v[64:67], v[152:155], a[132:135], v[64:67]
    v_mul_f32_e64 v95, v95, v39
    v_cvt_pk_bf16_f32 v92, v92, v93
    v_mfma_f32_16x16x32_bf16 v[68:71], v[172:175], a[132:135], v[68:71]
    v_cvt_pk_bf16_f32 v93, v94, v95
    v_mfma_f32_16x16x32_bf16 v[72:75], v[152:155], a[136:139], v[72:75]
    buffer_load_dwordx4 v[204:207], v9, s[64:67], s4 offen offset:3072 sc1
    v_mfma_f32_16x16x32_bf16 v[76:79], v[172:175], a[136:139], v[76:79]
    ds_write_b64 v18, v[92:93] offset:18432
    v_mul_f32_e64 v88, s89, v40
    v_mfma_f32_16x16x32_bf16 v[80:83], v[152:155], a[140:143], v[80:83]
    v_mfma_f32_16x16x32_bf16 v[84:87], v[172:175], a[140:143], v[84:87]
    v_mul_f32 v89, s89, v41
    s_waitcnt vmcnt(25)
    v_mfma_f32_16x16x32_bf16 v[56:59], v[192:195], a[144:147], v[56:59]
    v_mul_f32_e64 v90, s89, v42
    v_mfma_f32_16x16x32_bf16 v[60:63], v[212:215], a[144:147], v[60:63]
    buffer_load_dwordx4 v[148:151], v10, s[64:67], s4 offen offset:0 sc1
    v_mfma_f32_16x16x32_bf16 v[64:67], v[192:195], a[148:151], v[64:67]
    v_mul_f32_e64 v91, s89, v43
    v_mfma_f32_16x16x32_bf16 v[68:71], v[212:215], a[148:151], v[68:71]
    v_exp_f32_e64 v88, v88
    v_mfma_f32_16x16x32_bf16 v[72:75], v[192:195], a[152:155], v[72:75]
    buffer_load_dwordx4 v[168:171], v10, s[64:67], s4 offen offset:1024 sc1
    v_mfma_f32_16x16x32_bf16 v[76:79], v[212:215], a[152:155], v[76:79]
    v_exp_f32_e64 v89, v89
    v_mfma_f32_16x16x32_bf16 v[80:83], v[192:195], a[156:159], v[80:83]
    v_exp_f32_e64 v90, v90
    v_mfma_f32_16x16x32_bf16 v[84:87], v[212:215], a[156:159], v[84:87]
    s_waitcnt vmcnt(25)
    s_nop 0
    v_mfma_f32_16x16x32_bf16 v[56:59], v[156:159], a[160:163], v[56:59]
    v_exp_f32_e64 v91, v91
    v_mfma_f32_16x16x32_bf16 v[60:63], v[176:179], a[160:163], v[60:63]
    buffer_load_dwordx4 v[188:191], v10, s[64:67], s4 offen offset:2048 sc1
    v_mfma_f32_16x16x32_bf16 v[64:67], v[156:159], a[164:167], v[64:67]
    v_add_f32_e64 v88, 1.0, v88
    v_mfma_f32_16x16x32_bf16 v[68:71], v[176:179], a[164:167], v[68:71]
    v_add_f32_e64 v89, 1.0, v89
    v_mfma_f32_16x16x32_bf16 v[72:75], v[156:159], a[168:171], v[72:75]
    buffer_load_dwordx4 v[208:211], v10, s[64:67], s4 offen offset:3072 sc1
    v_mfma_f32_16x16x32_bf16 v[76:79], v[176:179], a[168:171], v[76:79]
    v_add_f32 v90, 1.0, v90
    v_add_f32 v91, 1.0, v91
    v_mfma_f32_16x16x32_bf16 v[80:83], v[156:159], a[172:175], v[80:83]
    v_mfma_f32_16x16x32_bf16 v[84:87], v[176:179], a[172:175], v[84:87]
    s_waitcnt vmcnt(25)
    s_nop 0
    v_mfma_f32_16x16x32_bf16 v[56:59], v[196:199], a[176:179], v[56:59]
L_stub_12:
    s_cbranch_execz L_stub_16
    v_rcp_f32 v88, v88
    v_mfma_f32_16x16x32_bf16 v[60:63], v[216:219], a[176:179], v[60:63]
    buffer_load_dwordx4 v[152:155], v11, s[64:67], s4 offen offset:0 sc1
    v_mfma_f32_16x16x32_bf16 v[64:67], v[196:199], a[180:183], v[64:67]
    v_rcp_f32_e64 v89, v89
    v_mfma_f32_16x16x32_bf16 v[68:71], v[216:219], a[180:183], v[68:71]
    v_rcp_f32_e64 v90, v90
    v_mfma_f32_16x16x32_bf16 v[72:75], v[196:199], a[184:187], v[72:75]
    buffer_load_dwordx4 v[172:175], v11, s[64:67], s4 offen offset:1024 sc1
    v_mfma_f32_16x16x32_bf16 v[76:79], v[216:219], a[184:187], v[76:79]
    v_rcp_f32_e64 v91, v91
    v_mfma_f32_16x16x32_bf16 v[80:83], v[196:199], a[188:191], v[80:83]
    v_mfma_f32_16x16x32_bf16 v[84:87], v[216:219], a[188:191], v[84:87]
    v_mul_f32 v88, v88, v44
    s_waitcnt vmcnt(25)
    v_mfma_f32_16x16x32_bf16 v[56:59], v[160:163], a[192:195], v[56:59]
    v_mul_f32_e64 v89, v89, v45
    v_mfma_f32_16x16x32_bf16 v[60:63], v[180:183], a[192:195], v[60:63]
    buffer_load_dwordx4 v[192:195], v11, s[64:67], s4 offen offset:2048 sc1
    v_mfma_f32_16x16x32_bf16 v[64:67], v[160:163], a[196:199], v[64:67]
    v_mul_f32 v90, v90, v46
    v_mul_f32 v91, v91, v47
    v_mfma_f32_16x16x32_bf16 v[68:71], v[180:183], a[196:199], v[68:71]
    v_cvt_pk_bf16_f32 v88, v88, v89
    v_mfma_f32_16x16x32_bf16 v[72:75], v[160:163], a[200:203], v[72:75]
    buffer_load_dwordx4 v[212:215], v11, s[64:67], s4 offen offset:3072 sc1
    v_mfma_f32_16x16x32_bf16 v[76:79], v[180:183], a[200:203], v[76:79]
    v_cvt_pk_bf16_f32 v89, v90, v91
    ds_write_b64 v18, v[88:89] offset:36864
    v_mfma_f32_16x16x32_bf16 v[80:83], v[160:163], a[204:207], v[80:83]
    v_mul_f32_e64 v92, s89, v48
    v_mfma_f32_16x16x32_bf16 v[84:87], v[180:183], a[204:207], v[84:87]
    s_waitcnt vmcnt(25)
    s_nop 0
    v_mfma_f32_16x16x32_bf16 v[56:59], v[200:203], a[208:211], v[56:59]
    v_mul_f32_e64 v93, s89, v49
    v_mfma_f32_16x16x32_bf16 v[60:63], v[220:223], a[208:211], v[60:63]
    buffer_load_dwordx4 v[156:159], v12, s[64:67], s4 offen offset:0 sc1
    v_mfma_f32_16x16x32_bf16 v[64:67], v[200:203], a[212:215], v[64:67]
    v_mul_f32 v94, s89, v50
    v_mul_f32 v95, s89, v51
    v_mfma_f32_16x16x32_bf16 v[68:71], v[220:223], a[212:215], v[68:71]
    v_exp_f32_e64 v92, v92
    v_mfma_f32_16x16x32_bf16 v[72:75], v[200:203], a[216:219], v[72:75]
    buffer_load_dwordx4 v[176:179], v12, s[64:67], s4 offen offset:1024 sc1
    v_mfma_f32_16x16x32_bf16 v[76:79], v[220:223], a[216:219], v[76:79]
    v_exp_f32_e64 v93, v93
    v_mfma_f32_16x16x32_bf16 v[80:83], v[200:203], a[220:223], v[80:83]
    v_mfma_f32_16x16x32_bf16 v[84:87], v[220:223], a[220:223], v[84:87]
    s_waitcnt vmcnt(25)
    s_nop 0
    v_mfma_f32_16x16x32_bf16 v[56:59], v[96:99], a[224:227], v[56:59]
    v_exp_f32_e64 v94, v94
    v_mfma_f32_16x16x32_bf16 v[60:63], v[100:103], a[224:227], v[60:63]
    buffer_load_dwordx4 v[196:199], v12, s[64:67], s4 offen offset:2048 sc1
    v_mfma_f32_16x16x32_bf16 v[64:67], v[96:99], a[228:231], v[64:67]
    v_exp_f32_e64 v95, v95
    v_mfma_f32_16x16x32_bf16 v[68:71], v[100:103], a[228:231], v[68:71]
    v_add_f32_e64 v92, 1.0, v92
    v_mfma_f32_16x16x32_bf16 v[72:75], v[96:99], a[232:235], v[72:75]
    buffer_load_dwordx4 v[216:219], v12, s[64:67], s4 offen offset:3072 sc1
    v_mfma_f32_16x16x32_bf16 v[76:79], v[100:103], a[232:235], v[76:79]
    v_add_f32 v93, 1.0, v93
    v_add_f32 v94, 1.0, v94
    v_mfma_f32_16x16x32_bf16 v[80:83], v[96:99], a[236:239], v[80:83]
    v_add_f32_e64 v95, 1.0, v95
    v_mfma_f32_16x16x32_bf16 v[84:87], v[100:103], a[236:239], v[84:87]
    s_waitcnt vmcnt(24)
    s_nop 0
    v_mfma_f32_16x16x32_bf16 v[56:59], v[104:107], a[240:243], v[56:59]
    v_rcp_f32_e64 v92, v92
    v_mfma_f32_16x16x32_bf16 v[60:63], v[108:111], a[240:243], v[60:63]
    buffer_load_dwordx4 v[160:163], v13, s[64:67], s4 offen offset:0 sc1
    v_mfma_f32_16x16x32_bf16 v[64:67], v[104:107], a[244:247], v[64:67]
    v_rcp_f32_e64 v93, v93
    v_mfma_f32_16x16x32_bf16 v[68:71], v[108:111], a[244:247], v[68:71]
    v_mfma_f32_16x16x32_bf16 v[72:75], v[104:107], a[248:251], v[72:75]
    buffer_load_dwordx4 v[180:183], v13, s[64:67], s4 offen offset:1024 sc1
    v_mfma_f32_16x16x32_bf16 v[76:79], v[108:111], a[248:251], v[76:79]
    v_rcp_f32_e64 v94, v94
    v_mfma_f32_16x16x32_bf16 v[80:83], v[104:107], a[252:255], v[80:83]
    v_rcp_f32_e64 v95, v95
    v_mfma_f32_16x16x32_bf16 v[84:87], v[108:111], a[252:255], v[84:87]
    s_waitcnt vmcnt(24)
    s_nop 0
    v_mfma_f32_16x16x32_bf16 v[56:59], v[112:115], v[224:227], v[56:59]
    v_mul_f32_e64 v92, v92, v52
    v_mfma_f32_16x16x32_bf16 v[60:63], v[116:119], v[224:227], v[60:63]
    buffer_load_dwordx4 v[200:203], v13, s[64:67], s4 offen offset:2048 sc1
    v_mfma_f32_16x16x32_bf16 v[64:67], v[112:115], v[228:231], v[64:67]
    v_mul_f32 v93, v93, v53
    v_mul_f32 v94, v94, v54
    v_mfma_f32_16x16x32_bf16 v[68:71], v[116:119], v[228:231], v[68:71]
    v_mul_f32_e64 v95, v95, v55
    v_mfma_f32_16x16x32_bf16 v[72:75], v[112:115], v[232:235], v[72:75]
    buffer_load_dwordx4 v[220:223], v13, s[64:67], s4 offen offset:3072 sc1
    v_mfma_f32_16x16x32_bf16 v[76:79], v[116:119], v[232:235], v[76:79]
    v_cvt_pk_bf16_f32 v92, v92, v93
    v_cvt_pk_bf16_f32 v93, v94, v95
    v_mfma_f32_16x16x32_bf16 v[80:83], v[112:115], v[236:239], v[80:83]
    ds_write_b64 v19, v[92:93] offset:0
    v_mfma_f32_16x16x32_bf16 v[84:87], v[116:119], v[236:239], v[84:87]
    s_waitcnt vmcnt(24)
    s_nop 0
    v_mfma_f32_16x16x32_bf16 v[56:59], v[120:123], v[240:243], v[56:59]
    v_mfma_f32_16x16x32_bf16 v[60:63], v[124:127], v[240:243], v[60:63]
    buffer_load_dwordx4 v[96:99], v14, s[64:67], s4 offen offset:0 sc1
    v_mfma_f32_16x16x32_bf16 v[64:67], v[120:123], v[244:247], v[64:67]
    v_mfma_f32_16x16x32_bf16 v[68:71], v[124:127], v[244:247], v[68:71]
    v_mfma_f32_16x16x32_bf16 v[72:75], v[120:123], v[248:251], v[72:75]
    buffer_load_dwordx4 v[100:103], v14, s[64:67], s4 offen offset:1024 sc1
    v_mfma_f32_16x16x32_bf16 v[76:79], v[124:127], v[248:251], v[76:79]
    v_mfma_f32_16x16x32_bf16 v[80:83], v[120:123], v[252:255], v[80:83]
    v_mfma_f32_16x16x32_bf16 v[84:87], v[124:127], v[252:255], v[84:87]
    s_mov_b32 s88, 0
L_ps1:
    v_cmp_ne_u32 vcc, s3, v6
    s_nop 2
    s_cbranch_vccz L_ps1_ok
    s_add_u32 s88, s88, 1
    s_cmp_gt_u32 s88, 262144
    s_cbranch_scc1 L_ps1_ok
    buffer_load_dword v6, v23, s[64:67], s92 offen sc1
    s_waitcnt vmcnt(0)
    s_branch L_ps1
L_ps1_ok:
    s_waitcnt vmcnt(24)
    s_nop 0
    v_mfma_f32_16x16x32_bf16 v[24:27], v[128:131], a[0:3], 0
    v_mfma_f32_16x16x32_bf16 v[28:31], v[132:135], a[0:3], 0
    buffer_load_dwordx4 v[104:107], v14, s[64:67], s4 offen offset:2048 sc1
    v_mfma_f32_16x16x32_bf16 v[32:35], v[128:131], a[4:7], 0
    v_mfma_f32_16x16x32_bf16 v[36:39], v[132:135], a[4:7], 0
    v_mfma_f32_16x16x32_bf16 v[40:43], v[128:131], a[8:11], 0
    buffer_load_dwordx4 v[108:111], v14, s[64:67], s4 offen offset:3072 sc1
    v_mfma_f32_16x16x32_bf16 v[44:47], v[132:135], a[8:11], 0
    v_mul_f32 v88, s89, v56
    v_mul_f32 v89, s89, v57
    v_mfma_f32_16x16x32_bf16 v[48:51], v[128:131], a[12:15], 0
    v_mul_f32_e64 v90, s89, v58
    v_mfma_f32_16x16x32_bf16 v[52:55], v[132:135], a[12:15], 0
    v_mul_f32 v91, s89, v59
    s_waitcnt vmcnt(24)
    v_mfma_f32_16x16x32_bf16 v[24:27], v[136:139], a[16:19], v[24:27]
    v_exp_f32_e64 v88, v88
    v_mfma_f32_16x16x32_bf16 v[28:31], v[140:143], a[16:19], v[28:31]
    buffer_load_dwordx4 v[112:115], v15, s[64:67], s4 offen offset:0 sc1
    v_mfma_f32_16x16x32_bf16 v[32:35], v[136:139], a[20:23], v[32:35]
    v_exp_f32_e64 v89, v89
    v_mfma_f32_16x16x32_bf16 v[36:39], v[140:143], a[20:23], v[36:39]
    v_mfma_f32_16x16x32_bf16 v[40:43], v[136:139], a[24:27], v[40:43]
    buffer_load_dwordx4 v[116:119], v15, s[64:67], s4 offen offset:1024 sc1
    v_mfma_f32_16x16x32_bf16 v[44:47], v[140:143], a[24:27], v[44:47]
    v_exp_f32_e64 v90, v90
    v_mfma_f32_16x16x32_bf16 v[48:51], v[136:139], a[28:31], v[48:51]
    v_exp_f32_e64 v91, v91
    v_mfma_f32_16x16x32_bf16 v[52:55], v[140:143], a[28:31], v[52:55]
    s_waitcnt vmcnt(24)
    s_nop 0
    v_mfma_f32_16x16x32_bf16 v[24:27], v[144:147], a[32:35], v[24:27]
    v_add_f32_e64 v88, 1.0, v88
    v_mfma_f32_16x16x32_bf16 v[28:31], v[164:167], a[32:35], v[28:31]
    buffer_load_dwordx4 v[120:123], v15, s[64:67], s4 offen offset:2048 sc1
    v_mfma_f32_16x16x32_bf16 v[32:35], v[144:147], a[36:39], v[32:35]
    v_add_f32 v89, 1.0, v89
    v_add_f32 v90, 1.0, v90
    v_mfma_f32_16x16x32_bf16 v[36:39], v[164:167], a[36:39], v[36:39]
    v_add_f32_e64 v91, 1.0, v91
    v_mfma_f32_16x16x32_bf16 v[40:43], v[144:147], a[40:43], v[40:43]
    buffer_load_dwordx4 v[124:127], v15, s[64:67], s4 offen offset:3072 sc1
    v_mfma_f32_16x16x32_bf16 v[44:47], v[164:167], a[40:43], v[44:47]
    v_rcp_f32_e64 v88, v88
    v_mfma_f32_16x16x32_bf16 v[48:51], v[144:147], a[44:47], v[48:51]
    v_mfma_f32_16x16x32_bf16 v[52:55], v[164:167], a[44:47], v[52:55]
    s_waitcnt vmcnt(24)
    s_nop 0
    v_mfma_f32_16x16x32_bf16 v[24:27], v[184:187], a[48:51], v[24:27]
    v_rcp_f32_e64 v89, v89
    v_mfma_f32_16x16x32_bf16 v[28:31], v[204:207], a[48:51], v[28:31]
    buffer_load_dwordx4 v[128:131], v16, s[64:67], s4 offen offset:0 sc1
    v_mfma_f32_16x16x32_bf16 v[32:35], v[184:187], a[52:55], v[32:35]
    v_rcp_f32_e64 v90, v90
    v_mfma_f32_16x16x32_bf16 v[36:39], v[204:207], a[52:55], v[36:39]
    v_rcp_f32_e64 v91, v91
    v_mfma_f32_16x16x32_bf16 v[40:43], v[184:187], a[56:59], v[40:43]
    buffer_load_dwordx4 v[132:135], v16, s[64:67], s4 offen offset:1024 sc1
    v_mfma_f32_16x16x32_bf16 v[44:47], v[204:207], a[56:59], v[44:47]
    v_mul_f32_e64 v88, v88, v60
    v_mfma_f32_16x16x32_bf16 v[48:51], v[184:187], a[60:63], v[48:51]
    v_mul_f32_e64 v89, v89, v61
    v_mfma_f32_16x16x32_bf16 v[52:55], v[204:207], a[60:63], v[52:55]
    v_mul_f32 v90, v90, v62
    s_waitcnt vmcnt(24)
    v_mfma_f32_16x16x32_bf16 v[24:27], v[148:151], a[64:67], v[24:27]
    v_mul_f32_e64 v91, v91, v63
    v_mfma_f32_16x16x32_bf16 v[28:31], v[168:171], a[64:67], v[28:31]
    buffer_load_dwordx4 v[136:139], v16, s[64:67], s4 offen offset:2048 sc1
    v_mfma_f32_16x16x32_bf16 v[32:35], v[148:151], a[68:71], v[32:35]
    v_cvt_pk_bf16_f32 v88, v88, v89
    v_cvt_pk_bf16_f32 v89, v90, v91
    v_mfma_f32_16x16x32_bf16 v[36:39], v[168:171], a[68:71], v[36:39]
    ds_write_b64 v18, v[88:89] offset:2048
    v_mfma_f32_16x16x32_bf16 v[40:43], v[148:151], a[72:75], v[40:43]
    buffer_load_dwordx4 v[140:143], v16, s[64:67], s4 offen offset:3072 sc1
    v_mfma_f32_16x16x32_bf16 v[44:47], v[168:171], a[72:75], v[44:47]
    v_mul_f32_e64 v92, s89, v64
    v_mfma_f32_16x16x32_bf16 v[48:51], v[148:151], a[76:79], v[48:51]
    v_mul_f32_e64 v93, s89, v65
    v_mfma_f32_16x16x32_bf16 v[52:55], v[168:171], a[76:79], v[52:55]
    v_mul_f32 v94, s89, v66
    s_waitcnt vmcnt(24)
    v_mfma_f32_16x16x32_bf16 v[24:27], v[188:191], a[80:83], v[24:27]
    v_mul_f32_e64 v95, s89, v67
    v_mfma_f32_16x16x32_bf16 v[28:31], v[208:211], a[80:83], v[28:31]
    s_add_u32 s4, s4, 147456
    buffer_load_dwordx4 v[144:147], v8, s[64:67], s4 offen offset:0 sc1
    v_mfma_f32_16x16x32_bf16 v[32:35], v[188:191], a[84:87], v[32:35]
    v_exp_f32_e64 v92, v92
    v_mfma_f32_16x16x32_bf16 v[36:39], v[208:211], a[84:87], v[36:39]
    v_exp_f32_e64 v93, v93
    v_mfma_f32_16x16x32_bf16 v[40:43], v[188:191], a[88:91], v[40:43]
    buffer_load_dwordx4 v[164:167], v8, s[64:67], s4 offen offset:1024 sc1
    v_mfma_f32_16x16x32_bf16 v[44:47], v[208:211], a[88:91], v[44:47]
    v_exp_f32_e64 v94, v94
    v_mfma_f32_16x16x32_bf16 v[48:51], v[188:191], a[92:95], v[48:51]
    v_mfma_f32_16x16x32_bf16 v[52:55], v[208:211], a[92:95], v[52:55]
    s_waitcnt vmcnt(24)
    s_nop 0
    v_mfma_f32_16x16x32_bf16 v[24:27], v[152:155], a[96:99], v[24:27]
    v_exp_f32_e64 v95, v95
    v_mfma_f32_16x16x32_bf16 v[28:31], v[172:175], a[96:99], v[28:31]
    buffer_load_dwordx4 v[184:187], v8, s[64:67], s4 offen offset:2048 sc1
    v_mfma_f32_16x16x32_bf16 v[32:35], v[152:155], a[100:103], v[32:35]
    v_add_f32 v92, 1.0, v92
    v_add_f32 v93, 1.0, v93
    v_mfma_f32_16x16x32_bf16 v[36:39], v[172:175], a[100:103], v[36:39]
    v_add_f32_e64 v94, 1.0, v94
    v_mfma_f32_16x16x32_bf16 v[40:43], v[152:155], a[104:107], v[40:43]
    buffer_load_dwordx4 v[204:207], v8, s[64:67], s4 offen offset:3072 sc1
    v_mfma_f32_16x16x32_bf16 v[44:47], v[172:175], a[104:107], v[44:47]
    v_add_f32_e64 v95, 1.0, v95
    v_mfma_f32_16x16x32_bf16 v[48:51], v[152:155], a[108:111], v[48:51]
    v_rcp_f32_e64 v92, v92
    v_mfma_f32_16x16x32_bf16 v[52:55], v[172:175], a[108:111], v[52:55]
    s_waitcnt vmcnt(24)
    s_nop 0
    v_mfma_f32_16x16x32_bf16 v[24:27], v[192:195], a[112:115], v[24:27]
    v_rcp_f32_e64 v93, v93
    v_mfma_f32_16x16x32_bf16 v[28:31], v[212:215], a[112:115], v[28:31]
    buffer_load_dwordx4 v[148:151], v9, s[64:67], s4 offen offset:0 sc1
    v_mfma_f32_16x16x32_bf16 v[32:35], v[192:195], a[116:119], v[32:35]
    v_rcp_f32_e64 v94, v94
    v_mfma_f32_16x16x32_bf16 v[36:39], v[212:215], a[116:119], v[36:39]
    v_mfma_f32_16x16x32_bf16 v[40:43], v[192:195], a[120:123], v[40:43]
    buffer_load_dwordx4 v[168:171], v9, s[64:67], s4 offen offset:1024 sc1
    v_mfma_f32_16x16x32_bf16 v[44:47], v[212:215], a[120:123], v[44:47]
    v_rcp_f32_e64 v95, v95
    v_mfma_f32_16x16x32_bf16 v[48:51], v[192:195], a[124:127], v[48:51]
    v_mul_f32_e64 v92, v92, v68
    v_mfma_f32_16x16x32_bf16 v[52:55], v[212:215], a[124:127], v[52:55]
    v_mul_f32 v93, v93, v69
    s_waitcnt vmcnt(24)
    v_mfma_f32_16x16x32_bf16 v[24:27], v[156:159], a[128:131], v[24:27]
    v_mul_f32_e64 v94, v94, v70
    v_mfma_f32_16x16x32_bf16 v[28:31], v[176:179], a[128:131], v[28:31]
    buffer_load_dwordx4 v[188:191], v9, s[64:67], s4 offen offset:2048 sc1
    v_mfma_f32_16x16x32_bf16 v[32:35], v[156:159], a[132:135], v[32:35]
    v_mul_f32_e64 v95, v95, v71
    v_cvt_pk_bf16_f32 v92, v92, v93
    v_mfma_f32_16x16x32_bf16 v[36:39], v[176:179], a[132:135], v[36:39]
    v_cvt_pk_bf16_f32 v93, v94, v95
    v_mfma_f32_16x16x32_bf16 v[40:43], v[156:159], a[136:139], v[40:43]
    buffer_load_dwordx4 v[208:211], v9, s[64:67], s4 offen offset:3072 sc1
    v_mfma_f32_16x16x32_bf16 v[44:47], v[176:179], a[136:139], v[44:47]
    ds_write_b64 v18, v[92:93] offset:20480
    v_mul_f32_e64 v88, s89, v72
    v_mfma_f32_16x16x32_bf16 v[48:51], v[156:159], a[140:143], v[48:51]
    v_mfma_f32_16x16x32_bf16 v[52:55], v[176:179], a[140:143], v[52:55]
    v_mul_f32 v89, s89, v73
    s_waitcnt vmcnt(24)
    v_mfma_f32_16x16x32_bf16 v[24:27], v[196:199], a[144:147], v[24:27]
    v_mul_f32_e64 v90, s89, v74
    v_mfma_f32_16x16x32_bf16 v[28:31], v[216:219], a[144:147], v[28:31]
    buffer_load_dwordx4 v[152:155], v10, s[64:67], s4 offen offset:0 sc1
    v_mfma_f32_16x16x32_bf16 v[32:35], v[196:199], a[148:151], v[32:35]
    v_mul_f32_e64 v91, s89, v75
    v_mfma_f32_16x16x32_bf16 v[36:39], v[216:219], a[148:151], v[36:39]
    v_exp_f32_e64 v88, v88
    v_mfma_f32_16x16x32_bf16 v[40:43], v[196:199], a[152:155], v[40:43]
    buffer_load_dwordx4 v[172:175], v10, s[64:67], s4 offen offset:1024 sc1
    v_mfma_f32_16x16x32_bf16 v[44:47], v[216:219], a[152:155], v[44:47]
    v_exp_f32_e64 v89, v89
    v_mfma_f32_16x16x32_bf16 v[48:51], v[196:199], a[156:159], v[48:51]
    v_exp_f32_e64 v90, v90
    v_mfma_f32_16x16x32_bf16 v[52:55], v[216:219], a[156:159], v[52:55]
    s_waitcnt vmcnt(24)
    s_nop 0
    v_mfma_f32_16x16x32_bf16 v[24:27], v[160:163], a[160:163], v[24:27]
    v_exp_f32_e64 v91, v91
    v_mfma_f32_16x16x32_bf16 v[28:31], v[180:183], a[160:163], v[28:31]
    buffer_load_dwordx4 v[192:195], v10, s[64:67], s4 offen offset:2048 sc1
    v_mfma_f32_16x16x32_bf16 v[32:35], v[160:163], a[164:167], v[32:35]
    v_add_f32_e64 v88, 1.0, v88
    v_mfma_f32_16x16x32_bf16 v[36:39], v[180:183], a[164:167], v[36:39]
    v_add_f32_e64 v89, 1.0, v89
    v_mfma_f32_16x16x32_bf16 v[40:43], v[160:163], a[168:171], v[40:43]
    buffer_load_dwordx4 v[212:215], v10, s[64:67], s4 offen offset:3072 sc1
    v_mfma_f32_16x16x32_bf16 v[44:47], v[180:183], a[168:171], v[44:47]
    v_add_f32 v90, 1.0, v90
    v_add_f32 v91, 1.0, v91
    v_mfma_f32_16x16x32_bf16 v[48:51], v[160:163], a[172:175], v[48:51]
    v_mfma_f32_16x16x32_bf16 v[52:55], v[180:183], a[172:175], v[52:55]
    s_waitcnt vmcnt(24)
    s_nop 0
    v_mfma_f32_16x16x32_bf16 v[24:27], v[200:203], a[176:179], v[24:27]
    v_rcp_f32_e64 v88, v88
    v_mfma_f32_16x16x32_bf16 v[28:31], v[220:223], a[176:179], v[28:31]
    buffer_load_dwordx4 v[156:159], v11, s[64:67], s4 offen offset:0 sc1
    v_mfma_f32_16x16x32_bf16 v[32:35], v[200:203], a[180:183], v[32:35]
    v_rcp_f32_e64 v89, v89
    v_mfma_f32_16x16x32_bf16 v[36:39], v[220:223], a[180:183], v[36:39]
    v_rcp_f32_e64 v90, v90
    v_mfma_f32_16x16x32_bf16 v[40:43], v[200:203], a[184:187], v[40:43]
    buffer_load_dwordx4 v[176:179], v11, s[64:67], s4 offen offset:1024 sc1
    v_mfma_f32_16x16x32_bf16 v[44:47], v[220:223], a[184:187], v[44:47]
    v_rcp_f32_e64 v91, v91
    v_mfma_f32_16x16x32_bf16 v[48:51], v[200:203], a[188:191], v[48:51]
    v_mfma_f32_16x16x32_bf16 v[52:55], v[220:223], a[188:191], v[52:55]
    v_mul_f32 v88, v88, v76
    s_waitcnt vmcnt(24)
    v_mfma_f32_16x16x32_bf16 v[24:27], v[96:99], a[192:195], v[24:27]
    v_mul_f32_e64 v89, v89, v77
    v_mfma_f32_16x16x32_bf16 v[28:31], v[100:103], a[192:195], v[28:31]
    buffer_load_dwordx4 v[196:199], v11, s[64:67], s4 offen offset:2048 sc1
    v_mfma_f32_16x16x32_bf16 v[32:35], v[96:99], a[196:199], v[32:35]
    v_mul_f32 v90, v90, v78
    v_mul_f32 v91, v91, v79
    v_mfma_f32_16x16x32_bf16 v[36:39], v[100:103], a[196:199], v[36:39]
    v_cvt_pk_bf16_f32 v88, v88, v89
    v_mfma_f32_16x16x32_bf16 v[40:43], v[96:99], a[200:203], v[40:43]
    buffer_load_dwordx4 v[216:219], v11, s[64:67], s4 offen offset:3072 sc1
    v_mfma_f32_16x16x32_bf16 v[44:47], v[100:103], a[200:203], v[44:47]
    v_cvt_pk_bf16_f32 v89, v90, v91
    ds_write_b64 v18, v[88:89] offset:38912
    v_mfma_f32_16x16x32_bf16 v[48:51], v[96:99], a[204:207], v[48:51]
    v_mul_f32_e64 v92, s89, v80
    v_mfma_f32_16x16x32_bf16 v[52:55], v[100:103], a[204:207], v[52:55]
    s_waitcnt vmcnt(24)
    s_nop 0
    v_mfma_f32_16x16x32_bf16 v[24:27], v[104:107], a[208:211], v[24:27]
    v_mul_f32_e64 v93, s89, v81
    v_mfma_f32_16x16x32_bf16 v[28:31], v[108:111], a[208:211], v[28:31]
    buffer_load_dwordx4 v[160:163], v12, s[64:67], s4 offen offset:0 sc1
    v_mfma_f32_16x16x32_bf16 v[32:35], v[104:107], a[212:215], v[32:35]
    v_mul_f32 v94, s89, v82
    v_mul_f32 v95, s89, v83
    v_mfma_f32_16x16x32_bf16 v[36:39], v[108:111], a[212:215], v[36:39]
    v_exp_f32_e64 v92, v92
    v_mfma_f32_16x16x32_bf16 v[40:43], v[104:107], a[216:219], v[40:43]
    buffer_load_dwordx4 v[180:183], v12, s[64:67], s4 offen offset:1024 sc1
    v_mfma_f32_16x16x32_bf16 v[44:47], v[108:111], a[216:219], v[44:47]
    v_exp_f32_e64 v93, v93
    v_mfma_f32_16x16x32_bf16 v[48:51], v[104:107], a[220:223], v[48:51]
    v_mfma_f32_16x16x32_bf16 v[52:55], v[108:111], a[220:223], v[52:55]
    s_waitcnt vmcnt(24)
    s_nop 0
    v_mfma_f32_16x16x32_bf16 v[24:27], v[112:115], a[224:227], v[24:27]
    v_exp_f32_e64 v94, v94
    v_mfma_f32_16x16x32_bf16 v[28:31], v[116:119], a[224:227], v[28:31]
    buffer_load_dwordx4 v[200:203], v12, s[64:67], s4 offen offset:2048 sc1
    v_mfma_f32_16x16x32_bf16 v[32:35], v[112:115], a[228:231], v[32:35]
    v_exp_f32_e64 v95, v95
    v_mfma_f32_16x16x32_bf16 v[36:39], v[116:119], a[228:231], v[36:39]
    v_add_f32_e64 v92, 1.0, v92
    v_mfma_f32_16x16x32_bf16 v[40:43], v[112:115], a[232:235], v[40:43]
    buffer_load_dwordx4 v[220:223], v12, s[64:67], s4 offen offset:3072 sc1
    v_mfma_f32_16x16x32_bf16 v[44:47], v[116:119], a[232:235], v[44:47]
    v_add_f32 v93, 1.0, v93
    v_add_f32 v94, 1.0, v94
    v_mfma_f32_16x16x32_bf16 v[48:51], v[112:115], a[236:239], v[48:51]
    v_add_f32_e64 v95, 1.0, v95
    v_mfma_f32_16x16x32_bf16 v[52:55], v[116:119], a[236:239], v[52:55]
    s_waitcnt vmcnt(24)
    s_nop 0
    v_mfma_f32_16x16x32_bf16 v[24:27], v[120:123], a[240:243], v[24:27]
    v_rcp_f32_e64 v92, v92
    v_mfma_f32_16x16x32_bf16 v[28:31], v[124:127], a[240:243], v[28:31]
    buffer_load_dwordx4 v[96:99], v13, s[64:67], s4 offen offset:0 sc1
    v_mfma_f32_16x16x32_bf16 v[32:35], v[120:123], a[244:247], v[32:35]
    v_rcp_f32_e64 v93, v93
    v_mfma_f32_16x16x32_bf16 v[36:39], v[124:127], a[244:247], v[36:39]
    v_mfma_f32_16x16x32_bf16 v[40:43], v[120:123], a[248:251], v[40:43]
    buffer_load_dwordx4 v[100:103], v13, s[64:67], s4 offen offset:1024 sc1
    v_mfma_f32_16x16x32_bf16 v[44:47], v[124:127], a[248:251], v[44:47]
    v_rcp_f32_e64 v94, v94
    v_mfma_f32_16x16x32_bf16 v[48:51], v[120:123], a[252:255], v[48:51]
    v_rcp_f32_e64 v95, v95
    v_mfma_f32_16x16x32_bf16 v[52:55], v[124:127], a[252:255], v[52:55]
    s_waitcnt vmcnt(24)
    s_nop 0
    v_mfma_f32_16x16x32_bf16 v[24:27], v[128:131], v[224:227], v[24:27]
    v_mul_f32_e64 v92, v92, v84
    v_mfma_f32_16x16x32_bf16 v[28:31], v[132:135], v[224:227], v[28:31]
    buffer_load_dwordx4 v[104:107], v13, s[64:67], s4 offen offset:2048 sc1
    v_mfma_f32_16x16x32_bf16 v[32:35], v[128:131], v[228:231], v[32:35]
    v_mul_f32 v93, v93, v85
    v_mul_f32 v94, v94, v86
    v_mfma_f32_16x16x32_bf16 v[36:39], v[132:135], v[228:231], v[36:39]
    v_mul_f32_e64 v95, v95, v87
    v_mfma_f32_16x16x32_bf16 v[40:43], v[128:131], v[232:235], v[40:43]
    buffer_load_dwordx4 v[108:111], v13, s[64:67], s4 offen offset:3072 sc1
    v_mfma_f32_16x16x32_bf16 v[44:47], v[132:135], v[232:235], v[44:47]
    v_cvt_pk_bf16_f32 v92, v92, v93
    v_cvt_pk_bf16_f32 v93, v94, v95
    v_mfma_f32_16x16x32_bf16 v[48:51], v[128:131], v[236:239], v[48:51]
    ds_write_b64 v19, v[92:93] offset:2048
    v_mfma_f32_16x16x32_bf16 v[52:55], v[132:135], v[236:239], v[52:55]
    s_waitcnt vmcnt(24)
    s_nop 0
    v_mfma_f32_16x16x32_bf16 v[24:27], v[136:139], v[240:243], v[24:27]
    v_mfma_f32_16x16x32_bf16 v[28:31], v[140:143], v[240:243], v[28:31]
    buffer_load_dwordx4 v[112:115], v14, s[64:67], s4 offen offset:0 sc1
    v_mfma_f32_16x16x32_bf16 v[32:35], v[136:139], v[244:247], v[32:35]
    v_mfma_f32_16x16x32_bf16 v[36:39], v[140:143], v[244:247], v[36:39]
    v_mfma_f32_16x16x32_bf16 v[40:43], v[136:139], v[248:251], v[40:43]
    buffer_load_dwordx4 v[116:119], v14, s[64:67], s4 offen offset:1024 sc1
    v_mfma_f32_16x16x32_bf16 v[44:47], v[140:143], v[248:251], v[44:47]
    v_mfma_f32_16x16x32_bf16 v[48:51], v[136:139], v[252:255], v[48:51]
    v_mfma_f32_16x16x32_bf16 v[52:55], v[140:143], v[252:255], v[52:55]
    s_waitcnt vmcnt(24)
    s_nop 0
    v_mfma_f32_16x16x32_bf16 v[56:59], v[144:147], a[0:3], 0
    v_mfma_f32_16x16x32_bf16 v[60:63], v[164:167], a[0:3], 0
    buffer_load_dwordx4 v[120:123], v14, s[64:67], s4 offen offset:2048 sc1
    v_mfma_f32_16x16x32_bf16 v[64:67], v[144:147], a[4:7], 0
    v_mfma_f32_16x16x32_bf16 v[68:71], v[164:167], a[4:7], 0
    v_mfma_f32_16x16x32_bf16 v[72:75], v[144:147], a[8:11], 0
    buffer_load_dwordx4 v[124:127], v14, s[64:67], s4 offen offset:3072 sc1
    v_mfma_f32_16x16x32_bf16 v[76:79], v[164:167], a[8:11], 0
    v_mul_f32 v88, s89, v24
    v_mul_f32 v89, s89, v25
    v_mfma_f32_16x16x32_bf16 v[80:83], v[144:147], a[12:15], 0
    v_mul_f32_e64 v90, s89, v26
    v_mfma_f32_16x16x32_bf16 v[84:87], v[164:167], a[12:15], 0
    v_mul_f32 v91, s89, v27
    s_waitcnt vmcnt(24)
    v_mfma_f32_16x16x32_bf16 v[56:59], v[184:187], a[16:19], v[56:59]
    v_exp_f32_e64 v88, v88
    v_mfma_f32_16x16x32_bf16 v[60:63], v[204:207], a[16:19], v[60:63]
    buffer_load_dwordx4 v[128:131], v15, s[64:67], s4 offen offset:0 sc1
    v_mfma_f32_16x16x32_bf16 v[64:67], v[184:187], a[20:23], v[64:67]
    v_exp_f32_e64 v89, v89
    v_mfma_f32_16x16x32_bf16 v[68:71], v[204:207], a[20:23], v[68:71]
    v_mfma_f32_16x16x32_bf16 v[72:75], v[184:187], a[24:27], v[72:75]
    buffer_load_dwordx4 v[132:135], v15, s[64:67], s4 offen offset:1024 sc1
    v_mfma_f32_16x16x32_bf16 v[76:79], v[204:207], a[24:27], v[76:79]
    v_exp_f32_e64 v90, v90
    v_mfma_f32_16x16x32_bf16 v[80:83], v[184:187], a[28:31], v[80:83]
    v_exp_f32_e64 v91, v91
    v_mfma_f32_16x16x32_bf16 v[84:87], v[204:207], a[28:31], v[84:87]
    s_waitcnt vmcnt(24)
    s_nop 0
    v_mfma_f32_16x16x32_bf16 v[56:59], v[148:151], a[32:35], v[56:59]
    v_add_f32_e64 v88, 1.0, v88
    v_mfma_f32_16x16x32_bf16 v[60:63], v[168:171], a[32:35], v[60:63]
    buffer_load_dwordx4 v[136:139], v15, s[64:67], s4 offen offset:2048 sc1
    v_mfma_f32_16x16x32_bf16 v[64:67], v[148:151], a[36:39], v[64:67]
    v_add_f32 v89, 1.0, v89
    v_add_f32 v90, 1.0, v90
    v_mfma_f32_16x16x32_bf16 v[68:71], v[168:171], a[36:39], v[68:71]
    v_add_f32_e64 v91, 1.0, v91
    v_mfma_f32_16x16x32_bf16 v[72:75], v[148:151], a[40:43], v[72:75]
    buffer_load_dwordx4 v[140:143], v15, s[64:67], s4 offen offset:3072 sc1
    v_mfma_f32_16x16x32_bf16 v[76:79], v[168:171], a[40:43], v[76:79]
    v_rcp_f32_e64 v88, v88
    v_mfma_f32_16x16x32_bf16 v[80:83], v[148:151], a[44:47], v[80:83]
    v_mfma_f32_16x16x32_bf16 v[84:87], v[168:171], a[44:47], v[84:87]
    s_waitcnt vmcnt(24)
    s_nop 0
    v_mfma_f32_16x16x32_bf16 v[56:59], v[188:191], a[48:51], v[56:59]
    v_rcp_f32_e64 v89, v89
    v_mfma_f32_16x16x32_bf16 v[60:63], v[208:211], a[48:51], v[60:63]
    buffer_load_dwordx4 v[144:147], v16, s[64:67], s4 offen offset:0 sc1
    v_mfma_f32_16x16x32_bf16 v[64:67], v[188:191], a[52:55], v[64:67]
    v_rcp_f32_e64 v90, v90
    v_mfma_f32_16x16x32_bf16 v[68:71], v[208:211], a[52:55], v[68:71]
    v_rcp_f32_e64 v91, v91
    v_mfma_f32_16x16x32_bf16 v[72:75], v[188:191], a[56:59], v[72:75]
    buffer_load_dwordx4 v[164:167], v16, s[64:67], s4 offen offset:1024 sc1
    v_mfma_f32_16x16x32_bf16 v[76:79], v[208:211], a[56:59], v[76:79]
    v_mul_f32_e64 v88, v88, v28
    v_mfma_f32_16x16x32_bf16 v[80:83], v[188:191], a[60:63], v[80:83]
    v_mul_f32_e64 v89, v89, v29
    v_mfma_f32_16x16x32_bf16 v[84:87], v[208:211], a[60:63], v[84:87]
    v_mul_f32 v90, v90, v30
    s_waitcnt vmcnt(24)
    v_mfma_f32_16x16x32_bf16 v[56:59], v[152:155], a[64:67], v[56:59]
    v_mul_f32_e64 v91, v91, v31
    v_mfma_f32_16x16x32_bf16 v[60:63], v[172:175], a[64:67], v[60:63]
    buffer_load_dwordx4 v[184:187], v16, s[64:67], s4 offen offset:2048 sc1
    v_mfma_f32_16x16x32_bf16 v[64:67], v[152:155], a[68:71], v[64:67]
    v_cvt_pk_bf16_f32 v88, v88, v89
    v_cvt_pk_bf16_f32 v89, v90, v91
    v_mfma_f32_16x16x32_bf16 v[68:71], v[172:175], a[68:71], v[68:71]
    ds_write_b64 v18, v[88:89] offset:4096
    v_mfma_f32_16x16x32_bf16 v[72:75], v[152:155], a[72:75], v[72:75]
    buffer_load_dwordx4 v[204:207], v16, s[64:67], s4 offen offset:3072 sc1
    v_mfma_f32_16x16x32_bf16 v[76:79], v[172:175], a[72:75], v[76:79]
    v_mul_f32_e64 v92, s89, v32
    v_mfma_f32_16x16x32_bf16 v[80:83], v[152:155], a[76:79], v[80:83]
    v_mul_f32_e64 v93, s89, v33
    v_mfma_f32_16x16x32_bf16 v[84:87], v[172:175], a[76:79], v[84:87]
    v_mul_f32 v94, s89, v34
    s_waitcnt vmcnt(24)
    v_mfma_f32_16x16x32_bf16 v[56:59], v[192:195], a[80:83], v[56:59]
    v_mul_f32_e64 v95, s89, v35
    v_mfma_f32_16x16x32_bf16 v[60:63], v[212:215], a[80:83], v[60:63]
    s_add_u32 s4, s4, 147456
    buffer_load_dwordx4 v[148:151], v8, s[64:67], s4 offen offset:0 sc1
    v_mfma_f32_16x16x32_bf16 v[64:67], v[192:195], a[84:87], v[64:67]
    v_exp_f32_e64 v92, v92
    v_mfma_f32_16x16x32_bf16 v[68:71], v[212:215], a[84:87], v[68:71]
    v_exp_f32_e64 v93, v93
    v_mfma_f32_16x16x32_bf16 v[72:75], v[192:195], a[88:91], v[72:75]
    buffer_load_dwordx4 v[168:171], v8, s[64:67], s4 offen offset:1024 sc1
    v_mfma_f32_16x16x32_bf16 v[76:79], v[212:215], a[88:91], v[76:79]
    v_exp_f32_e64 v94, v94
    v_mfma_f32_16x16x32_bf16 v[80:83], v[192:195], a[92:95], v[80:83]
    v_mfma_f32_16x16x32_bf16 v[84:87], v[212:215], a[92:95], v[84:87]
    s_waitcnt vmcnt(24)
    s_nop 0
    v_mfma_f32_16x16x32_bf16 v[56:59], v[156:159], a[96:99], v[56:59]
    v_exp_f32_e64 v95, v95
    v_mfma_f32_16x16x32_bf16 v[60:63], v[176:179], a[96:99], v[60:63]
    buffer_load_dwordx4 v[188:191], v8, s[64:67], s4 offen offset:2048 sc1
    v_mfma_f32_16x16x32_bf16 v[64:67], v[156:159], a[100:103], v[64:67]
    v_add_f32 v92, 1.0, v92
    v_add_f32 v93, 1.0, v93
    v_mfma_f32_16x16x32_bf16 v[68:71], v[176:179], a[100:103], v[68:71]
    v_add_f32_e64 v94, 1.0, v94
    v_mfma_f32_16x16x32_bf16 v[72:75], v[156:159], a[104:107], v[72:75]
    buffer_load_dwordx4 v[208:211], v8, s[64:67], s4 offen offset:3072 sc1
    v_mfma_f32_16x16x32_bf16 v[76:79], v[176:179], a[104:107], v[76:79]
    v_add_f32_e64 v95, 1.0, v95
    v_mfma_f32_16x16x32_bf16 v[80:83], v[156:159], a[108:111], v[80:83]
    v_rcp_f32_e64 v92, v92
    v_mfma_f32_16x16x32_bf16 v[84:87], v[176:179], a[108:111], v[84:87]
    s_waitcnt vmcnt(24)
    s_nop 0
    v_mfma_f32_16x16x32_bf16 v[56:59], v[196:199], a[112:115], v[56:59]
    v_rcp_f32_e64 v93, v93
    v_mfma_f32_16x16x32_bf16 v[60:63], v[216:219], a[112:115], v[60:63]
    buffer_load_dwordx4 v[152:155], v9, s[64:67], s4 offen offset:0 sc1
    v_mfma_f32_16x16x32_bf16 v[64:67], v[196:199], a[116:119], v[64:67]
    v_rcp_f32_e64 v94, v94
    v_mfma_f32_16x16x32_bf16 v[68:71], v[216:219], a[116:119], v[68:71]
    v_mfma_f32_16x16x32_bf16 v[72:75], v[196:199], a[120:123], v[72:75]
    buffer_load_dwordx4 v[172:175], v9, s[64:67], s4 offen offset:1024 sc1
    v_mfma_f32_16x16x32_bf16 v[76:79], v[216:219], a[120:123], v[76:79]
    v_rcp_f32_e64 v95, v95
    v_mfma_f32_16x16x32_bf16 v[80:83], v[196:199], a[124:127], v[80:83]
    v_mul_f32_e64 v92, v92, v36
    v_mfma_f32_16x16x32_bf16 v[84:87], v[216:219], a[124:127], v[84:87]
    v_mul_f32 v93, v93, v37
    s_waitcnt vmcnt(24)
L_stub_13:
    s_cbranch_execz L_stub_17
    s_nop 0
    v_mfma_f32_16x16x32_bf16 v[56:59], v[160:163], a[128:131], v[56:59]
    v_mul_f32_e64 v94, v94, v38
    v_mfma_f32_16x16x32_bf16 v[60:63], v[180:183], a[128:131], v[60:63]
    buffer_load_dwordx4 v[192:195], v9, s[64:67], s4 offen offset:2048 sc1
    v_mfma_f32_16x16x32_bf16 v[64:67], v[160:163], a[132:135], v[64:67]
    v_mul_f32_e64 v95, v95, v39
    v_cvt_pk_bf16_f32 v92, v92, v93
    v_mfma_f32_16x16x32_bf16 v[68:71], v[180:183], a[132:135], v[68:71]
    v_cvt_pk_bf16_f32 v93, v94, v95
    v_mfma_f32_16x16x32_bf16 v[72:75], v[160:163], a[136:139], v[72:75]
    buffer_load_dwordx4 v[212:215], v9, s[64:67], s4 offen offset:3072 sc1
    v_mfma_f32_16x16x32_bf16 v[76:79], v[180:183], a[136:139], v[76:79]
    ds_write_b64 v18, v[92:93] offset:22528
    v_mul_f32_e64 v88, s89, v40
    v_mfma_f32_16x16x32_bf16 v[80:83], v[160:163], a[140:143], v[80:83]
    v_mfma_f32_16x16x32_bf16 v[84:87], v[180:183], a[140:143], v[84:87]
    v_mul_f32 v89, s89, v41
    s_waitcnt vmcnt(24)
    v_mfma_f32_16x16x32_bf16 v[56:59], v[200:203], a[144:147], v[56:59]
    v_mul_f32_e64 v90, s89, v42
    v_mfma_f32_16x16x32_bf16 v[60:63], v[220:223], a[144:147], v[60:63]
    buffer_load_dwordx4 v[156:159], v10, s[64:67], s4 offen offset:0 sc1
    v_mfma_f32_16x16x32_bf16 v[64:67], v[200:203], a[148:151], v[64:67]
    v_mul_f32_e64 v91, s89, v43
    v_mfma_f32_16x16x32_bf16 v[68:71], v[220:223], a[148:151], v[68:71]
    v_exp_f32_e64 v88, v88
    v_mfma_f32_16x16x32_bf16 v[72:75], v[200:203], a[152:155], v[72:75]
    buffer_load_dwordx4 v[176:179], v10, s[64:67], s4 offen offset:1024 sc1
    v_mfma_f32_16x16x32_bf16 v[76:79], v[220:223], a[152:155], v[76:79]
    v_exp_f32_e64 v89, v89
    v_mfma_f32_16x16x32_bf16 v[80:83], v[200:203], a[156:159], v[80:83]
    v_exp_f32_e64 v90, v90
    v_mfma_f32_16x16x32_bf16 v[84:87], v[220:223], a[156:159], v[84:87]
    s_waitcnt vmcnt(24)
    s_nop 0
    v_mfma_f32_16x16x32_bf16 v[56:59], v[96:99], a[160:163], v[56:59]
    v_exp_f32_e64 v91, v91
    v_mfma_f32_16x16x32_bf16 v[60:63], v[100:103], a[160:163], v[60:63]
    buffer_load_dwordx4 v[196:199], v10, s[64:67], s4 offen offset:2048 sc1
    v_mfma_f32_16x16x32_bf16 v[64:67], v[96:99], a[164:167], v[64:67]
    v_add_f32_e64 v88, 1.0, v88
    v_mfma_f32_16x16x32_bf16 v[68:71], v[100:103], a[164:167], v[68:71]
    v_add_f32_e64 v89, 1.0, v89
    v_mfma_f32_16x16x32_bf16 v[72:75], v[96:99], a[168:171], v[72:75]
    buffer_load_dwordx4 v[216:219], v10, s[64:67], s4 offen offset:3072 sc1
    v_mfma_f32_16x16x32_bf16 v[76:79], v[100:103], a[168:171], v[76:79]
    v_add_f32 v90, 1.0, v90
    v_add_f32 v91, 1.0, v91
    v_mfma_f32_16x16x32_bf16 v[80:83], v[96:99], a[172:175], v[80:83]
    v_mfma_f32_16x16x32_bf16 v[84:87], v[100:103], a[172:175], v[84:87]
    s_waitcnt vmcnt(24)
    s_nop 0
    v_mfma_f32_16x16x32_bf16 v[56:59], v[104:107], a[176:179], v[56:59]
    v_rcp_f32_e64 v88, v88
    v_mfma_f32_16x16x32_bf16 v[60:63], v[108:111], a[176:179], v[60:63]
    buffer_load_dwordx4 v[160:163], v11, s[64:67], s4 offen offset:0 sc1
    v_mfma_f32_16x16x32_bf16 v[64:67], v[104:107], a[180:183], v[64:67]
    v_rcp_f32_e64 v89, v89
    v_mfma_f32_16x16x32_bf16 v[68:71], v[108:111], a[180:183], v[68:71]
    v_rcp_f32_e64 v90, v90
    v_mfma_f32_16x16x32_bf16 v[72:75], v[104:107], a[184:187], v[72:75]
    buffer_load_dwordx4 v[180:183], v11, s[64:67], s4 offen offset:1024 sc1
    v_mfma_f32_16x16x32_bf16 v[76:79], v[108:111], a[184:187], v[76:79]
    v_rcp_f32_e64 v91, v91
    v_mfma_f32_16x16x32_bf16 v[80:83], v[104:107], a[188:191], v[80:83]
    v_mfma_f32_16x16x32_bf16 v[84:87], v[108:111], a[188:191], v[84:87]
    v_mul_f32 v88, v88, v44
    s_waitcnt vmcnt(24)
    v_mfma_f32_16x16x32_bf16 v[56:59], v[112:115], a[192:195], v[56:59]
    v_mul_f32_e64 v89, v89, v45
    v_mfma_f32_16x16x32_bf16 v[60:63], v[116:119], a[192:195], v[60:63]
    buffer_load_dwordx4 v[200:203], v11, s[64:67], s4 offen offset:2048 sc1
    v_mfma_f32_16x16x32_bf16 v[64:67], v[112:115], a[196:199], v[64:67]
    v_mul_f32 v90, v90, v46
    v_mul_f32 v91, v91, v47
    v_mfma_f32_16x16x32_bf16 v[68:71], v[116:119], a[196:199], v[68:71]
    v_cvt_pk_bf16_f32 v88, v88, v89
    v_mfma_f32_16x16x32_bf16 v[72:75], v[112:115], a[200:203], v[72:75]
    buffer_load_dwordx4 v[220:223], v11, s[64:67], s4 offen offset:3072 sc1
    v_mfma_f32_16x16x32_bf16 v[76:79], v[116:119], a[200:203], v[76:79]
    v_cvt_pk_bf16_f32 v89, v90, v91
    ds_write_b64 v18, v[88:89] offset:40960
    v_mfma_f32_16x16x32_bf16 v[80:83], v[112:115], a[204:207], v[80:83]
    v_mul_f32_e64 v92, s89, v48
    v_mfma_f32_16x16x32_bf16 v[84:87], v[116:119], a[204:207], v[84:87]
    s_waitcnt vmcnt(24)
    s_nop 0
    v_mfma_f32_16x16x32_bf16 v[56:59], v[120:123], a[208:211], v[56:59]
    v_mul_f32_e64 v93, s89, v49
    v_mfma_f32_16x16x32_bf16 v[60:63], v[124:127], a[208:211], v[60:63]
    buffer_load_dwordx4 v[96:99], v12, s[64:67], s4 offen offset:0 sc1
    v_mfma_f32_16x16x32_bf16 v[64:67], v[120:123], a[212:215], v[64:67]
    v_mul_f32 v94, s89, v50
    v_mul_f32 v95, s89, v51
    v_mfma_f32_16x16x32_bf16 v[68:71], v[124:127], a[212:215], v[68:71]
    v_exp_f32_e64 v92, v92
    v_mfma_f32_16x16x32_bf16 v[72:75], v[120:123], a[216:219], v[72:75]
    buffer_load_dwordx4 v[100:103], v12, s[64:67], s4 offen offset:1024 sc1
    v_mfma_f32_16x16x32_bf16 v[76:79], v[124:127], a[216:219], v[76:79]
    v_exp_f32_e64 v93, v93
    v_mfma_f32_16x16x32_bf16 v[80:83], v[120:123], a[220:223], v[80:83]
    v_mfma_f32_16x16x32_bf16 v[84:87], v[124:127], a[220:223], v[84:87]
    s_waitcnt vmcnt(24)
    s_nop 0
    v_mfma_f32_16x16x32_bf16 v[56:59], v[128:131], a[224:227], v[56:59]
    v_exp_f32_e64 v94, v94
    v_mfma_f32_16x16x32_bf16 v[60:63], v[132:135], a[224:227], v[60:63]
    buffer_load_dwordx4 v[104:107], v12, s[64:67], s4 offen offset:2048 sc1
    v_mfma_f32_16x16x32_bf16 v[64:67], v[128:131], a[228:231], v[64:67]
    v_exp_f32_e64 v95, v95
    v_mfma_f32_16x16x32_bf16 v[68:71], v[132:135], a[228:231], v[68:71]
    v_add_f32_e64 v92, 1.0, v92
    v_mfma_f32_16x16x32_bf16 v[72:75], v[128:131], a[232:235], v[72:75]
    buffer_load_dwordx4 v[108:111], v12, s[64:67], s4 offen offset:3072 sc1
    v_mfma_f32_16x16x32_bf16 v[76:79], v[132:135], a[232:235], v[76:79]
    v_add_f32 v93, 1.0, v93
    v_add_f32 v94, 1.0, v94
    v_mfma_f32_16x16x32_bf16 v[80:83], v[128:131], a[236:239], v[80:83]
    v_add_f32_e64 v95, 1.0, v95
    v_mfma_f32_16x16x32_bf16 v[84:87], v[132:135], a[236:239], v[84:87]
    s_waitcnt vmcnt(24)
    s_nop 0
    v_mfma_f32_16x16x32_bf16 v[56:59], v[136:139], a[240:243], v[56:59]
    v_rcp_f32_e64 v92, v92
    v_mfma_f32_16x16x32_bf16 v[60:63], v[140:143], a[240:243], v[60:63]
    buffer_load_dwordx4 v[112:115], v13, s[64:67], s4 offen offset:0 sc1
    v_mfma_f32_16x16x32_bf16 v[64:67], v[136:139], a[244:247], v[64:67]
    v_rcp_f32_e64 v93, v93
    v_mfma_f32_16x16x32_bf16 v[68:71], v[140:143], a[244:247], v[68:71]
    v_mfma_f32_16x16x32_bf16 v[72:75], v[136:139], a[248:251], v[72:75]
    buffer_load_dwordx4 v[116:119], v13, s[64:67], s4 offen offset:1024 sc1
    v_mfma_f32_16x16x32_bf16 v[76:79], v[140:143], a[248:251], v[76:79]
    v_rcp_f32_e64 v94, v94
    v_mfma_f32_16x16x32_bf16 v[80:83], v[136:139], a[252:255], v[80:83]
    v_rcp_f32_e64 v95, v95
    v_mfma_f32_16x16x32_bf16 v[84:87], v[140:143], a[252:255], v[84:87]
    s_waitcnt vmcnt(24)
    s_nop 0
    v_mfma_f32_16x16x32_bf16 v[56:59], v[144:147], v[224:227], v[56:59]
    v_mul_f32_e64 v92, v92, v52
    v_mfma_f32_16x16x32_bf16 v[60:63], v[164:167], v[224:227], v[60:63]
    buffer_load_dwordx4 v[120:123], v13, s[64:67], s4 offen offset:2048 sc1
    v_mfma_f32_16x16x32_bf16 v[64:67], v[144:147], v[228:231], v[64:67]
    v_mul_f32 v93, v93, v53
    v_mul_f32 v94, v94, v54
    v_mfma_f32_16x16x32_bf16 v[68:71], v[164:167], v[228:231], v[68:71]
    v_mul_f32_e64 v95, v95, v55
    v_mfma_f32_16x16x32_bf16 v[72:75], v[144:147], v[232:235], v[72:75]
    buffer_load_dwordx4 v[124:127], v13, s[64:67], s4 offen offset:3072 sc1
    v_mfma_f32_16x16x32_bf16 v[76:79], v[164:167], v[232:235], v[76:79]
    v_cvt_pk_bf16_f32 v92, v92, v93
    v_cvt_pk_bf16_f32 v93, v94, v95
    v_mfma_f32_16x16x32_bf16 v[80:83], v[144:147], v[236:239], v[80:83]
    ds_write_b64 v19, v[92:93] offset:4096
    v_mfma_f32_16x16x32_bf16 v[84:87], v[164:167], v[236:239], v[84:87]
    s_waitcnt vmcnt(24)
    s_nop 0
    v_mfma_f32_16x16x32_bf16 v[56:59], v[184:187], v[240:243], v[56:59]
    v_mfma_f32_16x16x32_bf16 v[60:63], v[204:207], v[240:243], v[60:63]
    buffer_load_dwordx4 v[128:131], v14, s[64:67], s4 offen offset:0 sc1
    v_mfma_f32_16x16x32_bf16 v[64:67], v[184:187], v[244:247], v[64:67]
    v_mfma_f32_16x16x32_bf16 v[68:71], v[204:207], v[244:247], v[68:71]
    v_mfma_f32_16x16x32_bf16 v[72:75], v[184:187], v[248:251], v[72:75]
    buffer_load_dwordx4 v[132:135], v14, s[64:67], s4 offen offset:1024 sc1
    v_mfma_f32_16x16x32_bf16 v[76:79], v[204:207], v[248:251], v[76:79]
    v_mfma_f32_16x16x32_bf16 v[80:83], v[184:187], v[252:255], v[80:83]
    v_mfma_f32_16x16x32_bf16 v[84:87], v[204:207], v[252:255], v[84:87]
    s_waitcnt vmcnt(24)
    s_nop 0
    v_mfma_f32_16x16x32_bf16 v[24:27], v[148:151], a[0:3], 0
    v_mfma_f32_16x16x32_bf16 v[28:31], v[168:171], a[0:3], 0
    buffer_load_dwordx4 v[136:139], v14, s[64:67], s4 offen offset:2048 sc1
    v_mfma_f32_16x16x32_bf16 v[32:35], v[148:151], a[4:7], 0
    v_mfma_f32_16x16x32_bf16 v[36:39], v[168:171], a[4:7], 0
    v_mfma_f32_16x16x32_bf16 v[40:43], v[148:151], a[8:11], 0
    buffer_load_dwordx4 v[140:143], v14, s[64:67], s4 offen offset:3072 sc1
    v_mfma_f32_16x16x32_bf16 v[44:47], v[168:171], a[8:11], 0
    v_mul_f32 v88, s89, v56
    v_mul_f32 v89, s89, v57
    v_mfma_f32_16x16x32_bf16 v[48:51], v[148:151], a[12:15], 0
    v_mul_f32_e64 v90, s89, v58
    v_mfma_f32_16x16x32_bf16 v[52:55], v[168:171], a[12:15], 0
    v_mul_f32 v91, s89, v59
    s_waitcnt vmcnt(24)
    v_mfma_f32_16x16x32_bf16 v[24:27], v[188:191], a[16:19], v[24:27]
    v_exp_f32_e64 v88, v88
    v_mfma_f32_16x16x32_bf16 v[28:31], v[208:211], a[16:19], v[28:31]
    buffer_load_dwordx4 v[144:147], v15, s[64:67], s4 offen offset:0 sc1
    v_mfma_f32_16x16x32_bf16 v[32:35], v[188:191], a[20:23], v[32:35]
    v_exp_f32_e64 v89, v89
    v_mfma_f32_16x16x32_bf16 v[36:39], v[208:211], a[20:23], v[36:39]
    v_mfma_f32_16x16x32_bf16 v[40:43], v[188:191], a[24:27], v[40:43]
    buffer_load_dwordx4 v[164:167], v15, s[64:67], s4 offen offset:1024 sc1
    v_mfma_f32_16x16x32_bf16 v[44:47], v[208:211], a[24:27], v[44:47]
    v_exp_f32_e64 v90, v90
    v_mfma_f32_16x16x32_bf16 v[48:51], v[188:191], a[28:31], v[48:51]
    v_exp_f32_e64 v91, v91
    v_mfma_f32_16x16x32_bf16 v[52:55], v[208:211], a[28:31], v[52:55]
    s_waitcnt vmcnt(24)
    s_nop 0
    v_mfma_f32_16x16x32_bf16 v[24:27], v[152:155], a[32:35], v[24:27]
    v_add_f32_e64 v88, 1.0, v88
    v_mfma_f32_16x16x32_bf16 v[28:31], v[172:175], a[32:35], v[28:31]
    buffer_load_dwordx4 v[184:187], v15, s[64:67], s4 offen offset:2048 sc1
    v_mfma_f32_16x16x32_bf16 v[32:35], v[152:155], a[36:39], v[32:35]
    v_add_f32 v89, 1.0, v89
    v_add_f32 v90, 1.0, v90
    v_mfma_f32_16x16x32_bf16 v[36:39], v[172:175], a[36:39], v[36:39]
    v_add_f32_e64 v91, 1.0, v91
    v_mfma_f32_16x16x32_bf16 v[40:43], v[152:155], a[40:43], v[40:43]
    buffer_load_dwordx4 v[204:207], v15, s[64:67], s4 offen offset:3072 sc1
    v_mfma_f32_16x16x32_bf16 v[44:47], v[172:175], a[40:43], v[44:47]
    v_rcp_f32_e64 v88, v88
    v_mfma_f32_16x16x32_bf16 v[48:51], v[152:155], a[44:47], v[48:51]
    v_mfma_f32_16x16x32_bf16 v[52:55], v[172:175], a[44:47], v[52:55]
    s_waitcnt vmcnt(24)
    s_nop 0
    v_mfma_f32_16x16x32_bf16 v[24:27], v[192:195], a[48:51], v[24:27]
    v_rcp_f32_e64 v89, v89
    v_mfma_f32_16x16x32_bf16 v[28:31], v[212:215], a[48:51], v[28:31]
    buffer_load_dwordx4 v[148:151], v16, s[64:67], s4 offen offset:0 sc1
    v_mfma_f32_16x16x32_bf16 v[32:35], v[192:195], a[52:55], v[32:35]
    v_rcp_f32_e64 v90, v90
    v_mfma_f32_16x16x32_bf16 v[36:39], v[212:215], a[52:55], v[36:39]
    v_rcp_f32_e64 v91, v91
    v_mfma_f32_16x16x32_bf16 v[40:43], v[192:195], a[56:59], v[40:43]
    buffer_load_dwordx4 v[168:171], v16, s[64:67], s4 offen offset:1024 sc1
    v_mfma_f32_16x16x32_bf16 v[44:47], v[212:215], a[56:59], v[44:47]
    v_mul_f32_e64 v88, v88, v60
    v_mfma_f32_16x16x32_bf16 v[48:51], v[192:195], a[60:63], v[48:51]
    v_mul_f32_e64 v89, v89, v61
    v_mfma_f32_16x16x32_bf16 v[52:55], v[212:215], a[60:63], v[52:55]
    v_mul_f32 v90, v90, v62
    s_waitcnt vmcnt(24)
    v_mfma_f32_16x16x32_bf16 v[24:27], v[156:159], a[64:67], v[24:27]
    v_mul_f32_e64 v91, v91, v63
    v_mfma_f32_16x16x32_bf16 v[28:31], v[176:179], a[64:67], v[28:31]
    buffer_load_dwordx4 v[188:191], v16, s[64:67], s4 offen offset:2048 sc1
    v_mfma_f32_16x16x32_bf16 v[32:35], v[156:159], a[68:71], v[32:35]
    v_cvt_pk_bf16_f32 v88, v88, v89
    v_cvt_pk_bf16_f32 v89, v90, v91
    v_mfma_f32_16x16x32_bf16 v[36:39], v[176:179], a[68:71], v[36:39]
    ds_write_b64 v18, v[88:89] offset:6144
    v_mfma_f32_16x16x32_bf16 v[40:43], v[156:159], a[72:75], v[40:43]
    buffer_load_dwordx4 v[208:211], v16, s[64:67], s4 offen offset:3072 sc1
    v_mfma_f32_16x16x32_bf16 v[44:47], v[176:179], a[72:75], v[44:47]
    v_mul_f32_e64 v92, s89, v64
    v_mfma_f32_16x16x32_bf16 v[48:51], v[156:159], a[76:79], v[48:51]
    v_mul_f32_e64 v93, s89, v65
    v_mfma_f32_16x16x32_bf16 v[52:55], v[176:179], a[76:79], v[52:55]
    v_mul_f32 v94, s89, v66
    s_waitcnt vmcnt(24)
    v_mfma_f32_16x16x32_bf16 v[24:27], v[196:199], a[80:83], v[24:27]
    v_mul_f32_e64 v95, s89, v67
    v_mfma_f32_16x16x32_bf16 v[28:31], v[216:219], a[80:83], v[28:31]
    s_add_u32 s4, s4, 147456
    buffer_load_dwordx4 v[152:155], v8, s[64:67], s4 offen offset:0 sc1
    v_mfma_f32_16x16x32_bf16 v[32:35], v[196:199], a[84:87], v[32:35]
    v_exp_f32_e64 v92, v92
    v_mfma_f32_16x16x32_bf16 v[36:39], v[216:219], a[84:87], v[36:39]
    v_exp_f32_e64 v93, v93
    v_mfma_f32_16x16x32_bf16 v[40:43], v[196:199], a[88:91], v[40:43]
    buffer_load_dwordx4 v[172:175], v8, s[64:67], s4 offen offset:1024 sc1
    v_mfma_f32_16x16x32_bf16 v[44:47], v[216:219], a[88:91], v[44:47]
    v_exp_f32_e64 v94, v94
    v_mfma_f32_16x16x32_bf16 v[48:51], v[196:199], a[92:95], v[48:51]
    v_mfma_f32_16x16x32_bf16 v[52:55], v[216:219], a[92:95], v[52:55]
    s_waitcnt vmcnt(24)
    s_nop 0
    v_mfma_f32_16x16x32_bf16 v[24:27], v[160:163], a[96:99], v[24:27]
    v_exp_f32_e64 v95, v95
    v_mfma_f32_16x16x32_bf16 v[28:31], v[180:183], a[96:99], v[28:31]
    buffer_load_dwordx4 v[192:195], v8, s[64:67], s4 offen offset:2048 sc1
    v_mfma_f32_16x16x32_bf16 v[32:35], v[160:163], a[100:103], v[32:35]
    v_add_f32 v92, 1.0, v92
    v_add_f32 v93, 1.0, v93
    v_mfma_f32_16x16x32_bf16 v[36:39], v[180:183], a[100:103], v[36:39]
    v_add_f32_e64 v94, 1.0, v94
    v_mfma_f32_16x16x32_bf16 v[40:43], v[160:163], a[104:107], v[40:43]
    buffer_load_dwordx4 v[212:215], v8, s[64:67], s4 offen offset:3072 sc1
    v_mfma_f32_16x16x32_bf16 v[44:47], v[180:183], a[104:107], v[44:47]
    v_add_f32_e64 v95, 1.0, v95
    v_mfma_f32_16x16x32_bf16 v[48:51], v[160:163], a[108:111], v[48:51]
    v_rcp_f32_e64 v92, v92
    v_mfma_f32_16x16x32_bf16 v[52:55], v[180:183], a[108:111], v[52:55]
    s_waitcnt vmcnt(24)
    s_nop 0
    v_mfma_f32_16x16x32_bf16 v[24:27], v[200:203], a[112:115], v[24:27]
    v_rcp_f32_e64 v93, v93
    v_mfma_f32_16x16x32_bf16 v[28:31], v[220:223], a[112:115], v[28:31]
    buffer_load_dwordx4 v[156:159], v9, s[64:67], s4 offen offset:0 sc1
    v_mfma_f32_16x16x32_bf16 v[32:35], v[200:203], a[116:119], v[32:35]
    v_rcp_f32_e64 v94, v94
    v_mfma_f32_16x16x32_bf16 v[36:39], v[220:223], a[116:119], v[36:39]
    v_mfma_f32_16x16x32_bf16 v[40:43], v[200:203], a[120:123], v[40:43]
    buffer_load_dwordx4 v[176:179], v9, s[64:67], s4 offen offset:1024 sc1
    v_mfma_f32_16x16x32_bf16 v[44:47], v[220:223], a[120:123], v[44:47]
    v_rcp_f32_e64 v95, v95
    v_mfma_f32_16x16x32_bf16 v[48:51], v[200:203], a[124:127], v[48:51]
    v_mul_f32_e64 v92, v92, v68
    v_mfma_f32_16x16x32_bf16 v[52:55], v[220:223], a[124:127], v[52:55]
    v_mul_f32 v93, v93, v69
    s_waitcnt vmcnt(24)
    v_mfma_f32_16x16x32_bf16 v[24:27], v[96:99], a[128:131], v[24:27]
    v_mul_f32_e64 v94, v94, v70
    v_mfma_f32_16x16x32_bf16 v[28:31], v[100:103], a[128:131], v[28:31]
    buffer_load_dwordx4 v[196:199], v9, s[64:67], s4 offen offset:2048 sc1
    v_mfma_f32_16x16x32_bf16 v[32:35], v[96:99], a[132:135], v[32:35]
    v_mul_f32_e64 v95, v95, v71
    v_cvt_pk_bf16_f32 v92, v92, v93
    v_mfma_f32_16x16x32_bf16 v[36:39], v[100:103], a[132:135], v[36:39]
    v_cvt_pk_bf16_f32 v93, v94, v95
    v_mfma_f32_16x16x32_bf16 v[40:43], v[96:99], a[136:139], v[40:43]
    buffer_load_dwordx4 v[216:219], v9, s[64:67], s4 offen offset:3072 sc1
    v_mfma_f32_16x16x32_bf16 v[44:47], v[100:103], a[136:139], v[44:47]
    ds_write_b64 v18, v[92:93] offset:24576
    v_mul_f32_e64 v88, s89, v72
    v_mfma_f32_16x16x32_bf16 v[48:51], v[96:99], a[140:143], v[48:51]
    v_mfma_f32_16x16x32_bf16 v[52:55], v[100:103], a[140:143], v[52:55]
    v_mul_f32 v89, s89, v73
    s_waitcnt vmcnt(24)
    v_mfma_f32_16x16x32_bf16 v[24:27], v[104:107], a[144:147], v[24:27]
    v_mul_f32_e64 v90, s89, v74
    v_mfma_f32_16x16x32_bf16 v[28:31], v[108:111], a[144:147], v[28:31]
    buffer_load_dwordx4 v[160:163], v10, s[64:67], s4 offen offset:0 sc1
    v_mfma_f32_16x16x32_bf16 v[32:35], v[104:107], a[148:151], v[32:35]
    v_mul_f32_e64 v91, s89, v75
    v_mfma_f32_16x16x32_bf16 v[36:39], v[108:111], a[148:151], v[36:39]
    v_exp_f32_e64 v88, v88
    v_mfma_f32_16x16x32_bf16 v[40:43], v[104:107], a[152:155], v[40:43]
    buffer_load_dwordx4 v[180:183], v10, s[64:67], s4 offen offset:1024 sc1
    v_mfma_f32_16x16x32_bf16 v[44:47], v[108:111], a[152:155], v[44:47]
    v_exp_f32_e64 v89, v89
    v_mfma_f32_16x16x32_bf16 v[48:51], v[104:107], a[156:159], v[48:51]
    v_exp_f32_e64 v90, v90
    v_mfma_f32_16x16x32_bf16 v[52:55], v[108:111], a[156:159], v[52:55]
    s_waitcnt vmcnt(24)
    s_nop 0
    v_mfma_f32_16x16x32_bf16 v[24:27], v[112:115], a[160:163], v[24:27]
    v_exp_f32_e64 v91, v91
    v_mfma_f32_16x16x32_bf16 v[28:31], v[116:119], a[160:163], v[28:31]
    buffer_load_dwordx4 v[200:203], v10, s[64:67], s4 offen offset:2048 sc1
    v_mfma_f32_16x16x32_bf16 v[32:35], v[112:115], a[164:167], v[32:35]
    v_add_f32_e64 v88, 1.0, v88
    v_mfma_f32_16x16x32_bf16 v[36:39], v[116:119], a[164:167], v[36:39]
    v_add_f32_e64 v89, 1.0, v89
    v_mfma_f32_16x16x32_bf16 v[40:43], v[112:115], a[168:171], v[40:43]
    buffer_load_dwordx4 v[220:223], v10, s[64:67], s4 offen offset:3072 sc1
    v_mfma_f32_16x16x32_bf16 v[44:47], v[116:119], a[168:171], v[44:47]
    v_add_f32 v90, 1.0, v90
    v_add_f32 v91, 1.0, v91
    v_mfma_f32_16x16x32_bf16 v[48:51], v[112:115], a[172:175], v[48:51]
    v_mfma_f32_16x16x32_bf16 v[52:55], v[116:119], a[172:175], v[52:55]
    s_waitcnt vmcnt(24)
    s_nop 0
    v_mfma_f32_16x16x32_bf16 v[24:27], v[120:123], a[176:179], v[24:27]
    v_rcp_f32_e64 v88, v88
    v_mfma_f32_16x16x32_bf16 v[28:31], v[124:127], a[176:179], v[28:31]
    buffer_load_dwordx4 v[96:99], v11, s[64:67], s4 offen offset:0 sc1
    v_mfma_f32_16x16x32_bf16 v[32:35], v[120:123], a[180:183], v[32:35]
    v_rcp_f32_e64 v89, v89
    v_mfma_f32_16x16x32_bf16 v[36:39], v[124:127], a[180:183], v[36:39]
    v_rcp_f32_e64 v90, v90
    v_mfma_f32_16x16x32_bf16 v[40:43], v[120:123], a[184:187], v[40:43]
    buffer_load_dwordx4 v[100:103], v11, s[64:67], s4 offen offset:1024 sc1
    v_mfma_f32_16x16x32_bf16 v[44:47], v[124:127], a[184:187], v[44:47]
    v_rcp_f32_e64 v91, v91
    v_mfma_f32_16x16x32_bf16 v[48:51], v[120:123], a[188:191], v[48:51]
    v_mfma_f32_16x16x32_bf16 v[52:55], v[124:127], a[188:191], v[52:55]
    v_mul_f32 v88, v88, v76
    s_waitcnt vmcnt(24)
    v_mfma_f32_16x16x32_bf16 v[24:27], v[128:131], a[192:195], v[24:27]
    v_mul_f32_e64 v89, v89, v77
    v_mfma_f32_16x16x32_bf16 v[28:31], v[132:135], a[192:195], v[28:31]
    buffer_load_dwordx4 v[104:107], v11, s[64:67], s4 offen offset:2048 sc1
    v_mfma_f32_16x16x32_bf16 v[32:35], v[128:131], a[196:199], v[32:35]
    v_mul_f32 v90, v90, v78
    v_mul_f32 v91, v91, v79
    v_mfma_f32_16x16x32_bf16 v[36:39], v[132:135], a[196:199], v[36:39]
    v_cvt_pk_bf16_f32 v88, v88, v89
    v_mfma_f32_16x16x32_bf16 v[40:43], v[128:131], a[200:203], v[40:43]
    buffer_load_dwordx4 v[108:111], v11, s[64:67], s4 offen offset:3072 sc1
    v_mfma_f32_16x16x32_bf16 v[44:47], v[132:135], a[200:203], v[44:47]
    v_cvt_pk_bf16_f32 v89, v90, v91
    ds_write_b64 v18, v[88:89] offset:43008
    v_mfma_f32_16x16x32_bf16 v[48:51], v[128:131], a[204:207], v[48:51]
    v_mul_f32_e64 v92, s89, v80
    v_mfma_f32_16x16x32_bf16 v[52:55], v[132:135], a[204:207], v[52:55]
    s_waitcnt vmcnt(24)
    s_nop 0
    v_mfma_f32_16x16x32_bf16 v[24:27], v[136:139], a[208:211], v[24:27]
    v_mul_f32_e64 v93, s89, v81
    v_mfma_f32_16x16x32_bf16 v[28:31], v[140:143], a[208:211], v[28:31]
    buffer_load_dwordx4 v[112:115], v12, s[64:67], s4 offen offset:0 sc1
    v_mfma_f32_16x16x32_bf16 v[32:35], v[136:139], a[212:215], v[32:35]
    v_mul_f32 v94, s89, v82
    v_mul_f32 v95, s89, v83
    v_mfma_f32_16x16x32_bf16 v[36:39], v[140:143], a[212:215], v[36:39]
    v_exp_f32_e64 v92, v92
    v_mfma_f32_16x16x32_bf16 v[40:43], v[136:139], a[216:219], v[40:43]
    buffer_load_dwordx4 v[116:119], v12, s[64:67], s4 offen offset:1024 sc1
    v_mfma_f32_16x16x32_bf16 v[44:47], v[140:143], a[216:219], v[44:47]
    v_exp_f32_e64 v93, v93
    v_mfma_f32_16x16x32_bf16 v[48:51], v[136:139], a[220:223], v[48:51]
    v_mfma_f32_16x16x32_bf16 v[52:55], v[140:143], a[220:223], v[52:55]
    s_waitcnt vmcnt(24)
    s_nop 0
    v_mfma_f32_16x16x32_bf16 v[24:27], v[144:147], a[224:227], v[24:27]
    v_exp_f32_e64 v94, v94
    v_mfma_f32_16x16x32_bf16 v[28:31], v[164:167], a[224:227], v[28:31]
    buffer_load_dwordx4 v[120:123], v12, s[64:67], s4 offen offset:2048 sc1
    v_mfma_f32_16x16x32_bf16 v[32:35], v[144:147], a[228:231], v[32:35]
    v_exp_f32_e64 v95, v95
    v_mfma_f32_16x16x32_bf16 v[36:39], v[164:167], a[228:231], v[36:39]
    v_add_f32_e64 v92, 1.0, v92
    v_mfma_f32_16x16x32_bf16 v[40:43], v[144:147], a[232:235], v[40:43]
    buffer_load_dwordx4 v[124:127], v12, s[64:67], s4 offen offset:3072 sc1
    v_mfma_f32_16x16x32_bf16 v[44:47], v[164:167], a[232:235], v[44:47]
    v_add_f32 v93, 1.0, v93
    v_add_f32 v94, 1.0, v94
    v_mfma_f32_16x16x32_bf16 v[48:51], v[144:147], a[236:239], v[48:51]
    v_add_f32_e64 v95, 1.0, v95
    v_mfma_f32_16x16x32_bf16 v[52:55], v[164:167], a[236:239], v[52:55]
    s_waitcnt vmcnt(24)
    s_nop 0
    v_mfma_f32_16x16x32_bf16 v[24:27], v[184:187], a[240:243], v[24:27]
    v_rcp_f32_e64 v92, v92
    v_mfma_f32_16x16x32_bf16 v[28:31], v[204:207], a[240:243], v[28:31]
    buffer_load_dwordx4 v[128:131], v13, s[64:67], s4 offen offset:0 sc1
    v_mfma_f32_16x16x32_bf16 v[32:35], v[184:187], a[244:247], v[32:35]
    v_rcp_f32_e64 v93, v93
    v_mfma_f32_16x16x32_bf16 v[36:39], v[204:207], a[244:247], v[36:39]
    v_mfma_f32_16x16x32_bf16 v[40:43], v[184:187], a[248:251], v[40:43]
    buffer_load_dwordx4 v[132:135], v13, s[64:67], s4 offen offset:1024 sc1
    v_mfma_f32_16x16x32_bf16 v[44:47], v[204:207], a[248:251], v[44:47]
    v_rcp_f32_e64 v94, v94
    v_mfma_f32_16x16x32_bf16 v[48:51], v[184:187], a[252:255], v[48:51]
    v_rcp_f32_e64 v95, v95
    v_mfma_f32_16x16x32_bf16 v[52:55], v[204:207], a[252:255], v[52:55]
    s_waitcnt vmcnt(24)
    s_nop 0
    v_mfma_f32_16x16x32_bf16 v[24:27], v[148:151], v[224:227], v[24:27]
    v_mul_f32_e64 v92, v92, v84
    v_mfma_f32_16x16x32_bf16 v[28:31], v[168:171], v[224:227], v[28:31]
    buffer_load_dwordx4 v[136:139], v13, s[64:67], s4 offen offset:2048 sc1
    v_mfma_f32_16x16x32_bf16 v[32:35], v[148:151], v[228:231], v[32:35]
    v_mul_f32 v93, v93, v85
    v_mul_f32 v94, v94, v86
    v_mfma_f32_16x16x32_bf16 v[36:39], v[168:171], v[228:231], v[36:39]
    v_mul_f32_e64 v95, v95, v87
    v_mfma_f32_16x16x32_bf16 v[40:43], v[148:151], v[232:235], v[40:43]
    buffer_load_dwordx4 v[140:143], v13, s[64:67], s4 offen offset:3072 sc1
    v_mfma_f32_16x16x32_bf16 v[44:47], v[168:171], v[232:235], v[44:47]
    v_cvt_pk_bf16_f32 v92, v92, v93
    v_cvt_pk_bf16_f32 v93, v94, v95
    v_mfma_f32_16x16x32_bf16 v[48:51], v[148:151], v[236:239], v[48:51]
    ds_write_b64 v19, v[92:93] offset:6144
    v_mfma_f32_16x16x32_bf16 v[52:55], v[168:171], v[236:239], v[52:55]
    s_waitcnt vmcnt(24)
    s_nop 0
    v_mfma_f32_16x16x32_bf16 v[24:27], v[188:191], v[240:243], v[24:27]
    v_mfma_f32_16x16x32_bf16 v[28:31], v[208:211], v[240:243], v[28:31]
    buffer_load_dwordx4 v[144:147], v14, s[64:67], s4 offen offset:0 sc1
    v_mfma_f32_16x16x32_bf16 v[32:35], v[188:191], v[244:247], v[32:35]
    v_mfma_f32_16x16x32_bf16 v[36:39], v[208:211], v[244:247], v[36:39]
    v_mfma_f32_16x16x32_bf16 v[40:43], v[188:191], v[248:251], v[40:43]
    buffer_load_dwordx4 v[164:167], v14, s[64:67], s4 offen offset:1024 sc1
    v_mfma_f32_16x16x32_bf16 v[44:47], v[208:211], v[248:251], v[44:47]
    v_mfma_f32_16x16x32_bf16 v[48:51], v[188:191], v[252:255], v[48:51]
    v_mfma_f32_16x16x32_bf16 v[52:55], v[208:211], v[252:255], v[52:55]
    s_waitcnt vmcnt(24)
    s_nop 0
    v_mfma_f32_16x16x32_bf16 v[56:59], v[152:155], a[0:3], 0
    v_mfma_f32_16x16x32_bf16 v[60:63], v[172:175], a[0:3], 0
    buffer_load_dwordx4 v[184:187], v14, s[64:67], s4 offen offset:2048 sc1
    v_mfma_f32_16x16x32_bf16 v[64:67], v[152:155], a[4:7], 0
    v_mfma_f32_16x16x32_bf16 v[68:71], v[172:175], a[4:7], 0
    v_mfma_f32_16x16x32_bf16 v[72:75], v[152:155], a[8:11], 0
    buffer_load_dwordx4 v[204:207], v14, s[64:67], s4 offen offset:3072 sc1
    v_mfma_f32_16x16x32_bf16 v[76:79], v[172:175], a[8:11], 0
    v_mul_f32 v88, s89, v24
    v_mul_f32 v89, s89, v25
    v_mfma_f32_16x16x32_bf16 v[80:83], v[152:155], a[12:15], 0
    v_mul_f32_e64 v90, s89, v26
    v_mfma_f32_16x16x32_bf16 v[84:87], v[172:175], a[12:15], 0
    v_mul_f32 v91, s89, v27
    s_waitcnt vmcnt(24)
    v_mfma_f32_16x16x32_bf16 v[56:59], v[192:195], a[16:19], v[56:59]
    v_exp_f32_e64 v88, v88
    v_mfma_f32_16x16x32_bf16 v[60:63], v[212:215], a[16:19], v[60:63]
    buffer_load_dwordx4 v[148:151], v15, s[64:67], s4 offen offset:0 sc1
    v_mfma_f32_16x16x32_bf16 v[64:67], v[192:195], a[20:23], v[64:67]
    v_exp_f32_e64 v89, v89
    v_mfma_f32_16x16x32_bf16 v[68:71], v[212:215], a[20:23], v[68:71]
    v_mfma_f32_16x16x32_bf16 v[72:75], v[192:195], a[24:27], v[72:75]
    buffer_load_dwordx4 v[168:171], v15, s[64:67], s4 offen offset:1024 sc1
    v_mfma_f32_16x16x32_bf16 v[76:79], v[212:215], a[24:27], v[76:79]
    v_exp_f32_e64 v90, v90
    v_mfma_f32_16x16x32_bf16 v[80:83], v[192:195], a[28:31], v[80:83]
    v_exp_f32_e64 v91, v91
    v_mfma_f32_16x16x32_bf16 v[84:87], v[212:215], a[28:31], v[84:87]
    s_waitcnt vmcnt(24)
    s_nop 0
    v_mfma_f32_16x16x32_bf16 v[56:59], v[156:159], a[32:35], v[56:59]
    v_add_f32_e64 v88, 1.0, v88
    v_mfma_f32_16x16x32_bf16 v[60:63], v[176:179], a[32:35], v[60:63]
    buffer_load_dwordx4 v[188:191], v15, s[64:67], s4 offen offset:2048 sc1
    v_mfma_f32_16x16x32_bf16 v[64:67], v[156:159], a[36:39], v[64:67]
    v_add_f32 v89, 1.0, v89
    v_add_f32 v90, 1.0, v90
    v_mfma_f32_16x16x32_bf16 v[68:71], v[176:179], a[36:39], v[68:71]
    v_add_f32_e64 v91, 1.0, v91
    v_mfma_f32_16x16x32_bf16 v[72:75], v[156:159], a[40:43], v[72:75]
    buffer_load_dwordx4 v[208:211], v15, s[64:67], s4 offen offset:3072 sc1
    v_mfma_f32_16x16x32_bf16 v[76:79], v[176:179], a[40:43], v[76:79]
    v_rcp_f32_e64 v88, v88
    v_mfma_f32_16x16x32_bf16 v[80:83], v[156:159], a[44:47], v[80:83]
    v_mfma_f32_16x16x32_bf16 v[84:87], v[176:179], a[44:47], v[84:87]
    s_waitcnt vmcnt(24)
    s_nop 0
    v_mfma_f32_16x16x32_bf16 v[56:59], v[196:199], a[48:51], v[56:59]
    v_rcp_f32_e64 v89, v89
    v_mfma_f32_16x16x32_bf16 v[60:63], v[216:219], a[48:51], v[60:63]
    buffer_load_dwordx4 v[152:155], v16, s[64:67], s4 offen offset:0 sc1
    v_mfma_f32_16x16x32_bf16 v[64:67], v[196:199], a[52:55], v[64:67]
    v_rcp_f32_e64 v90, v90
    v_mfma_f32_16x16x32_bf16 v[68:71], v[216:219], a[52:55], v[68:71]
    v_rcp_f32_e64 v91, v91
    v_mfma_f32_16x16x32_bf16 v[72:75], v[196:199], a[56:59], v[72:75]
    buffer_load_dwordx4 v[172:175], v16, s[64:67], s4 offen offset:1024 sc1
    v_mfma_f32_16x16x32_bf16 v[76:79], v[216:219], a[56:59], v[76:79]
    v_mul_f32_e64 v88, v88, v28
    v_mfma_f32_16x16x32_bf16 v[80:83], v[196:199], a[60:63], v[80:83]
    v_mul_f32_e64 v89, v89, v29
    v_mfma_f32_16x16x32_bf16 v[84:87], v[216:219], a[60:63], v[84:87]
    v_mul_f32 v90, v90, v30
    s_waitcnt vmcnt(24)
    v_mfma_f32_16x16x32_bf16 v[56:59], v[160:163], a[64:67], v[56:59]
    v_mul_f32_e64 v91, v91, v31
    v_mfma_f32_16x16x32_bf16 v[60:63], v[180:183], a[64:67], v[60:63]
    buffer_load_dwordx4 v[192:195], v16, s[64:67], s4 offen offset:2048 sc1
    v_mfma_f32_16x16x32_bf16 v[64:67], v[160:163], a[68:71], v[64:67]
    v_cvt_pk_bf16_f32 v88, v88, v89
    v_cvt_pk_bf16_f32 v89, v90, v91
    v_mfma_f32_16x16x32_bf16 v[68:71], v[180:183], a[68:71], v[68:71]
    ds_write_b64 v18, v[88:89] offset:8192
    v_mfma_f32_16x16x32_bf16 v[72:75], v[160:163], a[72:75], v[72:75]
    buffer_load_dwordx4 v[212:215], v16, s[64:67], s4 offen offset:3072 sc1
    v_mfma_f32_16x16x32_bf16 v[76:79], v[180:183], a[72:75], v[76:79]
    v_mul_f32_e64 v92, s89, v32
    v_mfma_f32_16x16x32_bf16 v[80:83], v[160:163], a[76:79], v[80:83]
    v_mul_f32_e64 v93, s89, v33
    v_mfma_f32_16x16x32_bf16 v[84:87], v[180:183], a[76:79], v[84:87]
    v_mul_f32 v94, s89, v34
    s_waitcnt vmcnt(24)
    v_mfma_f32_16x16x32_bf16 v[56:59], v[200:203], a[80:83], v[56:59]
    v_mul_f32_e64 v95, s89, v35
    v_mfma_f32_16x16x32_bf16 v[60:63], v[220:223], a[80:83], v[60:63]
    s_add_u32 s4, s4, 147456
L_stub_14:
    s_cbranch_execz L_stub_18
    s_nop 0
    buffer_load_dwordx4 v[156:159], v8, s[64:67], s4 offen offset:0 sc1
    v_mfma_f32_16x16x32_bf16 v[64:67], v[200:203], a[84:87], v[64:67]
    v_exp_f32_e64 v92, v92
    v_mfma_f32_16x16x32_bf16 v[68:71], v[220:223], a[84:87], v[68:71]
    v_exp_f32_e64 v93, v93
    v_mfma_f32_16x16x32_bf16 v[72:75], v[200:203], a[88:91], v[72:75]
    buffer_load_dwordx4 v[176:179], v8, s[64:67], s4 offen offset:1024 sc1
    v_mfma_f32_16x16x32_bf16 v[76:79], v[220:223], a[88:91], v[76:79]
    v_exp_f32_e64 v94, v94
    v_mfma_f32_16x16x32_bf16 v[80:83], v[200:203], a[92:95], v[80:83]
    v_mfma_f32_16x16x32_bf16 v[84:87], v[220:223], a[92:95], v[84:87]
    s_waitcnt vmcnt(24)
    s_nop 0
    v_mfma_f32_16x16x32_bf16 v[56:59], v[96:99], a[96:99], v[56:59]
    v_exp_f32_e64 v95, v95
    v_mfma_f32_16x16x32_bf16 v[60:63], v[100:103], a[96:99], v[60:63]
    buffer_load_dwordx4 v[196:199], v8, s[64:67], s4 offen offset:2048 sc1
    v_mfma_f32_16x16x32_bf16 v[64:67], v[96:99], a[100:103], v[64:67]
    v_add_f32 v92, 1.0, v92
    v_add_f32 v93, 1.0, v93
    v_mfma_f32_16x16x32_bf16 v[68:71], v[100:103], a[100:103], v[68:71]
    v_add_f32_e64 v94, 1.0, v94
    v_mfma_f32_16x16x32_bf16 v[72:75], v[96:99], a[104:107], v[72:75]
    buffer_load_dwordx4 v[216:219], v8, s[64:67], s4 offen offset:3072 sc1
    v_mfma_f32_16x16x32_bf16 v[76:79], v[100:103], a[104:107], v[76:79]
    v_add_f32_e64 v95, 1.0, v95
    v_mfma_f32_16x16x32_bf16 v[80:83], v[96:99], a[108:111], v[80:83]
    v_rcp_f32_e64 v92, v92
    v_mfma_f32_16x16x32_bf16 v[84:87], v[100:103], a[108:111], v[84:87]
    s_waitcnt vmcnt(24)
    s_nop 0
    v_mfma_f32_16x16x32_bf16 v[56:59], v[104:107], a[112:115], v[56:59]
    v_rcp_f32_e64 v93, v93
    v_mfma_f32_16x16x32_bf16 v[60:63], v[108:111], a[112:115], v[60:63]
    buffer_load_dwordx4 v[160:163], v9, s[64:67], s4 offen offset:0 sc1
    v_mfma_f32_16x16x32_bf16 v[64:67], v[104:107], a[116:119], v[64:67]
    v_rcp_f32_e64 v94, v94
    v_mfma_f32_16x16x32_bf16 v[68:71], v[108:111], a[116:119], v[68:71]
    v_mfma_f32_16x16x32_bf16 v[72:75], v[104:107], a[120:123], v[72:75]
    buffer_load_dwordx4 v[180:183], v9, s[64:67], s4 offen offset:1024 sc1
    v_mfma_f32_16x16x32_bf16 v[76:79], v[108:111], a[120:123], v[76:79]
    v_rcp_f32_e64 v95, v95
    v_mfma_f32_16x16x32_bf16 v[80:83], v[104:107], a[124:127], v[80:83]
    v_mul_f32_e64 v92, v92, v36
    v_mfma_f32_16x16x32_bf16 v[84:87], v[108:111], a[124:127], v[84:87]
    v_mul_f32 v93, v93, v37
    s_waitcnt vmcnt(24)
    v_mfma_f32_16x16x32_bf16 v[56:59], v[112:115], a[128:131], v[56:59]
    v_mul_f32_e64 v94, v94, v38
    v_mfma_f32_16x16x32_bf16 v[60:63], v[116:119], a[128:131], v[60:63]
    buffer_load_dwordx4 v[200:203], v9, s[64:67], s4 offen offset:2048 sc1
    v_mfma_f32_16x16x32_bf16 v[64:67], v[112:115], a[132:135], v[64:67]
    v_mul_f32_e64 v95, v95, v39
    v_cvt_pk_bf16_f32 v92, v92, v93
    v_mfma_f32_16x16x32_bf16 v[68:71], v[116:119], a[132:135], v[68:71]
    v_cvt_pk_bf16_f32 v93, v94, v95
    v_mfma_f32_16x16x32_bf16 v[72:75], v[112:115], a[136:139], v[72:75]
    buffer_load_dwordx4 v[220:223], v9, s[64:67], s4 offen offset:3072 sc1
    v_mfma_f32_16x16x32_bf16 v[76:79], v[116:119], a[136:139], v[76:79]
    ds_write_b64 v18, v[92:93] offset:26624
    v_mul_f32_e64 v88, s89, v40
    v_mfma_f32_16x16x32_bf16 v[80:83], v[112:115], a[140:143], v[80:83]
    v_mfma_f32_16x16x32_bf16 v[84:87], v[116:119], a[140:143], v[84:87]
    v_mul_f32 v89, s89, v41
    s_waitcnt vmcnt(24)
    v_mfma_f32_16x16x32_bf16 v[56:59], v[120:123], a[144:147], v[56:59]
    v_mul_f32_e64 v90, s89, v42
    v_mfma_f32_16x16x32_bf16 v[60:63], v[124:127], a[144:147], v[60:63]
    buffer_load_dwordx4 v[96:99], v10, s[64:67], s4 offen offset:0 sc1
    v_mfma_f32_16x16x32_bf16 v[64:67], v[120:123], a[148:151], v[64:67]
    v_mul_f32_e64 v91, s89, v43
    v_mfma_f32_16x16x32_bf16 v[68:71], v[124:127], a[148:151], v[68:71]
    v_exp_f32_e64 v88, v88
    v_mfma_f32_16x16x32_bf16 v[72:75], v[120:123], a[152:155], v[72:75]
    buffer_load_dwordx4 v[100:103], v10, s[64:67], s4 offen offset:1024 sc1
    v_mfma_f32_16x16x32_bf16 v[76:79], v[124:127], a[152:155], v[76:79]
    v_exp_f32_e64 v89, v89
    v_mfma_f32_16x16x32_bf16 v[80:83], v[120:123], a[156:159], v[80:83]
    v_exp_f32_e64 v90, v90
    v_mfma_f32_16x16x32_bf16 v[84:87], v[124:127], a[156:159], v[84:87]
    s_waitcnt vmcnt(24)
    s_nop 0
    v_mfma_f32_16x16x32_bf16 v[56:59], v[128:131], a[160:163], v[56:59]
    v_exp_f32_e64 v91, v91
    v_mfma_f32_16x16x32_bf16 v[60:63], v[132:135], a[160:163], v[60:63]
    buffer_load_dwordx4 v[104:107], v10, s[64:67], s4 offen offset:2048 sc1
    v_mfma_f32_16x16x32_bf16 v[64:67], v[128:131], a[164:167], v[64:67]
    v_add_f32_e64 v88, 1.0, v88
    v_mfma_f32_16x16x32_bf16 v[68:71], v[132:135], a[164:167], v[68:71]
    v_add_f32_e64 v89, 1.0, v89
    v_mfma_f32_16x16x32_bf16 v[72:75], v[128:131], a[168:171], v[72:75]
    buffer_load_dwordx4 v[108:111], v10, s[64:67], s4 offen offset:3072 sc1
    v_mfma_f32_16x16x32_bf16 v[76:79], v[132:135], a[168:171], v[76:79]
    v_add_f32 v90, 1.0, v90
    v_add_f32 v91, 1.0, v91
    v_mfma_f32_16x16x32_bf16 v[80:83], v[128:131], a[172:175], v[80:83]
    v_mfma_f32_16x16x32_bf16 v[84:87], v[132:135], a[172:175], v[84:87]
    s_waitcnt vmcnt(24)
    s_nop 0
    v_mfma_f32_16x16x32_bf16 v[56:59], v[136:139], a[176:179], v[56:59]
    v_rcp_f32_e64 v88, v88
    v_mfma_f32_16x16x32_bf16 v[60:63], v[140:143], a[176:179], v[60:63]
    buffer_load_dwordx4 v[112:115], v11, s[64:67], s4 offen offset:0 sc1
    v_mfma_f32_16x16x32_bf16 v[64:67], v[136:139], a[180:183], v[64:67]
    v_rcp_f32_e64 v89, v89
    v_mfma_f32_16x16x32_bf16 v[68:71], v[140:143], a[180:183], v[68:71]
    v_rcp_f32_e64 v90, v90
    v_mfma_f32_16x16x32_bf16 v[72:75], v[136:139], a[184:187], v[72:75]
    buffer_load_dwordx4 v[116:119], v11, s[64:67], s4 offen offset:1024 sc1
    v_mfma_f32_16x16x32_bf16 v[76:79], v[140:143], a[184:187], v[76:79]
    v_rcp_f32_e64 v91, v91
    v_mfma_f32_16x16x32_bf16 v[80:83], v[136:139], a[188:191], v[80:83]
    v_mfma_f32_16x16x32_bf16 v[84:87], v[140:143], a[188:191], v[84:87]
    v_mul_f32 v88, v88, v44
    s_waitcnt vmcnt(24)
    v_mfma_f32_16x16x32_bf16 v[56:59], v[144:147], a[192:195], v[56:59]
    v_mul_f32_e64 v89, v89, v45
    v_mfma_f32_16x16x32_bf16 v[60:63], v[164:167], a[192:195], v[60:63]
    buffer_load_dwordx4 v[120:123], v11, s[64:67], s4 offen offset:2048 sc1
    v_mfma_f32_16x16x32_bf16 v[64:67], v[144:147], a[196:199], v[64:67]
    v_mul_f32 v90, v90, v46
    v_mul_f32 v91, v91, v47
    v_mfma_f32_16x16x32_bf16 v[68:71], v[164:167], a[196:199], v[68:71]
    v_cvt_pk_bf16_f32 v88, v88, v89
    v_mfma_f32_16x16x32_bf16 v[72:75], v[144:147], a[200:203], v[72:75]
    buffer_load_dwordx4 v[124:127], v11, s[64:67], s4 offen offset:3072 sc1
    v_mfma_f32_16x16x32_bf16 v[76:79], v[164:167], a[200:203], v[76:79]
    v_cvt_pk_bf16_f32 v89, v90, v91
    ds_write_b64 v18, v[88:89] offset:45056
    v_mfma_f32_16x16x32_bf16 v[80:83], v[144:147], a[204:207], v[80:83]
    v_mul_f32_e64 v92, s89, v48
    v_mfma_f32_16x16x32_bf16 v[84:87], v[164:167], a[204:207], v[84:87]
    s_waitcnt vmcnt(24)
    s_nop 0
    v_mfma_f32_16x16x32_bf16 v[56:59], v[184:187], a[208:211], v[56:59]
    v_mul_f32_e64 v93, s89, v49
    v_mfma_f32_16x16x32_bf16 v[60:63], v[204:207], a[208:211], v[60:63]
    buffer_load_dwordx4 v[128:131], v12, s[64:67], s4 offen offset:0 sc1
    v_mfma_f32_16x16x32_bf16 v[64:67], v[184:187], a[212:215], v[64:67]
    v_mul_f32 v94, s89, v50
    v_mul_f32 v95, s89, v51
    v_mfma_f32_16x16x32_bf16 v[68:71], v[204:207], a[212:215], v[68:71]
    v_exp_f32_e64 v92, v92
    v_mfma_f32_16x16x32_bf16 v[72:75], v[184:187], a[216:219], v[72:75]
    buffer_load_dwordx4 v[132:135], v12, s[64:67], s4 offen offset:1024 sc1
    v_mfma_f32_16x16x32_bf16 v[76:79], v[204:207], a[216:219], v[76:79]
    v_exp_f32_e64 v93, v93
    v_mfma_f32_16x16x32_bf16 v[80:83], v[184:187], a[220:223], v[80:83]
    v_mfma_f32_16x16x32_bf16 v[84:87], v[204:207], a[220:223], v[84:87]
    s_waitcnt vmcnt(24)
    s_nop 0
    v_mfma_f32_16x16x32_bf16 v[56:59], v[148:151], a[224:227], v[56:59]
    v_exp_f32_e64 v94, v94
    v_mfma_f32_16x16x32_bf16 v[60:63], v[168:171], a[224:227], v[60:63]
    buffer_load_dwordx4 v[136:139], v12, s[64:67], s4 offen offset:2048 sc1
    v_mfma_f32_16x16x32_bf16 v[64:67], v[148:151], a[228:231], v[64:67]
    v_exp_f32_e64 v95, v95
    v_mfma_f32_16x16x32_bf16 v[68:71], v[168:171], a[228:231], v[68:71]
    v_add_f32_e64 v92, 1.0, v92
    v_mfma_f32_16x16x32_bf16 v[72:75], v[148:151], a[232:235], v[72:75]
    buffer_load_dwordx4 v[140:143], v12, s[64:67], s4 offen offset:3072 sc1
    v_mfma_f32_16x16x32_bf16 v[76:79], v[168:171], a[232:235], v[76:79]
    v_add_f32 v93, 1.0, v93
    v_add_f32 v94, 1.0, v94
    v_mfma_f32_16x16x32_bf16 v[80:83], v[148:151], a[236:239], v[80:83]
    v_add_f32_e64 v95, 1.0, v95
    v_mfma_f32_16x16x32_bf16 v[84:87], v[168:171], a[236:239], v[84:87]
    s_waitcnt vmcnt(24)
    s_nop 0
    v_mfma_f32_16x16x32_bf16 v[56:59], v[188:191], a[240:243], v[56:59]
    v_rcp_f32_e64 v92, v92
    v_mfma_f32_16x16x32_bf16 v[60:63], v[208:211], a[240:243], v[60:63]
    buffer_load_dwordx4 v[144:147], v13, s[64:67], s4 offen offset:0 sc1
    v_mfma_f32_16x16x32_bf16 v[64:67], v[188:191], a[244:247], v[64:67]
    v_rcp_f32_e64 v93, v93
    v_mfma_f32_16x16x32_bf16 v[68:71], v[208:211], a[244:247], v[68:71]
    v_mfma_f32_16x16x32_bf16 v[72:75], v[188:191], a[248:251], v[72:75]
    buffer_load_dwordx4 v[164:167], v13, s[64:67], s4 offen offset:1024 sc1
    v_mfma_f32_16x16x32_bf16 v[76:79], v[208:211], a[248:251], v[76:79]
    v_rcp_f32_e64 v94, v94
    v_mfma_f32_16x16x32_bf16 v[80:83], v[188:191], a[252:255], v[80:83]
    v_rcp_f32_e64 v95, v95
    v_mfma_f32_16x16x32_bf16 v[84:87], v[208:211], a[252:255], v[84:87]
    s_waitcnt vmcnt(24)
    s_nop 0
    v_mfma_f32_16x16x32_bf16 v[56:59], v[152:155], v[224:227], v[56:59]
    v_mul_f32_e64 v92, v92, v52
    v_mfma_f32_16x16x32_bf16 v[60:63], v[172:175], v[224:227], v[60:63]
    buffer_load_dwordx4 v[184:187], v13, s[64:67], s4 offen offset:2048 sc1
    v_mfma_f32_16x16x32_bf16 v[64:67], v[152:155], v[228:231], v[64:67]
    v_mul_f32 v93, v93, v53
    v_mul_f32 v94, v94, v54
    v_mfma_f32_16x16x32_bf16 v[68:71], v[172:175], v[228:231], v[68:71]
    v_mul_f32_e64 v95, v95, v55
    v_mfma_f32_16x16x32_bf16 v[72:75], v[152:155], v[232:235], v[72:75]
    buffer_load_dwordx4 v[204:207], v13, s[64:67], s4 offen offset:3072 sc1
    v_mfma_f32_16x16x32_bf16 v[76:79], v[172:175], v[232:235], v[76:79]
    v_cvt_pk_bf16_f32 v92, v92, v93
    v_cvt_pk_bf16_f32 v93, v94, v95
    v_mfma_f32_16x16x32_bf16 v[80:83], v[152:155], v[236:239], v[80:83]
    ds_write_b64 v19, v[92:93] offset:8192
    v_mfma_f32_16x16x32_bf16 v[84:87], v[172:175], v[236:239], v[84:87]
    s_waitcnt vmcnt(24)
    s_nop 0
    v_mfma_f32_16x16x32_bf16 v[56:59], v[192:195], v[240:243], v[56:59]
    v_mfma_f32_16x16x32_bf16 v[60:63], v[212:215], v[240:243], v[60:63]
    buffer_load_dwordx4 v[148:151], v14, s[64:67], s4 offen offset:0 sc1
    v_mfma_f32_16x16x32_bf16 v[64:67], v[192:195], v[244:247], v[64:67]
    v_mfma_f32_16x16x32_bf16 v[68:71], v[212:215], v[244:247], v[68:71]
    v_mfma_f32_16x16x32_bf16 v[72:75], v[192:195], v[248:251], v[72:75]
    buffer_load_dwordx4 v[168:171], v14, s[64:67], s4 offen offset:1024 sc1
    v_mfma_f32_16x16x32_bf16 v[76:79], v[212:215], v[248:251], v[76:79]
    v_mfma_f32_16x16x32_bf16 v[80:83], v[192:195], v[252:255], v[80:83]
    v_mfma_f32_16x16x32_bf16 v[84:87], v[212:215], v[252:255], v[84:87]
    s_waitcnt vmcnt(24)
    s_nop 0
    v_mfma_f32_16x16x32_bf16 v[24:27], v[156:159], a[0:3], 0
    v_mfma_f32_16x16x32_bf16 v[28:31], v[176:179], a[0:3], 0
    buffer_load_dwordx4 v[188:191], v14, s[64:67], s4 offen offset:2048 sc1
    v_mfma_f32_16x16x32_bf16 v[32:35], v[156:159], a[4:7], 0
    v_mfma_f32_16x16x32_bf16 v[36:39], v[176:179], a[4:7], 0
    v_mfma_f32_16x16x32_bf16 v[40:43], v[156:159], a[8:11], 0
    buffer_load_dwordx4 v[208:211], v14, s[64:67], s4 offen offset:3072 sc1
    v_mfma_f32_16x16x32_bf16 v[44:47], v[176:179], a[8:11], 0
    v_mul_f32 v88, s89, v56
    v_mul_f32 v89, s89, v57
    v_mfma_f32_16x16x32_bf16 v[48:51], v[156:159], a[12:15], 0
    v_mul_f32_e64 v90, s89, v58
    v_mfma_f32_16x16x32_bf16 v[52:55], v[176:179], a[12:15], 0
    v_mul_f32 v91, s89, v59
    s_waitcnt vmcnt(24)
    v_mfma_f32_16x16x32_bf16 v[24:27], v[196:199], a[16:19], v[24:27]
    v_exp_f32_e64 v88, v88
    v_mfma_f32_16x16x32_bf16 v[28:31], v[216:219], a[16:19], v[28:31]
    buffer_load_dwordx4 v[152:155], v15, s[64:67], s4 offen offset:0 sc1
    v_mfma_f32_16x16x32_bf16 v[32:35], v[196:199], a[20:23], v[32:35]
    v_exp_f32_e64 v89, v89
    v_mfma_f32_16x16x32_bf16 v[36:39], v[216:219], a[20:23], v[36:39]
    v_mfma_f32_16x16x32_bf16 v[40:43], v[196:199], a[24:27], v[40:43]
    buffer_load_dwordx4 v[172:175], v15, s[64:67], s4 offen offset:1024 sc1
    v_mfma_f32_16x16x32_bf16 v[44:47], v[216:219], a[24:27], v[44:47]
    v_exp_f32_e64 v90, v90
    v_mfma_f32_16x16x32_bf16 v[48:51], v[196:199], a[28:31], v[48:51]
    v_exp_f32_e64 v91, v91
    v_mfma_f32_16x16x32_bf16 v[52:55], v[216:219], a[28:31], v[52:55]
    s_waitcnt vmcnt(24)
    s_nop 0
    v_mfma_f32_16x16x32_bf16 v[24:27], v[160:163], a[32:35], v[24:27]
    v_add_f32_e64 v88, 1.0, v88
    v_mfma_f32_16x16x32_bf16 v[28:31], v[180:183], a[32:35], v[28:31]
    buffer_load_dwordx4 v[192:195], v15, s[64:67], s4 offen offset:2048 sc1
    v_mfma_f32_16x16x32_bf16 v[32:35], v[160:163], a[36:39], v[32:35]
    v_add_f32 v89, 1.0, v89
    v_add_f32 v90, 1.0, v90
    v_mfma_f32_16x16x32_bf16 v[36:39], v[180:183], a[36:39], v[36:39]
    v_add_f32_e64 v91, 1.0, v91
    v_mfma_f32_16x16x32_bf16 v[40:43], v[160:163], a[40:43], v[40:43]
    buffer_load_dwordx4 v[212:215], v15, s[64:67], s4 offen offset:3072 sc1
    v_mfma_f32_16x16x32_bf16 v[44:47], v[180:183], a[40:43], v[44:47]
    v_rcp_f32_e64 v88, v88
    v_mfma_f32_16x16x32_bf16 v[48:51], v[160:163], a[44:47], v[48:51]
    v_mfma_f32_16x16x32_bf16 v[52:55], v[180:183], a[44:47], v[52:55]
    s_waitcnt vmcnt(24)
    s_nop 0
    v_mfma_f32_16x16x32_bf16 v[24:27], v[200:203], a[48:51], v[24:27]
    v_rcp_f32_e64 v89, v89
    v_mfma_f32_16x16x32_bf16 v[28:31], v[220:223], a[48:51], v[28:31]
    buffer_load_dwordx4 v[156:159], v16, s[64:67], s4 offen offset:0 sc1
    v_mfma_f32_16x16x32_bf16 v[32:35], v[200:203], a[52:55], v[32:35]
    v_rcp_f32_e64 v90, v90
    v_mfma_f32_16x16x32_bf16 v[36:39], v[220:223], a[52:55], v[36:39]
    v_rcp_f32_e64 v91, v91
    v_mfma_f32_16x16x32_bf16 v[40:43], v[200:203], a[56:59], v[40:43]
    buffer_load_dwordx4 v[176:179], v16, s[64:67], s4 offen offset:1024 sc1
    v_mfma_f32_16x16x32_bf16 v[44:47], v[220:223], a[56:59], v[44:47]
    v_mul_f32_e64 v88, v88, v60
    v_mfma_f32_16x16x32_bf16 v[48:51], v[200:203], a[60:63], v[48:51]
    v_mul_f32_e64 v89, v89, v61
    v_mfma_f32_16x16x32_bf16 v[52:55], v[220:223], a[60:63], v[52:55]
    v_mul_f32 v90, v90, v62
    s_waitcnt vmcnt(24)
    v_mfma_f32_16x16x32_bf16 v[24:27], v[96:99], a[64:67], v[24:27]
    v_mul_f32_e64 v91, v91, v63
    v_mfma_f32_16x16x32_bf16 v[28:31], v[100:103], a[64:67], v[28:31]
    buffer_load_dwordx4 v[196:199], v16, s[64:67], s4 offen offset:2048 sc1
    v_mfma_f32_16x16x32_bf16 v[32:35], v[96:99], a[68:71], v[32:35]
    v_cvt_pk_bf16_f32 v88, v88, v89
    v_cvt_pk_bf16_f32 v89, v90, v91
    v_mfma_f32_16x16x32_bf16 v[36:39], v[100:103], a[68:71], v[36:39]
    ds_write_b64 v18, v[88:89] offset:10240
    v_mfma_f32_16x16x32_bf16 v[40:43], v[96:99], a[72:75], v[40:43]
    buffer_load_dwordx4 v[216:219], v16, s[64:67], s4 offen offset:3072 sc1
    v_mfma_f32_16x16x32_bf16 v[44:47], v[100:103], a[72:75], v[44:47]
    v_mul_f32_e64 v92, s89, v64
    v_mfma_f32_16x16x32_bf16 v[48:51], v[96:99], a[76:79], v[48:51]
    v_mul_f32_e64 v93, s89, v65
    v_mfma_f32_16x16x32_bf16 v[52:55], v[100:103], a[76:79], v[52:55]
    v_mul_f32 v94, s89, v66
    s_waitcnt vmcnt(24)
    v_mfma_f32_16x16x32_bf16 v[24:27], v[104:107], a[80:83], v[24:27]
    v_mul_f32_e64 v95, s89, v67
    v_mfma_f32_16x16x32_bf16 v[28:31], v[108:111], a[80:83], v[28:31]
    s_add_u32 s4, s4, 147456
    buffer_load_dwordx4 v[160:163], v8, s[64:67], s4 offen offset:0 sc1
    v_mfma_f32_16x16x32_bf16 v[32:35], v[104:107], a[84:87], v[32:35]
    v_exp_f32_e64 v92, v92
    v_mfma_f32_16x16x32_bf16 v[36:39], v[108:111], a[84:87], v[36:39]
    v_exp_f32_e64 v93, v93
    v_mfma_f32_16x16x32_bf16 v[40:43], v[104:107], a[88:91], v[40:43]
    buffer_load_dwordx4 v[180:183], v8, s[64:67], s4 offen offset:1024 sc1
    v_mfma_f32_16x16x32_bf16 v[44:47], v[108:111], a[88:91], v[44:47]
    v_exp_f32_e64 v94, v94
    v_mfma_f32_16x16x32_bf16 v[48:51], v[104:107], a[92:95], v[48:51]
    v_mfma_f32_16x16x32_bf16 v[52:55], v[108:111], a[92:95], v[52:55]
    s_waitcnt vmcnt(24)
    s_nop 0
    v_mfma_f32_16x16x32_bf16 v[24:27], v[112:115], a[96:99], v[24:27]
    v_exp_f32_e64 v95, v95
    v_mfma_f32_16x16x32_bf16 v[28:31], v[116:119], a[96:99], v[28:31]
    buffer_load_dwordx4 v[200:203], v8, s[64:67], s4 offen offset:2048 sc1
    v_mfma_f32_16x16x32_bf16 v[32:35], v[112:115], a[100:103], v[32:35]
    v_add_f32 v92, 1.0, v92
    v_add_f32 v93, 1.0, v93
    v_mfma_f32_16x16x32_bf16 v[36:39], v[116:119], a[100:103], v[36:39]
    v_add_f32_e64 v94, 1.0, v94
    v_mfma_f32_16x16x32_bf16 v[40:43], v[112:115], a[104:107], v[40:43]
    buffer_load_dwordx4 v[220:223], v8, s[64:67], s4 offen offset:3072 sc1
    v_mfma_f32_16x16x32_bf16 v[44:47], v[116:119], a[104:107], v[44:47]
    v_add_f32_e64 v95, 1.0, v95
    v_mfma_f32_16x16x32_bf16 v[48:51], v[112:115], a[108:111], v[48:51]
    v_rcp_f32_e64 v92, v92
    v_mfma_f32_16x16x32_bf16 v[52:55], v[116:119], a[108:111], v[52:55]
    s_waitcnt vmcnt(24)
    s_nop 0
    v_mfma_f32_16x16x32_bf16 v[24:27], v[120:123], a[112:115], v[24:27]
    v_rcp_f32_e64 v93, v93
    v_mfma_f32_16x16x32_bf16 v[28:31], v[124:127], a[112:115], v[28:31]
    buffer_load_dwordx4 v[96:99], v9, s[64:67], s4 offen offset:0 sc1
    v_mfma_f32_16x16x32_bf16 v[32:35], v[120:123], a[116:119], v[32:35]
    v_rcp_f32_e64 v94, v94
    v_mfma_f32_16x16x32_bf16 v[36:39], v[124:127], a[116:119], v[36:39]
    v_mfma_f32_16x16x32_bf16 v[40:43], v[120:123], a[120:123], v[40:43]
    buffer_load_dwordx4 v[100:103], v9, s[64:67], s4 offen offset:1024 sc1
    v_mfma_f32_16x16x32_bf16 v[44:47], v[124:127], a[120:123], v[44:47]
    v_rcp_f32_e64 v95, v95
    v_mfma_f32_16x16x32_bf16 v[48:51], v[120:123], a[124:127], v[48:51]
    v_mul_f32_e64 v92, v92, v68
    v_mfma_f32_16x16x32_bf16 v[52:55], v[124:127], a[124:127], v[52:55]
    v_mul_f32 v93, v93, v69
    s_waitcnt vmcnt(24)
    v_mfma_f32_16x16x32_bf16 v[24:27], v[128:131], a[128:131], v[24:27]
    v_mul_f32_e64 v94, v94, v70
    v_mfma_f32_16x16x32_bf16 v[28:31], v[132:135], a[128:131], v[28:31]
    buffer_load_dwordx4 v[104:107], v9, s[64:67], s4 offen offset:2048 sc1
    v_mfma_f32_16x16x32_bf16 v[32:35], v[128:131], a[132:135], v[32:35]
    v_mul_f32_e64 v95, v95, v71
    v_cvt_pk_bf16_f32 v92, v92, v93
    v_mfma_f32_16x16x32_bf16 v[36:39], v[132:135], a[132:135], v[36:39]
    v_cvt_pk_bf16_f32 v93, v94, v95
    v_mfma_f32_16x16x32_bf16 v[40:43], v[128:131], a[136:139], v[40:43]
    buffer_load_dwordx4 v[108:111], v9, s[64:67], s4 offen offset:3072 sc1
    v_mfma_f32_16x16x32_bf16 v[44:47], v[132:135], a[136:139], v[44:47]
    ds_write_b64 v18, v[92:93] offset:28672
    v_mul_f32_e64 v88, s89, v72
    v_mfma_f32_16x16x32_bf16 v[48:51], v[128:131], a[140:143], v[48:51]
    v_mfma_f32_16x16x32_bf16 v[52:55], v[132:135], a[140:143], v[52:55]
    v_mul_f32 v89, s89, v73
    s_waitcnt vmcnt(24)
    v_mfma_f32_16x16x32_bf16 v[24:27], v[136:139], a[144:147], v[24:27]
    v_mul_f32_e64 v90, s89, v74
    v_mfma_f32_16x16x32_bf16 v[28:31], v[140:143], a[144:147], v[28:31]
    buffer_load_dwordx4 v[112:115], v10, s[64:67], s4 offen offset:0 sc1
    v_mfma_f32_16x16x32_bf16 v[32:35], v[136:139], a[148:151], v[32:35]
    v_mul_f32_e64 v91, s89, v75
    v_mfma_f32_16x16x32_bf16 v[36:39], v[140:143], a[148:151], v[36:39]
    v_exp_f32_e64 v88, v88
    v_mfma_f32_16x16x32_bf16 v[40:43], v[136:139], a[152:155], v[40:43]
    buffer_load_dwordx4 v[116:119], v10, s[64:67], s4 offen offset:1024 sc1
    v_mfma_f32_16x16x32_bf16 v[44:47], v[140:143], a[152:155], v[44:47]
    v_exp_f32_e64 v89, v89
    v_mfma_f32_16x16x32_bf16 v[48:51], v[136:139], a[156:159], v[48:51]
    v_exp_f32_e64 v90, v90
    v_mfma_f32_16x16x32_bf16 v[52:55], v[140:143], a[156:159], v[52:55]
    s_waitcnt vmcnt(24)
    s_nop 0
    v_mfma_f32_16x16x32_bf16 v[24:27], v[144:147], a[160:163], v[24:27]
    v_exp_f32_e64 v91, v91
    v_mfma_f32_16x16x32_bf16 v[28:31], v[164:167], a[160:163], v[28:31]
    buffer_load_dwordx4 v[120:123], v10, s[64:67], s4 offen offset:2048 sc1
    v_mfma_f32_16x16x32_bf16 v[32:35], v[144:147], a[164:167], v[32:35]
    v_add_f32_e64 v88, 1.0, v88
    v_mfma_f32_16x16x32_bf16 v[36:39], v[164:167], a[164:167], v[36:39]
    v_add_f32_e64 v89, 1.0, v89
    v_mfma_f32_16x16x32_bf16 v[40:43], v[144:147], a[168:171], v[40:43]
    buffer_load_dwordx4 v[124:127], v10, s[64:67], s4 offen offset:3072 sc1
    v_mfma_f32_16x16x32_bf16 v[44:47], v[164:167], a[168:171], v[44:47]
    v_add_f32 v90, 1.0, v90
    v_add_f32 v91, 1.0, v91
    v_mfma_f32_16x16x32_bf16 v[48:51], v[144:147], a[172:175], v[48:51]
    v_mfma_f32_16x16x32_bf16 v[52:55], v[164:167], a[172:175], v[52:55]
    s_waitcnt vmcnt(24)
    s_nop 0
    v_mfma_f32_16x16x32_bf16 v[24:27], v[184:187], a[176:179], v[24:27]
    v_rcp_f32_e64 v88, v88
    v_mfma_f32_16x16x32_bf16 v[28:31], v[204:207], a[176:179], v[28:31]
    buffer_load_dwordx4 v[128:131], v11, s[64:67], s4 offen offset:0 sc1
    v_mfma_f32_16x16x32_bf16 v[32:35], v[184:187], a[180:183], v[32:35]
    v_rcp_f32_e64 v89, v89
    v_mfma_f32_16x16x32_bf16 v[36:39], v[204:207], a[180:183], v[36:39]
    v_rcp_f32_e64 v90, v90
    v_mfma_f32_16x16x32_bf16 v[40:43], v[184:187], a[184:187], v[40:43]
    buffer_load_dwordx4 v[132:135], v11, s[64:67], s4 offen offset:1024 sc1
    v_mfma_f32_16x16x32_bf16 v[44:47], v[204:207], a[184:187], v[44:47]
    v_rcp_f32_e64 v91, v91
    v_mfma_f32_16x16x32_bf16 v[48:51], v[184:187], a[188:191], v[48:51]
    v_mfma_f32_16x16x32_bf16 v[52:55], v[204:207], a[188:191], v[52:55]
    v_mul_f32 v88, v88, v76
    s_waitcnt vmcnt(24)
    v_mfma_f32_16x16x32_bf16 v[24:27], v[148:151], a[192:195], v[24:27]
    v_mul_f32_e64 v89, v89, v77
    v_mfma_f32_16x16x32_bf16 v[28:31], v[168:171], a[192:195], v[28:31]
    buffer_load_dwordx4 v[136:139], v11, s[64:67], s4 offen offset:2048 sc1
    v_mfma_f32_16x16x32_bf16 v[32:35], v[148:151], a[196:199], v[32:35]
    v_mul_f32 v90, v90, v78
    v_mul_f32 v91, v91, v79
    v_mfma_f32_16x16x32_bf16 v[36:39], v[168:171], a[196:199], v[36:39]
    v_cvt_pk_bf16_f32 v88, v88, v89
    v_mfma_f32_16x16x32_bf16 v[40:43], v[148:151], a[200:203], v[40:43]
    buffer_load_dwordx4 v[140:143], v11, s[64:67], s4 offen offset:3072 sc1
    v_mfma_f32_16x16x32_bf16 v[44:47], v[168:171], a[200:203], v[44:47]
    v_cvt_pk_bf16_f32 v89, v90, v91
    ds_write_b64 v18, v[88:89] offset:47104
    v_mfma_f32_16x16x32_bf16 v[48:51], v[148:151], a[204:207], v[48:51]
    v_mul_f32_e64 v92, s89, v80
    v_mfma_f32_16x16x32_bf16 v[52:55], v[168:171], a[204:207], v[52:55]
    s_waitcnt vmcnt(24)
    s_nop 0
    v_mfma_f32_16x16x32_bf16 v[24:27], v[188:191], a[208:211], v[24:27]
    v_mul_f32_e64 v93, s89, v81
    v_mfma_f32_16x16x32_bf16 v[28:31], v[208:211], a[208:211], v[28:31]
    buffer_load_dwordx4 v[144:147], v12, s[64:67], s4 offen offset:0 sc1
    v_mfma_f32_16x16x32_bf16 v[32:35], v[188:191], a[212:215], v[32:35]
    v_mul_f32 v94, s89, v82
    v_mul_f32 v95, s89, v83
    v_mfma_f32_16x16x32_bf16 v[36:39], v[208:211], a[212:215], v[36:39]
    v_exp_f32_e64 v92, v92
    v_mfma_f32_16x16x32_bf16 v[40:43], v[188:191], a[216:219], v[40:43]
    buffer_load_dwordx4 v[164:167], v12, s[64:67], s4 offen offset:1024 sc1
    v_mfma_f32_16x16x32_bf16 v[44:47], v[208:211], a[216:219], v[44:47]
    v_exp_f32_e64 v93, v93
    v_mfma_f32_16x16x32_bf16 v[48:51], v[188:191], a[220:223], v[48:51]
    v_mfma_f32_16x16x32_bf16 v[52:55], v[208:211], a[220:223], v[52:55]
    s_waitcnt vmcnt(24)
    s_nop 0
    v_mfma_f32_16x16x32_bf16 v[24:27], v[152:155], a[224:227], v[24:27]
    v_exp_f32_e64 v94, v94
    v_mfma_f32_16x16x32_bf16 v[28:31], v[172:175], a[224:227], v[28:31]
    buffer_load_dwordx4 v[184:187], v12, s[64:67], s4 offen offset:2048 sc1
    v_mfma_f32_16x16x32_bf16 v[32:35], v[152:155], a[228:231], v[32:35]
    v_exp_f32_e64 v95, v95
    v_mfma_f32_16x16x32_bf16 v[36:39], v[172:175], a[228:231], v[36:39]
    v_add_f32_e64 v92, 1.0, v92
    v_mfma_f32_16x16x32_bf16 v[40:43], v[152:155], a[232:235], v[40:43]
    buffer_load_dwordx4 v[204:207], v12, s[64:67], s4 offen offset:3072 sc1
    v_mfma_f32_16x16x32_bf16 v[44:47], v[172:175], a[232:235], v[44:47]
    v_add_f32 v93, 1.0, v93
    v_add_f32 v94, 1.0, v94
    v_mfma_f32_16x16x32_bf16 v[48:51], v[152:155], a[236:239], v[48:51]
    v_add_f32_e64 v95, 1.0, v95
    v_mfma_f32_16x16x32_bf16 v[52:55], v[172:175], a[236:239], v[52:55]
    s_waitcnt vmcnt(24)
    s_nop 0
    v_mfma_f32_16x16x32_bf16 v[24:27], v[192:195], a[240:243], v[24:27]
    v_rcp_f32_e64 v92, v92
    v_mfma_f32_16x16x32_bf16 v[28:31], v[212:215], a[240:243], v[28:31]
    buffer_load_dwordx4 v[148:151], v13, s[64:67], s4 offen offset:0 sc1
    v_mfma_f32_16x16x32_bf16 v[32:35], v[192:195], a[244:247], v[32:35]
    v_rcp_f32_e64 v93, v93
    v_mfma_f32_16x16x32_bf16 v[36:39], v[212:215], a[244:247], v[36:39]
    v_mfma_f32_16x16x32_bf16 v[40:43], v[192:195], a[248:251], v[40:43]
    buffer_load_dwordx4 v[168:171], v13, s[64:67], s4 offen offset:1024 sc1
    v_mfma_f32_16x16x32_bf16 v[44:47], v[212:215], a[248:251], v[44:47]
    v_rcp_f32_e64 v94, v94
    v_mfma_f32_16x16x32_bf16 v[48:51], v[192:195], a[252:255], v[48:51]
    v_rcp_f32_e64 v95, v95
    v_mfma_f32_16x16x32_bf16 v[52:55], v[212:215], a[252:255], v[52:55]
    s_waitcnt vmcnt(24)
    s_nop 0
    v_mfma_f32_16x16x32_bf16 v[24:27], v[156:159], v[224:227], v[24:27]
    v_mul_f32_e64 v92, v92, v84
    v_mfma_f32_16x16x32_bf16 v[28:31], v[176:179], v[224:227], v[28:31]
    buffer_load_dwordx4 v[188:191], v13, s[64:67], s4 offen offset:2048 sc1
    v_mfma_f32_16x16x32_bf16 v[32:35], v[156:159], v[228:231], v[32:35]
    v_mul_f32 v93, v93, v85
    v_mul_f32 v94, v94, v86
    v_mfma_f32_16x16x32_bf16 v[36:39], v[176:179], v[228:231], v[36:39]
    v_mul_f32_e64 v95, v95, v87
    v_mfma_f32_16x16x32_bf16 v[40:43], v[156:159], v[232:235], v[40:43]
    buffer_load_dwordx4 v[208:211], v13, s[64:67], s4 offen offset:3072 sc1
    v_mfma_f32_16x16x32_bf16 v[44:47], v[176:179], v[232:235], v[44:47]
    v_cvt_pk_bf16_f32 v92, v92, v93
    v_cvt_pk_bf16_f32 v93, v94, v95
    v_mfma_f32_16x16x32_bf16 v[48:51], v[156:159], v[236:239], v[48:51]
    ds_write_b64 v19, v[92:93] offset:10240
    v_mfma_f32_16x16x32_bf16 v[52:55], v[176:179], v[236:239], v[52:55]
    s_waitcnt vmcnt(24)
    s_nop 0
    v_mfma_f32_16x16x32_bf16 v[24:27], v[196:199], v[240:243], v[24:27]
    v_mfma_f32_16x16x32_bf16 v[28:31], v[216:219], v[240:243], v[28:31]
    buffer_load_dwordx4 v[152:155], v14, s[64:67], s4 offen offset:0 sc1
    v_mfma_f32_16x16x32_bf16 v[32:35], v[196:199], v[244:247], v[32:35]
    v_mfma_f32_16x16x32_bf16 v[36:39], v[216:219], v[244:247], v[36:39]
    v_mfma_f32_16x16x32_bf16 v[40:43], v[196:199], v[248:251], v[40:43]
    buffer_load_dwordx4 v[172:175], v14, s[64:67], s4 offen offset:1024 sc1
    v_mfma_f32_16x16x32_bf16 v[44:47], v[216:219], v[248:251], v[44:47]
    v_mfma_f32_16x16x32_bf16 v[48:51], v[196:199], v[252:255], v[48:51]
    v_mfma_f32_16x16x32_bf16 v[52:55], v[216:219], v[252:255], v[52:55]
    s_waitcnt vmcnt(24)
    s_nop 0
    v_mfma_f32_16x16x32_bf16 v[56:59], v[160:163], a[0:3], 0
    v_mfma_f32_16x16x32_bf16 v[60:63], v[180:183], a[0:3], 0
    buffer_load_dwordx4 v[192:195], v14, s[64:67], s4 offen offset:2048 sc1
    v_mfma_f32_16x16x32_bf16 v[64:67], v[160:163], a[4:7], 0
    v_mfma_f32_16x16x32_bf16 v[68:71], v[180:183], a[4:7], 0
    v_mfma_f32_16x16x32_bf16 v[72:75], v[160:163], a[8:11], 0
    buffer_load_dwordx4 v[212:215], v14, s[64:67], s4 offen offset:3072 sc1
    v_mfma_f32_16x16x32_bf16 v[76:79], v[180:183], a[8:11], 0
    v_mul_f32 v88, s89, v24
    v_mul_f32 v89, s89, v25
    v_mfma_f32_16x16x32_bf16 v[80:83], v[160:163], a[12:15], 0
    v_mul_f32_e64 v90, s89, v26
    v_mfma_f32_16x16x32_bf16 v[84:87], v[180:183], a[12:15], 0
    v_mul_f32 v91, s89, v27
    s_waitcnt vmcnt(24)
    v_mfma_f32_16x16x32_bf16 v[56:59], v[200:203], a[16:19], v[56:59]
    v_exp_f32_e64 v88, v88
    v_mfma_f32_16x16x32_bf16 v[60:63], v[220:223], a[16:19], v[60:63]
    buffer_load_dwordx4 v[156:159], v15, s[64:67], s4 offen offset:0 sc1
    v_mfma_f32_16x16x32_bf16 v[64:67], v[200:203], a[20:23], v[64:67]
    v_exp_f32_e64 v89, v89
    v_mfma_f32_16x16x32_bf16 v[68:71], v[220:223], a[20:23], v[68:71]
    v_mfma_f32_16x16x32_bf16 v[72:75], v[200:203], a[24:27], v[72:75]
    buffer_load_dwordx4 v[176:179], v15, s[64:67], s4 offen offset:1024 sc1
    v_mfma_f32_16x16x32_bf16 v[76:79], v[220:223], a[24:27], v[76:79]
    v_exp_f32_e64 v90, v90
    v_mfma_f32_16x16x32_bf16 v[80:83], v[200:203], a[28:31], v[80:83]
    v_exp_f32_e64 v91, v91
    v_mfma_f32_16x16x32_bf16 v[84:87], v[220:223], a[28:31], v[84:87]
    s_waitcnt vmcnt(24)
    s_nop 0
    v_mfma_f32_16x16x32_bf16 v[56:59], v[96:99], a[32:35], v[56:59]
    v_add_f32_e64 v88, 1.0, v88
    v_mfma_f32_16x16x32_bf16 v[60:63], v[100:103], a[32:35], v[60:63]
    buffer_load_dwordx4 v[196:199], v15, s[64:67], s4 offen offset:2048 sc1
    v_mfma_f32_16x16x32_bf16 v[64:67], v[96:99], a[36:39], v[64:67]
    v_add_f32 v89, 1.0, v89
    v_add_f32 v90, 1.0, v90
    v_mfma_f32_16x16x32_bf16 v[68:71], v[100:103], a[36:39], v[68:71]
    v_add_f32_e64 v91, 1.0, v91
    v_mfma_f32_16x16x32_bf16 v[72:75], v[96:99], a[40:43], v[72:75]
L_stub_15:
    s_cbranch_execz L_tchret_m2_m3
    s_nop 0
    buffer_load_dwordx4 v[216:219], v15, s[64:67], s4 offen offset:3072 sc1
    v_mfma_f32_16x16x32_bf16 v[76:79], v[100:103], a[40:43], v[76:79]
    v_rcp_f32_e64 v88, v88
    v_mfma_f32_16x16x32_bf16 v[80:83], v[96:99], a[44:47], v[80:83]
    v_mfma_f32_16x16x32_bf16 v[84:87], v[100:103], a[44:47], v[84:87]
    s_waitcnt vmcnt(24)
    s_nop 0
    v_mfma_f32_16x16x32_bf16 v[56:59], v[104:107], a[48:51], v[56:59]
    v_rcp_f32_e64 v89, v89
    v_mfma_f32_16x16x32_bf16 v[60:63], v[108:111], a[48:51], v[60:63]
    buffer_load_dwordx4 v[160:163], v16, s[64:67], s4 offen offset:0 sc1
    v_mfma_f32_16x16x32_bf16 v[64:67], v[104:107], a[52:55], v[64:67]
    v_rcp_f32_e64 v90, v90
    v_mfma_f32_16x16x32_bf16 v[68:71], v[108:111], a[52:55], v[68:71]
    v_rcp_f32_e64 v91, v91
    v_mfma_f32_16x16x32_bf16 v[72:75], v[104:107], a[56:59], v[72:75]
    buffer_load_dwordx4 v[180:183], v16, s[64:67], s4 offen offset:1024 sc1
    v_mfma_f32_16x16x32_bf16 v[76:79], v[108:111], a[56:59], v[76:79]
    v_mul_f32_e64 v88, v88, v28
    v_mfma_f32_16x16x32_bf16 v[80:83], v[104:107], a[60:63], v[80:83]
    v_mul_f32_e64 v89, v89, v29
    v_mfma_f32_16x16x32_bf16 v[84:87], v[108:111], a[60:63], v[84:87]
    v_mul_f32 v90, v90, v30
    s_waitcnt vmcnt(24)
    v_mfma_f32_16x16x32_bf16 v[56:59], v[112:115], a[64:67], v[56:59]
    v_mul_f32_e64 v91, v91, v31
    v_mfma_f32_16x16x32_bf16 v[60:63], v[116:119], a[64:67], v[60:63]
    buffer_load_dwordx4 v[200:203], v16, s[64:67], s4 offen offset:2048 sc1
    v_mfma_f32_16x16x32_bf16 v[64:67], v[112:115], a[68:71], v[64:67]
    v_cvt_pk_bf16_f32 v88, v88, v89
    v_cvt_pk_bf16_f32 v89, v90, v91
    v_mfma_f32_16x16x32_bf16 v[68:71], v[116:119], a[68:71], v[68:71]
    ds_write_b64 v18, v[88:89] offset:12288
    v_mfma_f32_16x16x32_bf16 v[72:75], v[112:115], a[72:75], v[72:75]
    buffer_load_dwordx4 v[220:223], v16, s[64:67], s4 offen offset:3072 sc1
    v_mfma_f32_16x16x32_bf16 v[76:79], v[116:119], a[72:75], v[76:79]
    v_mul_f32_e64 v92, s89, v32
    v_mfma_f32_16x16x32_bf16 v[80:83], v[112:115], a[76:79], v[80:83]
    v_mul_f32_e64 v93, s89, v33
    v_mfma_f32_16x16x32_bf16 v[84:87], v[116:119], a[76:79], v[84:87]
    v_mul_f32 v94, s89, v34
    s_waitcnt vmcnt(24)
    v_mfma_f32_16x16x32_bf16 v[56:59], v[120:123], a[80:83], v[56:59]
    v_mul_f32_e64 v95, s89, v35
    v_mfma_f32_16x16x32_bf16 v[60:63], v[124:127], a[80:83], v[60:63]
    s_add_u32 s4, s4, 147456
    buffer_load_dwordx4 v[96:99], v8, s[64:67], s4 offen offset:0 sc1
    v_mfma_f32_16x16x32_bf16 v[64:67], v[120:123], a[84:87], v[64:67]
    v_exp_f32_e64 v92, v92
    v_mfma_f32_16x16x32_bf16 v[68:71], v[124:127], a[84:87], v[68:71]
    v_exp_f32_e64 v93, v93
    v_mfma_f32_16x16x32_bf16 v[72:75], v[120:123], a[88:91], v[72:75]
    buffer_load_dwordx4 v[100:103], v8, s[64:67], s4 offen offset:1024 sc1
    v_mfma_f32_16x16x32_bf16 v[76:79], v[124:127], a[88:91], v[76:79]
    v_exp_f32_e64 v94, v94
    v_mfma_f32_16x16x32_bf16 v[80:83], v[120:123], a[92:95], v[80:83]
    v_mfma_f32_16x16x32_bf16 v[84:87], v[124:127], a[92:95], v[84:87]
    s_waitcnt vmcnt(24)
    s_nop 0
    v_mfma_f32_16x16x32_bf16 v[56:59], v[128:131], a[96:99], v[56:59]
    v_exp_f32_e64 v95, v95
    v_mfma_f32_16x16x32_bf16 v[60:63], v[132:135], a[96:99], v[60:63]
    buffer_load_dwordx4 v[104:107], v8, s[64:67], s4 offen offset:2048 sc1
    v_mfma_f32_16x16x32_bf16 v[64:67], v[128:131], a[100:103], v[64:67]
    v_add_f32 v92, 1.0, v92
    v_add_f32 v93, 1.0, v93
    v_mfma_f32_16x16x32_bf16 v[68:71], v[132:135], a[100:103], v[68:71]
    v_add_f32_e64 v94, 1.0, v94
    v_mfma_f32_16x16x32_bf16 v[72:75], v[128:131], a[104:107], v[72:75]
    buffer_load_dwordx4 v[108:111], v8, s[64:67], s4 offen offset:3072 sc1
    v_mfma_f32_16x16x32_bf16 v[76:79], v[132:135], a[104:107], v[76:79]
    v_add_f32_e64 v95, 1.0, v95
    v_mfma_f32_16x16x32_bf16 v[80:83], v[128:131], a[108:111], v[80:83]
    v_rcp_f32_e64 v92, v92
    v_mfma_f32_16x16x32_bf16 v[84:87], v[132:135], a[108:111], v[84:87]
    s_waitcnt vmcnt(24)
    s_nop 0
    v_mfma_f32_16x16x32_bf16 v[56:59], v[136:139], a[112:115], v[56:59]
    v_rcp_f32_e64 v93, v93
    v_mfma_f32_16x16x32_bf16 v[60:63], v[140:143], a[112:115], v[60:63]
    buffer_load_dwordx4 v[112:115], v9, s[64:67], s4 offen offset:0 sc1
    v_mfma_f32_16x16x32_bf16 v[64:67], v[136:139], a[116:119], v[64:67]
    v_rcp_f32_e64 v94, v94
    v_mfma_f32_16x16x32_bf16 v[68:71], v[140:143], a[116:119], v[68:71]
    v_mfma_f32_16x16x32_bf16 v[72:75], v[136:139], a[120:123], v[72:75]
    buffer_load_dwordx4 v[116:119], v9, s[64:67], s4 offen offset:1024 sc1
    v_mfma_f32_16x16x32_bf16 v[76:79], v[140:143], a[120:123], v[76:79]
    v_rcp_f32_e64 v95, v95
    v_mfma_f32_16x16x32_bf16 v[80:83], v[136:139], a[124:127], v[80:83]
    v_mul_f32_e64 v92, v92, v36
    v_mfma_f32_16x16x32_bf16 v[84:87], v[140:143], a[124:127], v[84:87]
    v_mul_f32 v93, v93, v37
    s_waitcnt vmcnt(24)
    v_mfma_f32_16x16x32_bf16 v[56:59], v[144:147], a[128:131], v[56:59]
    v_mul_f32_e64 v94, v94, v38
    v_mfma_f32_16x16x32_bf16 v[60:63], v[164:167], a[128:131], v[60:63]
    buffer_load_dwordx4 v[120:123], v9, s[64:67], s4 offen offset:2048 sc1
    v_mfma_f32_16x16x32_bf16 v[64:67], v[144:147], a[132:135], v[64:67]
    v_mul_f32_e64 v95, v95, v39
    v_cvt_pk_bf16_f32 v92, v92, v93
    v_mfma_f32_16x16x32_bf16 v[68:71], v[164:167], a[132:135], v[68:71]
    v_cvt_pk_bf16_f32 v93, v94, v95
    v_mfma_f32_16x16x32_bf16 v[72:75], v[144:147], a[136:139], v[72:75]
    buffer_load_dwordx4 v[124:127], v9, s[64:67], s4 offen offset:3072 sc1
    v_mfma_f32_16x16x32_bf16 v[76:79], v[164:167], a[136:139], v[76:79]
    ds_write_b64 v18, v[92:93] offset:30720
    v_mul_f32_e64 v88, s89, v40
    v_mfma_f32_16x16x32_bf16 v[80:83], v[144:147], a[140:143], v[80:83]
    v_mfma_f32_16x16x32_bf16 v[84:87], v[164:167], a[140:143], v[84:87]
    v_mul_f32 v89, s89, v41
    s_waitcnt vmcnt(24)
    v_mfma_f32_16x16x32_bf16 v[56:59], v[184:187], a[144:147], v[56:59]
    v_mul_f32_e64 v90, s89, v42
    v_mfma_f32_16x16x32_bf16 v[60:63], v[204:207], a[144:147], v[60:63]
    buffer_load_dwordx4 v[128:131], v10, s[64:67], s4 offen offset:0 sc1
    v_mfma_f32_16x16x32_bf16 v[64:67], v[184:187], a[148:151], v[64:67]
    v_mul_f32_e64 v91, s89, v43
    v_mfma_f32_16x16x32_bf16 v[68:71], v[204:207], a[148:151], v[68:71]
    v_exp_f32_e64 v88, v88
    v_mfma_f32_16x16x32_bf16 v[72:75], v[184:187], a[152:155], v[72:75]
    buffer_load_dwordx4 v[132:135], v10, s[64:67], s4 offen offset:1024 sc1
    v_mfma_f32_16x16x32_bf16 v[76:79], v[204:207], a[152:155], v[76:79]
    v_exp_f32_e64 v89, v89
    v_mfma_f32_16x16x32_bf16 v[80:83], v[184:187], a[156:159], v[80:83]
    v_exp_f32_e64 v90, v90
    v_mfma_f32_16x16x32_bf16 v[84:87], v[204:207], a[156:159], v[84:87]
    s_waitcnt vmcnt(24)
    s_nop 0
    v_mfma_f32_16x16x32_bf16 v[56:59], v[148:151], a[160:163], v[56:59]
    v_exp_f32_e64 v91, v91
    v_mfma_f32_16x16x32_bf16 v[60:63], v[168:171], a[160:163], v[60:63]
    buffer_load_dwordx4 v[136:139], v10, s[64:67], s4 offen offset:2048 sc1
    v_mfma_f32_16x16x32_bf16 v[64:67], v[148:151], a[164:167], v[64:67]
    v_add_f32_e64 v88, 1.0, v88
    v_mfma_f32_16x16x32_bf16 v[68:71], v[168:171], a[164:167], v[68:71]
    v_add_f32_e64 v89, 1.0, v89
    v_mfma_f32_16x16x32_bf16 v[72:75], v[148:151], a[168:171], v[72:75]
    buffer_load_dwordx4 v[140:143], v10, s[64:67], s4 offen offset:3072 sc1
    v_mfma_f32_16x16x32_bf16 v[76:79], v[168:171], a[168:171], v[76:79]
    v_add_f32 v90, 1.0, v90
    v_add_f32 v91, 1.0, v91
    v_mfma_f32_16x16x32_bf16 v[80:83], v[148:151], a[172:175], v[80:83]
    v_mfma_f32_16x16x32_bf16 v[84:87], v[168:171], a[172:175], v[84:87]
    s_waitcnt vmcnt(24)
    s_nop 0
    v_mfma_f32_16x16x32_bf16 v[56:59], v[188:191], a[176:179], v[56:59]
    v_rcp_f32_e64 v88, v88
    v_mfma_f32_16x16x32_bf16 v[60:63], v[208:211], a[176:179], v[60:63]
    buffer_load_dwordx4 v[144:147], v11, s[64:67], s4 offen offset:0 sc1
    v_mfma_f32_16x16x32_bf16 v[64:67], v[188:191], a[180:183], v[64:67]
    v_rcp_f32_e64 v89, v89
    v_mfma_f32_16x16x32_bf16 v[68:71], v[208:211], a[180:183], v[68:71]
    v_rcp_f32_e64 v90, v90
    v_mfma_f32_16x16x32_bf16 v[72:75], v[188:191], a[184:187], v[72:75]
    buffer_load_dwordx4 v[164:167], v11, s[64:67], s4 offen offset:1024 sc1
    v_mfma_f32_16x16x32_bf16 v[76:79], v[208:211], a[184:187], v[76:79]
    v_rcp_f32_e64 v91, v91
    v_mfma_f32_16x16x32_bf16 v[80:83], v[188:191], a[188:191], v[80:83]
    v_mfma_f32_16x16x32_bf16 v[84:87], v[208:211], a[188:191], v[84:87]
    v_mul_f32 v88, v88, v44
    s_waitcnt vmcnt(24)
    v_mfma_f32_16x16x32_bf16 v[56:59], v[152:155], a[192:195], v[56:59]
    v_mul_f32_e64 v89, v89, v45
    v_mfma_f32_16x16x32_bf16 v[60:63], v[172:175], a[192:195], v[60:63]
    buffer_load_dwordx4 v[184:187], v11, s[64:67], s4 offen offset:2048 sc1
    v_mfma_f32_16x16x32_bf16 v[64:67], v[152:155], a[196:199], v[64:67]
    v_mul_f32 v90, v90, v46
    v_mul_f32 v91, v91, v47
    v_mfma_f32_16x16x32_bf16 v[68:71], v[172:175], a[196:199], v[68:71]
    v_cvt_pk_bf16_f32 v88, v88, v89
    v_mfma_f32_16x16x32_bf16 v[72:75], v[152:155], a[200:203], v[72:75]
    buffer_load_dwordx4 v[204:207], v11, s[64:67], s4 offen offset:3072 sc1
    v_mfma_f32_16x16x32_bf16 v[76:79], v[172:175], a[200:203], v[76:79]
    v_cvt_pk_bf16_f32 v89, v90, v91
    ds_write_b64 v18, v[88:89] offset:49152
    v_mfma_f32_16x16x32_bf16 v[80:83], v[152:155], a[204:207], v[80:83]
    v_mul_f32_e64 v92, s89, v48
    v_mfma_f32_16x16x32_bf16 v[84:87], v[172:175], a[204:207], v[84:87]
    s_waitcnt vmcnt(24)
    s_nop 0
    v_mfma_f32_16x16x32_bf16 v[56:59], v[192:195], a[208:211], v[56:59]
    v_mul_f32_e64 v93, s89, v49
    v_mfma_f32_16x16x32_bf16 v[60:63], v[212:215], a[208:211], v[60:63]
    buffer_load_dwordx4 v[148:151], v12, s[64:67], s4 offen offset:0 sc1
    v_mfma_f32_16x16x32_bf16 v[64:67], v[192:195], a[212:215], v[64:67]
    v_mul_f32 v94, s89, v50
    v_mul_f32 v95, s89, v51
    v_mfma_f32_16x16x32_bf16 v[68:71], v[212:215], a[212:215], v[68:71]
    v_exp_f32_e64 v92, v92
    v_mfma_f32_16x16x32_bf16 v[72:75], v[192:195], a[216:219], v[72:75]
    buffer_load_dwordx4 v[168:171], v12, s[64:67], s4 offen offset:1024 sc1
    v_mfma_f32_16x16x32_bf16 v[76:79], v[212:215], a[216:219], v[76:79]
    v_exp_f32_e64 v93, v93
    v_mfma_f32_16x16x32_bf16 v[80:83], v[192:195], a[220:223], v[80:83]
    v_mfma_f32_16x16x32_bf16 v[84:87], v[212:215], a[220:223], v[84:87]
    s_waitcnt vmcnt(24)
    s_nop 0
    v_mfma_f32_16x16x32_bf16 v[56:59], v[156:159], a[224:227], v[56:59]
    v_exp_f32_e64 v94, v94
    v_mfma_f32_16x16x32_bf16 v[60:63], v[176:179], a[224:227], v[60:63]
    buffer_load_dwordx4 v[188:191], v12, s[64:67], s4 offen offset:2048 sc1
    v_mfma_f32_16x16x32_bf16 v[64:67], v[156:159], a[228:231], v[64:67]
    v_exp_f32_e64 v95, v95
    v_mfma_f32_16x16x32_bf16 v[68:71], v[176:179], a[228:231], v[68:71]
    v_add_f32_e64 v92, 1.0, v92
    v_mfma_f32_16x16x32_bf16 v[72:75], v[156:159], a[232:235], v[72:75]
    buffer_load_dwordx4 v[208:211], v12, s[64:67], s4 offen offset:3072 sc1
    v_mfma_f32_16x16x32_bf16 v[76:79], v[176:179], a[232:235], v[76:79]
    v_add_f32 v93, 1.0, v93
    v_add_f32 v94, 1.0, v94
    v_mfma_f32_16x16x32_bf16 v[80:83], v[156:159], a[236:239], v[80:83]
    v_add_f32_e64 v95, 1.0, v95
    v_mfma_f32_16x16x32_bf16 v[84:87], v[176:179], a[236:239], v[84:87]
    s_waitcnt vmcnt(24)
    s_nop 0
    v_mfma_f32_16x16x32_bf16 v[56:59], v[196:199], a[240:243], v[56:59]
    v_rcp_f32_e64 v92, v92
    v_mfma_f32_16x16x32_bf16 v[60:63], v[216:219], a[240:243], v[60:63]
    buffer_load_dwordx4 v[152:155], v13, s[64:67], s4 offen offset:0 sc1
    v_mfma_f32_16x16x32_bf16 v[64:67], v[196:199], a[244:247], v[64:67]
    v_rcp_f32_e64 v93, v93
    v_mfma_f32_16x16x32_bf16 v[68:71], v[216:219], a[244:247], v[68:71]
    v_mfma_f32_16x16x32_bf16 v[72:75], v[196:199], a[248:251], v[72:75]
    buffer_load_dwordx4 v[172:175], v13, s[64:67], s4 offen offset:1024 sc1
    v_mfma_f32_16x16x32_bf16 v[76:79], v[216:219], a[248:251], v[76:79]
    v_rcp_f32_e64 v94, v94
    v_mfma_f32_16x16x32_bf16 v[80:83], v[196:199], a[252:255], v[80:83]
    v_rcp_f32_e64 v95, v95
    v_mfma_f32_16x16x32_bf16 v[84:87], v[216:219], a[252:255], v[84:87]
    s_waitcnt vmcnt(24)
    s_nop 0
    v_mfma_f32_16x16x32_bf16 v[56:59], v[160:163], v[224:227], v[56:59]
    v_mul_f32_e64 v92, v92, v52
    v_mfma_f32_16x16x32_bf16 v[60:63], v[180:183], v[224:227], v[60:63]
    buffer_load_dwordx4 v[192:195], v13, s[64:67], s4 offen offset:2048 sc1
    v_mfma_f32_16x16x32_bf16 v[64:67], v[160:163], v[228:231], v[64:67]
    v_mul_f32 v93, v93, v53
    v_mul_f32 v94, v94, v54
    v_mfma_f32_16x16x32_bf16 v[68:71], v[180:183], v[228:231], v[68:71]
    v_mul_f32_e64 v95, v95, v55
    v_mfma_f32_16x16x32_bf16 v[72:75], v[160:163], v[232:235], v[72:75]
    buffer_load_dwordx4 v[212:215], v13, s[64:67], s4 offen offset:3072 sc1
    v_mfma_f32_16x16x32_bf16 v[76:79], v[180:183], v[232:235], v[76:79]
    v_cvt_pk_bf16_f32 v92, v92, v93
    v_cvt_pk_bf16_f32 v93, v94, v95
    v_mfma_f32_16x16x32_bf16 v[80:83], v[160:163], v[236:239], v[80:83]
    ds_write_b64 v19, v[92:93] offset:12288
    v_mfma_f32_16x16x32_bf16 v[84:87], v[180:183], v[236:239], v[84:87]
    s_waitcnt vmcnt(24)
    s_nop 0
    v_mfma_f32_16x16x32_bf16 v[56:59], v[200:203], v[240:243], v[56:59]
    v_mfma_f32_16x16x32_bf16 v[60:63], v[220:223], v[240:243], v[60:63]
    buffer_load_dwordx4 v[156:159], v14, s[64:67], s4 offen offset:0 sc1
    v_mfma_f32_16x16x32_bf16 v[64:67], v[200:203], v[244:247], v[64:67]
    v_mfma_f32_16x16x32_bf16 v[68:71], v[220:223], v[244:247], v[68:71]
    v_mfma_f32_16x16x32_bf16 v[72:75], v[200:203], v[248:251], v[72:75]
    buffer_load_dwordx4 v[176:179], v14, s[64:67], s4 offen offset:1024 sc1
    v_mfma_f32_16x16x32_bf16 v[76:79], v[220:223], v[248:251], v[76:79]
    v_mfma_f32_16x16x32_bf16 v[80:83], v[200:203], v[252:255], v[80:83]
    v_mfma_f32_16x16x32_bf16 v[84:87], v[220:223], v[252:255], v[84:87]
    s_waitcnt vmcnt(24)
    s_nop 0
    v_mfma_f32_16x16x32_bf16 v[24:27], v[96:99], a[0:3], 0
    v_mfma_f32_16x16x32_bf16 v[28:31], v[100:103], a[0:3], 0
    buffer_load_dwordx4 v[196:199], v14, s[64:67], s4 offen offset:2048 sc1
    v_mfma_f32_16x16x32_bf16 v[32:35], v[96:99], a[4:7], 0
    v_mfma_f32_16x16x32_bf16 v[36:39], v[100:103], a[4:7], 0
    v_mfma_f32_16x16x32_bf16 v[40:43], v[96:99], a[8:11], 0
    buffer_load_dwordx4 v[216:219], v14, s[64:67], s4 offen offset:3072 sc1
    v_mfma_f32_16x16x32_bf16 v[44:47], v[100:103], a[8:11], 0
    v_mul_f32 v88, s89, v56
    v_mul_f32 v89, s89, v57
    v_mfma_f32_16x16x32_bf16 v[48:51], v[96:99], a[12:15], 0
    v_mul_f32_e64 v90, s89, v58
    v_mfma_f32_16x16x32_bf16 v[52:55], v[100:103], a[12:15], 0
    v_mul_f32 v91, s89, v59
    s_waitcnt vmcnt(24)
    v_mfma_f32_16x16x32_bf16 v[24:27], v[104:107], a[16:19], v[24:27]
    v_exp_f32_e64 v88, v88
    v_mfma_f32_16x16x32_bf16 v[28:31], v[108:111], a[16:19], v[28:31]
    buffer_load_dwordx4 v[160:163], v15, s[64:67], s4 offen offset:0 sc1
    v_mfma_f32_16x16x32_bf16 v[32:35], v[104:107], a[20:23], v[32:35]
    v_exp_f32_e64 v89, v89
    v_mfma_f32_16x16x32_bf16 v[36:39], v[108:111], a[20:23], v[36:39]
    v_mfma_f32_16x16x32_bf16 v[40:43], v[104:107], a[24:27], v[40:43]
    buffer_load_dwordx4 v[180:183], v15, s[64:67], s4 offen offset:1024 sc1
    v_mfma_f32_16x16x32_bf16 v[44:47], v[108:111], a[24:27], v[44:47]
    v_exp_f32_e64 v90, v90
    v_mfma_f32_16x16x32_bf16 v[48:51], v[104:107], a[28:31], v[48:51]
    v_exp_f32_e64 v91, v91
    v_mfma_f32_16x16x32_bf16 v[52:55], v[108:111], a[28:31], v[52:55]
    s_waitcnt vmcnt(24)
    s_nop 0
    v_mfma_f32_16x16x32_bf16 v[24:27], v[112:115], a[32:35], v[24:27]
    v_add_f32_e64 v88, 1.0, v88
    v_mfma_f32_16x16x32_bf16 v[28:31], v[116:119], a[32:35], v[28:31]
    buffer_load_dwordx4 v[200:203], v15, s[64:67], s4 offen offset:2048 sc1
    v_mfma_f32_16x16x32_bf16 v[32:35], v[112:115], a[36:39], v[32:35]
    v_add_f32 v89, 1.0, v89
    v_add_f32 v90, 1.0, v90
    v_mfma_f32_16x16x32_bf16 v[36:39], v[116:119], a[36:39], v[36:39]
    v_add_f32_e64 v91, 1.0, v91
    v_mfma_f32_16x16x32_bf16 v[40:43], v[112:115], a[40:43], v[40:43]
    buffer_load_dwordx4 v[220:223], v15, s[64:67], s4 offen offset:3072 sc1
    v_mfma_f32_16x16x32_bf16 v[44:47], v[116:119], a[40:43], v[44:47]
    v_rcp_f32_e64 v88, v88
    v_mfma_f32_16x16x32_bf16 v[48:51], v[112:115], a[44:47], v[48:51]
    v_mfma_f32_16x16x32_bf16 v[52:55], v[116:119], a[44:47], v[52:55]
    s_waitcnt vmcnt(24)
    s_nop 0
    v_mfma_f32_16x16x32_bf16 v[24:27], v[120:123], a[48:51], v[24:27]
    v_rcp_f32_e64 v89, v89
    v_mfma_f32_16x16x32_bf16 v[28:31], v[124:127], a[48:51], v[28:31]
    buffer_load_dwordx4 v[96:99], v16, s[64:67], s4 offen offset:0 sc1
    v_mfma_f32_16x16x32_bf16 v[32:35], v[120:123], a[52:55], v[32:35]
    v_rcp_f32_e64 v90, v90
    v_mfma_f32_16x16x32_bf16 v[36:39], v[124:127], a[52:55], v[36:39]
    v_rcp_f32_e64 v91, v91
    v_mfma_f32_16x16x32_bf16 v[40:43], v[120:123], a[56:59], v[40:43]
    buffer_load_dwordx4 v[100:103], v16, s[64:67], s4 offen offset:1024 sc1
    v_mfma_f32_16x16x32_bf16 v[44:47], v[124:127], a[56:59], v[44:47]
    v_mul_f32_e64 v88, v88, v60
    v_mfma_f32_16x16x32_bf16 v[48:51], v[120:123], a[60:63], v[48:51]
    v_mul_f32_e64 v89, v89, v61
    v_mfma_f32_16x16x32_bf16 v[52:55], v[124:127], a[60:63], v[52:55]
    v_mul_f32 v90, v90, v62
    s_waitcnt vmcnt(24)
    v_mfma_f32_16x16x32_bf16 v[24:27], v[128:131], a[64:67], v[24:27]
    v_mul_f32_e64 v91, v91, v63
    v_mfma_f32_16x16x32_bf16 v[28:31], v[132:135], a[64:67], v[28:31]
    buffer_load_dwordx4 v[104:107], v16, s[64:67], s4 offen offset:2048 sc1
    v_mfma_f32_16x16x32_bf16 v[32:35], v[128:131], a[68:71], v[32:35]
    v_cvt_pk_bf16_f32 v88, v88, v89
    v_cvt_pk_bf16_f32 v89, v90, v91
    v_mfma_f32_16x16x32_bf16 v[36:39], v[132:135], a[68:71], v[36:39]
    ds_write_b64 v18, v[88:89] offset:14336
    v_mfma_f32_16x16x32_bf16 v[40:43], v[128:131], a[72:75], v[40:43]
    buffer_load_dwordx4 v[108:111], v16, s[64:67], s4 offen offset:3072 sc1
    v_mfma_f32_16x16x32_bf16 v[44:47], v[132:135], a[72:75], v[44:47]
    v_mul_f32_e64 v92, s89, v64
    v_mfma_f32_16x16x32_bf16 v[48:51], v[128:131], a[76:79], v[48:51]
    v_mul_f32_e64 v93, s89, v65
    v_mfma_f32_16x16x32_bf16 v[52:55], v[132:135], a[76:79], v[52:55]
    v_mul_f32 v94, s89, v66
    s_waitcnt vmcnt(24)
    v_mfma_f32_16x16x32_bf16 v[24:27], v[136:139], a[80:83], v[24:27]
    v_mul_f32_e64 v95, s89, v67
    v_mfma_f32_16x16x32_bf16 v[28:31], v[140:143], a[80:83], v[28:31]
    buffer_load_dwordx4 v[112:115], v8, s[64:67], s13 offen offset:0 sc1
    v_mfma_f32_16x16x32_bf16 v[32:35], v[136:139], a[84:87], v[32:35]
    v_exp_f32_e64 v92, v92
    v_mfma_f32_16x16x32_bf16 v[36:39], v[140:143], a[84:87], v[36:39]
    v_exp_f32_e64 v93, v93
    v_mfma_f32_16x16x32_bf16 v[40:43], v[136:139], a[88:91], v[40:43]
    buffer_load_dwordx4 v[116:119], v8, s[64:67], s13 offen offset:1024 sc1
    v_mfma_f32_16x16x32_bf16 v[44:47], v[140:143], a[88:91], v[44:47]
    v_exp_f32_e64 v94, v94
    v_mfma_f32_16x16x32_bf16 v[48:51], v[136:139], a[92:95], v[48:51]
    v_mfma_f32_16x16x32_bf16 v[52:55], v[140:143], a[92:95], v[52:55]
    s_waitcnt vmcnt(24)
    s_nop 0
    v_mfma_f32_16x16x32_bf16 v[24:27], v[144:147], a[96:99], v[24:27]
    v_exp_f32_e64 v95, v95
    v_mfma_f32_16x16x32_bf16 v[28:31], v[164:167], a[96:99], v[28:31]
    buffer_load_dwordx4 v[120:123], v8, s[64:67], s13 offen offset:2048 sc1
    v_mfma_f32_16x16x32_bf16 v[32:35], v[144:147], a[100:103], v[32:35]
    v_add_f32 v92, 1.0, v92
    v_add_f32 v93, 1.0, v93
    v_mfma_f32_16x16x32_bf16 v[36:39], v[164:167], a[100:103], v[36:39]
    v_add_f32_e64 v94, 1.0, v94
    v_mfma_f32_16x16x32_bf16 v[40:43], v[144:147], a[104:107], v[40:43]
    buffer_load_dwordx4 v[124:127], v8, s[64:67], s13 offen offset:3072 sc1
    v_mfma_f32_16x16x32_bf16 v[44:47], v[164:167], a[104:107], v[44:47]
    v_add_f32_e64 v95, 1.0, v95
    v_mfma_f32_16x16x32_bf16 v[48:51], v[144:147], a[108:111], v[48:51]
    v_rcp_f32_e64 v92, v92
    v_mfma_f32_16x16x32_bf16 v[52:55], v[164:167], a[108:111], v[52:55]
    s_waitcnt vmcnt(24)
    s_nop 0
    v_mfma_f32_16x16x32_bf16 v[24:27], v[184:187], a[112:115], v[24:27]
    v_rcp_f32_e64 v93, v93
    v_mfma_f32_16x16x32_bf16 v[28:31], v[204:207], a[112:115], v[28:31]
    buffer_load_dwordx4 v[128:131], v9, s[64:67], s13 offen offset:0 sc1
    v_mfma_f32_16x16x32_bf16 v[32:35], v[184:187], a[116:119], v[32:35]
    v_rcp_f32_e64 v94, v94
    v_mfma_f32_16x16x32_bf16 v[36:39], v[204:207], a[116:119], v[36:39]
    v_mfma_f32_16x16x32_bf16 v[40:43], v[184:187], a[120:123], v[40:43]
    buffer_load_dwordx4 v[132:135], v9, s[64:67], s13 offen offset:1024 sc1
    v_mfma_f32_16x16x32_bf16 v[44:47], v[204:207], a[120:123], v[44:47]
    v_rcp_f32_e64 v95, v95
    v_mfma_f32_16x16x32_bf16 v[48:51], v[184:187], a[124:127], v[48:51]
    v_mul_f32_e64 v92, v92, v68
    v_mfma_f32_16x16x32_bf16 v[52:55], v[204:207], a[124:127], v[52:55]
    v_mul_f32 v93, v93, v69
    s_waitcnt vmcnt(24)
    v_mfma_f32_16x16x32_bf16 v[24:27], v[148:151], a[128:131], v[24:27]
    v_mul_f32_e64 v94, v94, v70
    v_mfma_f32_16x16x32_bf16 v[28:31], v[168:171], a[128:131], v[28:31]
    buffer_load_dwordx4 v[136:139], v9, s[64:67], s13 offen offset:2048 sc1
    v_mfma_f32_16x16x32_bf16 v[32:35], v[148:151], a[132:135], v[32:35]
    v_mul_f32_e64 v95, v95, v71
    v_cvt_pk_bf16_f32 v92, v92, v93
    v_mfma_f32_16x16x32_bf16 v[36:39], v[168:171], a[132:135], v[36:39]
    v_cvt_pk_bf16_f32 v93, v94, v95
    v_mfma_f32_16x16x32_bf16 v[40:43], v[148:151], a[136:139], v[40:43]
    buffer_load_dwordx4 v[140:143], v9, s[64:67], s13 offen offset:3072 sc1
    v_mfma_f32_16x16x32_bf16 v[44:47], v[168:171], a[136:139], v[44:47]
    ds_write_b64 v18, v[92:93] offset:32768
    v_mul_f32_e64 v88, s89, v72
    v_mfma_f32_16x16x32_bf16 v[48:51], v[148:151], a[140:143], v[48:51]
    v_mfma_f32_16x16x32_bf16 v[52:55], v[168:171], a[140:143], v[52:55]
    v_mul_f32 v89, s89, v73
    s_waitcnt vmcnt(24)
    v_mfma_f32_16x16x32_bf16 v[24:27], v[188:191], a[144:147], v[24:27]
    v_mul_f32_e64 v90, s89, v74
    v_mfma_f32_16x16x32_bf16 v[28:31], v[208:211], a[144:147], v[28:31]
    buffer_load_dwordx4 v[144:147], v10, s[64:67], s13 offen offset:0 sc1
    v_mfma_f32_16x16x32_bf16 v[32:35], v[188:191], a[148:151], v[32:35]
    v_mul_f32_e64 v91, s89, v75
    v_mfma_f32_16x16x32_bf16 v[36:39], v[208:211], a[148:151], v[36:39]
    v_exp_f32_e64 v88, v88
    v_mfma_f32_16x16x32_bf16 v[40:43], v[188:191], a[152:155], v[40:43]
    buffer_load_dwordx4 v[164:167], v10, s[64:67], s13 offen offset:1024 sc1
    v_mfma_f32_16x16x32_bf16 v[44:47], v[208:211], a[152:155], v[44:47]
    v_exp_f32_e64 v89, v89
    v_mfma_f32_16x16x32_bf16 v[48:51], v[188:191], a[156:159], v[48:51]
    v_exp_f32_e64 v90, v90
    v_mfma_f32_16x16x32_bf16 v[52:55], v[208:211], a[156:159], v[52:55]
    s_waitcnt vmcnt(24)
    s_nop 0
    v_mfma_f32_16x16x32_bf16 v[24:27], v[152:155], a[160:163], v[24:27]
    v_exp_f32_e64 v91, v91
    v_mfma_f32_16x16x32_bf16 v[28:31], v[172:175], a[160:163], v[28:31]
    buffer_load_dwordx4 v[184:187], v10, s[64:67], s13 offen offset:2048 sc1
    v_mfma_f32_16x16x32_bf16 v[32:35], v[152:155], a[164:167], v[32:35]
    v_add_f32_e64 v88, 1.0, v88
    v_mfma_f32_16x16x32_bf16 v[36:39], v[172:175], a[164:167], v[36:39]
    v_add_f32_e64 v89, 1.0, v89
    v_mfma_f32_16x16x32_bf16 v[40:43], v[152:155], a[168:171], v[40:43]
    buffer_load_dwordx4 v[204:207], v10, s[64:67], s13 offen offset:3072 sc1
    v_mfma_f32_16x16x32_bf16 v[44:47], v[172:175], a[168:171], v[44:47]
    v_add_f32 v90, 1.0, v90
    v_add_f32 v91, 1.0, v91
    v_mfma_f32_16x16x32_bf16 v[48:51], v[152:155], a[172:175], v[48:51]
    v_mfma_f32_16x16x32_bf16 v[52:55], v[172:175], a[172:175], v[52:55]
    s_waitcnt vmcnt(24)
    s_nop 0
    v_mfma_f32_16x16x32_bf16 v[24:27], v[192:195], a[176:179], v[24:27]
    v_rcp_f32_e64 v88, v88
    v_mfma_f32_16x16x32_bf16 v[28:31], v[212:215], a[176:179], v[28:31]
    buffer_load_dwordx4 v[148:151], v11, s[64:67], s13 offen offset:0 sc1
    v_mfma_f32_16x16x32_bf16 v[32:35], v[192:195], a[180:183], v[32:35]
    v_rcp_f32_e64 v89, v89
    v_mfma_f32_16x16x32_bf16 v[36:39], v[212:215], a[180:183], v[36:39]
    v_rcp_f32_e64 v90, v90
    v_mfma_f32_16x16x32_bf16 v[40:43], v[192:195], a[184:187], v[40:43]
    buffer_load_dwordx4 v[168:171], v11, s[64:67], s13 offen offset:1024 sc1
    v_mfma_f32_16x16x32_bf16 v[44:47], v[212:215], a[184:187], v[44:47]
    v_rcp_f32_e64 v91, v91
    v_mfma_f32_16x16x32_bf16 v[48:51], v[192:195], a[188:191], v[48:51]
    v_mfma_f32_16x16x32_bf16 v[52:55], v[212:215], a[188:191], v[52:55]
    v_mul_f32 v88, v88, v76
    s_waitcnt vmcnt(24)
    v_mfma_f32_16x16x32_bf16 v[24:27], v[156:159], a[192:195], v[24:27]
    v_mul_f32_e64 v89, v89, v77
    v_mfma_f32_16x16x32_bf16 v[28:31], v[176:179], a[192:195], v[28:31]
    buffer_load_dwordx4 v[188:191], v11, s[64:67], s13 offen offset:2048 sc1
    v_mfma_f32_16x16x32_bf16 v[32:35], v[156:159], a[196:199], v[32:35]
    v_mul_f32 v90, v90, v78
    v_mul_f32 v91, v91, v79
    v_mfma_f32_16x16x32_bf16 v[36:39], v[176:179], a[196:199], v[36:39]
    v_cvt_pk_bf16_f32 v88, v88, v89
    v_mfma_f32_16x16x32_bf16 v[40:43], v[156:159], a[200:203], v[40:43]
    buffer_load_dwordx4 v[208:211], v11, s[64:67], s13 offen offset:3072 sc1
    v_mfma_f32_16x16x32_bf16 v[44:47], v[176:179], a[200:203], v[44:47]
    v_cvt_pk_bf16_f32 v89, v90, v91
    ds_write_b64 v18, v[88:89] offset:51200
    v_mfma_f32_16x16x32_bf16 v[48:51], v[156:159], a[204:207], v[48:51]
    v_mul_f32_e64 v92, s89, v80
    v_mfma_f32_16x16x32_bf16 v[52:55], v[176:179], a[204:207], v[52:55]
    s_waitcnt vmcnt(24)
    s_nop 0
    v_mfma_f32_16x16x32_bf16 v[24:27], v[196:199], a[208:211], v[24:27]
    v_mul_f32_e64 v93, s89, v81
    v_mfma_f32_16x16x32_bf16 v[28:31], v[216:219], a[208:211], v[28:31]
    buffer_load_dwordx4 v[152:155], v12, s[64:67], s13 offen offset:0 sc1
    v_mfma_f32_16x16x32_bf16 v[32:35], v[196:199], a[212:215], v[32:35]
    v_mul_f32 v94, s89, v82
    v_mul_f32 v95, s89, v83
    v_mfma_f32_16x16x32_bf16 v[36:39], v[216:219], a[212:215], v[36:39]
    v_exp_f32_e64 v92, v92
    v_mfma_f32_16x16x32_bf16 v[40:43], v[196:199], a[216:219], v[40:43]
    buffer_load_dwordx4 v[172:175], v12, s[64:67], s13 offen offset:1024 sc1
    v_mfma_f32_16x16x32_bf16 v[44:47], v[216:219], a[216:219], v[44:47]
    v_exp_f32_e64 v93, v93
    v_mfma_f32_16x16x32_bf16 v[48:51], v[196:199], a[220:223], v[48:51]
    v_mfma_f32_16x16x32_bf16 v[52:55], v[216:219], a[220:223], v[52:55]
    s_waitcnt vmcnt(24)
    s_nop 0
    v_mfma_f32_16x16x32_bf16 v[24:27], v[160:163], a[224:227], v[24:27]
    v_exp_f32_e64 v94, v94
    v_mfma_f32_16x16x32_bf16 v[28:31], v[180:183], a[224:227], v[28:31]
    buffer_load_dwordx4 v[192:195], v8, s[64:67], s14 offen offset:0 sc1
    v_mfma_f32_16x16x32_bf16 v[32:35], v[160:163], a[228:231], v[32:35]
    v_exp_f32_e64 v95, v95
    v_mfma_f32_16x16x32_bf16 v[36:39], v[180:183], a[228:231], v[36:39]
    v_add_f32_e64 v92, 1.0, v92
    v_mfma_f32_16x16x32_bf16 v[40:43], v[160:163], a[232:235], v[40:43]
    buffer_load_dwordx4 v[212:215], v8, s[64:67], s14 offen offset:1024 sc1
    v_mfma_f32_16x16x32_bf16 v[44:47], v[180:183], a[232:235], v[44:47]
    v_add_f32 v93, 1.0, v93
    v_add_f32 v94, 1.0, v94
    v_mfma_f32_16x16x32_bf16 v[48:51], v[160:163], a[236:239], v[48:51]
    v_add_f32_e64 v95, 1.0, v95
    v_mfma_f32_16x16x32_bf16 v[52:55], v[180:183], a[236:239], v[52:55]
    s_waitcnt vmcnt(24)
    s_nop 0
    v_mfma_f32_16x16x32_bf16 v[24:27], v[200:203], a[240:243], v[24:27]
    v_rcp_f32_e64 v92, v92
    v_mfma_f32_16x16x32_bf16 v[28:31], v[220:223], a[240:243], v[28:31]
    buffer_load_dwordx4 v[156:159], v8, s[64:67], s14 offen offset:2048 sc1
    v_mfma_f32_16x16x32_bf16 v[32:35], v[200:203], a[244:247], v[32:35]
    v_rcp_f32_e64 v93, v93
    v_mfma_f32_16x16x32_bf16 v[36:39], v[220:223], a[244:247], v[36:39]
    v_mfma_f32_16x16x32_bf16 v[40:43], v[200:203], a[248:251], v[40:43]
    buffer_load_dwordx4 v[176:179], v8, s[64:67], s14 offen offset:3072 sc1
    v_mfma_f32_16x16x32_bf16 v[44:47], v[220:223], a[248:251], v[44:47]
    v_rcp_f32_e64 v94, v94
    v_mfma_f32_16x16x32_bf16 v[48:51], v[200:203], a[252:255], v[48:51]
    v_rcp_f32_e64 v95, v95
    v_mfma_f32_16x16x32_bf16 v[52:55], v[220:223], a[252:255], v[52:55]
    s_waitcnt vmcnt(24)
    s_nop 0
    v_mfma_f32_16x16x32_bf16 v[24:27], v[96:99], v[224:227], v[24:27]
    v_mul_f32_e64 v92, v92, v84
    v_mfma_f32_16x16x32_bf16 v[28:31], v[100:103], v[224:227], v[28:31]
    buffer_load_dwordx4 v[196:199], v9, s[64:67], s14 offen offset:0 sc1
    v_mfma_f32_16x16x32_bf16 v[32:35], v[96:99], v[228:231], v[32:35]
    v_mul_f32 v93, v93, v85
    v_mul_f32 v94, v94, v86
    v_mfma_f32_16x16x32_bf16 v[36:39], v[100:103], v[228:231], v[36:39]
    v_mul_f32_e64 v95, v95, v87
    v_mfma_f32_16x16x32_bf16 v[40:43], v[96:99], v[232:235], v[40:43]
    buffer_load_dwordx4 v[216:219], v9, s[64:67], s14 offen offset:1024 sc1
    v_mfma_f32_16x16x32_bf16 v[44:47], v[100:103], v[232:235], v[44:47]
    v_cvt_pk_bf16_f32 v92, v92, v93
    v_cvt_pk_bf16_f32 v93, v94, v95
    v_mfma_f32_16x16x32_bf16 v[48:51], v[96:99], v[236:239], v[48:51]
    ds_write_b64 v19, v[92:93] offset:14336
    v_mfma_f32_16x16x32_bf16 v[52:55], v[100:103], v[236:239], v[52:55]
    s_waitcnt vmcnt(24)
    s_nop 0
    v_mfma_f32_16x16x32_bf16 v[24:27], v[104:107], v[240:243], v[24:27]
    v_mfma_f32_16x16x32_bf16 v[28:31], v[108:111], v[240:243], v[28:31]
    buffer_load_dwordx4 v[160:163], v9, s[64:67], s14 offen offset:2048 sc1
    v_mfma_f32_16x16x32_bf16 v[32:35], v[104:107], v[244:247], v[32:35]
    v_mfma_f32_16x16x32_bf16 v[36:39], v[108:111], v[244:247], v[36:39]
    v_mfma_f32_16x16x32_bf16 v[40:43], v[104:107], v[248:251], v[40:43]
L_stub_16:
    s_cbranch_execz L_tchret_m2_m3
    s_nop 0
    buffer_load_dwordx4 v[180:183], v9, s[64:67], s14 offen offset:3072 sc1
    v_mfma_f32_16x16x32_bf16 v[44:47], v[108:111], v[248:251], v[44:47]
    v_mfma_f32_16x16x32_bf16 v[48:51], v[104:107], v[252:255], v[48:51]
    v_mfma_f32_16x16x32_bf16 v[52:55], v[108:111], v[252:255], v[52:55]
    v_mul_f32 v88, s89, v24
    v_mul_f32 v89, s89, v25
    v_mul_f32 v90, s89, v26
    v_mul_f32 v91, s89, v27
    v_exp_f32 v88, v88
    v_exp_f32 v89, v89
    v_exp_f32 v90, v90
    v_exp_f32 v91, v91
    v_add_f32 v88, 1.0, v88
    v_add_f32 v89, 1.0, v89
    v_add_f32 v90, 1.0, v90
    v_add_f32 v91, 1.0, v91
    v_rcp_f32 v88, v88
    v_rcp_f32 v89, v89
    v_rcp_f32 v90, v90
    v_rcp_f32 v91, v91
    v_mul_f32 v88, v88, v28
    v_mul_f32 v89, v89, v29
    v_mul_f32 v90, v90, v30
    v_mul_f32 v91, v91, v31
    v_cvt_pk_bf16_f32 v88, v88, v89
    v_cvt_pk_bf16_f32 v89, v90, v91
    ds_write_b64 v18, v[88:89] offset:16384
    v_mul_f32 v92, s89, v32
    v_mul_f32 v93, s89, v33
    v_mul_f32 v94, s89, v34
    v_mul_f32 v95, s89, v35
    v_exp_f32 v92, v92
    v_exp_f32 v93, v93
    v_exp_f32 v94, v94
    v_exp_f32 v95, v95
    v_add_f32 v92, 1.0, v92
    v_add_f32 v93, 1.0, v93
    v_add_f32 v94, 1.0, v94
    v_add_f32 v95, 1.0, v95
    v_rcp_f32 v92, v92
    v_rcp_f32 v93, v93
    v_rcp_f32 v94, v94
    v_rcp_f32 v95, v95
    v_mul_f32 v92, v92, v36
    v_mul_f32 v93, v93, v37
    v_mul_f32 v94, v94, v38
    v_mul_f32 v95, v95, v39
    v_cvt_pk_bf16_f32 v92, v92, v93
    v_cvt_pk_bf16_f32 v93, v94, v95
    ds_write_b64 v18, v[92:93] offset:34816
    v_mul_f32 v88, s89, v40
    v_mul_f32 v89, s89, v41
    v_mul_f32 v90, s89, v42
    v_mul_f32 v91, s89, v43
    v_exp_f32 v88, v88
    v_exp_f32 v89, v89
    v_exp_f32 v90, v90
    v_exp_f32 v91, v91
    v_add_f32 v88, 1.0, v88
    v_add_f32 v89, 1.0, v89
    v_add_f32 v90, 1.0, v90
    v_add_f32 v91, 1.0, v91
    v_rcp_f32 v88, v88
    v_rcp_f32 v89, v89
    v_rcp_f32 v90, v90
    v_rcp_f32 v91, v91
    v_mul_f32 v88, v88, v44
    v_mul_f32 v89, v89, v45
    v_mul_f32 v90, v90, v46
    v_mul_f32 v91, v91, v47
    v_cvt_pk_bf16_f32 v88, v88, v89
    v_cvt_pk_bf16_f32 v89, v90, v91
    ds_write_b64 v18, v[88:89] offset:53248
    v_mul_f32 v92, s89, v48
    v_mul_f32 v93, s89, v49
    v_mul_f32 v94, s89, v50
    v_mul_f32 v95, s89, v51
    v_exp_f32 v92, v92
    v_exp_f32 v93, v93
    v_exp_f32 v94, v94
    v_exp_f32 v95, v95
    v_add_f32 v92, 1.0, v92
    v_add_f32 v93, 1.0, v93
    v_add_f32 v94, 1.0, v94
    v_add_f32 v95, 1.0, v95
    v_rcp_f32 v92, v92
    v_rcp_f32 v93, v93
    v_rcp_f32 v94, v94
    v_rcp_f32 v95, v95
    v_mul_f32 v92, v92, v52
    v_mul_f32 v93, v93, v53
    v_mul_f32 v94, v94, v54
    v_mul_f32 v95, v95, v55
    v_cvt_pk_bf16_f32 v92, v92, v93
    v_cvt_pk_bf16_f32 v93, v94, v95
    ds_write_b64 v19, v[92:93] offset:16384
    s_waitcnt lgkmcnt(0)
    s_barrier
    v_add_u32 v20, 73728, v21
    v_add_u32 v22, 129024, v21
    ds_read_b128 a[0:3], v20 offset:0
    ds_read_b128 a[4:7], v20 offset:18432
    ds_read_b128 a[8:11], v20 offset:36864
    ds_read_b128 a[12:15], v22 offset:0
    ds_read_b128 a[16:19], v20 offset:1024
    ds_read_b128 a[20:23], v20 offset:19456
    ds_read_b128 a[24:27], v20 offset:37888
    ds_read_b128 a[28:31], v22 offset:1024
    ds_read_b128 a[32:35], v20 offset:2048
    ds_read_b128 a[36:39], v20 offset:20480
    ds_read_b128 a[40:43], v20 offset:38912
    ds_read_b128 a[44:47], v22 offset:2048
    s_waitcnt lgkmcnt(8)
    s_waitcnt vmcnt(25)
    v_mfma_f32_16x16x32_bf16 v[24:27], v[112:115], a[0:3], 0
    ds_read_b128 a[48:51], v20 offset:3072
    v_mfma_f32_16x16x32_bf16 v[28:31], v[112:115], a[4:7], 0
    ds_read_b128 a[52:55], v20 offset:21504
    buffer_load_dwordx4 v[200:203], v10, s[64:67], s14 offen offset:0 sc1
    v_mfma_f32_16x16x32_bf16 v[32:35], v[112:115], a[8:11], 0
    ds_read_b128 a[56:59], v20 offset:39936
    buffer_load_dwordx4 v[220:223], v10, s[64:67], s14 offen offset:1024 sc1
    v_mfma_f32_16x16x32_bf16 v[36:39], v[112:115], a[12:15], 0
    ds_read_b128 a[60:63], v22 offset:3072
    s_waitcnt lgkmcnt(8)
    s_waitcnt vmcnt(26)
    v_mfma_f32_16x16x32_bf16 v[24:27], v[116:119], a[16:19], v[24:27]
    ds_read_b128 a[64:67], v20 offset:4096
    v_mfma_f32_16x16x32_bf16 v[28:31], v[116:119], a[20:23], v[28:31]
    ds_read_b128 a[68:71], v20 offset:22528
    buffer_load_dwordx4 v[96:99], v10, s[64:67], s14 offen offset:2048 sc1
    v_mfma_f32_16x16x32_bf16 v[32:35], v[116:119], a[24:27], v[32:35]
    ds_read_b128 a[72:75], v20 offset:40960
    buffer_load_dwordx4 v[100:103], v10, s[64:67], s14 offen offset:3072 sc1
    v_mfma_f32_16x16x32_bf16 v[36:39], v[116:119], a[28:31], v[36:39]
    ds_read_b128 a[76:79], v22 offset:4096
    s_waitcnt lgkmcnt(8)
    s_waitcnt vmcnt(27)
    v_mfma_f32_16x16x32_bf16 v[24:27], v[120:123], a[32:35], v[24:27]
    ds_read_b128 a[80:83], v20 offset:5120
    v_mfma_f32_16x16x32_bf16 v[28:31], v[120:123], a[36:39], v[28:31]
    ds_read_b128 a[84:87], v20 offset:23552
    buffer_load_dwordx4 v[104:107], v11, s[64:67], s14 offen offset:0 sc1
    v_mfma_f32_16x16x32_bf16 v[32:35], v[120:123], a[40:43], v[32:35]
    ds_read_b128 a[88:91], v20 offset:41984
    buffer_load_dwordx4 v[108:111], v11, s[64:67], s14 offen offset:1024 sc1
    v_mfma_f32_16x16x32_bf16 v[36:39], v[120:123], a[44:47], v[36:39]
    ds_read_b128 a[92:95], v22 offset:5120
    s_waitcnt lgkmcnt(8)
    s_waitcnt vmcnt(28)
    v_mfma_f32_16x16x32_bf16 v[24:27], v[124:127], a[48:51], v[24:27]
    ds_read_b128 a[96:99], v20 offset:6144
    v_mfma_f32_16x16x32_bf16 v[28:31], v[124:127], a[52:55], v[28:31]
    ds_read_b128 a[100:103], v20 offset:24576
    buffer_load_dwordx4 v[64:67], v11, s[64:67], s14 offen offset:2048 sc1
    v_mfma_f32_16x16x32_bf16 v[32:35], v[124:127], a[56:59], v[32:35]
    ds_read_b128 a[104:107], v20 offset:43008
    buffer_load_dwordx4 v[68:71], v11, s[64:67], s14 offen offset:3072 sc1
    v_mfma_f32_16x16x32_bf16 v[36:39], v[124:127], a[60:63], v[36:39]
    ds_read_b128 a[108:111], v22 offset:6144
    s_waitcnt lgkmcnt(8)
    s_waitcnt vmcnt(29)
    v_mfma_f32_16x16x32_bf16 v[24:27], v[128:131], a[64:67], v[24:27]
    ds_read_b128 a[112:115], v20 offset:7168
    v_mfma_f32_16x16x32_bf16 v[28:31], v[128:131], a[68:71], v[28:31]
    ds_read_b128 a[116:119], v20 offset:25600
    buffer_load_dwordx4 v[72:75], v12, s[64:67], s14 offen offset:0 sc1
    v_mfma_f32_16x16x32_bf16 v[32:35], v[128:131], a[72:75], v[32:35]
    ds_read_b128 a[120:123], v20 offset:44032
    buffer_load_dwordx4 v[76:79], v12, s[64:67], s14 offen offset:1024 sc1
    v_mfma_f32_16x16x32_bf16 v[36:39], v[128:131], a[76:79], v[36:39]
    ds_read_b128 a[124:127], v22 offset:7168
    s_waitcnt lgkmcnt(8)
    s_waitcnt vmcnt(30)
    v_mfma_f32_16x16x32_bf16 v[24:27], v[132:135], a[80:83], v[24:27]
    ds_read_b128 a[128:131], v20 offset:8192
    v_mfma_f32_16x16x32_bf16 v[28:31], v[132:135], a[84:87], v[28:31]
    ds_read_b128 a[132:135], v20 offset:26624
    buffer_load_dwordx4 v[80:83], v8, s[64:67], s15 offen offset:0 sc1
    v_mfma_f32_16x16x32_bf16 v[32:35], v[132:135], a[88:91], v[32:35]
    ds_read_b128 a[136:139], v20 offset:45056
    buffer_load_dwordx4 v[84:87], v8, s[64:67], s15 offen offset:1024 sc1
    v_mfma_f32_16x16x32_bf16 v[36:39], v[132:135], a[92:95], v[36:39]
    ds_read_b128 a[140:143], v22 offset:8192
    s_waitcnt lgkmcnt(8)
    s_waitcnt vmcnt(31)
    v_mfma_f32_16x16x32_bf16 v[24:27], v[136:139], a[96:99], v[24:27]
    ds_read_b128 a[144:147], v20 offset:9216
    v_mfma_f32_16x16x32_bf16 v[28:31], v[136:139], a[100:103], v[28:31]
    ds_read_b128 a[148:151], v20 offset:27648
    buffer_load_dwordx4 v[112:115], v8, s[64:67], s15 offen offset:2048 sc1
    v_mfma_f32_16x16x32_bf16 v[32:35], v[136:139], a[104:107], v[32:35]
    ds_read_b128 a[152:155], v20 offset:46080
    buffer_load_dwordx4 v[116:119], v8, s[64:67], s15 offen offset:3072 sc1
    v_mfma_f32_16x16x32_bf16 v[36:39], v[136:139], a[108:111], v[36:39]
    ds_read_b128 a[156:159], v22 offset:9216
    s_waitcnt lgkmcnt(8)
    s_waitcnt vmcnt(32)
    v_mfma_f32_16x16x32_bf16 v[24:27], v[140:143], a[112:115], v[24:27]
    ds_read_b128 a[160:163], v20 offset:10240
    v_mfma_f32_16x16x32_bf16 v[28:31], v[140:143], a[116:119], v[28:31]
    ds_read_b128 a[164:167], v20 offset:28672
    buffer_load_dwordx4 v[120:123], v9, s[64:67], s15 offen offset:0 sc1
    v_mfma_f32_16x16x32_bf16 v[32:35], v[140:143], a[120:123], v[32:35]
    ds_read_b128 a[168:171], v20 offset:47104
    buffer_load_dwordx4 v[124:127], v9, s[64:67], s15 offen offset:1024 sc1
    v_mfma_f32_16x16x32_bf16 v[36:39], v[140:143], a[124:127], v[36:39]
    ds_read_b128 a[172:175], v22 offset:10240
    s_waitcnt lgkmcnt(8)
    s_waitcnt vmcnt(33)
    v_mfma_f32_16x16x32_bf16 v[24:27], v[144:147], a[128:131], v[24:27]
    ds_read_b128 a[176:179], v20 offset:11264
    v_mfma_f32_16x16x32_bf16 v[28:31], v[144:147], a[132:135], v[28:31]
    ds_read_b128 a[180:183], v20 offset:29696
    buffer_load_dwordx4 v[128:131], v9, s[64:67], s15 offen offset:2048 sc1
    v_mfma_f32_16x16x32_bf16 v[32:35], v[144:147], a[136:139], v[32:35]
    ds_read_b128 a[184:187], v20 offset:48128
    buffer_load_dwordx4 v[132:135], v9, s[64:67], s15 offen offset:3072 sc1
    v_mfma_f32_16x16x32_bf16 v[36:39], v[144:147], a[140:143], v[36:39]
    ds_read_b128 a[188:191], v22 offset:11264
    s_waitcnt lgkmcnt(8)
    s_waitcnt vmcnt(34)
    v_mfma_f32_16x16x32_bf16 v[24:27], v[164:167], a[144:147], v[24:27]
    ds_read_b128 a[192:195], v20 offset:12288
    v_mfma_f32_16x16x32_bf16 v[28:31], v[164:167], a[148:151], v[28:31]
    ds_read_b128 a[196:199], v20 offset:30720
    buffer_load_dwordx4 v[136:139], v10, s[64:67], s15 offen offset:0 sc1
    v_mfma_f32_16x16x32_bf16 v[32:35], v[164:167], a[152:155], v[32:35]
    ds_read_b128 a[200:203], v20 offset:49152
    buffer_load_dwordx4 v[140:143], v10, s[64:67], s15 offen offset:1024 sc1
    v_mfma_f32_16x16x32_bf16 v[36:39], v[164:167], a[156:159], v[36:39]
    ds_read_b128 a[204:207], v22 offset:12288
    s_waitcnt lgkmcnt(8)
    s_waitcnt vmcnt(35)
    v_mfma_f32_16x16x32_bf16 v[24:27], v[184:187], a[160:163], v[24:27]
    ds_read_b128 a[208:211], v20 offset:13312
    v_mfma_f32_16x16x32_bf16 v[28:31], v[184:187], a[164:167], v[28:31]
    ds_read_b128 a[212:215], v20 offset:31744
    buffer_load_dwordx4 v[144:147], v10, s[64:67], s15 offen offset:2048 sc1
    v_mfma_f32_16x16x32_bf16 v[32:35], v[184:187], a[168:171], v[32:35]
    ds_read_b128 a[216:219], v20 offset:50176
    v_mfma_f32_16x16x32_bf16 v[36:39], v[184:187], a[172:175], v[36:39]
    ds_read_b128 a[220:223], v22 offset:13312
    s_waitcnt lgkmcnt(8)
    s_waitcnt vmcnt(35)
    v_mfma_f32_16x16x32_bf16 v[24:27], v[204:207], a[176:179], v[24:27]
    ds_read_b128 a[224:227], v20 offset:14336
    v_mfma_f32_16x16x32_bf16 v[28:31], v[204:207], a[180:183], v[28:31]
    ds_read_b128 a[228:231], v20 offset:32768
    buffer_load_dwordx4 v[164:167], v10, s[64:67], s15 offen offset:3072 sc1
    v_mfma_f32_16x16x32_bf16 v[32:35], v[204:207], a[184:187], v[32:35]
    ds_read_b128 a[232:235], v20 offset:51200
    v_mfma_f32_16x16x32_bf16 v[36:39], v[204:207], a[188:191], v[36:39]
    ds_read_b128 a[236:239], v22 offset:14336
    s_waitcnt lgkmcnt(8)
    s_waitcnt vmcnt(35)
    v_mfma_f32_16x16x32_bf16 v[24:27], v[148:151], a[192:195], v[24:27]
    ds_read_b128 a[240:243], v20 offset:15360
    v_mfma_f32_16x16x32_bf16 v[28:31], v[148:151], a[196:199], v[28:31]
    ds_read_b128 a[244:247], v20 offset:33792
    buffer_load_dwordx4 v[184:187], v11, s[64:67], s15 offen offset:0 sc1
    v_mfma_f32_16x16x32_bf16 v[32:35], v[148:151], a[200:203], v[32:35]
    ds_read_b128 a[248:251], v20 offset:52224
    v_mfma_f32_16x16x32_bf16 v[36:39], v[148:151], a[204:207], v[36:39]
    ds_read_b128 a[252:255], v22 offset:15360
    s_waitcnt lgkmcnt(8)
    s_waitcnt vmcnt(35)
    v_mfma_f32_16x16x32_bf16 v[24:27], v[168:171], a[208:211], v[24:27]
    ds_read_b128 v[224:227], v20 offset:16384
    v_mfma_f32_16x16x32_bf16 v[28:31], v[168:171], a[212:215], v[28:31]
    ds_read_b128 v[228:231], v20 offset:34816
    buffer_load_dwordx4 v[204:207], v11, s[64:67], s15 offen offset:1024 sc1
    v_mfma_f32_16x16x32_bf16 v[32:35], v[168:171], a[216:219], v[32:35]
    ds_read_b128 v[232:235], v20 offset:53248
    v_mfma_f32_16x16x32_bf16 v[36:39], v[168:171], a[220:223], v[36:39]
    ds_read_b128 v[236:239], v22 offset:16384
    s_waitcnt lgkmcnt(8)
    s_waitcnt vmcnt(35)
    v_mfma_f32_16x16x32_bf16 v[24:27], v[188:191], a[224:227], v[24:27]
    ds_read_b128 v[240:243], v20 offset:17408
    v_mfma_f32_16x16x32_bf16 v[28:31], v[188:191], a[228:231], v[28:31]
    ds_read_b128 v[244:247], v20 offset:35840
    buffer_load_dwordx4 v[148:151], v11, s[64:67], s15 offen offset:2048 sc1
    v_mfma_f32_16x16x32_bf16 v[32:35], v[188:191], a[232:235], v[32:35]
    ds_read_b128 v[248:251], v20 offset:54272
    v_mfma_f32_16x16x32_bf16 v[36:39], v[188:191], a[236:239], v[36:39]
    ds_read_b128 v[252:255], v22 offset:17408
    s_waitcnt lgkmcnt(8)
    s_waitcnt vmcnt(35)
    v_mfma_f32_16x16x32_bf16 v[24:27], v[208:211], a[240:243], v[24:27]
    v_mfma_f32_16x16x32_bf16 v[28:31], v[208:211], a[244:247], v[28:31]
    buffer_load_dwordx4 v[168:171], v11, s[64:67], s15 offen offset:3072 sc1
    v_mfma_f32_16x16x32_bf16 v[32:35], v[208:211], a[248:251], v[32:35]
    v_mfma_f32_16x16x32_bf16 v[36:39], v[208:211], a[252:255], v[36:39]
    s_waitcnt lgkmcnt(4)
    s_waitcnt vmcnt(35)
    v_mfma_f32_16x16x32_bf16 v[24:27], v[152:155], v[224:227], v[24:27]
    v_mfma_f32_16x16x32_bf16 v[28:31], v[152:155], v[228:231], v[28:31]
    buffer_load_dwordx4 v[188:191], v12, s[64:67], s15 offen offset:0 sc1
    v_mfma_f32_16x16x32_bf16 v[32:35], v[152:155], v[232:235], v[32:35]
    v_mfma_f32_16x16x32_bf16 v[36:39], v[152:155], v[236:239], v[36:39]
    s_waitcnt lgkmcnt(0)
    s_waitcnt vmcnt(35)
    v_mfma_f32_16x16x32_bf16 v[24:27], v[172:175], v[240:243], v[24:27]
    v_mfma_f32_16x16x32_bf16 v[28:31], v[172:175], v[244:247], v[28:31]
    buffer_load_dwordx4 v[208:211], v12, s[64:67], s15 offen offset:1024 sc1
    v_mfma_f32_16x16x32_bf16 v[32:35], v[172:175], v[248:251], v[32:35]
    v_mfma_f32_16x16x32_bf16 v[36:39], v[172:175], v[252:255], v[36:39]
    s_waitcnt vmcnt(35)
    s_nop 0
    v_mfma_f32_16x16x32_bf16 v[40:43], v[192:195], a[0:3], 0
    v_mfma_f32_16x16x32_bf16 v[44:47], v[192:195], a[4:7], 0
    buffer_load_dwordx4 v[152:155], v8, s[64:67], s16 offen offset:0 sc1
    v_mfma_f32_16x16x32_bf16 v[48:51], v[192:195], a[8:11], 0
    v_mfma_f32_16x16x32_bf16 v[52:55], v[192:195], a[12:15], 0
    s_waitcnt vmcnt(35)
    s_nop 0
    v_mfma_f32_16x16x32_bf16 v[40:43], v[212:215], a[16:19], v[40:43]
    v_mfma_f32_16x16x32_bf16 v[44:47], v[212:215], a[20:23], v[44:47]
    buffer_load_dwordx4 v[172:175], v8, s[64:67], s16 offen offset:1024 sc1
    v_mfma_f32_16x16x32_bf16 v[48:51], v[212:215], a[24:27], v[48:51]
    v_mfma_f32_16x16x32_bf16 v[52:55], v[212:215], a[28:31], v[52:55]
    s_waitcnt vmcnt(35)
    s_nop 0
    v_mfma_f32_16x16x32_bf16 v[40:43], v[156:159], a[32:35], v[40:43]
    v_cvt_pk_bf16_f32 v56, v24, v25
    v_mfma_f32_16x16x32_bf16 v[44:47], v[156:159], a[36:39], v[44:47]
    buffer_load_dwordx4 v[192:195], v8, s[64:67], s16 offen offset:2048 sc1
    v_mfma_f32_16x16x32_bf16 v[48:51], v[156:159], a[40:43], v[48:51]
    v_cvt_pk_bf16_f32 v57, v26, v27
    v_mfma_f32_16x16x32_bf16 v[52:55], v[156:159], a[44:47], v[52:55]
    v_cvt_pk_bf16_f32 v58, v28, v29
    s_waitcnt vmcnt(35)
    s_nop 0
    v_mfma_f32_16x16x32_bf16 v[40:43], v[176:179], a[48:51], v[40:43]
    v_cvt_pk_bf16_f32 v59, v30, v31
    v_mfma_f32_16x16x32_bf16 v[44:47], v[176:179], a[52:55], v[44:47]
    buffer_load_dwordx4 v[212:215], v8, s[64:67], s16 offen offset:3072 sc1
    v_mfma_f32_16x16x32_bf16 v[48:51], v[176:179], a[56:59], v[48:51]
    buffer_store_dwordx4 v[56:59], v21, s[64:67], s32 offen offset:0 sc1
    v_mfma_f32_16x16x32_bf16 v[52:55], v[176:179], a[60:63], v[52:55]
    s_waitcnt vmcnt(36)
    s_nop 0
    v_mfma_f32_16x16x32_bf16 v[40:43], v[196:199], a[64:67], v[40:43]
    v_mfma_f32_16x16x32_bf16 v[44:47], v[196:199], a[68:71], v[44:47]
    buffer_load_dwordx4 v[156:159], v9, s[64:67], s16 offen offset:0 sc1
    v_mfma_f32_16x16x32_bf16 v[48:51], v[196:199], a[72:75], v[48:51]
    v_mfma_f32_16x16x32_bf16 v[52:55], v[196:199], a[76:79], v[52:55]
    s_waitcnt vmcnt(36)
    s_nop 0
    v_mfma_f32_16x16x32_bf16 v[40:43], v[216:219], a[80:83], v[40:43]
    v_mfma_f32_16x16x32_bf16 v[44:47], v[216:219], a[84:87], v[44:47]
    buffer_load_dwordx4 v[176:179], v9, s[64:67], s16 offen offset:1024 sc1
    v_mfma_f32_16x16x32_bf16 v[48:51], v[216:219], a[88:91], v[48:51]
    v_mfma_f32_16x16x32_bf16 v[52:55], v[216:219], a[92:95], v[52:55]
    s_waitcnt vmcnt(36)
    s_nop 0
    v_mfma_f32_16x16x32_bf16 v[40:43], v[160:163], a[96:99], v[40:43]
    v_mfma_f32_16x16x32_bf16 v[44:47], v[160:163], a[100:103], v[44:47]
    buffer_load_dwordx4 v[196:199], v9, s[64:67], s16 offen offset:2048 sc1
    v_mfma_f32_16x16x32_bf16 v[48:51], v[160:163], a[104:107], v[48:51]
    v_mfma_f32_16x16x32_bf16 v[52:55], v[160:163], a[108:111], v[52:55]
    s_waitcnt vmcnt(36)
    s_nop 0
    v_mfma_f32_16x16x32_bf16 v[40:43], v[180:183], a[112:115], v[40:43]
    v_mfma_f32_16x16x32_bf16 v[44:47], v[180:183], a[116:119], v[44:47]
    buffer_load_dwordx4 v[216:219], v9, s[64:67], s16 offen offset:3072 sc1
    v_mfma_f32_16x16x32_bf16 v[48:51], v[180:183], a[120:123], v[48:51]
    v_mfma_f32_16x16x32_bf16 v[52:55], v[180:183], a[124:127], v[52:55]
    s_waitcnt vmcnt(36)
    s_nop 0
    v_mfma_f32_16x16x32_bf16 v[40:43], v[200:203], a[128:131], v[40:43]
    v_mfma_f32_16x16x32_bf16 v[44:47], v[200:203], a[132:135], v[44:47]
    buffer_load_dwordx4 v[160:163], v10, s[64:67], s16 offen offset:0 sc1
    v_mfma_f32_16x16x32_bf16 v[48:51], v[200:203], a[136:139], v[48:51]
    v_mfma_f32_16x16x32_bf16 v[52:55], v[200:203], a[140:143], v[52:55]
    s_waitcnt vmcnt(36)
    s_nop 0
    v_mfma_f32_16x16x32_bf16 v[40:43], v[220:223], a[144:147], v[40:43]
    v_mfma_f32_16x16x32_bf16 v[44:47], v[220:223], a[148:151], v[44:47]
    buffer_load_dwordx4 v[180:183], v10, s[64:67], s16 offen offset:1024 sc1
    v_mfma_f32_16x16x32_bf16 v[48:51], v[220:223], a[152:155], v[48:51]
    v_mfma_f32_16x16x32_bf16 v[52:55], v[220:223], a[156:159], v[52:55]
    s_waitcnt vmcnt(36)
    s_nop 0
    v_mfma_f32_16x16x32_bf16 v[40:43], v[96:99], a[160:163], v[40:43]
    v_cvt_pk_bf16_f32 v60, v32, v33
    v_mfma_f32_16x16x32_bf16 v[44:47], v[96:99], a[164:167], v[44:47]
    buffer_load_dwordx4 v[200:203], v10, s[64:67], s16 offen offset:2048 sc1
    v_mfma_f32_16x16x32_bf16 v[48:51], v[96:99], a[168:171], v[48:51]
    v_cvt_pk_bf16_f32 v61, v34, v35
    v_mfma_f32_16x16x32_bf16 v[52:55], v[96:99], a[172:175], v[52:55]
    v_cvt_pk_bf16_f32 v62, v36, v37
    s_waitcnt vmcnt(36)
    s_nop 0
    v_mfma_f32_16x16x32_bf16 v[40:43], v[100:103], a[176:179], v[40:43]
    v_cvt_pk_bf16_f32 v63, v38, v39
    v_mfma_f32_16x16x32_bf16 v[44:47], v[100:103], a[180:183], v[44:47]
    buffer_load_dwordx4 v[220:223], v10, s[64:67], s16 offen offset:3072 sc1
    v_mfma_f32_16x16x32_bf16 v[48:51], v[100:103], a[184:187], v[48:51]
    buffer_store_dwordx4 v[60:63], v21, s[64:67], s32 offen offset:1024 sc1
    v_mfma_f32_16x16x32_bf16 v[52:55], v[100:103], a[188:191], v[52:55]
    s_waitcnt vmcnt(37)
    s_nop 0
    v_mfma_f32_16x16x32_bf16 v[40:43], v[104:107], a[192:195], v[40:43]
    v_mfma_f32_16x16x32_bf16 v[44:47], v[104:107], a[196:199], v[44:47]
    buffer_load_dwordx4 v[96:99], v11, s[64:67], s16 offen offset:0 sc1
    v_mfma_f32_16x16x32_bf16 v[48:51], v[104:107], a[200:203], v[48:51]
    v_mfma_f32_16x16x32_bf16 v[52:55], v[104:107], a[204:207], v[52:55]
    s_waitcnt vmcnt(37)
    s_nop 0
    v_mfma_f32_16x16x32_bf16 v[40:43], v[108:111], a[208:211], v[40:43]
    v_mfma_f32_16x16x32_bf16 v[44:47], v[108:111], a[212:215], v[44:47]
    buffer_load_dwordx4 v[100:103], v11, s[64:67], s16 offen offset:1024 sc1
    v_mfma_f32_16x16x32_bf16 v[48:51], v[108:111], a[216:219], v[48:51]
    v_mfma_f32_16x16x32_bf16 v[52:55], v[108:111], a[220:223], v[52:55]
    s_waitcnt vmcnt(37)
    s_nop 0
    v_mfma_f32_16x16x32_bf16 v[40:43], v[64:67], a[224:227], v[40:43]
    v_mfma_f32_16x16x32_bf16 v[44:47], v[64:67], a[228:231], v[44:47]
    buffer_load_dwordx4 v[104:107], v11, s[64:67], s16 offen offset:2048 sc1
    v_mfma_f32_16x16x32_bf16 v[48:51], v[64:67], a[232:235], v[48:51]
    v_mfma_f32_16x16x32_bf16 v[52:55], v[64:67], a[236:239], v[52:55]
    s_waitcnt vmcnt(37)
    s_nop 0
    v_mfma_f32_16x16x32_bf16 v[40:43], v[68:71], a[240:243], v[40:43]
    v_mfma_f32_16x16x32_bf16 v[44:47], v[68:71], a[244:247], v[44:47]
    buffer_load_dwordx4 v[108:111], v11, s[64:67], s16 offen offset:3072 sc1
    v_mfma_f32_16x16x32_bf16 v[48:51], v[68:71], a[248:251], v[48:51]
    v_mfma_f32_16x16x32_bf16 v[52:55], v[68:71], a[252:255], v[52:55]
    s_waitcnt vmcnt(37)
    s_nop 0
    v_mfma_f32_16x16x32_bf16 v[40:43], v[72:75], v[224:227], v[40:43]
    v_mfma_f32_16x16x32_bf16 v[44:47], v[72:75], v[228:231], v[44:47]
    buffer_load_dwordx4 v[64:67], v12, s[64:67], s16 offen offset:0 sc1
    v_mfma_f32_16x16x32_bf16 v[48:51], v[72:75], v[232:235], v[48:51]
    v_mfma_f32_16x16x32_bf16 v[52:55], v[72:75], v[236:239], v[52:55]
    s_waitcnt vmcnt(37)
    s_nop 0
    v_mfma_f32_16x16x32_bf16 v[40:43], v[76:79], v[240:243], v[40:43]
    v_mfma_f32_16x16x32_bf16 v[44:47], v[76:79], v[244:247], v[44:47]
    buffer_load_dwordx4 v[68:71], v12, s[64:67], s16 offen offset:1024 sc1
    v_mfma_f32_16x16x32_bf16 v[48:51], v[76:79], v[248:251], v[48:51]
    v_mfma_f32_16x16x32_bf16 v[52:55], v[76:79], v[252:255], v[52:55]
    s_waitcnt vmcnt(37)
    s_nop 0
    v_mfma_f32_16x16x32_bf16 v[24:27], v[80:83], a[0:3], 0
    v_mfma_f32_16x16x32_bf16 v[28:31], v[80:83], a[4:7], 0
    v_mfma_f32_16x16x32_bf16 v[32:35], v[80:83], a[8:11], 0
    v_mfma_f32_16x16x32_bf16 v[36:39], v[80:83], a[12:15], 0
    s_waitcnt vmcnt(36)
    s_nop 0
    v_mfma_f32_16x16x32_bf16 v[24:27], v[84:87], a[16:19], v[24:27]
    v_mfma_f32_16x16x32_bf16 v[28:31], v[84:87], a[20:23], v[28:31]
    v_mfma_f32_16x16x32_bf16 v[32:35], v[84:87], a[24:27], v[32:35]
    v_mfma_f32_16x16x32_bf16 v[36:39], v[84:87], a[28:31], v[36:39]
    s_waitcnt vmcnt(35)
    s_nop 0
    v_mfma_f32_16x16x32_bf16 v[24:27], v[112:115], a[32:35], v[24:27]
    v_cvt_pk_bf16_f32 v56, v40, v41
    v_mfma_f32_16x16x32_bf16 v[28:31], v[112:115], a[36:39], v[28:31]
    v_cvt_pk_bf16_f32 v57, v42, v43
    v_mfma_f32_16x16x32_bf16 v[32:35], v[112:115], a[40:43], v[32:35]
    v_cvt_pk_bf16_f32 v58, v44, v45
    v_mfma_f32_16x16x32_bf16 v[36:39], v[112:115], a[44:47], v[36:39]
    v_cvt_pk_bf16_f32 v59, v46, v47
    s_waitcnt vmcnt(34)
    s_nop 0
    v_mfma_f32_16x16x32_bf16 v[24:27], v[116:119], a[48:51], v[24:27]
    buffer_store_dwordx4 v[56:59], v21, s[64:67], s33 offen offset:0 sc1
    v_mfma_f32_16x16x32_bf16 v[28:31], v[116:119], a[52:55], v[28:31]
    buffer_load_dwordx4 v[112:115], v8, s[64:67], s17 offen offset:0 sc1
    v_mfma_f32_16x16x32_bf16 v[32:35], v[116:119], a[56:59], v[32:35]
    v_mfma_f32_16x16x32_bf16 v[36:39], v[116:119], a[60:63], v[36:39]
    s_waitcnt vmcnt(35)
    s_nop 0
    v_mfma_f32_16x16x32_bf16 v[24:27], v[120:123], a[64:67], v[24:27]
    v_mfma_f32_16x16x32_bf16 v[28:31], v[120:123], a[68:71], v[28:31]
    buffer_load_dwordx4 v[116:119], v8, s[64:67], s17 offen offset:1024 sc1
    v_mfma_f32_16x16x32_bf16 v[32:35], v[120:123], a[72:75], v[32:35]
    v_mfma_f32_16x16x32_bf16 v[36:39], v[120:123], a[76:79], v[36:39]
    s_waitcnt vmcnt(35)
    s_nop 0
    v_mfma_f32_16x16x32_bf16 v[24:27], v[124:127], a[80:83], v[24:27]
    v_mfma_f32_16x16x32_bf16 v[28:31], v[124:127], a[84:87], v[28:31]
    buffer_load_dwordx4 v[120:123], v8, s[64:67], s17 offen offset:2048 sc1
    v_mfma_f32_16x16x32_bf16 v[32:35], v[124:127], a[88:91], v[32:35]
    v_mfma_f32_16x16x32_bf16 v[36:39], v[124:127], a[92:95], v[36:39]
    s_waitcnt vmcnt(35)
    s_nop 0
    v_mfma_f32_16x16x32_bf16 v[24:27], v[128:131], a[96:99], v[24:27]
    v_mfma_f32_16x16x32_bf16 v[28:31], v[128:131], a[100:103], v[28:31]
    buffer_load_dwordx4 v[124:127], v8, s[64:67], s17 offen offset:3072 sc1
    v_mfma_f32_16x16x32_bf16 v[32:35], v[128:131], a[104:107], v[32:35]
    v_mfma_f32_16x16x32_bf16 v[36:39], v[128:131], a[108:111], v[36:39]
    s_waitcnt vmcnt(35)
    s_nop 0
    v_mfma_f32_16x16x32_bf16 v[24:27], v[132:135], a[112:115], v[24:27]
    v_mfma_f32_16x16x32_bf16 v[28:31], v[132:135], a[116:119], v[28:31]
    buffer_load_dwordx4 v[128:131], v9, s[64:67], s17 offen offset:0 sc1
    v_mfma_f32_16x16x32_bf16 v[32:35], v[132:135], a[120:123], v[32:35]
    v_mfma_f32_16x16x32_bf16 v[36:39], v[132:135], a[124:127], v[36:39]
    s_waitcnt vmcnt(35)
    s_nop 0
    v_mfma_f32_16x16x32_bf16 v[24:27], v[136:139], a[128:131], v[24:27]
    v_mfma_f32_16x16x32_bf16 v[28:31], v[136:139], a[132:135], v[28:31]
    buffer_load_dwordx4 v[132:135], v9, s[64:67], s17 offen offset:1024 sc1
    v_mfma_f32_16x16x32_bf16 v[32:35], v[136:139], a[136:139], v[32:35]
    v_mfma_f32_16x16x32_bf16 v[36:39], v[136:139], a[140:143], v[36:39]
    s_waitcnt vmcnt(35)
    s_nop 0
    v_mfma_f32_16x16x32_bf16 v[24:27], v[140:143], a[144:147], v[24:27]
    v_mfma_f32_16x16x32_bf16 v[28:31], v[140:143], a[148:151], v[28:31]
    buffer_load_dwordx4 v[136:139], v9, s[64:67], s17 offen offset:2048 sc1
    v_mfma_f32_16x16x32_bf16 v[32:35], v[140:143], a[152:155], v[32:35]
    v_mfma_f32_16x16x32_bf16 v[36:39], v[140:143], a[156:159], v[36:39]
    s_waitcnt vmcnt(35)
    s_nop 0
    v_mfma_f32_16x16x32_bf16 v[24:27], v[144:147], a[160:163], v[24:27]
    v_cvt_pk_bf16_f32 v60, v48, v49
    v_mfma_f32_16x16x32_bf16 v[28:31], v[144:147], a[164:167], v[28:31]
    buffer_load_dwordx4 v[140:143], v9, s[64:67], s17 offen offset:3072 sc1
    v_mfma_f32_16x16x32_bf16 v[32:35], v[144:147], a[168:171], v[32:35]
    v_cvt_pk_bf16_f32 v61, v50, v51
    v_mfma_f32_16x16x32_bf16 v[36:39], v[144:147], a[172:175], v[36:39]
    v_cvt_pk_bf16_f32 v62, v52, v53
    s_waitcnt vmcnt(35)
    s_nop 0
    v_mfma_f32_16x16x32_bf16 v[24:27], v[164:167], a[176:179], v[24:27]
    v_cvt_pk_bf16_f32 v63, v54, v55
    v_mfma_f32_16x16x32_bf16 v[28:31], v[164:167], a[180:183], v[28:31]
    buffer_load_dwordx4 v[144:147], v10, s[64:67], s17 offen offset:0 sc1
    v_mfma_f32_16x16x32_bf16 v[32:35], v[164:167], a[184:187], v[32:35]
    buffer_store_dwordx4 v[60:63], v21, s[64:67], s33 offen offset:1024 sc1
    v_mfma_f32_16x16x32_bf16 v[36:39], v[164:167], a[188:191], v[36:39]
    s_waitcnt vmcnt(36)
    s_nop 0
    v_mfma_f32_16x16x32_bf16 v[24:27], v[184:187], a[192:195], v[24:27]
    v_mfma_f32_16x16x32_bf16 v[28:31], v[184:187], a[196:199], v[28:31]
    buffer_load_dwordx4 v[164:167], v10, s[64:67], s17 offen offset:1024 sc1
    v_mfma_f32_16x16x32_bf16 v[32:35], v[184:187], a[200:203], v[32:35]
    v_mfma_f32_16x16x32_bf16 v[36:39], v[184:187], a[204:207], v[36:39]
    s_waitcnt vmcnt(36)
    s_nop 0
    v_mfma_f32_16x16x32_bf16 v[24:27], v[204:207], a[208:211], v[24:27]
    v_mfma_f32_16x16x32_bf16 v[28:31], v[204:207], a[212:215], v[28:31]
    buffer_load_dwordx4 v[184:187], v10, s[64:67], s17 offen offset:2048 sc1
    v_mfma_f32_16x16x32_bf16 v[32:35], v[204:207], a[216:219], v[32:35]
    v_mfma_f32_16x16x32_bf16 v[36:39], v[204:207], a[220:223], v[36:39]
    s_waitcnt vmcnt(36)
    s_nop 0
    v_mfma_f32_16x16x32_bf16 v[24:27], v[148:151], a[224:227], v[24:27]
    v_mfma_f32_16x16x32_bf16 v[28:31], v[148:151], a[228:231], v[28:31]
    buffer_load_dwordx4 v[204:207], v10, s[64:67], s17 offen offset:3072 sc1
    v_mfma_f32_16x16x32_bf16 v[32:35], v[148:151], a[232:235], v[32:35]
    v_mfma_f32_16x16x32_bf16 v[36:39], v[148:151], a[236:239], v[36:39]
    s_waitcnt vmcnt(36)
    s_nop 0
    v_mfma_f32_16x16x32_bf16 v[24:27], v[168:171], a[240:243], v[24:27]
    v_mfma_f32_16x16x32_bf16 v[28:31], v[168:171], a[244:247], v[28:31]
    buffer_load_dwordx4 v[148:151], v11, s[64:67], s17 offen offset:0 sc1
    v_mfma_f32_16x16x32_bf16 v[32:35], v[168:171], a[248:251], v[32:35]
    v_mfma_f32_16x16x32_bf16 v[36:39], v[168:171], a[252:255], v[36:39]
    s_waitcnt vmcnt(36)
    s_nop 0
    v_mfma_f32_16x16x32_bf16 v[24:27], v[188:191], v[224:227], v[24:27]
    v_mfma_f32_16x16x32_bf16 v[28:31], v[188:191], v[228:231], v[28:31]
    buffer_load_dwordx4 v[168:171], v11, s[64:67], s17 offen offset:1024 sc1
    v_mfma_f32_16x16x32_bf16 v[32:35], v[188:191], v[232:235], v[32:35]
    v_mfma_f32_16x16x32_bf16 v[36:39], v[188:191], v[236:239], v[36:39]
    s_waitcnt vmcnt(36)
    s_nop 0
    v_mfma_f32_16x16x32_bf16 v[24:27], v[208:211], v[240:243], v[24:27]
    v_mfma_f32_16x16x32_bf16 v[28:31], v[208:211], v[244:247], v[28:31]
    buffer_load_dwordx4 v[188:191], v11, s[64:67], s17 offen offset:2048 sc1
    v_mfma_f32_16x16x32_bf16 v[32:35], v[208:211], v[248:251], v[32:35]
    v_mfma_f32_16x16x32_bf16 v[36:39], v[208:211], v[252:255], v[36:39]
    s_waitcnt vmcnt(36)
    s_nop 0
    v_mfma_f32_16x16x32_bf16 v[40:43], v[152:155], a[0:3], 0
    v_mfma_f32_16x16x32_bf16 v[44:47], v[152:155], a[4:7], 0
    buffer_load_dwordx4 v[208:211], v11, s[64:67], s17 offen offset:3072 sc1
    v_mfma_f32_16x16x32_bf16 v[48:51], v[152:155], a[8:11], 0
    v_mfma_f32_16x16x32_bf16 v[52:55], v[152:155], a[12:15], 0
    s_waitcnt vmcnt(36)
    s_nop 0
    v_mfma_f32_16x16x32_bf16 v[40:43], v[172:175], a[16:19], v[40:43]
    v_mfma_f32_16x16x32_bf16 v[44:47], v[172:175], a[20:23], v[44:47]
    buffer_load_dwordx4 v[152:155], v12, s[64:67], s17 offen offset:0 sc1
    v_mfma_f32_16x16x32_bf16 v[48:51], v[172:175], a[24:27], v[48:51]
    v_mfma_f32_16x16x32_bf16 v[52:55], v[172:175], a[28:31], v[52:55]
    s_waitcnt vmcnt(36)
    s_nop 0
    v_mfma_f32_16x16x32_bf16 v[40:43], v[192:195], a[32:35], v[40:43]
    v_cvt_pk_bf16_f32 v56, v24, v25
    v_mfma_f32_16x16x32_bf16 v[44:47], v[192:195], a[36:39], v[44:47]
    buffer_load_dwordx4 v[172:175], v12, s[64:67], s17 offen offset:1024 sc1
    v_mfma_f32_16x16x32_bf16 v[48:51], v[192:195], a[40:43], v[48:51]
    v_cvt_pk_bf16_f32 v57, v26, v27
    v_mfma_f32_16x16x32_bf16 v[52:55], v[192:195], a[44:47], v[52:55]
    v_cvt_pk_bf16_f32 v58, v28, v29
    s_waitcnt vmcnt(36)
    s_nop 0
    v_mfma_f32_16x16x32_bf16 v[40:43], v[212:215], a[48:51], v[40:43]
    v_cvt_pk_bf16_f32 v59, v30, v31
    v_mfma_f32_16x16x32_bf16 v[44:47], v[212:215], a[52:55], v[44:47]
    buffer_load_dwordx4 v[192:195], v8, s[64:67], s18 offen offset:0 sc1
    v_mfma_f32_16x16x32_bf16 v[48:51], v[212:215], a[56:59], v[48:51]
    buffer_store_dwordx4 v[56:59], v21, s[64:67], s34 offen offset:0 sc1
    v_mfma_f32_16x16x32_bf16 v[52:55], v[212:215], a[60:63], v[52:55]
L_stub_17:
    s_cbranch_execz L_tchret_m2_m3
    s_waitcnt vmcnt(36)
    v_mfma_f32_16x16x32_bf16 v[40:43], v[156:159], a[64:67], v[40:43]
    v_mfma_f32_16x16x32_bf16 v[44:47], v[156:159], a[68:71], v[44:47]
    buffer_load_dwordx4 v[212:215], v8, s[64:67], s18 offen offset:1024 sc1
    v_mfma_f32_16x16x32_bf16 v[48:51], v[156:159], a[72:75], v[48:51]
    v_mfma_f32_16x16x32_bf16 v[52:55], v[156:159], a[76:79], v[52:55]
    s_waitcnt vmcnt(36)
    s_nop 0
    v_mfma_f32_16x16x32_bf16 v[40:43], v[176:179], a[80:83], v[40:43]
    v_mfma_f32_16x16x32_bf16 v[44:47], v[176:179], a[84:87], v[44:47]
    buffer_load_dwordx4 v[156:159], v8, s[64:67], s18 offen offset:2048 sc1
    v_mfma_f32_16x16x32_bf16 v[48:51], v[176:179], a[88:91], v[48:51]
    v_mfma_f32_16x16x32_bf16 v[52:55], v[176:179], a[92:95], v[52:55]
    s_waitcnt vmcnt(36)
    s_nop 0
    v_mfma_f32_16x16x32_bf16 v[40:43], v[196:199], a[96:99], v[40:43]
    v_mfma_f32_16x16x32_bf16 v[44:47], v[196:199], a[100:103], v[44:47]
    buffer_load_dwordx4 v[176:179], v8, s[64:67], s18 offen offset:3072 sc1
    v_mfma_f32_16x16x32_bf16 v[48:51], v[196:199], a[104:107], v[48:51]
    v_mfma_f32_16x16x32_bf16 v[52:55], v[196:199], a[108:111], v[52:55]
    s_waitcnt vmcnt(36)
    s_nop 0
    v_mfma_f32_16x16x32_bf16 v[40:43], v[216:219], a[112:115], v[40:43]
    v_mfma_f32_16x16x32_bf16 v[44:47], v[216:219], a[116:119], v[44:47]
    buffer_load_dwordx4 v[196:199], v9, s[64:67], s18 offen offset:0 sc1
    v_mfma_f32_16x16x32_bf16 v[48:51], v[216:219], a[120:123], v[48:51]
    v_mfma_f32_16x16x32_bf16 v[52:55], v[216:219], a[124:127], v[52:55]
    s_waitcnt vmcnt(36)
    s_nop 0
    v_mfma_f32_16x16x32_bf16 v[40:43], v[160:163], a[128:131], v[40:43]
    v_mfma_f32_16x16x32_bf16 v[44:47], v[160:163], a[132:135], v[44:47]
    buffer_load_dwordx4 v[216:219], v9, s[64:67], s18 offen offset:1024 sc1
    v_mfma_f32_16x16x32_bf16 v[48:51], v[160:163], a[136:139], v[48:51]
    v_mfma_f32_16x16x32_bf16 v[52:55], v[160:163], a[140:143], v[52:55]
    s_waitcnt vmcnt(36)
    s_nop 0
    v_mfma_f32_16x16x32_bf16 v[40:43], v[180:183], a[144:147], v[40:43]
    v_mfma_f32_16x16x32_bf16 v[44:47], v[180:183], a[148:151], v[44:47]
    buffer_load_dwordx4 v[160:163], v9, s[64:67], s18 offen offset:2048 sc1
    v_mfma_f32_16x16x32_bf16 v[48:51], v[180:183], a[152:155], v[48:51]
    v_mfma_f32_16x16x32_bf16 v[52:55], v[180:183], a[156:159], v[52:55]
    s_waitcnt vmcnt(36)
    s_nop 0
    v_mfma_f32_16x16x32_bf16 v[40:43], v[200:203], a[160:163], v[40:43]
    v_cvt_pk_bf16_f32 v60, v32, v33
    v_mfma_f32_16x16x32_bf16 v[44:47], v[200:203], a[164:167], v[44:47]
    buffer_load_dwordx4 v[180:183], v9, s[64:67], s18 offen offset:3072 sc1
    v_mfma_f32_16x16x32_bf16 v[48:51], v[200:203], a[168:171], v[48:51]
    v_cvt_pk_bf16_f32 v61, v34, v35
    v_mfma_f32_16x16x32_bf16 v[52:55], v[200:203], a[172:175], v[52:55]
    v_cvt_pk_bf16_f32 v62, v36, v37
    s_waitcnt vmcnt(36)
    s_nop 0
    v_mfma_f32_16x16x32_bf16 v[40:43], v[220:223], a[176:179], v[40:43]
    v_cvt_pk_bf16_f32 v63, v38, v39
    v_mfma_f32_16x16x32_bf16 v[44:47], v[220:223], a[180:183], v[44:47]
    buffer_load_dwordx4 v[200:203], v10, s[64:67], s18 offen offset:0 sc1
    v_mfma_f32_16x16x32_bf16 v[48:51], v[220:223], a[184:187], v[48:51]
    buffer_store_dwordx4 v[60:63], v21, s[64:67], s34 offen offset:1024 sc1
    v_mfma_f32_16x16x32_bf16 v[52:55], v[220:223], a[188:191], v[52:55]
    s_waitcnt vmcnt(36)
    s_nop 0
    v_mfma_f32_16x16x32_bf16 v[40:43], v[96:99], a[192:195], v[40:43]
    v_mfma_f32_16x16x32_bf16 v[44:47], v[96:99], a[196:199], v[44:47]
    buffer_load_dwordx4 v[220:223], v10, s[64:67], s18 offen offset:1024 sc1
    v_mfma_f32_16x16x32_bf16 v[48:51], v[96:99], a[200:203], v[48:51]
    v_mfma_f32_16x16x32_bf16 v[52:55], v[96:99], a[204:207], v[52:55]
    s_waitcnt vmcnt(36)
    s_nop 0
    v_mfma_f32_16x16x32_bf16 v[40:43], v[100:103], a[208:211], v[40:43]
    v_mfma_f32_16x16x32_bf16 v[44:47], v[100:103], a[212:215], v[44:47]
    buffer_load_dwordx4 v[96:99], v10, s[64:67], s18 offen offset:2048 sc1
    v_mfma_f32_16x16x32_bf16 v[48:51], v[100:103], a[216:219], v[48:51]
    v_mfma_f32_16x16x32_bf16 v[52:55], v[100:103], a[220:223], v[52:55]
    s_waitcnt vmcnt(36)
    s_nop 0
    v_mfma_f32_16x16x32_bf16 v[40:43], v[104:107], a[224:227], v[40:43]
    v_mfma_f32_16x16x32_bf16 v[44:47], v[104:107], a[228:231], v[44:47]
    buffer_load_dwordx4 v[100:103], v10, s[64:67], s18 offen offset:3072 sc1
    v_mfma_f32_16x16x32_bf16 v[48:51], v[104:107], a[232:235], v[48:51]
    v_mfma_f32_16x16x32_bf16 v[52:55], v[104:107], a[236:239], v[52:55]
    s_waitcnt vmcnt(36)
    s_nop 0
    v_mfma_f32_16x16x32_bf16 v[40:43], v[108:111], a[240:243], v[40:43]
    v_mfma_f32_16x16x32_bf16 v[44:47], v[108:111], a[244:247], v[44:47]
    buffer_load_dwordx4 v[104:107], v11, s[64:67], s18 offen offset:0 sc1
    v_mfma_f32_16x16x32_bf16 v[48:51], v[108:111], a[248:251], v[48:51]
    v_mfma_f32_16x16x32_bf16 v[52:55], v[108:111], a[252:255], v[52:55]
    s_waitcnt vmcnt(36)
    s_nop 0
    v_mfma_f32_16x16x32_bf16 v[40:43], v[64:67], v[224:227], v[40:43]
    v_mfma_f32_16x16x32_bf16 v[44:47], v[64:67], v[228:231], v[44:47]
    buffer_load_dwordx4 v[108:111], v11, s[64:67], s18 offen offset:1024 sc1
    v_mfma_f32_16x16x32_bf16 v[48:51], v[64:67], v[232:235], v[48:51]
    v_mfma_f32_16x16x32_bf16 v[52:55], v[64:67], v[236:239], v[52:55]
    s_waitcnt vmcnt(36)
    s_nop 0
    v_mfma_f32_16x16x32_bf16 v[40:43], v[68:71], v[240:243], v[40:43]
    v_mfma_f32_16x16x32_bf16 v[44:47], v[68:71], v[244:247], v[44:47]
    v_mfma_f32_16x16x32_bf16 v[48:51], v[68:71], v[248:251], v[48:51]
    v_mfma_f32_16x16x32_bf16 v[52:55], v[68:71], v[252:255], v[52:55]
    s_waitcnt vmcnt(34)
    s_nop 0
    v_mfma_f32_16x16x32_bf16 v[24:27], v[112:115], a[0:3], 0
    v_lshrrev_b32 v4, 1, v3
    v_lshlrev_b32 v4, 8, v4
    v_mfma_f32_16x16x32_bf16 v[28:31], v[112:115], a[4:7], 0
    v_lshl_add_u32 v4, v2, 4, v4
    v_and_b32_e64 v5, 1, v3
    v_mfma_f32_16x16x32_bf16 v[32:35], v[112:115], a[8:11], 0
    v_lshl_add_u32 v4, v5, 3, v4
    v_mul_u32_u24 v5, 1152, v2
    v_mfma_f32_16x16x32_bf16 v[36:39], v[112:115], a[12:15], 0
    v_lshl_add_u32 v5, v3, 3, v5
    s_waitcnt vmcnt(33)
    s_nop 0
    v_mfma_f32_16x16x32_bf16 v[24:27], v[116:119], a[16:19], v[24:27]
    v_lshlrev_b32 v6, 4, v3
    s_lshl_b32 s50, s69, 2
    v_mfma_f32_16x16x32_bf16 v[28:31], v[116:119], a[20:23], v[28:31]
    buffer_load_dwordx4 v[112:115], v11, s[64:67], s18 offen offset:2048 sc1
    v_mfma_f32_16x16x32_bf16 v[32:35], v[116:119], a[24:27], v[32:35]
    s_mul_i32 s51, s50, 72
    s_lshl_b32 s52, s70, 3
    s_nop 0
    v_mfma_f32_16x16x32_bf16 v[36:39], v[116:119], a[28:31], v[36:39]
    s_lshl_b32 s53, s68, 1
    s_waitcnt vmcnt(33)
    v_mfma_f32_16x16x32_bf16 v[24:27], v[120:123], a[32:35], v[24:27]
    v_cvt_pk_bf16_f32 v56, v40, v41
    s_add_u32 s52, s52, s53
    s_nop 0
    v_mfma_f32_16x16x32_bf16 v[28:31], v[120:123], a[36:39], v[28:31]
    buffer_load_dwordx4 v[116:119], v11, s[64:67], s18 offen offset:3072 sc1
    v_mfma_f32_16x16x32_bf16 v[32:35], v[120:123], a[40:43], v[32:35]
    v_cvt_pk_bf16_f32 v57, v42, v43
    s_add_u32 s52, s52, s51
    s_nop 0
    v_mfma_f32_16x16x32_bf16 v[36:39], v[120:123], a[44:47], v[36:39]
    v_cvt_pk_bf16_f32 v58, v44, v45
    s_waitcnt vmcnt(33)
    s_nop 0
    v_mfma_f32_16x16x32_bf16 v[24:27], v[124:127], a[48:51], v[24:27]
    v_cvt_pk_bf16_f32 v59, v46, v47
    s_lshl_b32 s52, s52, 8
    s_nop 0
    v_mfma_f32_16x16x32_bf16 v[28:31], v[124:127], a[52:55], v[28:31]
    buffer_load_dwordx4 v[120:123], v12, s[64:67], s18 offen offset:0 sc1
    v_mfma_f32_16x16x32_bf16 v[32:35], v[124:127], a[56:59], v[32:35]
    buffer_store_dwordx4 v[56:59], v21, s[64:67], s35 offen offset:0 sc1
    v_mfma_f32_16x16x32_bf16 v[36:39], v[124:127], a[60:63], v[36:39]
    s_add_u32 s52, s52, 23068672
    s_waitcnt vmcnt(34)
    s_nop 0
    v_mfma_f32_16x16x32_bf16 v[24:27], v[128:131], a[64:67], v[24:27]
    s_lshl_b32 s53, s70, 2
    s_add_u32 s53, s53, s68
    v_mfma_f32_16x16x32_bf16 v[28:31], v[128:131], a[68:71], v[28:31]
    buffer_load_dwordx4 v[124:127], v12, s[64:67], s18 offen offset:1024 sc1
    v_mfma_f32_16x16x32_bf16 v[32:35], v[128:131], a[72:75], v[32:35]
    s_lshl_b32 s54, s53, 6
    s_add_u32 s54, s54, 18885888
    s_nop 0
    v_mfma_f32_16x16x32_bf16 v[36:39], v[128:131], a[76:79], v[36:39]
    s_mul_i32 s55, s69, 73728
    s_waitcnt vmcnt(34)
    s_nop 0
    v_mfma_f32_16x16x32_bf16 v[24:27], v[132:135], a[80:83], v[24:27]
    s_lshl_b32 s53, s53, 5
    s_add_u32 s55, s55, s53
    v_mfma_f32_16x16x32_bf16 v[28:31], v[132:135], a[84:87], v[28:31]
    buffer_load_dwordx4 v[128:131], v8, s[64:67], s19 offen offset:0 sc1
    v_mfma_f32_16x16x32_bf16 v[32:35], v[132:135], a[88:91], v[32:35]
    s_and_b32 s56, s70, 1
    s_lshl_b32 s56, s56, 1
    v_mfma_f32_16x16x32_bf16 v[36:39], v[132:135], a[92:95], v[36:39]
    s_and_b32 s57, s68, 1
    s_waitcnt vmcnt(34)
    v_mfma_f32_16x16x32_bf16 v[24:27], v[136:139], a[96:99], v[24:27]
    s_add_u32 s56, s56, s57
    s_lshr_b32 s57, s70, 1
    v_mfma_f32_16x16x32_bf16 v[28:31], v[136:139], a[100:103], v[28:31]
    buffer_load_dwordx4 v[132:135], v8, s[64:67], s19 offen offset:1024 sc1
    v_mfma_f32_16x16x32_bf16 v[32:35], v[136:139], a[104:107], v[32:35]
    s_add_u32 s58, s50, s57
    s_mul_i32 s59, s58, 18432
    s_nop 0
    v_mfma_f32_16x16x32_bf16 v[36:39], v[136:139], a[108:111], v[36:39]
    s_lshl_b32 s53, s56, 5
    s_waitcnt vmcnt(34)
    v_mfma_f32_16x16x32_bf16 v[24:27], v[140:143], a[112:115], v[24:27]
    s_add_u32 s59, s59, s53
    s_add_u32 s59, s59, 1024
    s_nop 0
    v_mfma_f32_16x16x32_bf16 v[28:31], v[140:143], a[116:119], v[28:31]
    buffer_load_dwordx4 v[136:139], v8, s[64:67], s19 offen offset:2048 sc1
    v_mfma_f32_16x16x32_bf16 v[32:35], v[140:143], a[120:123], v[32:35]
    s_mul_i32 s58, s58, 72
    s_lshl_b32 s53, s56, 1
    s_nop 0
    v_mfma_f32_16x16x32_bf16 v[36:39], v[140:143], a[124:127], v[36:39]
    s_add_u32 s58, s58, s53
    s_waitcnt vmcnt(34)
    v_mfma_f32_16x16x32_bf16 v[24:27], v[144:147], a[128:131], v[24:27]
    s_add_u32 s58, s58, 64
    s_lshl_b32 s58, s58, 8
    v_mfma_f32_16x16x32_bf16 v[28:31], v[144:147], a[132:135], v[28:31]
    buffer_load_dwordx4 v[140:143], v8, s[64:67], s19 offen offset:3072 sc1
    v_mfma_f32_16x16x32_bf16 v[32:35], v[144:147], a[136:139], v[32:35]
    s_add_u32 s58, s58, 23068672
    s_lshl_b32 s53, s56, 6
    s_nop 0
    v_mfma_f32_16x16x32_bf16 v[36:39], v[144:147], a[140:143], v[36:39]
    s_add_u32 s53, s53, 18887936
    s_waitcnt vmcnt(33)
    s_nop 0
    v_mfma_f32_16x16x32_bf16 v[24:27], v[164:167], a[144:147], v[24:27]
    s_cmp_lt_u32 s68, 2
    s_cselect_b32 s51, 0, 0x7ff00000
    s_nop 0
    v_mfma_f32_16x16x32_bf16 v[28:31], v[164:167], a[148:151], v[28:31]
    buffer_load_dwordx4 v[144:147], v9, s[64:67], s19 offen offset:0 sc1
    v_mfma_f32_16x16x32_bf16 v[32:35], v[164:167], a[152:155], v[32:35]
    v_add_u32 v7, s51, v5
    v_add_u32 v17, s51, v21
    v_mfma_f32_16x16x32_bf16 v[36:39], v[164:167], a[156:159], v[36:39]
    s_waitcnt vmcnt(33)
    s_nop 0
    v_mfma_f32_16x16x32_bf16 v[24:27], v[184:187], a[160:163], v[24:27]
    v_cvt_pk_bf16_f32 v60, v48, v49
    v_mfma_f32_16x16x32_bf16 v[28:31], v[184:187], a[164:167], v[28:31]
    buffer_load_dwordx4 v[164:167], v9, s[64:67], s19 offen offset:1024 sc1
    v_mfma_f32_16x16x32_bf16 v[32:35], v[184:187], a[168:171], v[32:35]
    v_cvt_pk_bf16_f32 v61, v50, v51
    v_mfma_f32_16x16x32_bf16 v[36:39], v[184:187], a[172:175], v[36:39]
    v_cvt_pk_bf16_f32 v62, v52, v53
    s_waitcnt vmcnt(33)
    s_nop 0
    v_mfma_f32_16x16x32_bf16 v[24:27], v[204:207], a[176:179], v[24:27]
    v_cvt_pk_bf16_f32 v63, v54, v55
    v_mfma_f32_16x16x32_bf16 v[28:31], v[204:207], a[180:183], v[28:31]
    buffer_load_dwordx4 v[184:187], v9, s[64:67], s19 offen offset:2048 sc1
    v_mfma_f32_16x16x32_bf16 v[32:35], v[204:207], a[184:187], v[32:35]
    buffer_store_dwordx4 v[60:63], v21, s[64:67], s35 offen offset:1024 sc1
    v_mfma_f32_16x16x32_bf16 v[36:39], v[204:207], a[188:191], v[36:39]
    s_waitcnt vmcnt(34)
    s_nop 0
    v_mfma_f32_16x16x32_bf16 v[24:27], v[148:151], a[192:195], v[24:27]
    buffer_load_dwordx2 v[64:65], v4, s[64:67], s52 offen sc1
    v_mfma_f32_16x16x32_bf16 v[28:31], v[148:151], a[196:199], v[28:31]
    buffer_load_dwordx4 v[204:207], v9, s[64:67], s19 offen offset:3072 sc1
    v_mfma_f32_16x16x32_bf16 v[32:35], v[148:151], a[200:203], v[32:35]
    s_add_u32 s52, s52, 18432
    v_mfma_f32_16x16x32_bf16 v[36:39], v[148:151], a[204:207], v[36:39]
    s_waitcnt vmcnt(35)
    s_nop 0
    v_mfma_f32_16x16x32_bf16 v[24:27], v[168:171], a[208:211], v[24:27]
    buffer_load_dwordx2 v[66:67], v4, s[64:67], s52 offen sc1
    v_mfma_f32_16x16x32_bf16 v[28:31], v[168:171], a[212:215], v[28:31]
    buffer_load_dwordx4 v[148:151], v10, s[64:67], s19 offen offset:0 sc1
    v_mfma_f32_16x16x32_bf16 v[32:35], v[168:171], a[216:219], v[32:35]
    s_add_u32 s52, s52, 18432
    v_mfma_f32_16x16x32_bf16 v[36:39], v[168:171], a[220:223], v[36:39]
    s_waitcnt vmcnt(36)
    s_nop 0
    v_mfma_f32_16x16x32_bf16 v[24:27], v[188:191], a[224:227], v[24:27]
    buffer_load_dwordx2 v[68:69], v4, s[64:67], s52 offen sc1
    v_mfma_f32_16x16x32_bf16 v[28:31], v[188:191], a[228:231], v[28:31]
    buffer_load_dwordx4 v[168:171], v10, s[64:67], s19 offen offset:1024 sc1
    v_mfma_f32_16x16x32_bf16 v[32:35], v[188:191], a[232:235], v[32:35]
    s_add_u32 s52, s52, 18432
    v_mfma_f32_16x16x32_bf16 v[36:39], v[188:191], a[236:239], v[36:39]
    s_waitcnt vmcnt(37)
    s_nop 0
    v_mfma_f32_16x16x32_bf16 v[24:27], v[208:211], a[240:243], v[24:27]
    buffer_load_dwordx2 v[70:71], v4, s[64:67], s52 offen sc1
    v_mfma_f32_16x16x32_bf16 v[28:31], v[208:211], a[244:247], v[28:31]
    buffer_load_dwordx4 v[188:191], v10, s[64:67], s19 offen offset:2048 sc1
    v_mfma_f32_16x16x32_bf16 v[32:35], v[208:211], a[248:251], v[32:35]
    buffer_load_dwordx4 v[72:75], v6, s[64:67], s54 offen sc1
    v_mfma_f32_16x16x32_bf16 v[36:39], v[208:211], a[252:255], v[36:39]
    s_waitcnt vmcnt(39)
    s_nop 0
    v_mfma_f32_16x16x32_bf16 v[24:27], v[152:155], v[224:227], v[24:27]
    buffer_load_dwordx2 v[76:77], v4, s[64:67], s58 offen sc1
    v_mfma_f32_16x16x32_bf16 v[28:31], v[152:155], v[228:231], v[28:31]
    buffer_load_dwordx4 v[208:211], v10, s[64:67], s19 offen offset:3072 sc1
    v_mfma_f32_16x16x32_bf16 v[32:35], v[152:155], v[232:235], v[32:35]
    buffer_load_dwordx4 v[80:83], v6, s[64:67], s53 offen sc1
    v_mfma_f32_16x16x32_bf16 v[36:39], v[152:155], v[236:239], v[36:39]
    s_lshl_b32 s23, s69, 2
    s_waitcnt vmcnt(41)
    v_mfma_f32_16x16x32_bf16 v[24:27], v[172:175], v[240:243], v[24:27]
    s_add_u32 s24, s23, s68
    s_lshl_b32 s24, s24, 10
    v_mfma_f32_16x16x32_bf16 v[28:31], v[172:175], v[244:247], v[28:31]
    buffer_load_dwordx4 v[152:155], v11, s[64:67], s19 offen offset:0 sc1
    v_mfma_f32_16x16x32_bf16 v[32:35], v[172:175], v[248:251], v[32:35]
    s_add_u32 s24, s24, 46661632
    s_add_u32 s23, s23, s56
    s_nop 0
    v_mfma_f32_16x16x32_bf16 v[36:39], v[172:175], v[252:255], v[36:39]
    s_lshl_b32 s23, s23, 10
    s_waitcnt vmcnt(41)
    v_mfma_f32_16x16x32_bf16 v[40:43], v[192:195], a[0:3], 0
    s_add_u32 s23, s23, 46661632
    v_and_b32_e64 v16, 3, v1
    v_mfma_f32_16x16x32_bf16 v[44:47], v[192:195], a[4:7], 0
    buffer_load_dwordx4 v[172:175], v11, s[64:67], s19 offen offset:1024 sc1
    v_mfma_f32_16x16x32_bf16 v[48:51], v[192:195], a[8:11], 0
    v_min_u32 v16, 2, v16
    v_sub_u32 v15, s70, v16
    v_mfma_f32_16x16x32_bf16 v[52:55], v[192:195], a[12:15], 0
    v_add_u32 v16, -1, v15
    s_waitcnt vmcnt(40)
    v_mfma_f32_16x16x32_bf16 v[40:43], v[212:215], a[16:19], v[40:43]
    v_and_b32 v16, 7, v16
    v_lshlrev_b32 v16, 7, v16
    v_mfma_f32_16x16x32_bf16 v[44:47], v[212:215], a[20:23], v[44:47]
    buffer_load_dwordx4 v[192:195], v11, s[64:67], s19 offen offset:2048 sc1
    v_mfma_f32_16x16x32_bf16 v[48:51], v[212:215], a[24:27], v[48:51]
    v_add_u32 v13, s24, v16
    v_add_u32 v16, -4, v15
    v_mfma_f32_16x16x32_bf16 v[52:55], v[212:215], a[28:31], v[52:55]
    v_and_b32 v16, 7, v16
    s_waitcnt vmcnt(40)
    v_mfma_f32_16x16x32_bf16 v[40:43], v[156:159], a[32:35], v[40:43]
    v_cvt_pk_bf16_f32 v56, v24, v25
    v_lshlrev_b32_e64 v16, 7, v16
    v_mfma_f32_16x16x32_bf16 v[44:47], v[156:159], a[36:39], v[44:47]
    buffer_load_dwordx4 v[212:215], v11, s[64:67], s19 offen offset:3072 sc1
    v_mfma_f32_16x16x32_bf16 v[48:51], v[156:159], a[40:43], v[48:51]
    v_cvt_pk_bf16_f32 v57, v26, v27
    s_add_u32 s24, s24, 131072
    v_mfma_f32_16x16x32_bf16 v[52:55], v[156:159], a[44:47], v[52:55]
    v_cvt_pk_bf16_f32 v58, v28, v29
    s_waitcnt vmcnt(40)
    s_nop 0
    v_mfma_f32_16x16x32_bf16 v[40:43], v[176:179], a[48:51], v[40:43]
    v_cvt_pk_bf16_f32 v59, v30, v31
    v_add_u32_e64 v14, s24, v16
    v_mfma_f32_16x16x32_bf16 v[44:47], v[176:179], a[52:55], v[44:47]
    buffer_load_dwordx4 v[156:159], v12, s[64:67], s19 offen offset:0 sc1
    v_mfma_f32_16x16x32_bf16 v[48:51], v[176:179], a[56:59], v[48:51]
    buffer_store_dwordx4 v[56:59], v21, s[64:67], s36 offen offset:0 sc1
    v_mfma_f32_16x16x32_bf16 v[52:55], v[176:179], a[60:63], v[52:55]
    v_and_b32 v16, 7, v1
    s_waitcnt vmcnt(41)
    v_mfma_f32_16x16x32_bf16 v[40:43], v[196:199], a[64:67], v[40:43]
    v_lshlrev_b32 v16, 7, v16
    v_add_u32 v16, s23, v16
    v_mfma_f32_16x16x32_bf16 v[44:47], v[196:199], a[68:71], v[44:47]
    buffer_load_dwordx4 v[176:179], v12, s[64:67], s19 offen offset:1024 sc1
    v_mfma_f32_16x16x32_bf16 v[48:51], v[196:199], a[72:75], v[48:51]
    v_cmp_gt_u32 vcc, 8, v1
    s_nop 1
    v_cndmask_b32_e64 v13, v16, v13, vcc
    v_mfma_f32_16x16x32_bf16 v[52:55], v[196:199], a[76:79], v[52:55]
    s_add_u32 s23, s70, 1
    s_waitcnt vmcnt(41)
    v_mfma_f32_16x16x32_bf16 v[40:43], v[216:219], a[80:83], v[40:43]
    s_and_b32 s23, s23, 7
    s_lshl_b32 s23, s23, 7
    v_mfma_f32_16x16x32_bf16 v[44:47], v[216:219], a[84:87], v[44:47]
    buffer_load_dwordx4 v[196:199], v8, s[64:67], s20 offen offset:0 sc1
    v_mfma_f32_16x16x32_bf16 v[48:51], v[216:219], a[88:91], v[48:51]
    s_add_u32 s23, s23, s24
    s_add_u32 s91, s23, 131072
    s_nop 0
    v_mfma_f32_16x16x32_bf16 v[52:55], v[216:219], a[92:95], v[52:55]
    s_mul_i32 s23, s69, 9
    s_waitcnt vmcnt(41)
    v_mfma_f32_16x16x32_bf16 v[40:43], v[160:163], a[96:99], v[40:43]
    s_add_u32 s25, s23, s70
    s_lshl_b32 s25, s25, 5
    v_mfma_f32_16x16x32_bf16 v[44:47], v[160:163], a[100:103], v[44:47]
    buffer_load_dwordx4 v[216:219], v8, s[64:67], s20 offen offset:1024 sc1
    v_mfma_f32_16x16x32_bf16 v[48:51], v[160:163], a[104:107], v[48:51]
    s_add_u32 s25, s25, s68
    s_lshl_b32 s25, s25, 11
    v_mfma_f32_16x16x32_bf16 v[52:55], v[160:163], a[108:111], v[52:55]
    s_add_u32 s25, s25, 26214400
    s_waitcnt vmcnt(41)
    s_nop 0
    v_mfma_f32_16x16x32_bf16 v[40:43], v[180:183], a[112:115], v[40:43]
    s_add_u32 s27, s23, 8
    s_lshl_b32 s27, s27, 5
    v_mfma_f32_16x16x32_bf16 v[44:47], v[180:183], a[116:119], v[44:47]
    buffer_load_dwordx4 v[160:163], v8, s[64:67], s20 offen offset:2048 sc1
    v_mfma_f32_16x16x32_bf16 v[48:51], v[180:183], a[120:123], v[48:51]
    s_add_u32 s27, s27, s56
    s_lshl_b32 s27, s27, 11
    v_mfma_f32_16x16x32_bf16 v[52:55], v[180:183], a[124:127], v[52:55]
    s_add_u32 s27, s27, 26214400
    s_waitcnt vmcnt(41)
    s_nop 0
    v_mfma_f32_16x16x32_bf16 v[40:43], v[200:203], a[128:131], v[40:43]
    s_lshr_b32 s23, s57, 1
    s_lshl_b32 s23, s23, 10
    v_mfma_f32_16x16x32_bf16 v[44:47], v[200:203], a[132:135], v[44:47]
    buffer_load_dwordx4 v[180:183], v8, s[64:67], s20 offen offset:3072 sc1
    v_mfma_f32_16x16x32_bf16 v[48:51], v[200:203], a[136:139], v[48:51]
    s_add_u32 s27, s27, s23
    s_and_b32 s23, s57, 1
    v_mfma_f32_16x16x32_bf16 v[52:55], v[200:203], a[140:143], v[52:55]
    s_lshl_b32 s23, s23, 3
    s_waitcnt vmcnt(40)
    v_mfma_f32_16x16x32_bf16 v[40:43], v[220:223], a[144:147], v[40:43]
    s_add_u32 s27, s27, s23
    s_nop 0
    v_mfma_f32_16x16x32_bf16 v[44:47], v[220:223], a[148:151], v[44:47]
    buffer_load_dwordx4 v[200:203], v9, s[64:67], s20 offen offset:0 sc1
    v_mfma_f32_16x16x32_bf16 v[48:51], v[220:223], a[152:155], v[48:51]
    v_mfma_f32_16x16x32_bf16 v[52:55], v[220:223], a[156:159], v[52:55]
    s_waitcnt vmcnt(40)
    s_nop 0
    v_mfma_f32_16x16x32_bf16 v[40:43], v[96:99], a[160:163], v[40:43]
    v_cvt_pk_bf16_f32 v60, v32, v33
    v_mfma_f32_16x16x32_bf16 v[44:47], v[96:99], a[164:167], v[44:47]
    buffer_load_dwordx4 v[220:223], v9, s[64:67], s20 offen offset:1024 sc1
    v_mfma_f32_16x16x32_bf16 v[48:51], v[96:99], a[168:171], v[48:51]
    v_cvt_pk_bf16_f32 v61, v34, v35
    v_mfma_f32_16x16x32_bf16 v[52:55], v[96:99], a[172:175], v[52:55]
    v_cvt_pk_bf16_f32 v62, v36, v37
    s_waitcnt vmcnt(40)
    s_nop 0
    v_mfma_f32_16x16x32_bf16 v[40:43], v[100:103], a[176:179], v[40:43]
    v_cvt_pk_bf16_f32 v63, v38, v39
    v_mfma_f32_16x16x32_bf16 v[44:47], v[100:103], a[180:183], v[44:47]
    buffer_load_dwordx4 v[96:99], v9, s[64:67], s20 offen offset:2048 sc1
    v_mfma_f32_16x16x32_bf16 v[48:51], v[100:103], a[184:187], v[48:51]
    buffer_store_dwordx4 v[60:63], v21, s[64:67], s36 offen offset:1024 sc1
    v_mfma_f32_16x16x32_bf16 v[52:55], v[100:103], a[188:191], v[52:55]
    s_waitcnt vmcnt(41)
    s_nop 0
    v_mfma_f32_16x16x32_bf16 v[40:43], v[104:107], a[192:195], v[40:43]
    v_mfma_f32_16x16x32_bf16 v[44:47], v[104:107], a[196:199], v[44:47]
    buffer_load_dwordx4 v[100:103], v9, s[64:67], s20 offen offset:3072 sc1
    v_mfma_f32_16x16x32_bf16 v[48:51], v[104:107], a[200:203], v[48:51]
    v_mfma_f32_16x16x32_bf16 v[52:55], v[104:107], a[204:207], v[52:55]
    s_waitcnt vmcnt(41)
    s_nop 0
    v_mfma_f32_16x16x32_bf16 v[40:43], v[108:111], a[208:211], v[40:43]
    v_mfma_f32_16x16x32_bf16 v[44:47], v[108:111], a[212:215], v[44:47]
    buffer_load_dwordx4 v[104:107], v10, s[64:67], s20 offen offset:0 sc1
    v_mfma_f32_16x16x32_bf16 v[48:51], v[108:111], a[216:219], v[48:51]
    v_mfma_f32_16x16x32_bf16 v[52:55], v[108:111], a[220:223], v[52:55]
    s_waitcnt vmcnt(41)
    s_nop 0
    v_mfma_f32_16x16x32_bf16 v[40:43], v[112:115], a[224:227], v[40:43]
    s_lshl_b32 s22, s69, 2
    s_add_u32 s22, s22, s68
    v_mfma_f32_16x16x32_bf16 v[44:47], v[112:115], a[228:231], v[44:47]
    buffer_load_dwordx4 v[108:111], v10, s[64:67], s20 offen offset:1024 sc1
    v_mfma_f32_16x16x32_bf16 v[48:51], v[112:115], a[232:235], v[48:51]
    s_lshl_b32 s22, s22, 3
    s_add_u32 s22, s22, s70
    v_mfma_f32_16x16x32_bf16 v[52:55], v[112:115], a[236:239], v[52:55]
    s_lshl_b32 s22, s22, 7
    s_waitcnt vmcnt(41)
    v_mfma_f32_16x16x32_bf16 v[40:43], v[116:119], a[240:243], v[40:43]
    s_add_u32 s22, s22, 46661632
    v_mfma_f32_16x16x32_bf16 v[44:47], v[116:119], a[244:247], v[44:47]
    buffer_load_dwordx4 v[112:115], v10, s[64:67], s20 offen offset:2048 sc1
    v_mfma_f32_16x16x32_bf16 v[48:51], v[116:119], a[248:251], v[48:51]
    s_waitcnt vmcnt(31)
    s_nop 0
    v_mfma_f32_16x16x32_bf16 v[52:55], v[116:119], a[252:255], v[52:55]
    v_mfma_f32_16x16x32_bf16 v[40:43], v[120:123], v[224:227], v[40:43]
    v_mov_b32 v16, s3
    s_mov_b64 exec, 1
    buffer_store_dword v16, off, s[64:67], s22 sc1
    s_mov_b64 exec, -1
    s_nop 0
    v_mfma_f32_16x16x32_bf16 v[44:47], v[120:123], v[228:231], v[44:47]
    buffer_load_dwordx4 v[116:119], v10, s[64:67], s20 offen offset:3072 sc1
    v_mfma_f32_16x16x32_bf16 v[48:51], v[120:123], v[232:235], v[48:51]
    v_mfma_f32_16x16x32_bf16 v[52:55], v[120:123], v[236:239], v[52:55]
    v_mfma_f32_16x16x32_bf16 v[40:43], v[124:127], v[240:243], v[40:43]
    v_mfma_f32_16x16x32_bf16 v[44:47], v[124:127], v[244:247], v[44:47]
    buffer_load_dwordx4 v[120:123], v11, s[64:67], s20 offen offset:0 sc1
    v_mfma_f32_16x16x32_bf16 v[48:51], v[124:127], v[248:251], v[48:51]
    v_mfma_f32_16x16x32_bf16 v[52:55], v[124:127], v[252:255], v[52:55]
    v_mfma_f32_16x16x32_bf16 v[24:27], v[128:131], a[0:3], 0
    v_mfma_f32_16x16x32_bf16 v[28:31], v[128:131], a[4:7], 0
    buffer_load_dwordx4 v[124:127], v11, s[64:67], s20 offen offset:1024 sc1
    v_mfma_f32_16x16x32_bf16 v[32:35], v[128:131], a[8:11], 0
    v_mfma_f32_16x16x32_bf16 v[36:39], v[128:131], a[12:15], 0
    v_mfma_f32_16x16x32_bf16 v[24:27], v[132:135], a[16:19], v[24:27]
    v_mfma_f32_16x16x32_bf16 v[28:31], v[132:135], a[20:23], v[28:31]
    buffer_load_dwordx4 v[128:131], v11, s[64:67], s20 offen offset:2048 sc1
    v_mfma_f32_16x16x32_bf16 v[32:35], v[132:135], a[24:27], v[32:35]
    v_mfma_f32_16x16x32_bf16 v[36:39], v[132:135], a[28:31], v[36:39]
    v_mfma_f32_16x16x32_bf16 v[24:27], v[136:139], a[32:35], v[24:27]
    v_cvt_pk_bf16_f32 v56, v40, v41
    v_mfma_f32_16x16x32_bf16 v[28:31], v[136:139], a[36:39], v[28:31]
    buffer_load_dwordx4 v[132:135], v11, s[64:67], s20 offen offset:3072 sc1
    v_mfma_f32_16x16x32_bf16 v[32:35], v[136:139], a[40:43], v[32:35]
    v_cvt_pk_bf16_f32 v57, v42, v43
    v_mfma_f32_16x16x32_bf16 v[36:39], v[136:139], a[44:47], v[36:39]
    v_cvt_pk_bf16_f32 v58, v44, v45
    v_mfma_f32_16x16x32_bf16 v[24:27], v[140:143], a[48:51], v[24:27]
    v_cvt_pk_bf16_f32 v59, v46, v47
    v_mfma_f32_16x16x32_bf16 v[28:31], v[140:143], a[52:55], v[28:31]
    buffer_load_dwordx4 v[136:139], v12, s[64:67], s20 offen offset:0 sc1
    v_mfma_f32_16x16x32_bf16 v[32:35], v[140:143], a[56:59], v[32:35]
    buffer_store_dwordx4 v[56:59], v21, s[64:67], s37 offen offset:0 sc1
    v_mfma_f32_16x16x32_bf16 v[36:39], v[140:143], a[60:63], v[36:39]
    v_mfma_f32_16x16x32_bf16 v[24:27], v[144:147], a[64:67], v[24:27]
    v_mfma_f32_16x16x32_bf16 v[28:31], v[144:147], a[68:71], v[28:31]
    buffer_load_dwordx4 v[140:143], v12, s[64:67], s20 offen offset:1024 sc1
    v_mfma_f32_16x16x32_bf16 v[32:35], v[144:147], a[72:75], v[32:35]
    v_mfma_f32_16x16x32_bf16 v[36:39], v[144:147], a[76:79], v[36:39]
    v_mfma_f32_16x16x32_bf16 v[24:27], v[164:167], a[80:83], v[24:27]
    v_mfma_f32_16x16x32_bf16 v[28:31], v[164:167], a[84:87], v[28:31]
    buffer_load_dwordx4 v[144:147], v8, s[64:67], s21 offen offset:0 sc1
    v_mfma_f32_16x16x32_bf16 v[32:35], v[164:167], a[88:91], v[32:35]
    v_mfma_f32_16x16x32_bf16 v[36:39], v[164:167], a[92:95], v[36:39]
    v_mfma_f32_16x16x32_bf16 v[24:27], v[184:187], a[96:99], v[24:27]
    v_mfma_f32_16x16x32_bf16 v[28:31], v[184:187], a[100:103], v[28:31]
    buffer_load_dwordx4 v[164:167], v8, s[64:67], s21 offen offset:1024 sc1
    v_mfma_f32_16x16x32_bf16 v[32:35], v[184:187], a[104:107], v[32:35]
    v_mfma_f32_16x16x32_bf16 v[36:39], v[184:187], a[108:111], v[36:39]
    s_waitcnt vmcnt(40)
    s_nop 0
    v_mfma_f32_16x16x32_bf16 v[24:27], v[204:207], a[112:115], v[24:27]
    v_mfma_f32_16x16x32_bf16 v[28:31], v[204:207], a[116:119], v[28:31]
    buffer_load_dwordx4 v[184:187], v8, s[64:67], s21 offen offset:2048 sc1
    v_mfma_f32_16x16x32_bf16 v[32:35], v[204:207], a[120:123], v[32:35]
    v_mfma_f32_16x16x32_bf16 v[36:39], v[204:207], a[124:127], v[36:39]
    s_waitcnt vmcnt(39)
    s_nop 0
    v_mfma_f32_16x16x32_bf16 v[24:27], v[148:151], a[128:131], v[24:27]
    v_mfma_f32_16x16x32_bf16 v[28:31], v[148:151], a[132:135], v[28:31]
    buffer_load_dwordx4 v[204:207], v8, s[64:67], s21 offen offset:3072 sc1
    v_mfma_f32_16x16x32_bf16 v[32:35], v[148:151], a[136:139], v[32:35]
    v_mfma_f32_16x16x32_bf16 v[36:39], v[148:151], a[140:143], v[36:39]
    s_waitcnt vmcnt(38)
    s_nop 0
    v_mfma_f32_16x16x32_bf16 v[24:27], v[168:171], a[144:147], v[24:27]
    v_mfma_f32_16x16x32_bf16 v[28:31], v[168:171], a[148:151], v[28:31]
    buffer_load_dwordx4 v[148:151], v9, s[64:67], s21 offen offset:0 sc1
    v_mfma_f32_16x16x32_bf16 v[32:35], v[168:171], a[152:155], v[32:35]
    v_mfma_f32_16x16x32_bf16 v[36:39], v[168:171], a[156:159], v[36:39]
    s_waitcnt vmcnt(37)
    s_nop 0
    v_mfma_f32_16x16x32_bf16 v[24:27], v[188:191], a[160:163], v[24:27]
    v_cvt_pk_bf16_f32 v60, v48, v49
    v_mfma_f32_16x16x32_bf16 v[28:31], v[188:191], a[164:167], v[28:31]
    buffer_load_dwordx4 v[168:171], v9, s[64:67], s21 offen offset:1024 sc1
    v_mfma_f32_16x16x32_bf16 v[32:35], v[188:191], a[168:171], v[32:35]
    v_cvt_pk_bf16_f32 v61, v50, v51
    v_mfma_f32_16x16x32_bf16 v[36:39], v[188:191], a[172:175], v[36:39]
    v_cvt_pk_bf16_f32 v62, v52, v53
    s_waitcnt vmcnt(35)
    s_nop 0
    v_mfma_f32_16x16x32_bf16 v[24:27], v[208:211], a[176:179], v[24:27]
    v_cvt_pk_bf16_f32 v63, v54, v55
    v_mfma_f32_16x16x32_bf16 v[28:31], v[208:211], a[180:183], v[28:31]
    buffer_load_dwordx4 v[188:191], v9, s[64:67], s21 offen offset:2048 sc1
    v_mfma_f32_16x16x32_bf16 v[32:35], v[208:211], a[184:187], v[32:35]
    buffer_store_dwordx4 v[60:63], v21, s[64:67], s37 offen offset:1024 sc1
    v_mfma_f32_16x16x32_bf16 v[36:39], v[208:211], a[188:191], v[36:39]
    s_waitcnt vmcnt(35)
    s_nop 0
    v_mfma_f32_16x16x32_bf16 v[24:27], v[152:155], a[192:195], v[24:27]
    v_mfma_f32_16x16x32_bf16 v[28:31], v[152:155], a[196:199], v[28:31]
    buffer_load_dwordx4 v[208:211], v9, s[64:67], s21 offen offset:3072 sc1
    v_mfma_f32_16x16x32_bf16 v[32:35], v[152:155], a[200:203], v[32:35]
    v_mfma_f32_16x16x32_bf16 v[36:39], v[152:155], a[204:207], v[36:39]
    s_waitcnt vmcnt(35)
    s_nop 0
    v_mfma_f32_16x16x32_bf16 v[24:27], v[172:175], a[208:211], v[24:27]
    v_mfma_f32_16x16x32_bf16 v[28:31], v[172:175], a[212:215], v[28:31]
    buffer_load_dwordx4 v[152:155], v10, s[64:67], s21 offen offset:0 sc1
    v_mfma_f32_16x16x32_bf16 v[32:35], v[172:175], a[216:219], v[32:35]
    v_mfma_f32_16x16x32_bf16 v[36:39], v[172:175], a[220:223], v[36:39]
    s_waitcnt vmcnt(35)
    s_nop 0
    v_mfma_f32_16x16x32_bf16 v[24:27], v[192:195], a[224:227], v[24:27]
    v_mfma_f32_16x16x32_bf16 v[28:31], v[192:195], a[228:231], v[28:31]
    buffer_load_dwordx4 v[172:175], v10, s[64:67], s21 offen offset:1024 sc1
    v_mfma_f32_16x16x32_bf16 v[32:35], v[192:195], a[232:235], v[32:35]
    v_mfma_f32_16x16x32_bf16 v[36:39], v[192:195], a[236:239], v[36:39]
    s_waitcnt vmcnt(35)
    s_nop 0
    v_mfma_f32_16x16x32_bf16 v[24:27], v[212:215], a[240:243], v[24:27]
    v_mfma_f32_16x16x32_bf16 v[28:31], v[212:215], a[244:247], v[28:31]
    buffer_load_dwordx4 v[192:195], v10, s[64:67], s21 offen offset:2048 sc1
    v_mfma_f32_16x16x32_bf16 v[32:35], v[212:215], a[248:251], v[32:35]
    v_mfma_f32_16x16x32_bf16 v[36:39], v[212:215], a[252:255], v[36:39]
    s_waitcnt vmcnt(35)
    s_nop 0
    v_mfma_f32_16x16x32_bf16 v[24:27], v[156:159], v[224:227], v[24:27]
    v_mfma_f32_16x16x32_bf16 v[28:31], v[156:159], v[228:231], v[28:31]
    buffer_load_dwordx4 v[212:215], v10, s[64:67], s21 offen offset:3072 sc1
    v_mfma_f32_16x16x32_bf16 v[32:35], v[156:159], v[232:235], v[32:35]
    v_mfma_f32_16x16x32_bf16 v[36:39], v[156:159], v[236:239], v[36:39]
    s_waitcnt vmcnt(34)
    s_nop 0
    v_mfma_f32_16x16x32_bf16 v[24:27], v[176:179], v[240:243], v[24:27]
    v_mfma_f32_16x16x32_bf16 v[28:31], v[176:179], v[244:247], v[28:31]
    buffer_load_dwordx4 v[156:159], v11, s[64:67], s21 offen offset:0 sc1
    v_mfma_f32_16x16x32_bf16 v[32:35], v[176:179], v[248:251], v[32:35]
    v_mfma_f32_16x16x32_bf16 v[36:39], v[176:179], v[252:255], v[36:39]
    s_waitcnt vmcnt(34)
    s_nop 0
    v_mfma_f32_16x16x32_bf16 v[40:43], v[196:199], a[0:3], 0
    v_mfma_f32_16x16x32_bf16 v[44:47], v[196:199], a[4:7], 0
    buffer_load_dwordx4 v[176:179], v11, s[64:67], s21 offen offset:1024 sc1
L_stub_18:
    s_cbranch_execz L_tchret_m2_m3
    s_nop 0
    v_mfma_f32_16x16x32_bf16 v[48:51], v[196:199], a[8:11], 0
    v_mfma_f32_16x16x32_bf16 v[52:55], v[196:199], a[12:15], 0
    s_waitcnt vmcnt(34)
    s_nop 0
    v_mfma_f32_16x16x32_bf16 v[40:43], v[216:219], a[16:19], v[40:43]
    v_mfma_f32_16x16x32_bf16 v[44:47], v[216:219], a[20:23], v[44:47]
    buffer_load_dwordx4 v[196:199], v11, s[64:67], s21 offen offset:2048 sc1
    v_mfma_f32_16x16x32_bf16 v[48:51], v[216:219], a[24:27], v[48:51]
    v_mfma_f32_16x16x32_bf16 v[52:55], v[216:219], a[28:31], v[52:55]
    s_waitcnt vmcnt(34)
    s_nop 0
    v_mfma_f32_16x16x32_bf16 v[40:43], v[160:163], a[32:35], v[40:43]
    v_cvt_pk_bf16_f32 v56, v24, v25
    v_mfma_f32_16x16x32_bf16 v[44:47], v[160:163], a[36:39], v[44:47]
    buffer_load_dwordx4 v[216:219], v11, s[64:67], s21 offen offset:3072 sc1
    v_mfma_f32_16x16x32_bf16 v[48:51], v[160:163], a[40:43], v[48:51]
    v_cvt_pk_bf16_f32 v57, v26, v27
    v_mfma_f32_16x16x32_bf16 v[52:55], v[160:163], a[44:47], v[52:55]
    v_cvt_pk_bf16_f32 v58, v28, v29
    s_waitcnt vmcnt(34)
    s_nop 0
    v_mfma_f32_16x16x32_bf16 v[40:43], v[180:183], a[48:51], v[40:43]
    v_cvt_pk_bf16_f32 v59, v30, v31
    v_mfma_f32_16x16x32_bf16 v[44:47], v[180:183], a[52:55], v[44:47]
    buffer_load_dwordx4 v[160:163], v12, s[64:67], s21 offen offset:0 sc1
    v_mfma_f32_16x16x32_bf16 v[48:51], v[180:183], a[56:59], v[48:51]
    buffer_store_dwordx4 v[56:59], v21, s[64:67], s38 offen offset:0 sc1
    v_mfma_f32_16x16x32_bf16 v[52:55], v[180:183], a[60:63], v[52:55]
    v_cvt_pk_bf16_f32 v60, v32, v33
    s_waitcnt vmcnt(35)
    s_nop 0
    v_mfma_f32_16x16x32_bf16 v[40:43], v[200:203], a[64:67], v[40:43]
    v_cvt_pk_bf16_f32 v61, v34, v35
    v_mfma_f32_16x16x32_bf16 v[44:47], v[200:203], a[68:71], v[44:47]
    buffer_load_dwordx4 v[180:183], v12, s[64:67], s21 offen offset:1024 sc1
    v_mfma_f32_16x16x32_bf16 v[48:51], v[200:203], a[72:75], v[48:51]
    v_cvt_pk_bf16_f32 v62, v36, v37
    v_mfma_f32_16x16x32_bf16 v[52:55], v[200:203], a[76:79], v[52:55]
    v_cvt_pk_bf16_f32 v63, v38, v39
    s_waitcnt vmcnt(35)
    s_nop 0
    v_mfma_f32_16x16x32_bf16 v[40:43], v[220:223], a[80:83], v[40:43]
    buffer_store_dwordx4 v[60:63], v21, s[64:67], s38 offen offset:1024 sc1
    v_mfma_f32_16x16x32_bf16 v[44:47], v[220:223], a[84:87], v[44:47]
    v_mfma_f32_16x16x32_bf16 v[48:51], v[220:223], a[88:91], v[48:51]
    v_mfma_f32_16x16x32_bf16 v[52:55], v[220:223], a[92:95], v[52:55]
    s_waitcnt vmcnt(35)
    s_nop 0
    v_mfma_f32_16x16x32_bf16 v[40:43], v[96:99], a[96:99], v[40:43]
    v_mfma_f32_16x16x32_bf16 v[44:47], v[96:99], a[100:103], v[44:47]
    v_mfma_f32_16x16x32_bf16 v[48:51], v[96:99], a[104:107], v[48:51]
    v_mfma_f32_16x16x32_bf16 v[52:55], v[96:99], a[108:111], v[52:55]
    s_waitcnt vmcnt(33)
    s_nop 0
    v_mfma_f32_16x16x32_bf16 v[40:43], v[100:103], a[112:115], v[40:43]
    v_mfma_f32_16x16x32_bf16 v[44:47], v[100:103], a[116:119], v[44:47]
    v_mfma_f32_16x16x32_bf16 v[48:51], v[100:103], a[120:123], v[48:51]
    v_mfma_f32_16x16x32_bf16 v[52:55], v[100:103], a[124:127], v[52:55]
    s_waitcnt vmcnt(32)
    s_nop 0
    v_mfma_f32_16x16x32_bf16 v[40:43], v[104:107], a[128:131], v[40:43]
    v_mfma_f32_16x16x32_bf16 v[44:47], v[104:107], a[132:135], v[44:47]
    v_mfma_f32_16x16x32_bf16 v[48:51], v[104:107], a[136:139], v[48:51]
    v_mfma_f32_16x16x32_bf16 v[52:55], v[104:107], a[140:143], v[52:55]
    s_waitcnt vmcnt(31)
    s_nop 0
    v_mfma_f32_16x16x32_bf16 v[40:43], v[108:111], a[144:147], v[40:43]
    v_mfma_f32_16x16x32_bf16 v[44:47], v[108:111], a[148:151], v[44:47]
    v_mfma_f32_16x16x32_bf16 v[48:51], v[108:111], a[152:155], v[48:51]
    v_mfma_f32_16x16x32_bf16 v[52:55], v[108:111], a[156:159], v[52:55]
    s_waitcnt vmcnt(30)
    s_nop 0
    v_mfma_f32_16x16x32_bf16 v[40:43], v[112:115], a[160:163], v[40:43]
    v_mfma_f32_16x16x32_bf16 v[44:47], v[112:115], a[164:167], v[44:47]
    v_mfma_f32_16x16x32_bf16 v[48:51], v[112:115], a[168:171], v[48:51]
    v_mfma_f32_16x16x32_bf16 v[52:55], v[112:115], a[172:175], v[52:55]
    s_waitcnt vmcnt(28)
    s_nop 0
    v_mfma_f32_16x16x32_bf16 v[40:43], v[116:119], a[176:179], v[40:43]
    v_mfma_f32_16x16x32_bf16 v[44:47], v[116:119], a[180:183], v[44:47]
    v_mfma_f32_16x16x32_bf16 v[48:51], v[116:119], a[184:187], v[48:51]
    v_mfma_f32_16x16x32_bf16 v[52:55], v[116:119], a[188:191], v[52:55]
    s_waitcnt vmcnt(27)
    s_nop 0
    v_mfma_f32_16x16x32_bf16 v[40:43], v[120:123], a[192:195], v[40:43]
    buffer_load_dword v15, v13, s[64:67], 0 offen sc1
    v_mfma_f32_16x16x32_bf16 v[44:47], v[120:123], a[196:199], v[44:47]
    v_mfma_f32_16x16x32_bf16 v[48:51], v[120:123], a[200:203], v[48:51]
    v_mfma_f32_16x16x32_bf16 v[52:55], v[120:123], a[204:207], v[52:55]
    s_waitcnt vmcnt(27)
    s_nop 0
    v_mfma_f32_16x16x32_bf16 v[40:43], v[124:127], a[208:211], v[40:43]
    v_mfma_f32_16x16x32_bf16 v[44:47], v[124:127], a[212:215], v[44:47]
    v_mfma_f32_16x16x32_bf16 v[48:51], v[124:127], a[216:219], v[48:51]
    v_mfma_f32_16x16x32_bf16 v[52:55], v[124:127], a[220:223], v[52:55]
    s_waitcnt vmcnt(26)
    s_nop 0
    v_mfma_f32_16x16x32_bf16 v[40:43], v[128:131], a[224:227], v[40:43]
    v_mfma_f32_16x16x32_bf16 v[44:47], v[128:131], a[228:231], v[44:47]
    v_mfma_f32_16x16x32_bf16 v[48:51], v[128:131], a[232:235], v[48:51]
    v_mfma_f32_16x16x32_bf16 v[52:55], v[128:131], a[236:239], v[52:55]
    s_waitcnt vmcnt(25)
    s_nop 0
    v_mfma_f32_16x16x32_bf16 v[40:43], v[132:135], a[240:243], v[40:43]
    s_lshl_b32 s22, s69, 2
    s_add_u32 s22, s22, s68
    v_mfma_f32_16x16x32_bf16 v[44:47], v[132:135], a[244:247], v[44:47]
    s_lshl_b32 s22, s22, 3
    s_add_u32 s22, s22, s70
    v_mfma_f32_16x16x32_bf16 v[48:51], v[132:135], a[248:251], v[48:51]
    s_lshl_b32 s22, s22, 7
    s_add_u32 s22, s22, 46792704
    s_nop 0
    v_mfma_f32_16x16x32_bf16 v[52:55], v[132:135], a[252:255], v[52:55]
    s_waitcnt vmcnt(24)
    s_nop 0
    v_mfma_f32_16x16x32_bf16 v[40:43], v[136:139], v[224:227], v[40:43]
    s_waitcnt vmcnt(1)
    s_nop 0
    v_mfma_f32_16x16x32_bf16 v[44:47], v[136:139], v[228:231], v[44:47]
    v_mov_b32 v16, s3
    s_mov_b64 exec, 1
    buffer_store_dword v16, off, s[64:67], s22 sc1
    s_mov_b64 exec, -1
    s_nop 0
    v_mfma_f32_16x16x32_bf16 v[48:51], v[136:139], v[232:235], v[48:51]
    v_and_b32 v8, 1, v2
    v_lshlrev_b32 v8, 4, v8
    v_mfma_f32_16x16x32_bf16 v[52:55], v[136:139], v[236:239], v[52:55]
    v_mov_b32 v9, 0x3f80
    v_mfma_f32_16x16x32_bf16 v[40:43], v[140:143], v[240:243], v[40:43]
    v_lshlrev_b32_e64 v8, v8, v9
    v_cndmask_b32 v8, 0, v8, s[82:83]
    v_mfma_f32_16x16x32_bf16 v[44:47], v[140:143], v[244:247], v[44:47]
    v_and_b32_e64 v9, 2, v2
    v_mfma_f32_16x16x32_bf16 v[48:51], v[140:143], v[248:251], v[48:51]
    v_cmp_eq_u32 vcc, 0, v9
    s_nop 1
    v_cndmask_b32_e64 v88, 0, v8, vcc
    v_cndmask_b32 v89, v8, 0, vcc
    v_mfma_f32_16x16x32_bf16 v[52:55], v[140:143], v[252:255], v[52:55]
    v_mov_b32_e64 v90, 0
    v_mfma_f32_16x16x32_bf16 v[24:27], v[144:147], a[0:3], 0
    v_mov_b32 v91, 0
    v_mov_b32 v92, 0
    v_mfma_f32_16x16x32_bf16 v[28:31], v[144:147], a[4:7], 0
    v_mov_b32 v93, 0
    v_mov_b32 v94, v88
    v_mfma_f32_16x16x32_bf16 v[32:35], v[144:147], a[8:11], 0
    v_mov_b32 v95, v89
    v_mov_b32 v8, v88
    v_mfma_f32_16x16x32_bf16 v[36:39], v[144:147], a[12:15], 0
    v_mov_b32_e64 v9, v89
    v_mfma_f32_16x16x32_bf16 v[24:27], v[164:167], a[16:19], v[24:27]
    v_mov_b32 v10, v88
    v_mov_b32 v11, v89
    v_mfma_f32_16x16x32_bf16 v[28:31], v[164:167], a[20:23], v[28:31]
    v_mfma_f32_16x16x32_bf16 v[32:35], v[164:167], a[24:27], v[32:35]
    v_mfma_f32_16x16x32_bf16 v[36:39], v[164:167], a[28:31], v[36:39]
    v_mfma_f32_16x16x32_bf16 v[24:27], v[184:187], a[32:35], v[24:27]
    v_cvt_pk_bf16_f32 v56, v40, v41
    v_mfma_f32_16x16x32_bf16 v[28:31], v[184:187], a[36:39], v[28:31]
    v_cvt_pk_bf16_f32 v57, v42, v43
    v_mfma_f32_16x16x32_bf16 v[32:35], v[184:187], a[40:43], v[32:35]
    v_min_u32_e64 v56, -2, v56
    v_mfma_f32_16x16x32_bf16 v[36:39], v[184:187], a[44:47], v[36:39]
    v_min_u32 v57, -2, v57
    s_waitcnt vmcnt(1)
    s_mov_b32 s88, 0
L_pr1:
    v_cmp_ne_u32 vcc, s3, v15
    s_nop 2
    s_cbranch_vccz L_pr1_ok
    s_add_u32 s88, s88, 1
    s_cmp_gt_u32 s88, 262144
    s_cbranch_scc1 L_pr1_ok
    buffer_load_dword v15, v13, s[64:67], 0 offen sc1
    s_waitcnt vmcnt(0)
    s_branch L_pr1
L_pr1_ok:
    v_mfma_f32_16x16x32_bf16 v[24:27], v[204:207], a[48:51], v[24:27]
    v_cvt_pk_bf16_f32 v58, v44, v45
    v_mfma_f32_16x16x32_bf16 v[28:31], v[204:207], a[52:55], v[28:31]
    v_cvt_pk_bf16_f32 v59, v46, v47
    v_mfma_f32_16x16x32_bf16 v[32:35], v[204:207], a[56:59], v[32:35]
    v_min_u32_e64 v58, -2, v58
    v_mfma_f32_16x16x32_bf16 v[36:39], v[204:207], a[60:63], v[36:39]
    v_min_u32_e64 v59, -2, v59
    v_mfma_f32_16x16x32_bf16 v[24:27], v[148:151], a[64:67], v[24:27]
    buffer_store_dwordx4 v[56:59], v21, s[64:67], s39 offen offset:0 sc1
    v_mfma_f32_16x16x32_bf16 v[28:31], v[148:151], a[68:71], v[28:31]
    v_cvt_pk_bf16_f32 v60, v48, v49
    v_mfma_f32_16x16x32_bf16 v[32:35], v[148:151], a[72:75], v[32:35]
    v_cvt_pk_bf16_f32 v61, v50, v51
    v_mfma_f32_16x16x32_bf16 v[36:39], v[148:151], a[76:79], v[36:39]
    v_min_u32_e64 v60, -2, v60
    v_mfma_f32_16x16x32_bf16 v[24:27], v[168:171], a[80:83], v[24:27]
    v_min_u32_e64 v61, -2, v61
    v_mfma_f32_16x16x32_bf16 v[28:31], v[168:171], a[84:87], v[28:31]
    v_cvt_pk_bf16_f32 v62, v52, v53
    v_mfma_f32_16x16x32_bf16 v[32:35], v[168:171], a[88:91], v[32:35]
    v_cvt_pk_bf16_f32 v63, v54, v55
    v_mfma_f32_16x16x32_bf16 v[36:39], v[168:171], a[92:95], v[36:39]
    v_min_u32_e64 v62, -2, v62
    v_mfma_f32_16x16x32_bf16 v[24:27], v[188:191], a[96:99], v[24:27]
    v_min_u32_e64 v63, -2, v63
    v_mfma_f32_16x16x32_bf16 v[28:31], v[188:191], a[100:103], v[28:31]
    buffer_store_dwordx4 v[60:63], v21, s[64:67], s39 offen offset:1024 sc1
    v_mfma_f32_16x16x32_bf16 v[32:35], v[188:191], a[104:107], v[32:35]
    s_sub_u32 s24, s70, 1
    s_and_b32 s24, s24, 7
    s_lshl_b32 s24, s24, 13
    s_add_u32 s24, s24, s25
    v_mfma_f32_16x16x32_bf16 v[36:39], v[188:191], a[108:111], v[36:39]
    v_mfma_f32_16x16x32_bf16 v[24:27], v[208:211], a[112:115], v[24:27]
    buffer_load_dwordx4 v[200:203], v21, s[64:67], s24 offen offset:0 sc1
    v_mfma_f32_16x16x32_bf16 v[28:31], v[208:211], a[116:119], v[28:31]
    buffer_load_dwordx4 v[220:223], v21, s[64:67], s24 offen offset:1024 sc1
    v_mfma_f32_16x16x32_bf16 v[32:35], v[208:211], a[120:123], v[32:35]
    s_sub_u32 s24, s70, 2
    s_and_b32 s24, s24, 7
    s_lshl_b32 s24, s24, 13
    s_add_u32 s24, s24, s25
    v_mfma_f32_16x16x32_bf16 v[36:39], v[208:211], a[124:127], v[36:39]
    v_mfma_f32_16x16x32_bf16 v[24:27], v[152:155], a[128:131], v[24:27]
    buffer_load_dwordx4 v[96:99], v21, s[64:67], s24 offen offset:0 sc1
    v_mfma_f32_16x16x32_bf16 v[28:31], v[152:155], a[132:135], v[28:31]
    buffer_load_dwordx4 v[100:103], v21, s[64:67], s24 offen offset:1024 sc1
    v_mfma_f32_16x16x32_bf16 v[32:35], v[152:155], a[136:139], v[32:35]
    s_sub_u32 s24, s70, 3
    s_and_b32 s24, s24, 7
    s_lshl_b32 s24, s24, 13
    s_add_u32 s24, s24, s25
    v_mfma_f32_16x16x32_bf16 v[36:39], v[152:155], a[140:143], v[36:39]
    v_mfma_f32_16x16x32_bf16 v[24:27], v[172:175], a[144:147], v[24:27]
    buffer_load_dwordx4 v[104:107], v21, s[64:67], s24 offen offset:0 sc1
    v_mfma_f32_16x16x32_bf16 v[28:31], v[172:175], a[148:151], v[28:31]
    buffer_load_dwordx4 v[108:111], v21, s[64:67], s24 offen offset:1024 sc1
    v_mfma_f32_16x16x32_bf16 v[32:35], v[172:175], a[152:155], v[32:35]
    buffer_load_dwordx2 v[112:113], v17, s[64:67], s27 offen sc1
    v_mfma_f32_16x16x32_bf16 v[36:39], v[172:175], a[156:159], v[36:39]
    v_mfma_f32_16x16x32_bf16 v[24:27], v[192:195], a[160:163], v[24:27]
    s_add_u32 s27, s27, 8192
    buffer_load_dwordx2 v[114:115], v17, s[64:67], s27 offen sc1
    v_mfma_f32_16x16x32_bf16 v[28:31], v[192:195], a[164:167], v[28:31]
    s_add_u32 s27, s27, 8192
    buffer_load_dwordx2 v[116:117], v17, s[64:67], s27 offen sc1
    v_mfma_f32_16x16x32_bf16 v[32:35], v[192:195], a[168:171], v[32:35]
    s_add_u32 s27, s27, 8192
    buffer_load_dwordx2 v[118:119], v17, s[64:67], s27 offen sc1
    v_mfma_f32_16x16x32_bf16 v[36:39], v[192:195], a[172:175], v[36:39]
    v_mfma_f32_16x16x32_bf16 v[24:27], v[212:215], a[176:179], v[24:27]
    s_add_u32 s27, s27, 8192
    buffer_load_dwordx2 v[120:121], v17, s[64:67], s27 offen sc1
    v_mfma_f32_16x16x32_bf16 v[28:31], v[212:215], a[180:183], v[28:31]
    s_add_u32 s27, s27, 8192
    buffer_load_dwordx2 v[122:123], v17, s[64:67], s27 offen sc1
    v_mfma_f32_16x16x32_bf16 v[32:35], v[212:215], a[184:187], v[32:35]
    s_add_u32 s27, s27, 8192
    buffer_load_dwordx2 v[124:125], v17, s[64:67], s27 offen sc1
    v_mfma_f32_16x16x32_bf16 v[36:39], v[212:215], a[188:191], v[36:39]
    v_mfma_f32_16x16x32_bf16 v[24:27], v[156:159], a[192:195], v[24:27]
    s_add_u32 s27, s27, 8192
    buffer_load_dwordx2 v[126:127], v17, s[64:67], s27 offen sc1
    v_mfma_f32_16x16x32_bf16 v[28:31], v[156:159], a[196:199], v[28:31]
    buffer_load_dword v15, v14, s[64:67], 0 offen sc1
    v_mfma_f32_16x16x32_bf16 v[32:35], v[156:159], a[200:203], v[32:35]
    v_mfma_f32_16x16x32_bf16 v[36:39], v[156:159], a[204:207], v[36:39]
    v_mfma_f32_16x16x32_bf16 v[24:27], v[176:179], a[208:211], v[24:27]
    v_mfma_f32_16x16x32_bf16 v[28:31], v[176:179], a[212:215], v[28:31]
    v_mfma_f32_16x16x32_bf16 v[32:35], v[176:179], a[216:219], v[32:35]
    v_mfma_f32_16x16x32_bf16 v[36:39], v[176:179], a[220:223], v[36:39]
    v_mfma_f32_16x16x32_bf16 v[24:27], v[196:199], a[224:227], v[24:27]
    v_mfma_f32_16x16x32_bf16 v[28:31], v[196:199], a[228:231], v[28:31]
    v_mfma_f32_16x16x32_bf16 v[32:35], v[196:199], a[232:235], v[32:35]
    v_mfma_f32_16x16x32_bf16 v[36:39], v[196:199], a[236:239], v[36:39]
    v_mfma_f32_16x16x32_bf16 v[24:27], v[216:219], a[240:243], v[24:27]
    v_mfma_f32_16x16x32_bf16 v[28:31], v[216:219], a[244:247], v[28:31]
    v_mfma_f32_16x16x32_bf16 v[32:35], v[216:219], a[248:251], v[32:35]
    v_mfma_f32_16x16x32_bf16 v[36:39], v[216:219], a[252:255], v[36:39]
    v_mfma_f32_16x16x32_bf16 v[24:27], v[160:163], v[224:227], v[24:27]
    v_mfma_f32_16x16x32_bf16 v[28:31], v[160:163], v[228:231], v[28:31]
    v_mfma_f32_16x16x32_bf16 v[32:35], v[160:163], v[232:235], v[32:35]
    v_mfma_f32_16x16x32_bf16 v[36:39], v[160:163], v[236:239], v[36:39]
    s_waitcnt vmcnt(0)
    s_mov_b32 s88, 0
L_pr2:
    v_cmp_ne_u32 vcc, s3, v15
    s_nop 2
    s_cbranch_vccz L_pr2_ok
    s_add_u32 s88, s88, 1
    s_cmp_gt_u32 s88, 262144
    s_cbranch_scc1 L_pr2_ok
    s_nop 0
    buffer_load_dword v15, v14, s[64:67], 0 offen sc1
    s_waitcnt vmcnt(0)
    s_branch L_pr2
L_pr2_ok:
    v_mfma_f32_16x16x32_bf16 v[24:27], v[180:183], v[240:243], v[24:27]
    s_sub_u32 s24, s70, 4
    s_and_b32 s24, s24, 7
    s_lshl_b32 s24, s24, 13
    s_add_u32 s24, s24, s25
    v_mfma_f32_16x16x32_bf16 v[28:31], v[180:183], v[244:247], v[28:31]
    buffer_load_dwordx4 v[128:131], v21, s[64:67], s24 offen offset:0 sc1
    v_mfma_f32_16x16x32_bf16 v[32:35], v[180:183], v[248:251], v[32:35]
    buffer_load_dwordx4 v[132:135], v21, s[64:67], s24 offen offset:1024 sc1
    v_mfma_f32_16x16x32_bf16 v[36:39], v[180:183], v[252:255], v[36:39]
    s_sub_u32 s24, s70, 5
    s_and_b32 s24, s24, 7
    s_lshl_b32 s24, s24, 13
    s_add_u32 s24, s24, s25
    buffer_load_dwordx4 v[136:139], v21, s[64:67], s24 offen offset:0 sc1
    buffer_load_dwordx4 v[140:143], v21, s[64:67], s24 offen offset:1024 sc1
    s_sub_u32 s24, s70, 6
    s_and_b32 s24, s24, 7
    s_lshl_b32 s24, s24, 13
    s_add_u32 s24, s24, s25
    buffer_load_dwordx4 v[144:147], v21, s[64:67], s24 offen offset:0 sc1
    buffer_load_dwordx4 v[164:167], v21, s[64:67], s24 offen offset:1024 sc1
    s_sub_u32 s24, s70, 7
    s_and_b32 s24, s24, 7
    s_lshl_b32 s24, s24, 13
    s_add_u32 s24, s24, s25
    buffer_load_dwordx4 v[184:187], v21, s[64:67], s24 offen offset:0 sc1
    buffer_load_dwordx4 v[204:207], v21, s[64:67], s24 offen offset:1024 sc1
    v_mfma_f32_16x16x32_bf16 v[24:27], v[88:91], v[200:203], v[24:27]
    v_mfma_f32_16x16x32_bf16 v[28:31], v[92:95], v[200:203], v[28:31]
    v_mfma_f32_16x16x32_bf16 v[32:35], v[88:91], v[220:223], v[32:35]
    v_mfma_f32_16x16x32_bf16 v[36:39], v[92:95], v[220:223], v[36:39]
    v_mfma_f32_16x16x32_bf16 v[24:27], v[88:91], v[96:99], v[24:27]
    v_mfma_f32_16x16x32_bf16 v[28:31], v[92:95], v[96:99], v[28:31]
    v_mfma_f32_16x16x32_bf16 v[32:35], v[88:91], v[100:103], v[32:35]
    v_mfma_f32_16x16x32_bf16 v[36:39], v[92:95], v[100:103], v[36:39]
    v_mfma_f32_16x16x32_bf16 v[24:27], v[88:91], v[104:107], v[24:27]
    v_mfma_f32_16x16x32_bf16 v[28:31], v[92:95], v[104:107], v[28:31]
    v_mfma_f32_16x16x32_bf16 v[32:35], v[88:91], v[108:111], v[32:35]
    v_mfma_f32_16x16x32_bf16 v[36:39], v[92:95], v[108:111], v[36:39]
    v_mfma_f32_16x16x32_bf16 v[84:87], v[8:11], v[112:115], 0
    v_mfma_f32_16x16x32_bf16 v[84:87], v[8:11], v[116:119], v[84:87]
    v_mfma_f32_16x16x32_bf16 v[84:87], v[8:11], v[120:123], v[84:87]
    v_mfma_f32_16x16x32_bf16 v[84:87], v[8:11], v[124:127], v[84:87]
    s_waitcnt vmcnt(6)
    s_nop 0
    v_mfma_f32_16x16x32_bf16 v[24:27], v[88:91], v[128:131], v[24:27]
    v_mfma_f32_16x16x32_bf16 v[28:31], v[92:95], v[128:131], v[28:31]
    v_mfma_f32_16x16x32_bf16 v[32:35], v[88:91], v[132:135], v[32:35]
    v_mfma_f32_16x16x32_bf16 v[36:39], v[92:95], v[132:135], v[36:39]
    s_waitcnt vmcnt(4)
    s_nop 0
    v_mfma_f32_16x16x32_bf16 v[24:27], v[88:91], v[136:139], v[24:27]
    v_mfma_f32_16x16x32_bf16 v[28:31], v[92:95], v[136:139], v[28:31]
    v_mfma_f32_16x16x32_bf16 v[32:35], v[88:91], v[140:143], v[32:35]
    v_mfma_f32_16x16x32_bf16 v[36:39], v[92:95], v[140:143], v[36:39]
    s_waitcnt vmcnt(2)
    s_nop 0
    v_mfma_f32_16x16x32_bf16 v[24:27], v[88:91], v[144:147], v[24:27]
    v_mfma_f32_16x16x32_bf16 v[28:31], v[92:95], v[144:147], v[28:31]
    v_mfma_f32_16x16x32_bf16 v[32:35], v[88:91], v[164:167], v[32:35]
    v_mfma_f32_16x16x32_bf16 v[36:39], v[92:95], v[164:167], v[36:39]
    s_waitcnt vmcnt(0)
    v_lshlrev_b32 v12, 16, v76
    v_and_b32 v13, s90, v76
    v_lshlrev_b32 v14, 16, v77
    v_and_b32_e64 v15, s90, v77
    v_pk_fma_f32 v[12:13], v[84:85], v[80:81], v[12:13]
    v_pk_fma_f32 v[14:15], v[86:87], v[82:83], v[14:15]
    v_cvt_pk_bf16_f32 v84, v12, v13
    v_cvt_pk_bf16_f32 v85, v14, v15
    buffer_store_dwordx2 v[84:85], v7, s[60:63], s59 offen
    s_mov_b32 s88, 0
L_s7:
    s_nop 0
    v_max3_u32 v12, v184, v185, v186
    v_max3_u32 v13, v187, v204, v205
    v_max3_u32 v12, v12, v206, v207
    v_max_u32 v12, v12, v13
    v_cmp_eq_u32 vcc, -1, v12
    s_nop 2
    s_cbranch_vccz L_s7_ok
    s_add_u32 s88, s88, 1
    s_cmp_gt_u32 s88, 262144
    s_cbranch_scc1 L_s7_ok
    buffer_load_dwordx4 v[184:187], v21, s[64:67], s24 offen sc1
    buffer_load_dwordx4 v[204:207], v21, s[64:67], s24 offen offset:1024 sc1
    s_waitcnt vmcnt(0)
    s_branch L_s7
L_s7_ok:
    v_mfma_f32_16x16x32_bf16 v[24:27], v[88:91], v[184:187], v[24:27]
    v_mfma_f32_16x16x32_bf16 v[28:31], v[92:95], v[184:187], v[28:31]
    v_mfma_f32_16x16x32_bf16 v[32:35], v[88:91], v[204:207], v[32:35]
    v_mfma_f32_16x16x32_bf16 v[36:39], v[92:95], v[204:207], v[36:39]
    v_mul_u32_u24 v16, 144, v2
    v_lshl_add_u32 v16, v3, 3, v16
    s_lshl_b32 s4, s68, 5
    v_add_u32 v16, s4, v16
    v_lshrrev_b32 v17, 3, v1
    v_and_b32 v18, 7, v1
    v_mul_u32_u24 v19, 1152, v17
    v_lshl_add_u32 v19, v18, 4, v19
    v_mul_u32_u24 v17, 144, v17
    v_lshl_add_u32 v17, v18, 4, v17
    s_mul_i32 s4, s68, 2304
    v_add_u32 v17, s4, v17
    s_mul_i32 s55, s69, 73728
    s_mul_i32 s4, s68, 18432
    s_add_u32 s55, s55, s4
    s_lshl_b32 s4, s70, 7
    s_add_u32 s55, s55, s4
    s_add_u32 s54, s55, 9216
    v_lshlrev_b32 v12, 16, v64
    v_and_b32 v13, s90, v64
    v_lshlrev_b32 v14, 16, v65
    v_and_b32 v15, s90, v65
    v_pk_fma_f32 v[12:13], v[24:25], v[72:73], v[12:13]
    v_pk_fma_f32 v[14:15], v[26:27], v[74:75], v[14:15]
    v_cvt_pk_bf16_f32 v24, v12, v13
    v_cvt_pk_bf16_f32 v25, v14, v15
    ds_write_b64 v16, v[24:25] offset:0
    v_lshlrev_b32 v12, 16, v66
    v_and_b32 v13, s90, v66
    v_lshlrev_b32 v14, 16, v67
    v_and_b32 v15, s90, v67
    v_pk_fma_f32 v[12:13], v[28:29], v[72:73], v[12:13]
    v_pk_fma_f32 v[14:15], v[30:31], v[74:75], v[14:15]
    v_cvt_pk_bf16_f32 v28, v12, v13
    v_cvt_pk_bf16_f32 v29, v14, v15
    ds_write_b64 v16, v[28:29] offset:2304
    v_lshlrev_b32 v12, 16, v68
    v_and_b32 v13, s90, v68
    v_lshlrev_b32 v14, 16, v69
    v_and_b32 v15, s90, v69
    v_pk_fma_f32 v[12:13], v[32:33], v[72:73], v[12:13]
    v_pk_fma_f32 v[14:15], v[34:35], v[74:75], v[14:15]
    v_cvt_pk_bf16_f32 v32, v12, v13
    v_cvt_pk_bf16_f32 v33, v14, v15
    ds_write_b64 v16, v[32:33] offset:4608
    v_lshlrev_b32 v12, 16, v70
    v_and_b32 v13, s90, v70
    v_lshlrev_b32 v14, 16, v71
    v_and_b32 v15, s90, v71
    v_pk_fma_f32 v[12:13], v[36:37], v[72:73], v[12:13]
    v_pk_fma_f32 v[14:15], v[38:39], v[74:75], v[14:15]
    v_cvt_pk_bf16_f32 v36, v12, v13
    v_cvt_pk_bf16_f32 v37, v14, v15
    ds_write_b64 v16, v[36:37] offset:6912
    s_waitcnt lgkmcnt(0)
    s_barrier
    ds_read_b128 v[40:43], v17
    ds_read_b128 v[44:47], v17 offset:1152
    s_waitcnt lgkmcnt(1)
    s_nop 0
    buffer_store_dwordx4 v[40:43], v19, s[60:63], s55 offen
    s_waitcnt lgkmcnt(0)
    s_nop 0
    buffer_store_dwordx4 v[44:47], v19, s[60:63], s54 offen
    s_cmp_eq_u32 s2, 0
    s_cselect_b32 s4, s68, 1
    s_cmp_eq_u32 s4, 0
    s_cbranch_scc0 L_noep
    v_mov_b32 v4, s3
    s_mov_b32 s4, 46170112
    s_mov_b64 exec, 1
    buffer_store_dword v4, off, s[64:67], s4 sc1
    s_mov_b64 exec, -1
L_noep:
L_end:
    s_endpgm
.section .rodata,"a"
.p2align 6
.amdhsa_kernel adaLN_cond__sliding_local_dilated__glu_gated_glu__prompt_kernel
  .amdhsa_next_free_vgpr 512
  .amdhsa_next_free_sgpr 102
  .amdhsa_accum_offset 256
  .amdhsa_group_segment_fixed_size 0
  .amdhsa_kernarg_size 96
  .amdhsa_user_sgpr_count 2
  .amdhsa_user_sgpr_kernarg_segment_ptr 1
  .amdhsa_system_sgpr_workgroup_id_x 1
  .amdhsa_float_denorm_mode_32 3
.end_amdhsa_kernel
```
